```python
import torch

def _softmax(x, axis=-1):
    return torch.softmax(x, dim=axis)
def _gelu(x):
    return torch.nn.functional.gelu(x, approximate="tanh")
def _silu(x):
    return torch.nn.functional.silu(x)
def _sigmoid(x):
    return torch.sigmoid(x)
def _layernorm(x, axis=-1, eps=1e-5):
    m = x.mean(dim=axis, keepdim=True)
    v = x.var(dim=axis, keepdim=True, unbiased=False)
    return (x - m) / torch.sqrt(v + eps)
def _scatter_add(tgt, idx, src, axis=0):
    return tgt.clone().index_add_(axis, idx, src)
def _segment_sum(src, seg, n):
    out = torch.zeros((n,) + src.shape[1:], dtype=src.dtype)
    return out.index_add_(0, seg, src)
def _pad(x, pw):
    flat = tuple(v for pair in reversed(pw) for v in pair)
    return torch.nn.functional.pad(x, flat)

kernel_name = 'gated_mix__softmax_full_mha__mixer_channel_mlp__prompt'

def setup_inputs():

    _w = (lambda a: (lambda t: t.to(torch.bfloat16) if t.is_floating_point() else t)(torch.as_tensor(a)))
    def _A_setup():
        B, S, D = 1, 2048, 576
        return {
            "x": _w((lambda *s: torch.randn(*s, dtype=torch.bfloat16) * 0.05)(B, S, D)),
            "wqkv": _w((lambda *s: torch.randn(*s, dtype=torch.bfloat16) * 0.8)(D, 3 * D)),
            "wo": _w((lambda *s: torch.randn(*s, dtype=torch.bfloat16) * 0.1)(D, D)),
        }
    _A_in = _A_setup()

    def _B_setup():
        B, S, D, F = 1, 2048, 576, 4608
        return {
            "x": _w((lambda *s: torch.randn(*s, dtype=torch.bfloat16) * 0.05)(B, S, D)),
            "w1": _w((lambda *s: torch.randn(*s, dtype=torch.bfloat16) * 1.6)(D, F) * (D ** -0.5)),
            "b1": _w((lambda *s: torch.randn(*s, dtype=torch.bfloat16) * 0.8)(F)),
            "w2": _w((lambda *s: torch.randn(*s, dtype=torch.bfloat16) * 0.05)(F, D) * (F ** -0.5)),
            "b2": _w((lambda *s: torch.randn(*s, dtype=torch.bfloat16) * 0.05)(D)),
        }
    _B_in = _B_setup()

    return {
        "A_x": _A_in["x"],
        "A_wqkv": _A_in["wqkv"],
        "A_wo": _A_in["wo"],
        "B_x": _B_in["x"],
        "B_w1": _B_in["w1"],
        "B_b1": _B_in["b1"],
        "B_w2": _B_in["w2"],
        "B_b2": _B_in["b2"],
        "gate_w": _w((lambda *s: torch.randn(*s, dtype=torch.bfloat16) * 0.05)(576) * 16.0),
    }

def reference(A_x, A_wqkv, A_wo, B_x, B_w1, B_b1, B_w2, B_b2, gate_w):
    def _A_ref(x, wqkv, wo):
        B, S, D = x.shape
        H = 32; Dh = D // H
        qkv = (lambda x, *d: x.permute(*d))((x @ wqkv).reshape(B, S, 3, H, Dh), 2, 0, 3, 1, 4)
        q, k, v = qkv[0], qkv[1], qkv[2]
        scale = Dh ** -0.5
        scores = torch.einsum("bhqd,bhkd->bhqk", q, k) * scale
        p = _softmax(scores, axis=-1)
        o = torch.einsum("bhqk,bhkd->bhqd", p, v)
        return (lambda x, *d: x.permute(*d))(o, 0, 2, 1, 3).reshape(B, S, D) @ wo

    def _B_ref(x, w1, b1, w2, b2):
        y = _layernorm(x, axis=-1)
        h = _gelu(torch.einsum("bsd,df->bsf", y, w1) + b1)
        return torch.einsum("bsf,fd->bsd", h, w2) + b2

    x = A_x
    g = _sigmoid((x * gate_w).sum(-1, keepdims=True))
    a = _A_ref(x, A_wqkv, A_wo)
    b = _B_ref(x, B_w1, B_b1, B_w2, B_b2)
    return g * a + (1 - g) * b
```

```asm
; @launch kernel=l1_kernel grid=(256,1,1) block=(512,1,1) lds=161792
; @launch kernel=af_kernel grid=(256,1,1) block=(768,1,1) lds=161856
; @launch kernel=fin_kernel grid=(256,1,1) block=(256,1,1) lds=92160
.amdgcn_target "amdgcn-amd-amdhsa--gfx950"
.text
.globl l1_kernel
.p2align 8
.type l1_kernel,@function
l1_kernel:
    s_cmp_ge_u32 s2, 256
    s_cbranch_scc1 l1_done
    s_load_dwordx2 s[4:5], s[0:1], 0
    s_load_dwordx2 s[8:9], s[0:1], 32
    s_load_dwordx2 s[40:41], s[0:1], 8
    s_load_dwordx2 s[32:33], s[0:1], 64
    s_load_dwordx2 s[36:37], s[0:1], 40
    s_load_dwordx2 s[16:17], s[0:1], 88
    s_load_dwordx2 s[20:21], s[0:1], 88
    s_load_dwordx2 s[24:25], s[0:1], 88
    s_load_dwordx2 s[28:29], s[0:1], 88
    s_load_dwordx2 s[96:97], s[0:1], 48
    s_load_dwordx2 s[92:93], s[0:1], 16
    s_lshr_b32 s45, s2, 5
    s_lshl_b32 s45, s45, 8
    s_and_b32 s55, s2, 31
    s_lshl_b32 s46, s55, 7
    s_mul_i32 s56, s55, 192
    s_sub_u32 s56, s56, 1536
    s_cmp_ge_u32 s55, 24
    s_cselect_b32 s46, s56, s46
    s_lshr_b32 s48, s55, 3
    s_and_b32 s56, s55, 7
    s_mul_i32 s47, s56, 72
    s_add_u32 s48, s48, 1
    s_and_b32 s48, s48, 3
    s_mov_b32 s49, 0
    s_mov_b32 s50, 0
    s_mov_b32 s51, 0
    s_mov_b32 s68, 0
    s_mov_b32 s69, 147456
    s_mov_b32 s70, 294912
    s_mov_b32 s71, 442368
    v_and_b32 v1, 63, v0
    v_lshrrev_b32 v2, 6, v0
    s_nop 0
    v_readfirstlane_b32 s44, v2
    v_lshrrev_b32 v3, 3, v1
    v_and_b32 v4, 7, v1
    v_xor_b32 v4, v4, v3
    v_lshlrev_b32 v4, 4, v4
    s_lshl_b32 s55, s44, 5
    s_add_u32 s55, s55, s45
    v_add_u32 v5, s55, v3
    v_mul_u32_u24 v5, 1152, v5
    v_add_u32 v228, v5, v4
    v_add_u32 v229, 9216, v228
    v_add_u32 v230, 9216, v229
    v_add_u32 v231, 9216, v230
    s_lshl_b32 s53, s44, 12
    s_lshl_b32 s54, s44, 10
    s_add_u32 s54, s54, 98304
    s_and_b32 s59, s44, 3
    s_lshr_b32 s60, s44, 2
    s_lshl_b32 s55, s44, 6
    s_lshl_b32 s56, s46, 1
    v_add_u32 v3, s55, v1
    v_mul_u32_u24 v4, 3641, v3
    v_lshrrev_b32 v4, 16, v4
    v_mul_u32_u24 v5, 18, v4
    v_sub_u32 v5, v3, v5
    v_and_b32 v6, 3, v4
    v_bfe_u32 v7, v4, 2, 2
    v_lshl_add_u32 v6, v7, 3, v6
    v_bfe_u32 v7, v4, 4, 1
    v_lshl_add_u32 v6, v7, 2, v6
    v_mul_u32_u24 v6, 9216, v6
    v_lshl_add_u32 v6, v5, 4, v6
    v_cmp_le_u32 vcc, 16, v5
    v_add_u32 v232, s56, v6
    v_mov_b32 v7, 0x80000000
    v_cndmask_b32 v232, v232, v7, vcc
    s_waitcnt lgkmcnt(0)
    s_mov_b32 s6, 0x240000
    s_mov_b32 s7, 0x20000
    s_mov_b32 s10, 0x510000
    s_mov_b32 s11, 0x20000
    s_mov_b32 s42, 0x1e6000
    s_mov_b32 s43, 0x20000
    s_add_u32 m0, s53, 0
    s_nop 0
    buffer_load_dwordx4 v228, s[4:7], s49 offen lds
    s_add_u32 m0, s53, 1024
    s_nop 0
    buffer_load_dwordx4 v229, s[4:7], s49 offen lds
    s_add_u32 m0, s53, 2048
    s_nop 0
    buffer_load_dwordx4 v230, s[4:7], s49 offen lds
    s_add_u32 m0, s53, 3072
    s_nop 0
    buffer_load_dwordx4 v231, s[4:7], s49 offen lds
    s_add_u32 s49, s49, 128
    s_cmp_eq_u32 s44, 0
    s_cbranch_scc0 l1_p2q
    s_mov_b32 s55, 512
    v_add_u32 v3, s55, v1
    v_mul_u32_u24 v4, 3641, v3
    v_lshrrev_b32 v4, 16, v4
    v_mul_u32_u24 v5, 18, v4
    v_sub_u32 v5, v3, v5
    v_and_b32 v6, 3, v4
    v_bfe_u32 v7, v4, 2, 2
    v_lshl_add_u32 v6, v7, 3, v6
    v_bfe_u32 v7, v4, 4, 1
    v_lshl_add_u32 v6, v7, 2, v6
    v_mul_u32_u24 v6, 9216, v6
    v_lshl_add_u32 v6, v5, 4, v6
    v_cmp_le_u32 vcc, 16, v5
    v_add_u32 v233, s56, v6
    v_mov_b32 v7, 0x80000000
    v_cndmask_b32 v233, v233, v7, vcc
    s_mov_b32 s12, s8
    s_mov_b32 s13, s9
    s_mov_b32 s14, s10
    s_mov_b32 s15, s11
    s_mov_b32 s52, 294912
    s_mov_b32 s64, 106496
    s_mov_b32 s65, 115712
    s_mov_b32 s66, 124928
    s_mov_b32 s67, 134144
    s_branch l1_p2done
l1_p2q:
    s_sub_u32 s55, s44, 1
    s_lshl_b32 s56, s55, 10
    s_add_u32 s64, s56, 135168
    s_add_u32 s65, s56, 140288
    s_add_u32 s66, s56, 145408
    s_add_u32 s67, s56, 150528
    s_lshl_b32 s55, s55, 6
    s_cmp_eq_u32 s48, 0
    s_cbranch_scc1 l1_p2f
    s_mov_b32 s12, s40
    s_mov_b32 s13, s41
    s_mov_b32 s14, s42
    s_mov_b32 s15, s43
    s_mov_b32 s52, 110592
    s_sub_u32 s56, s48, 1
    s_mul_i32 s56, s56, 576
    s_add_u32 s56, s56, s47
    s_lshl_b32 s56, s56, 1
    v_add_u32 v3, s55, v1
    v_mul_u32_u24 v4, 6554, v3
    v_lshrrev_b32 v4, 16, v4
    v_mul_u32_u24 v5, 10, v4
    v_sub_u32 v5, v3, v5
    v_and_b32 v6, 3, v4
    v_bfe_u32 v7, v4, 2, 2
    v_lshl_add_u32 v6, v7, 3, v6
    v_bfe_u32 v7, v4, 4, 1
    v_lshl_add_u32 v6, v7, 2, v6
    v_mul_u32_u24 v6, 3456, v6
    v_lshl_add_u32 v6, v5, 4, v6
    v_cmp_le_u32 vcc, 9, v5
    v_add_u32 v233, s56, v6
    v_mov_b32 v7, 0x80000000
    v_cndmask_b32 v233, v233, v7, vcc
    s_branch l1_p2chk
l1_p2f:
    s_mov_b32 s12, s8
    s_mov_b32 s13, s9
    s_mov_b32 s14, s10
    s_mov_b32 s15, s11
    s_mov_b32 s52, 294912
    s_lshl_b32 s56, s46, 1
    s_add_u32 s56, s56, 256
    v_add_u32 v3, s55, v1
    v_mul_u32_u24 v4, 6554, v3
    v_lshrrev_b32 v4, 16, v4
    v_mul_u32_u24 v5, 10, v4
    v_sub_u32 v5, v3, v5
    v_and_b32 v6, 3, v4
    v_bfe_u32 v7, v4, 2, 2
    v_lshl_add_u32 v6, v7, 3, v6
    v_bfe_u32 v7, v4, 4, 1
    v_lshl_add_u32 v6, v7, 2, v6
    v_mul_u32_u24 v6, 9216, v6
    v_lshl_add_u32 v6, v5, 4, v6
    v_cmp_le_u32 vcc, 8, v5
    v_add_u32 v233, s56, v6
    v_mov_b32 v7, 0x80000000
    v_cndmask_b32 v233, v233, v7, vcc
l1_p2chk:
    s_cmp_le_u32 s44, 5
    s_cbranch_scc1 l1_p2done
l1_p2dummy:
    v_mov_b32 v233, 0x80000000
    s_mov_b32 s64, 155648
    s_mov_b32 s65, 155648
    s_mov_b32 s66, 155648
    s_mov_b32 s67, 155648
l1_p2done:
    s_add_u32 m0, s54, 0
    s_nop 0
    buffer_load_dwordx4 v232, s[8:11], s50 offen lds
    s_add_u32 s50, s50, 294912
    s_mov_b32 m0, s64
    s_nop 0
    buffer_load_dwordx4 v233, s[12:15], s51 offen lds
    s_add_u32 s51, s51, s52
    s_add_u32 m0, s54, 9216
    s_nop 0
    buffer_load_dwordx4 v232, s[8:11], s50 offen lds
    s_add_u32 s50, s50, 294912
    s_mov_b32 m0, s65
    s_nop 0
    buffer_load_dwordx4 v233, s[12:15], s51 offen lds
    s_add_u32 s51, s51, s52
    s_mov_b32 s34, 0x480
    s_mov_b32 s35, 0x20000
    s_mov_b32 s38, 0x2400
    s_mov_b32 s39, 0x20000
    s_cmp_lt_u32 s44, 6
    s_cbranch_scc1 l1_nogw
    v_lshlrev_b32 v3, 4, v0
    v_subrev_u32 v3, 6144, v3
    s_lshl_b32 s55, s44, 10
    s_add_u32 m0, s55, 150528
    s_nop 0
    buffer_load_dwordx4 v3, s[32:35], 0 offen lds
l1_nogw:
    s_cmp_lg_u32 s44, 5
    s_cbranch_scc1 l1_nobi
    v_lshlrev_b32 v3, 4, v1
    s_lshl_b32 s55, s46, 1
    v_cmp_lt_u32 vcc, 23, v1
    v_add_u32 v3, s55, v3
    v_mov_b32 v4, 0x80000000
    v_cndmask_b32 v3, v3, v4, vcc
    s_mov_b32 m0, 160768
    s_nop 0
    buffer_load_dwordx4 v3, s[36:39], 0 offen lds
l1_nobi:
    s_add_u32 m0, s53, 32768
    s_nop 0
    buffer_load_dwordx4 v228, s[4:7], s49 offen lds
    s_add_u32 m0, s53, 33792
    s_nop 0
    buffer_load_dwordx4 v229, s[4:7], s49 offen lds
    s_add_u32 m0, s53, 34816
    s_nop 0
    buffer_load_dwordx4 v230, s[4:7], s49 offen lds
    s_add_u32 m0, s53, 35840
    s_nop 0
    buffer_load_dwordx4 v231, s[4:7], s49 offen lds
    s_add_u32 s49, s49, 128
    s_add_u32 m0, s54, 18432
    s_nop 0
    buffer_load_dwordx4 v232, s[8:11], s50 offen lds
    s_add_u32 s50, s50, 294912
    s_mov_b32 m0, s66
    s_nop 0
    buffer_load_dwordx4 v233, s[12:15], s51 offen lds
    s_add_u32 s51, s51, s52
    s_add_u32 s16, s16, 0x1000000
    s_addc_u32 s17, s17, 0
    s_mov_b32 s18, 0x1200000
    s_mov_b32 s19, 0x20000
    s_mov_b32 s98, 0x510000
    s_mov_b32 s99, 0x20000
    s_mov_b32 s94, 0xa2000
    s_mov_b32 s95, 0x20000
    s_add_u32 s20, s20, 0x300000
    s_addc_u32 s21, s21, 0
    s_mov_b32 s22, 0x600000
    s_mov_b32 s23, 0x20000
    s_add_u32 s24, s24, 0x900000
    s_addc_u32 s25, s25, 0
    s_mov_b32 s26, 0x240000
    s_mov_b32 s27, 0x20000
    s_add_u32 s28, s28, 0x240000
    s_addc_u32 s29, s29, 0
    s_mov_b32 s30, 0x2000
    s_mov_b32 s31, 0x20000
    v_lshlrev_b32 v3, 2, v0
    v_add_u32 v3, 158720, v3
    v_mov_b32 v216, 0x3f803f80
    v_mov_b32 v217, 0x3f803f80
    v_mov_b32 v218, 0x3f803f80
    v_mov_b32 v219, 0x3f803f80
    ds_write_b32 v3, v216
    v_and_b32 v3, 15, v1
    v_lshrrev_b32 v4, 4, v1
    v_and_b32 v6, 7, v1
    v_xor_b32 v6, v6, v4
    v_lshlrev_b32 v6, 4, v6
    v_lshl_add_u32 v6, v3, 7, v6
    s_lshl_b32 s55, s59, 13
    v_add_u32 v234, s55, v6
    v_xor_b32 v236, 64, v234
    v_add_u32 v235, 0x10000, v234
    v_add_u32 v237, 0x10000, v236
    v_lshrrev_b32 v5, 2, v3
    v_lshl_add_u32 v5, v4, 2, v5
    v_and_b32 v6, 3, v1
    v_mul_u32_u24 v7, 288, v5
    v_lshl_add_u32 v7, v6, 3, v7
    v_add_u32 v238, 98304, v7
    s_lshl_b32 s55, s44, 5
    v_add_u32 v239, s55, v238
    v_mul_u32_u24 v7, 160, v5
    v_lshl_add_u32 v7, v6, 3, v7
    v_add_u32 v241, 135168, v7
    s_lshl_b32 s55, s59, 5
    v_add_u32 v242, s55, v241
    v_cmp_eq_u32 vcc, 1, v3
    v_mov_b32 v5, 158720
    v_mov_b32 v6, 156672
    v_cndmask_b32 v5, v5, v6, vcc
    v_lshl_add_u32 v240, v4, 4, v5
    s_waitcnt vmcnt(6) lgkmcnt(0)
    s_barrier
    s_cmp_eq_u32 s60, 0
    s_cbranch_scc0 l1_ty1
    ds_read_b128 v[128:131], v234 offset:0
    ds_read_b128 v[132:135], v234 offset:2048
    ds_read_b128 v[136:139], v234 offset:4096
    ds_read_b128 v[140:143], v234 offset:6144
    ds_read_b64_tr_b16 v[160:161], v238 offset:0
    ds_read_b64_tr_b16 v[162:163], v238 offset:4608
    ds_read_b128 v[184:187], v240 offset:0
    ds_read_b64_tr_b16 v[192:193], v239 offset:0
    ds_read_b64_tr_b16 v[194:195], v239 offset:4608
    ds_read_b64_tr_b16 v[164:165], v238 offset:32
    ds_read_b64_tr_b16 v[166:167], v238 offset:4640
    ds_read_b64_tr_b16 v[168:169], v238 offset:64
    ds_read_b64_tr_b16 v[170:171], v238 offset:4672
    ds_read_b64_tr_b16 v[172:173], v238 offset:96
    ds_read_b64_tr_b16 v[174:175], v238 offset:4704
    s_waitcnt lgkmcnt(9)
    v_mfma_f32_16x16x32_bf16 v[16:19], v[160:163], v[128:131], 0
    v_mfma_f32_16x16x32_bf16 v[20:23], v[160:163], v[132:135], 0
    v_mfma_f32_16x16x32_bf16 v[24:27], v[160:163], v[136:139], 0
    v_mfma_f32_16x16x32_bf16 v[28:31], v[160:163], v[140:143], 0
    ds_read_b64_tr_b16 v[176:177], v238 offset:128
    ds_read_b64_tr_b16 v[178:179], v238 offset:4736
    s_add_u32 m0, s53, 65536
    s_nop 0
    buffer_load_dwordx4 v228, s[4:7], s49 offen lds
    s_waitcnt lgkmcnt(6)
    v_mfma_f32_16x16x32_bf16 v[32:35], v[164:167], v[128:131], 0
    v_mfma_f32_16x16x32_bf16 v[36:39], v[164:167], v[132:135], 0
    v_mfma_f32_16x16x32_bf16 v[40:43], v[164:167], v[136:139], 0
    v_mfma_f32_16x16x32_bf16 v[44:47], v[164:167], v[140:143], 0
    v_mfma_f32_16x16x32_bf16 v[200:203], v[184:187], v[128:131], 0
    v_mfma_f32_16x16x32_bf16 v[204:207], v[184:187], v[132:135], 0
    ds_read_b64_tr_b16 v[180:181], v238 offset:160
    ds_read_b64_tr_b16 v[182:183], v238 offset:4768
    s_add_u32 m0, s53, 66560
    s_nop 0
    buffer_load_dwordx4 v229, s[4:7], s49 offen lds
    s_waitcnt lgkmcnt(6)
    v_mfma_f32_16x16x32_bf16 v[48:51], v[168:171], v[128:131], 0
    v_mfma_f32_16x16x32_bf16 v[52:55], v[168:171], v[132:135], 0
    v_mfma_f32_16x16x32_bf16 v[56:59], v[168:171], v[136:139], 0
    v_mfma_f32_16x16x32_bf16 v[60:63], v[168:171], v[140:143], 0
    v_mfma_f32_16x16x32_bf16 v[208:211], v[192:195], v[216:219], 0
    ds_read_b64_tr_b16 v[160:161], v238 offset:192
    ds_read_b64_tr_b16 v[162:163], v238 offset:4800
    s_add_u32 m0, s53, 67584
    s_nop 0
    buffer_load_dwordx4 v230, s[4:7], s49 offen lds
    s_waitcnt lgkmcnt(6)
    v_mfma_f32_16x16x32_bf16 v[64:67], v[172:175], v[128:131], 0
    v_mfma_f32_16x16x32_bf16 v[68:71], v[172:175], v[132:135], 0
    v_mfma_f32_16x16x32_bf16 v[72:75], v[172:175], v[136:139], 0
    v_mfma_f32_16x16x32_bf16 v[76:79], v[172:175], v[140:143], 0
    v_mfma_f32_16x16x32_bf16 v[220:223], v[128:131], v[128:131], 0
    v_mfma_f32_16x16x32_bf16 v[224:227], v[132:135], v[132:135], 0
    ds_read_b128 v[144:147], v236 offset:0
    ds_read_b128 v[148:151], v236 offset:2048
    ds_read_b128 v[152:155], v236 offset:4096
    ds_read_b128 v[156:159], v236 offset:6144
    ds_read_b64_tr_b16 v[164:165], v238 offset:9216
    ds_read_b64_tr_b16 v[166:167], v238 offset:13824
    s_add_u32 m0, s53, 68608
    s_nop 0
    buffer_load_dwordx4 v231, s[4:7], s49 offen lds
    s_add_u32 s49, s49, 128
    s_waitcnt lgkmcnt(10)
    v_mfma_f32_16x16x32_bf16 v[80:83], v[176:179], v[128:131], 0
    v_mfma_f32_16x16x32_bf16 v[84:87], v[176:179], v[132:135], 0
    v_mfma_f32_16x16x32_bf16 v[88:91], v[176:179], v[136:139], 0
    v_mfma_f32_16x16x32_bf16 v[92:95], v[176:179], v[140:143], 0
    ds_read_b128 v[188:191], v240 offset:64
    ds_read_b64_tr_b16 v[196:197], v239 offset:9216
    ds_read_b64_tr_b16 v[198:199], v239 offset:13824
    ds_read_b64_tr_b16 v[168:169], v238 offset:9248
    ds_read_b64_tr_b16 v[170:171], v238 offset:13856
    s_add_u32 m0, s54, 27648
    s_nop 0
    buffer_load_dwordx4 v232, s[8:11], s50 offen lds
    s_add_u32 s50, s50, 294912
    s_waitcnt lgkmcnt(13)
    v_mfma_f32_16x16x32_bf16 v[96:99], v[180:183], v[128:131], 0
    v_mfma_f32_16x16x32_bf16 v[100:103], v[180:183], v[132:135], 0
    v_mfma_f32_16x16x32_bf16 v[104:107], v[180:183], v[136:139], 0
    v_mfma_f32_16x16x32_bf16 v[108:111], v[180:183], v[140:143], 0
    ds_read_b64_tr_b16 v[172:173], v238 offset:9280
    ds_read_b64_tr_b16 v[174:175], v238 offset:13888
    s_mov_b32 m0, s67
    s_nop 0
    buffer_load_dwordx4 v233, s[12:15], s51 offen lds
    s_add_u32 s51, s51, s52
    s_waitcnt lgkmcnt(13)
    v_mfma_f32_16x16x32_bf16 v[112:115], v[160:163], v[128:131], 0
    v_mfma_f32_16x16x32_bf16 v[116:119], v[160:163], v[132:135], 0
    v_mfma_f32_16x16x32_bf16 v[120:123], v[160:163], v[136:139], 0
    v_mfma_f32_16x16x32_bf16 v[124:127], v[160:163], v[140:143], 0
    ds_read_b64_tr_b16 v[176:177], v238 offset:9312
    ds_read_b64_tr_b16 v[178:179], v238 offset:13920
    s_waitcnt vmcnt(6)
    s_barrier
    s_waitcnt lgkmcnt(9)
    v_mfma_f32_16x16x32_bf16 v[16:19], v[164:167], v[144:147], v[16:19]
    v_mfma_f32_16x16x32_bf16 v[20:23], v[164:167], v[148:151], v[20:23]
    v_mfma_f32_16x16x32_bf16 v[24:27], v[164:167], v[152:155], v[24:27]
    v_mfma_f32_16x16x32_bf16 v[28:31], v[164:167], v[156:159], v[28:31]
    ds_read_b64_tr_b16 v[180:181], v238 offset:9344
    ds_read_b64_tr_b16 v[182:183], v238 offset:13952
    s_add_u32 m0, s54, 0
    s_nop 0
    buffer_load_dwordx4 v232, s[8:11], s50 offen lds
    s_add_u32 s50, s50, 294912
    s_waitcnt lgkmcnt(6)
    v_mfma_f32_16x16x32_bf16 v[32:35], v[168:171], v[144:147], v[32:35]
    v_mfma_f32_16x16x32_bf16 v[36:39], v[168:171], v[148:151], v[36:39]
    v_mfma_f32_16x16x32_bf16 v[40:43], v[168:171], v[152:155], v[40:43]
    v_mfma_f32_16x16x32_bf16 v[44:47], v[168:171], v[156:159], v[44:47]
    v_mfma_f32_16x16x32_bf16 v[200:203], v[188:191], v[144:147], v[200:203]
    v_mfma_f32_16x16x32_bf16 v[204:207], v[188:191], v[148:151], v[204:207]
    ds_read_b64_tr_b16 v[160:161], v238 offset:9376
    ds_read_b64_tr_b16 v[162:163], v238 offset:13984
    s_mov_b32 m0, s64
    s_nop 0
    buffer_load_dwordx4 v233, s[12:15], s51 offen lds
    s_add_u32 s51, s51, s52
    s_waitcnt lgkmcnt(6)
    v_mfma_f32_16x16x32_bf16 v[48:51], v[172:175], v[144:147], v[48:51]
    v_mfma_f32_16x16x32_bf16 v[52:55], v[172:175], v[148:151], v[52:55]
    v_mfma_f32_16x16x32_bf16 v[56:59], v[172:175], v[152:155], v[56:59]
    v_mfma_f32_16x16x32_bf16 v[60:63], v[172:175], v[156:159], v[60:63]
    v_mfma_f32_16x16x32_bf16 v[208:211], v[196:199], v[216:219], v[208:211]
    ds_read_b64_tr_b16 v[164:165], v238 offset:9408
    ds_read_b64_tr_b16 v[166:167], v238 offset:14016
    s_waitcnt lgkmcnt(6)
    v_mfma_f32_16x16x32_bf16 v[64:67], v[176:179], v[144:147], v[64:67]
    v_mfma_f32_16x16x32_bf16 v[68:71], v[176:179], v[148:151], v[68:71]
    v_mfma_f32_16x16x32_bf16 v[72:75], v[176:179], v[152:155], v[72:75]
    v_mfma_f32_16x16x32_bf16 v[76:79], v[176:179], v[156:159], v[76:79]
    v_mfma_f32_16x16x32_bf16 v[220:223], v[144:147], v[144:147], v[220:223]
    v_mfma_f32_16x16x32_bf16 v[224:227], v[148:151], v[148:151], v[224:227]
    ds_read_b128 v[128:131], v234 offset:32768
    ds_read_b128 v[132:135], v234 offset:34816
    ds_read_b128 v[136:139], v234 offset:36864
    ds_read_b128 v[140:143], v234 offset:38912
    ds_read_b64_tr_b16 v[168:169], v238 offset:18432
    ds_read_b64_tr_b16 v[170:171], v238 offset:23040
    s_waitcnt lgkmcnt(10)
    v_mfma_f32_16x16x32_bf16 v[80:83], v[180:183], v[144:147], v[80:83]
    v_mfma_f32_16x16x32_bf16 v[84:87], v[180:183], v[148:151], v[84:87]
    v_mfma_f32_16x16x32_bf16 v[88:91], v[180:183], v[152:155], v[88:91]
    v_mfma_f32_16x16x32_bf16 v[92:95], v[180:183], v[156:159], v[92:95]
    ds_read_b128 v[184:187], v240 offset:128
    ds_read_b64_tr_b16 v[192:193], v239 offset:18432
    ds_read_b64_tr_b16 v[194:195], v239 offset:23040
    ds_read_b64_tr_b16 v[172:173], v238 offset:18464
    ds_read_b64_tr_b16 v[174:175], v238 offset:23072
    s_waitcnt lgkmcnt(13)
    v_mfma_f32_16x16x32_bf16 v[96:99], v[160:163], v[144:147], v[96:99]
    v_mfma_f32_16x16x32_bf16 v[100:103], v[160:163], v[148:151], v[100:103]
    v_mfma_f32_16x16x32_bf16 v[104:107], v[160:163], v[152:155], v[104:107]
    v_mfma_f32_16x16x32_bf16 v[108:111], v[160:163], v[156:159], v[108:111]
    ds_read_b64_tr_b16 v[176:177], v238 offset:18496
    ds_read_b64_tr_b16 v[178:179], v238 offset:23104
    s_waitcnt lgkmcnt(13)
    v_mfma_f32_16x16x32_bf16 v[112:115], v[164:167], v[144:147], v[112:115]
    v_mfma_f32_16x16x32_bf16 v[116:119], v[164:167], v[148:151], v[116:119]
    v_mfma_f32_16x16x32_bf16 v[120:123], v[164:167], v[152:155], v[120:123]
    v_mfma_f32_16x16x32_bf16 v[124:127], v[164:167], v[156:159], v[124:127]
    ds_read_b64_tr_b16 v[180:181], v238 offset:18528
    ds_read_b64_tr_b16 v[182:183], v238 offset:23136
    s_waitcnt vmcnt(2)
    s_barrier
    s_waitcnt lgkmcnt(9)
    v_mfma_f32_16x16x32_bf16 v[16:19], v[168:171], v[128:131], v[16:19]
    v_mfma_f32_16x16x32_bf16 v[20:23], v[168:171], v[132:135], v[20:23]
    v_mfma_f32_16x16x32_bf16 v[24:27], v[168:171], v[136:139], v[24:27]
    v_mfma_f32_16x16x32_bf16 v[28:31], v[168:171], v[140:143], v[28:31]
    ds_read_b64_tr_b16 v[160:161], v238 offset:18560
    ds_read_b64_tr_b16 v[162:163], v238 offset:23168
    s_add_u32 m0, s53, 0
    s_nop 0
    buffer_load_dwordx4 v228, s[4:7], s49 offen lds
    s_waitcnt lgkmcnt(6)
    v_mfma_f32_16x16x32_bf16 v[32:35], v[172:175], v[128:131], v[32:35]
    v_mfma_f32_16x16x32_bf16 v[36:39], v[172:175], v[132:135], v[36:39]
    v_mfma_f32_16x16x32_bf16 v[40:43], v[172:175], v[136:139], v[40:43]
    v_mfma_f32_16x16x32_bf16 v[44:47], v[172:175], v[140:143], v[44:47]
    v_mfma_f32_16x16x32_bf16 v[200:203], v[184:187], v[128:131], v[200:203]
    v_mfma_f32_16x16x32_bf16 v[204:207], v[184:187], v[132:135], v[204:207]
    ds_read_b64_tr_b16 v[164:165], v238 offset:18592
    ds_read_b64_tr_b16 v[166:167], v238 offset:23200
    s_add_u32 m0, s53, 1024
    s_nop 0
    buffer_load_dwordx4 v229, s[4:7], s49 offen lds
    s_waitcnt lgkmcnt(6)
    v_mfma_f32_16x16x32_bf16 v[48:51], v[176:179], v[128:131], v[48:51]
    v_mfma_f32_16x16x32_bf16 v[52:55], v[176:179], v[132:135], v[52:55]
    v_mfma_f32_16x16x32_bf16 v[56:59], v[176:179], v[136:139], v[56:59]
    v_mfma_f32_16x16x32_bf16 v[60:63], v[176:179], v[140:143], v[60:63]
    v_mfma_f32_16x16x32_bf16 v[208:211], v[192:195], v[216:219], v[208:211]
    ds_read_b64_tr_b16 v[168:169], v238 offset:18624
    ds_read_b64_tr_b16 v[170:171], v238 offset:23232
    s_add_u32 m0, s53, 2048
    s_nop 0
    buffer_load_dwordx4 v230, s[4:7], s49 offen lds
    s_waitcnt lgkmcnt(6)
    v_mfma_f32_16x16x32_bf16 v[64:67], v[180:183], v[128:131], v[64:67]
    v_mfma_f32_16x16x32_bf16 v[68:71], v[180:183], v[132:135], v[68:71]
    v_mfma_f32_16x16x32_bf16 v[72:75], v[180:183], v[136:139], v[72:75]
    v_mfma_f32_16x16x32_bf16 v[76:79], v[180:183], v[140:143], v[76:79]
    v_mfma_f32_16x16x32_bf16 v[220:223], v[128:131], v[128:131], v[220:223]
    v_mfma_f32_16x16x32_bf16 v[224:227], v[132:135], v[132:135], v[224:227]
    ds_read_b128 v[144:147], v236 offset:32768
    ds_read_b128 v[148:151], v236 offset:34816
    ds_read_b128 v[152:155], v236 offset:36864
    ds_read_b128 v[156:159], v236 offset:38912
    ds_read_b64_tr_b16 v[172:173], v238 offset:27648
    ds_read_b64_tr_b16 v[174:175], v238 offset:32256
    s_add_u32 m0, s53, 3072
    s_nop 0
    buffer_load_dwordx4 v231, s[4:7], s49 offen lds
    s_add_u32 s49, s49, 128
    s_waitcnt lgkmcnt(10)
    v_mfma_f32_16x16x32_bf16 v[80:83], v[160:163], v[128:131], v[80:83]
    v_mfma_f32_16x16x32_bf16 v[84:87], v[160:163], v[132:135], v[84:87]
    v_mfma_f32_16x16x32_bf16 v[88:91], v[160:163], v[136:139], v[88:91]
    v_mfma_f32_16x16x32_bf16 v[92:95], v[160:163], v[140:143], v[92:95]
    ds_read_b128 v[188:191], v240 offset:192
    ds_read_b64_tr_b16 v[196:197], v239 offset:27648
    ds_read_b64_tr_b16 v[198:199], v239 offset:32256
    ds_read_b64_tr_b16 v[176:177], v238 offset:27680
    ds_read_b64_tr_b16 v[178:179], v238 offset:32288
    s_add_u32 m0, s54, 9216
    s_nop 0
    buffer_load_dwordx4 v232, s[8:11], s50 offen lds
    s_add_u32 s50, s50, 294912
    s_waitcnt lgkmcnt(13)
    v_mfma_f32_16x16x32_bf16 v[96:99], v[164:167], v[128:131], v[96:99]
    v_mfma_f32_16x16x32_bf16 v[100:103], v[164:167], v[132:135], v[100:103]
    v_mfma_f32_16x16x32_bf16 v[104:107], v[164:167], v[136:139], v[104:107]
    v_mfma_f32_16x16x32_bf16 v[108:111], v[164:167], v[140:143], v[108:111]
    ds_read_b64_tr_b16 v[180:181], v238 offset:27712
    ds_read_b64_tr_b16 v[182:183], v238 offset:32320
    s_mov_b32 m0, s65
    s_nop 0
    buffer_load_dwordx4 v233, s[12:15], s51 offen lds
    s_add_u32 s51, s51, s52
    s_waitcnt lgkmcnt(13)
    v_mfma_f32_16x16x32_bf16 v[112:115], v[168:171], v[128:131], v[112:115]
    v_mfma_f32_16x16x32_bf16 v[116:119], v[168:171], v[132:135], v[116:119]
    v_mfma_f32_16x16x32_bf16 v[120:123], v[168:171], v[136:139], v[120:123]
    v_mfma_f32_16x16x32_bf16 v[124:127], v[168:171], v[140:143], v[124:127]
    ds_read_b64_tr_b16 v[160:161], v238 offset:27744
    ds_read_b64_tr_b16 v[162:163], v238 offset:32352
    s_waitcnt vmcnt(6)
    s_barrier
    s_waitcnt lgkmcnt(9)
    v_mfma_f32_16x16x32_bf16 v[16:19], v[172:175], v[144:147], v[16:19]
    v_mfma_f32_16x16x32_bf16 v[20:23], v[172:175], v[148:151], v[20:23]
    v_mfma_f32_16x16x32_bf16 v[24:27], v[172:175], v[152:155], v[24:27]
    v_mfma_f32_16x16x32_bf16 v[28:31], v[172:175], v[156:159], v[28:31]
    ds_read_b64_tr_b16 v[164:165], v238 offset:27776
    ds_read_b64_tr_b16 v[166:167], v238 offset:32384
    s_add_u32 m0, s54, 18432
    s_nop 0
    buffer_load_dwordx4 v232, s[8:11], s50 offen lds
    s_add_u32 s50, s50, 294912
    s_waitcnt lgkmcnt(6)
    v_mfma_f32_16x16x32_bf16 v[32:35], v[176:179], v[144:147], v[32:35]
    v_mfma_f32_16x16x32_bf16 v[36:39], v[176:179], v[148:151], v[36:39]
    v_mfma_f32_16x16x32_bf16 v[40:43], v[176:179], v[152:155], v[40:43]
    v_mfma_f32_16x16x32_bf16 v[44:47], v[176:179], v[156:159], v[44:47]
    v_mfma_f32_16x16x32_bf16 v[200:203], v[188:191], v[144:147], v[200:203]
    v_mfma_f32_16x16x32_bf16 v[204:207], v[188:191], v[148:151], v[204:207]
    ds_read_b64_tr_b16 v[168:169], v238 offset:27808
    ds_read_b64_tr_b16 v[170:171], v238 offset:32416
    s_mov_b32 m0, s66
    s_nop 0
    buffer_load_dwordx4 v233, s[12:15], s51 offen lds
    s_add_u32 s51, s51, s52
    s_waitcnt lgkmcnt(6)
    v_mfma_f32_16x16x32_bf16 v[48:51], v[180:183], v[144:147], v[48:51]
    v_mfma_f32_16x16x32_bf16 v[52:55], v[180:183], v[148:151], v[52:55]
    v_mfma_f32_16x16x32_bf16 v[56:59], v[180:183], v[152:155], v[56:59]
    v_mfma_f32_16x16x32_bf16 v[60:63], v[180:183], v[156:159], v[60:63]
    v_mfma_f32_16x16x32_bf16 v[208:211], v[196:199], v[216:219], v[208:211]
    ds_read_b64_tr_b16 v[172:173], v238 offset:27840
    ds_read_b64_tr_b16 v[174:175], v238 offset:32448
    s_waitcnt lgkmcnt(6)
    v_mfma_f32_16x16x32_bf16 v[64:67], v[160:163], v[144:147], v[64:67]
    v_mfma_f32_16x16x32_bf16 v[68:71], v[160:163], v[148:151], v[68:71]
    v_mfma_f32_16x16x32_bf16 v[72:75], v[160:163], v[152:155], v[72:75]
    v_mfma_f32_16x16x32_bf16 v[76:79], v[160:163], v[156:159], v[76:79]
    v_mfma_f32_16x16x32_bf16 v[220:223], v[144:147], v[144:147], v[220:223]
    v_mfma_f32_16x16x32_bf16 v[224:227], v[148:151], v[148:151], v[224:227]
    ds_read_b128 v[128:131], v235 offset:0
    ds_read_b128 v[132:135], v235 offset:2048
    ds_read_b128 v[136:139], v235 offset:4096
    ds_read_b128 v[140:143], v235 offset:6144
    ds_read_b64_tr_b16 v[176:177], v238 offset:0
    ds_read_b64_tr_b16 v[178:179], v238 offset:4608
    s_waitcnt lgkmcnt(10)
    v_mfma_f32_16x16x32_bf16 v[80:83], v[164:167], v[144:147], v[80:83]
    v_mfma_f32_16x16x32_bf16 v[84:87], v[164:167], v[148:151], v[84:87]
    v_mfma_f32_16x16x32_bf16 v[88:91], v[164:167], v[152:155], v[88:91]
    v_mfma_f32_16x16x32_bf16 v[92:95], v[164:167], v[156:159], v[92:95]
    ds_read_b128 v[184:187], v240 offset:256
    ds_read_b64_tr_b16 v[192:193], v239 offset:0
    ds_read_b64_tr_b16 v[194:195], v239 offset:4608
    ds_read_b64_tr_b16 v[180:181], v238 offset:32
    ds_read_b64_tr_b16 v[182:183], v238 offset:4640
    s_waitcnt lgkmcnt(13)
    v_mfma_f32_16x16x32_bf16 v[96:99], v[168:171], v[144:147], v[96:99]
    v_mfma_f32_16x16x32_bf16 v[100:103], v[168:171], v[148:151], v[100:103]
    v_mfma_f32_16x16x32_bf16 v[104:107], v[168:171], v[152:155], v[104:107]
    v_mfma_f32_16x16x32_bf16 v[108:111], v[168:171], v[156:159], v[108:111]
    ds_read_b64_tr_b16 v[160:161], v238 offset:64
    ds_read_b64_tr_b16 v[162:163], v238 offset:4672
    s_waitcnt lgkmcnt(13)
    v_mfma_f32_16x16x32_bf16 v[112:115], v[172:175], v[144:147], v[112:115]
    v_mfma_f32_16x16x32_bf16 v[116:119], v[172:175], v[148:151], v[116:119]
    v_mfma_f32_16x16x32_bf16 v[120:123], v[172:175], v[152:155], v[120:123]
    v_mfma_f32_16x16x32_bf16 v[124:127], v[172:175], v[156:159], v[124:127]
    ds_read_b64_tr_b16 v[164:165], v238 offset:96
    ds_read_b64_tr_b16 v[166:167], v238 offset:4704
    s_waitcnt vmcnt(2)
    s_barrier
    s_waitcnt lgkmcnt(9)
    v_mfma_f32_16x16x32_bf16 v[16:19], v[176:179], v[128:131], v[16:19]
    v_mfma_f32_16x16x32_bf16 v[20:23], v[176:179], v[132:135], v[20:23]
    v_mfma_f32_16x16x32_bf16 v[24:27], v[176:179], v[136:139], v[24:27]
    v_mfma_f32_16x16x32_bf16 v[28:31], v[176:179], v[140:143], v[28:31]
    ds_read_b64_tr_b16 v[168:169], v238 offset:128
    ds_read_b64_tr_b16 v[170:171], v238 offset:4736
    s_add_u32 m0, s53, 32768
    s_nop 0
    buffer_load_dwordx4 v228, s[4:7], s49 offen lds
    s_waitcnt lgkmcnt(6)
    v_mfma_f32_16x16x32_bf16 v[32:35], v[180:183], v[128:131], v[32:35]
    v_mfma_f32_16x16x32_bf16 v[36:39], v[180:183], v[132:135], v[36:39]
    v_mfma_f32_16x16x32_bf16 v[40:43], v[180:183], v[136:139], v[40:43]
    v_mfma_f32_16x16x32_bf16 v[44:47], v[180:183], v[140:143], v[44:47]
    v_mfma_f32_16x16x32_bf16 v[200:203], v[184:187], v[128:131], v[200:203]
    v_mfma_f32_16x16x32_bf16 v[204:207], v[184:187], v[132:135], v[204:207]
    ds_read_b64_tr_b16 v[172:173], v238 offset:160
    ds_read_b64_tr_b16 v[174:175], v238 offset:4768
    s_add_u32 m0, s53, 33792
    s_nop 0
    buffer_load_dwordx4 v229, s[4:7], s49 offen lds
    s_waitcnt lgkmcnt(6)
    v_mfma_f32_16x16x32_bf16 v[48:51], v[160:163], v[128:131], v[48:51]
    v_mfma_f32_16x16x32_bf16 v[52:55], v[160:163], v[132:135], v[52:55]
    v_mfma_f32_16x16x32_bf16 v[56:59], v[160:163], v[136:139], v[56:59]
    v_mfma_f32_16x16x32_bf16 v[60:63], v[160:163], v[140:143], v[60:63]
    v_mfma_f32_16x16x32_bf16 v[208:211], v[192:195], v[216:219], v[208:211]
    ds_read_b64_tr_b16 v[176:177], v238 offset:192
    ds_read_b64_tr_b16 v[178:179], v238 offset:4800
    s_add_u32 m0, s53, 34816
    s_nop 0
    buffer_load_dwordx4 v230, s[4:7], s49 offen lds
    s_waitcnt lgkmcnt(6)
    v_mfma_f32_16x16x32_bf16 v[64:67], v[164:167], v[128:131], v[64:67]
    v_mfma_f32_16x16x32_bf16 v[68:71], v[164:167], v[132:135], v[68:71]
    v_mfma_f32_16x16x32_bf16 v[72:75], v[164:167], v[136:139], v[72:75]
    v_mfma_f32_16x16x32_bf16 v[76:79], v[164:167], v[140:143], v[76:79]
    v_mfma_f32_16x16x32_bf16 v[220:223], v[128:131], v[128:131], v[220:223]
    v_mfma_f32_16x16x32_bf16 v[224:227], v[132:135], v[132:135], v[224:227]
    ds_read_b128 v[144:147], v237 offset:0
    ds_read_b128 v[148:151], v237 offset:2048
    ds_read_b128 v[152:155], v237 offset:4096
    ds_read_b128 v[156:159], v237 offset:6144
    ds_read_b64_tr_b16 v[180:181], v238 offset:9216
    ds_read_b64_tr_b16 v[182:183], v238 offset:13824
    s_add_u32 m0, s53, 35840
    s_nop 0
    buffer_load_dwordx4 v231, s[4:7], s49 offen lds
    s_add_u32 s49, s49, 128
    s_waitcnt lgkmcnt(10)
    v_mfma_f32_16x16x32_bf16 v[80:83], v[168:171], v[128:131], v[80:83]
    v_mfma_f32_16x16x32_bf16 v[84:87], v[168:171], v[132:135], v[84:87]
    v_mfma_f32_16x16x32_bf16 v[88:91], v[168:171], v[136:139], v[88:91]
    v_mfma_f32_16x16x32_bf16 v[92:95], v[168:171], v[140:143], v[92:95]
    ds_read_b128 v[188:191], v240 offset:320
    ds_read_b64_tr_b16 v[196:197], v239 offset:9216
    ds_read_b64_tr_b16 v[198:199], v239 offset:13824
    ds_read_b64_tr_b16 v[160:161], v238 offset:9248
    ds_read_b64_tr_b16 v[162:163], v238 offset:13856
    s_add_u32 m0, s54, 27648
    s_nop 0
    buffer_load_dwordx4 v232, s[8:11], s50 offen lds
    s_add_u32 s50, s50, 294912
    s_waitcnt lgkmcnt(13)
    v_mfma_f32_16x16x32_bf16 v[96:99], v[172:175], v[128:131], v[96:99]
    v_mfma_f32_16x16x32_bf16 v[100:103], v[172:175], v[132:135], v[100:103]
    v_mfma_f32_16x16x32_bf16 v[104:107], v[172:175], v[136:139], v[104:107]
    v_mfma_f32_16x16x32_bf16 v[108:111], v[172:175], v[140:143], v[108:111]
    ds_read_b64_tr_b16 v[164:165], v238 offset:9280
    ds_read_b64_tr_b16 v[166:167], v238 offset:13888
    s_mov_b32 m0, s67
    s_nop 0
    buffer_load_dwordx4 v233, s[12:15], s51 offen lds
    s_add_u32 s51, s51, s52
    s_waitcnt lgkmcnt(13)
    v_mfma_f32_16x16x32_bf16 v[112:115], v[176:179], v[128:131], v[112:115]
    v_mfma_f32_16x16x32_bf16 v[116:119], v[176:179], v[132:135], v[116:119]
    v_mfma_f32_16x16x32_bf16 v[120:123], v[176:179], v[136:139], v[120:123]
    v_mfma_f32_16x16x32_bf16 v[124:127], v[176:179], v[140:143], v[124:127]
    ds_read_b64_tr_b16 v[168:169], v238 offset:9312
    ds_read_b64_tr_b16 v[170:171], v238 offset:13920
    s_waitcnt vmcnt(6)
    s_barrier
    s_waitcnt lgkmcnt(9)
    v_mfma_f32_16x16x32_bf16 v[16:19], v[180:183], v[144:147], v[16:19]
    v_mfma_f32_16x16x32_bf16 v[20:23], v[180:183], v[148:151], v[20:23]
    v_mfma_f32_16x16x32_bf16 v[24:27], v[180:183], v[152:155], v[24:27]
    v_mfma_f32_16x16x32_bf16 v[28:31], v[180:183], v[156:159], v[28:31]
    ds_read_b64_tr_b16 v[172:173], v238 offset:9344
    ds_read_b64_tr_b16 v[174:175], v238 offset:13952
    s_add_u32 m0, s54, 0
    s_nop 0
    buffer_load_dwordx4 v232, s[8:11], s50 offen lds
    s_add_u32 s50, s50, 294912
    s_waitcnt lgkmcnt(6)
    v_mfma_f32_16x16x32_bf16 v[32:35], v[160:163], v[144:147], v[32:35]
    v_mfma_f32_16x16x32_bf16 v[36:39], v[160:163], v[148:151], v[36:39]
    v_mfma_f32_16x16x32_bf16 v[40:43], v[160:163], v[152:155], v[40:43]
    v_mfma_f32_16x16x32_bf16 v[44:47], v[160:163], v[156:159], v[44:47]
    v_mfma_f32_16x16x32_bf16 v[200:203], v[188:191], v[144:147], v[200:203]
    v_mfma_f32_16x16x32_bf16 v[204:207], v[188:191], v[148:151], v[204:207]
    ds_read_b64_tr_b16 v[176:177], v238 offset:9376
    ds_read_b64_tr_b16 v[178:179], v238 offset:13984
    s_mov_b32 m0, s64
    s_nop 0
    buffer_load_dwordx4 v233, s[12:15], s51 offen lds
    s_add_u32 s51, s51, s52
    s_waitcnt lgkmcnt(6)
    v_mfma_f32_16x16x32_bf16 v[48:51], v[164:167], v[144:147], v[48:51]
    v_mfma_f32_16x16x32_bf16 v[52:55], v[164:167], v[148:151], v[52:55]
    v_mfma_f32_16x16x32_bf16 v[56:59], v[164:167], v[152:155], v[56:59]
    v_mfma_f32_16x16x32_bf16 v[60:63], v[164:167], v[156:159], v[60:63]
    v_mfma_f32_16x16x32_bf16 v[208:211], v[196:199], v[216:219], v[208:211]
    ds_read_b64_tr_b16 v[180:181], v238 offset:9408
    ds_read_b64_tr_b16 v[182:183], v238 offset:14016
    s_waitcnt lgkmcnt(6)
    v_mfma_f32_16x16x32_bf16 v[64:67], v[168:171], v[144:147], v[64:67]
    v_mfma_f32_16x16x32_bf16 v[68:71], v[168:171], v[148:151], v[68:71]
    v_mfma_f32_16x16x32_bf16 v[72:75], v[168:171], v[152:155], v[72:75]
    v_mfma_f32_16x16x32_bf16 v[76:79], v[168:171], v[156:159], v[76:79]
    v_mfma_f32_16x16x32_bf16 v[220:223], v[144:147], v[144:147], v[220:223]
    v_mfma_f32_16x16x32_bf16 v[224:227], v[148:151], v[148:151], v[224:227]
    ds_read_b128 v[128:131], v234 offset:0
    ds_read_b128 v[132:135], v234 offset:2048
    ds_read_b128 v[136:139], v234 offset:4096
    ds_read_b128 v[140:143], v234 offset:6144
    ds_read_b64_tr_b16 v[160:161], v238 offset:18432
    ds_read_b64_tr_b16 v[162:163], v238 offset:23040
    s_waitcnt lgkmcnt(10)
    v_mfma_f32_16x16x32_bf16 v[80:83], v[172:175], v[144:147], v[80:83]
    v_mfma_f32_16x16x32_bf16 v[84:87], v[172:175], v[148:151], v[84:87]
    v_mfma_f32_16x16x32_bf16 v[88:91], v[172:175], v[152:155], v[88:91]
    v_mfma_f32_16x16x32_bf16 v[92:95], v[172:175], v[156:159], v[92:95]
    ds_read_b128 v[184:187], v240 offset:384
    ds_read_b64_tr_b16 v[192:193], v239 offset:18432
    ds_read_b64_tr_b16 v[194:195], v239 offset:23040
    ds_read_b64_tr_b16 v[164:165], v238 offset:18464
    ds_read_b64_tr_b16 v[166:167], v238 offset:23072
    s_waitcnt lgkmcnt(13)
    v_mfma_f32_16x16x32_bf16 v[96:99], v[176:179], v[144:147], v[96:99]
    v_mfma_f32_16x16x32_bf16 v[100:103], v[176:179], v[148:151], v[100:103]
    v_mfma_f32_16x16x32_bf16 v[104:107], v[176:179], v[152:155], v[104:107]
    v_mfma_f32_16x16x32_bf16 v[108:111], v[176:179], v[156:159], v[108:111]
    ds_read_b64_tr_b16 v[168:169], v238 offset:18496
    ds_read_b64_tr_b16 v[170:171], v238 offset:23104
    s_waitcnt lgkmcnt(13)
    v_mfma_f32_16x16x32_bf16 v[112:115], v[180:183], v[144:147], v[112:115]
    v_mfma_f32_16x16x32_bf16 v[116:119], v[180:183], v[148:151], v[116:119]
    v_mfma_f32_16x16x32_bf16 v[120:123], v[180:183], v[152:155], v[120:123]
    v_mfma_f32_16x16x32_bf16 v[124:127], v[180:183], v[156:159], v[124:127]
    ds_read_b64_tr_b16 v[172:173], v238 offset:18528
    ds_read_b64_tr_b16 v[174:175], v238 offset:23136
    s_waitcnt vmcnt(2)
    s_barrier
    s_waitcnt lgkmcnt(9)
    v_mfma_f32_16x16x32_bf16 v[16:19], v[160:163], v[128:131], v[16:19]
    v_mfma_f32_16x16x32_bf16 v[20:23], v[160:163], v[132:135], v[20:23]
    v_mfma_f32_16x16x32_bf16 v[24:27], v[160:163], v[136:139], v[24:27]
    v_mfma_f32_16x16x32_bf16 v[28:31], v[160:163], v[140:143], v[28:31]
    ds_read_b64_tr_b16 v[176:177], v238 offset:18560
    ds_read_b64_tr_b16 v[178:179], v238 offset:23168
    s_add_u32 m0, s53, 65536
    s_nop 0
    buffer_load_dwordx4 v228, s[4:7], s49 offen lds
    s_waitcnt lgkmcnt(6)
    v_mfma_f32_16x16x32_bf16 v[32:35], v[164:167], v[128:131], v[32:35]
    v_mfma_f32_16x16x32_bf16 v[36:39], v[164:167], v[132:135], v[36:39]
    v_mfma_f32_16x16x32_bf16 v[40:43], v[164:167], v[136:139], v[40:43]
    v_mfma_f32_16x16x32_bf16 v[44:47], v[164:167], v[140:143], v[44:47]
    v_mfma_f32_16x16x32_bf16 v[200:203], v[184:187], v[128:131], v[200:203]
    v_mfma_f32_16x16x32_bf16 v[204:207], v[184:187], v[132:135], v[204:207]
    ds_read_b64_tr_b16 v[180:181], v238 offset:18592
    ds_read_b64_tr_b16 v[182:183], v238 offset:23200
    s_add_u32 m0, s53, 66560
    s_nop 0
    buffer_load_dwordx4 v229, s[4:7], s49 offen lds
    s_waitcnt lgkmcnt(6)
    v_mfma_f32_16x16x32_bf16 v[48:51], v[168:171], v[128:131], v[48:51]
    v_mfma_f32_16x16x32_bf16 v[52:55], v[168:171], v[132:135], v[52:55]
    v_mfma_f32_16x16x32_bf16 v[56:59], v[168:171], v[136:139], v[56:59]
    v_mfma_f32_16x16x32_bf16 v[60:63], v[168:171], v[140:143], v[60:63]
    v_mfma_f32_16x16x32_bf16 v[208:211], v[192:195], v[216:219], v[208:211]
    ds_read_b64_tr_b16 v[160:161], v238 offset:18624
    ds_read_b64_tr_b16 v[162:163], v238 offset:23232
    s_add_u32 m0, s53, 67584
    s_nop 0
    buffer_load_dwordx4 v230, s[4:7], s49 offen lds
    s_waitcnt lgkmcnt(6)
    v_mfma_f32_16x16x32_bf16 v[64:67], v[172:175], v[128:131], v[64:67]
    v_mfma_f32_16x16x32_bf16 v[68:71], v[172:175], v[132:135], v[68:71]
    v_mfma_f32_16x16x32_bf16 v[72:75], v[172:175], v[136:139], v[72:75]
    v_mfma_f32_16x16x32_bf16 v[76:79], v[172:175], v[140:143], v[76:79]
    v_mfma_f32_16x16x32_bf16 v[220:223], v[128:131], v[128:131], v[220:223]
    v_mfma_f32_16x16x32_bf16 v[224:227], v[132:135], v[132:135], v[224:227]
    ds_read_b128 v[144:147], v236 offset:0
    ds_read_b128 v[148:151], v236 offset:2048
    ds_read_b128 v[152:155], v236 offset:4096
    ds_read_b128 v[156:159], v236 offset:6144
    ds_read_b64_tr_b16 v[164:165], v238 offset:27648
    ds_read_b64_tr_b16 v[166:167], v238 offset:32256
    s_add_u32 m0, s53, 68608
    s_nop 0
    buffer_load_dwordx4 v231, s[4:7], s49 offen lds
    s_add_u32 s49, s49, 128
    s_waitcnt lgkmcnt(10)
    v_mfma_f32_16x16x32_bf16 v[80:83], v[176:179], v[128:131], v[80:83]
    v_mfma_f32_16x16x32_bf16 v[84:87], v[176:179], v[132:135], v[84:87]
    v_mfma_f32_16x16x32_bf16 v[88:91], v[176:179], v[136:139], v[88:91]
    v_mfma_f32_16x16x32_bf16 v[92:95], v[176:179], v[140:143], v[92:95]
    ds_read_b128 v[188:191], v240 offset:448
    ds_read_b64_tr_b16 v[196:197], v239 offset:27648
    ds_read_b64_tr_b16 v[198:199], v239 offset:32256
    ds_read_b64_tr_b16 v[168:169], v238 offset:27680
    ds_read_b64_tr_b16 v[170:171], v238 offset:32288
    s_add_u32 m0, s54, 9216
    s_nop 0
    buffer_load_dwordx4 v232, s[8:11], s50 offen lds
    s_add_u32 s50, s50, 294912
    s_waitcnt lgkmcnt(13)
    v_mfma_f32_16x16x32_bf16 v[96:99], v[180:183], v[128:131], v[96:99]
    v_mfma_f32_16x16x32_bf16 v[100:103], v[180:183], v[132:135], v[100:103]
    v_mfma_f32_16x16x32_bf16 v[104:107], v[180:183], v[136:139], v[104:107]
    v_mfma_f32_16x16x32_bf16 v[108:111], v[180:183], v[140:143], v[108:111]
    ds_read_b64_tr_b16 v[172:173], v238 offset:27712
    ds_read_b64_tr_b16 v[174:175], v238 offset:32320
    s_mov_b32 m0, s65
    s_nop 0
    buffer_load_dwordx4 v233, s[12:15], s51 offen lds
    s_add_u32 s51, s51, s52
    s_waitcnt lgkmcnt(13)
    v_mfma_f32_16x16x32_bf16 v[112:115], v[160:163], v[128:131], v[112:115]
    v_mfma_f32_16x16x32_bf16 v[116:119], v[160:163], v[132:135], v[116:119]
    v_mfma_f32_16x16x32_bf16 v[120:123], v[160:163], v[136:139], v[120:123]
    v_mfma_f32_16x16x32_bf16 v[124:127], v[160:163], v[140:143], v[124:127]
    ds_read_b64_tr_b16 v[176:177], v238 offset:27744
    ds_read_b64_tr_b16 v[178:179], v238 offset:32352
    s_waitcnt vmcnt(6)
    s_barrier
    s_waitcnt lgkmcnt(9)
    v_mfma_f32_16x16x32_bf16 v[16:19], v[164:167], v[144:147], v[16:19]
    v_mfma_f32_16x16x32_bf16 v[20:23], v[164:167], v[148:151], v[20:23]
    v_mfma_f32_16x16x32_bf16 v[24:27], v[164:167], v[152:155], v[24:27]
    v_mfma_f32_16x16x32_bf16 v[28:31], v[164:167], v[156:159], v[28:31]
    ds_read_b64_tr_b16 v[180:181], v238 offset:27776
    ds_read_b64_tr_b16 v[182:183], v238 offset:32384
    s_add_u32 m0, s54, 18432
    s_nop 0
    buffer_load_dwordx4 v232, s[8:11], s50 offen lds
    s_add_u32 s50, s50, 294912
    s_waitcnt lgkmcnt(6)
    v_mfma_f32_16x16x32_bf16 v[32:35], v[168:171], v[144:147], v[32:35]
    v_mfma_f32_16x16x32_bf16 v[36:39], v[168:171], v[148:151], v[36:39]
    v_mfma_f32_16x16x32_bf16 v[40:43], v[168:171], v[152:155], v[40:43]
    v_mfma_f32_16x16x32_bf16 v[44:47], v[168:171], v[156:159], v[44:47]
    v_mfma_f32_16x16x32_bf16 v[200:203], v[188:191], v[144:147], v[200:203]
    v_mfma_f32_16x16x32_bf16 v[204:207], v[188:191], v[148:151], v[204:207]
    ds_read_b64_tr_b16 v[160:161], v238 offset:27808
    ds_read_b64_tr_b16 v[162:163], v238 offset:32416
    s_mov_b32 m0, s66
    s_nop 0
    buffer_load_dwordx4 v233, s[12:15], s51 offen lds
    s_add_u32 s51, s51, s52
    s_waitcnt lgkmcnt(6)
    v_mfma_f32_16x16x32_bf16 v[48:51], v[172:175], v[144:147], v[48:51]
    v_mfma_f32_16x16x32_bf16 v[52:55], v[172:175], v[148:151], v[52:55]
    v_mfma_f32_16x16x32_bf16 v[56:59], v[172:175], v[152:155], v[56:59]
    v_mfma_f32_16x16x32_bf16 v[60:63], v[172:175], v[156:159], v[60:63]
    v_mfma_f32_16x16x32_bf16 v[208:211], v[196:199], v[216:219], v[208:211]
    ds_read_b64_tr_b16 v[164:165], v238 offset:27840
    ds_read_b64_tr_b16 v[166:167], v238 offset:32448
    s_waitcnt lgkmcnt(6)
    v_mfma_f32_16x16x32_bf16 v[64:67], v[176:179], v[144:147], v[64:67]
    v_mfma_f32_16x16x32_bf16 v[68:71], v[176:179], v[148:151], v[68:71]
    v_mfma_f32_16x16x32_bf16 v[72:75], v[176:179], v[152:155], v[72:75]
    v_mfma_f32_16x16x32_bf16 v[76:79], v[176:179], v[156:159], v[76:79]
    v_mfma_f32_16x16x32_bf16 v[220:223], v[144:147], v[144:147], v[220:223]
    v_mfma_f32_16x16x32_bf16 v[224:227], v[148:151], v[148:151], v[224:227]
    ds_read_b128 v[128:131], v234 offset:32768
    ds_read_b128 v[132:135], v234 offset:34816
    ds_read_b128 v[136:139], v234 offset:36864
    ds_read_b128 v[140:143], v234 offset:38912
    ds_read_b64_tr_b16 v[168:169], v238 offset:0
    ds_read_b64_tr_b16 v[170:171], v238 offset:4608
    s_waitcnt lgkmcnt(10)
    v_mfma_f32_16x16x32_bf16 v[80:83], v[180:183], v[144:147], v[80:83]
    v_mfma_f32_16x16x32_bf16 v[84:87], v[180:183], v[148:151], v[84:87]
    v_mfma_f32_16x16x32_bf16 v[88:91], v[180:183], v[152:155], v[88:91]
    v_mfma_f32_16x16x32_bf16 v[92:95], v[180:183], v[156:159], v[92:95]
    ds_read_b128 v[184:187], v240 offset:512
    ds_read_b64_tr_b16 v[192:193], v239 offset:0
    ds_read_b64_tr_b16 v[194:195], v239 offset:4608
    ds_read_b64_tr_b16 v[172:173], v238 offset:32
    ds_read_b64_tr_b16 v[174:175], v238 offset:4640
    s_waitcnt lgkmcnt(13)
    v_mfma_f32_16x16x32_bf16 v[96:99], v[160:163], v[144:147], v[96:99]
    v_mfma_f32_16x16x32_bf16 v[100:103], v[160:163], v[148:151], v[100:103]
    v_mfma_f32_16x16x32_bf16 v[104:107], v[160:163], v[152:155], v[104:107]
    v_mfma_f32_16x16x32_bf16 v[108:111], v[160:163], v[156:159], v[108:111]
    ds_read_b64_tr_b16 v[176:177], v238 offset:64
    ds_read_b64_tr_b16 v[178:179], v238 offset:4672
    s_waitcnt lgkmcnt(13)
    v_mfma_f32_16x16x32_bf16 v[112:115], v[164:167], v[144:147], v[112:115]
    v_mfma_f32_16x16x32_bf16 v[116:119], v[164:167], v[148:151], v[116:119]
    v_mfma_f32_16x16x32_bf16 v[120:123], v[164:167], v[152:155], v[120:123]
    v_mfma_f32_16x16x32_bf16 v[124:127], v[164:167], v[156:159], v[124:127]
    ds_read_b64_tr_b16 v[180:181], v238 offset:96
    ds_read_b64_tr_b16 v[182:183], v238 offset:4704
    s_waitcnt vmcnt(2)
    s_barrier
    s_waitcnt lgkmcnt(9)
    v_mfma_f32_16x16x32_bf16 v[16:19], v[168:171], v[128:131], v[16:19]
    v_mfma_f32_16x16x32_bf16 v[20:23], v[168:171], v[132:135], v[20:23]
    v_mfma_f32_16x16x32_bf16 v[24:27], v[168:171], v[136:139], v[24:27]
    v_mfma_f32_16x16x32_bf16 v[28:31], v[168:171], v[140:143], v[28:31]
    ds_read_b64_tr_b16 v[160:161], v238 offset:128
    ds_read_b64_tr_b16 v[162:163], v238 offset:4736
    s_add_u32 m0, s53, 0
    s_nop 0
    buffer_load_dwordx4 v228, s[4:7], s49 offen lds
    s_waitcnt lgkmcnt(6)
    v_mfma_f32_16x16x32_bf16 v[32:35], v[172:175], v[128:131], v[32:35]
    v_mfma_f32_16x16x32_bf16 v[36:39], v[172:175], v[132:135], v[36:39]
    v_mfma_f32_16x16x32_bf16 v[40:43], v[172:175], v[136:139], v[40:43]
    v_mfma_f32_16x16x32_bf16 v[44:47], v[172:175], v[140:143], v[44:47]
    v_mfma_f32_16x16x32_bf16 v[200:203], v[184:187], v[128:131], v[200:203]
    v_mfma_f32_16x16x32_bf16 v[204:207], v[184:187], v[132:135], v[204:207]
    ds_read_b64_tr_b16 v[164:165], v238 offset:160
    ds_read_b64_tr_b16 v[166:167], v238 offset:4768
    s_add_u32 m0, s53, 1024
    s_nop 0
    buffer_load_dwordx4 v229, s[4:7], s49 offen lds
    s_waitcnt lgkmcnt(6)
    v_mfma_f32_16x16x32_bf16 v[48:51], v[176:179], v[128:131], v[48:51]
    v_mfma_f32_16x16x32_bf16 v[52:55], v[176:179], v[132:135], v[52:55]
    v_mfma_f32_16x16x32_bf16 v[56:59], v[176:179], v[136:139], v[56:59]
    v_mfma_f32_16x16x32_bf16 v[60:63], v[176:179], v[140:143], v[60:63]
    v_mfma_f32_16x16x32_bf16 v[208:211], v[192:195], v[216:219], v[208:211]
    ds_read_b64_tr_b16 v[168:169], v238 offset:192
    ds_read_b64_tr_b16 v[170:171], v238 offset:4800
    s_add_u32 m0, s53, 2048
    s_nop 0
    buffer_load_dwordx4 v230, s[4:7], s49 offen lds
    s_waitcnt lgkmcnt(6)
    v_mfma_f32_16x16x32_bf16 v[64:67], v[180:183], v[128:131], v[64:67]
    v_mfma_f32_16x16x32_bf16 v[68:71], v[180:183], v[132:135], v[68:71]
    v_mfma_f32_16x16x32_bf16 v[72:75], v[180:183], v[136:139], v[72:75]
    v_mfma_f32_16x16x32_bf16 v[76:79], v[180:183], v[140:143], v[76:79]
    v_mfma_f32_16x16x32_bf16 v[220:223], v[128:131], v[128:131], v[220:223]
    v_mfma_f32_16x16x32_bf16 v[224:227], v[132:135], v[132:135], v[224:227]
    ds_read_b128 v[144:147], v236 offset:32768
    ds_read_b128 v[148:151], v236 offset:34816
    ds_read_b128 v[152:155], v236 offset:36864
    ds_read_b128 v[156:159], v236 offset:38912
    ds_read_b64_tr_b16 v[172:173], v238 offset:9216
    ds_read_b64_tr_b16 v[174:175], v238 offset:13824
    s_add_u32 m0, s53, 3072
    s_nop 0
    buffer_load_dwordx4 v231, s[4:7], s49 offen lds
    s_add_u32 s49, s49, 128
    s_waitcnt lgkmcnt(10)
    v_mfma_f32_16x16x32_bf16 v[80:83], v[160:163], v[128:131], v[80:83]
    v_mfma_f32_16x16x32_bf16 v[84:87], v[160:163], v[132:135], v[84:87]
    v_mfma_f32_16x16x32_bf16 v[88:91], v[160:163], v[136:139], v[88:91]
    v_mfma_f32_16x16x32_bf16 v[92:95], v[160:163], v[140:143], v[92:95]
    ds_read_b128 v[188:191], v240 offset:576
    ds_read_b64_tr_b16 v[196:197], v239 offset:9216
    ds_read_b64_tr_b16 v[198:199], v239 offset:13824
    ds_read_b64_tr_b16 v[176:177], v238 offset:9248
    ds_read_b64_tr_b16 v[178:179], v238 offset:13856
    s_add_u32 m0, s54, 27648
    s_nop 0
    buffer_load_dwordx4 v232, s[8:11], s50 offen lds
    s_add_u32 s50, s50, 294912
    s_waitcnt lgkmcnt(13)
    v_mfma_f32_16x16x32_bf16 v[96:99], v[164:167], v[128:131], v[96:99]
    v_mfma_f32_16x16x32_bf16 v[100:103], v[164:167], v[132:135], v[100:103]
    v_mfma_f32_16x16x32_bf16 v[104:107], v[164:167], v[136:139], v[104:107]
    v_mfma_f32_16x16x32_bf16 v[108:111], v[164:167], v[140:143], v[108:111]
    ds_read_b64_tr_b16 v[180:181], v238 offset:9280
    ds_read_b64_tr_b16 v[182:183], v238 offset:13888
    s_mov_b32 m0, s67
    s_nop 0
    buffer_load_dwordx4 v233, s[12:15], s51 offen lds
    s_add_u32 s51, s51, s52
    s_waitcnt lgkmcnt(13)
    v_mfma_f32_16x16x32_bf16 v[112:115], v[168:171], v[128:131], v[112:115]
    v_mfma_f32_16x16x32_bf16 v[116:119], v[168:171], v[132:135], v[116:119]
    v_mfma_f32_16x16x32_bf16 v[120:123], v[168:171], v[136:139], v[120:123]
    v_mfma_f32_16x16x32_bf16 v[124:127], v[168:171], v[140:143], v[124:127]
    ds_read_b64_tr_b16 v[160:161], v238 offset:9312
    ds_read_b64_tr_b16 v[162:163], v238 offset:13920
    s_waitcnt vmcnt(6)
    s_barrier
    s_waitcnt lgkmcnt(9)
    v_mfma_f32_16x16x32_bf16 v[16:19], v[172:175], v[144:147], v[16:19]
    v_mfma_f32_16x16x32_bf16 v[20:23], v[172:175], v[148:151], v[20:23]
    v_mfma_f32_16x16x32_bf16 v[24:27], v[172:175], v[152:155], v[24:27]
    v_mfma_f32_16x16x32_bf16 v[28:31], v[172:175], v[156:159], v[28:31]
    ds_read_b64_tr_b16 v[164:165], v238 offset:9344
    ds_read_b64_tr_b16 v[166:167], v238 offset:13952
    s_add_u32 m0, s54, 0
    s_nop 0
    buffer_load_dwordx4 v232, s[8:11], s50 offen lds
    s_add_u32 s50, s50, 294912
    s_waitcnt lgkmcnt(6)
    v_mfma_f32_16x16x32_bf16 v[32:35], v[176:179], v[144:147], v[32:35]
    v_mfma_f32_16x16x32_bf16 v[36:39], v[176:179], v[148:151], v[36:39]
    v_mfma_f32_16x16x32_bf16 v[40:43], v[176:179], v[152:155], v[40:43]
    v_mfma_f32_16x16x32_bf16 v[44:47], v[176:179], v[156:159], v[44:47]
    v_mfma_f32_16x16x32_bf16 v[200:203], v[188:191], v[144:147], v[200:203]
    v_mfma_f32_16x16x32_bf16 v[204:207], v[188:191], v[148:151], v[204:207]
    ds_read_b64_tr_b16 v[168:169], v238 offset:9376
    ds_read_b64_tr_b16 v[170:171], v238 offset:13984
    s_mov_b32 m0, s64
    s_nop 0
    buffer_load_dwordx4 v233, s[12:15], s51 offen lds
    s_add_u32 s51, s51, s52
    s_waitcnt lgkmcnt(6)
    v_mfma_f32_16x16x32_bf16 v[48:51], v[180:183], v[144:147], v[48:51]
    v_mfma_f32_16x16x32_bf16 v[52:55], v[180:183], v[148:151], v[52:55]
    v_mfma_f32_16x16x32_bf16 v[56:59], v[180:183], v[152:155], v[56:59]
    v_mfma_f32_16x16x32_bf16 v[60:63], v[180:183], v[156:159], v[60:63]
    v_mfma_f32_16x16x32_bf16 v[208:211], v[196:199], v[216:219], v[208:211]
    ds_read_b64_tr_b16 v[172:173], v238 offset:9408
    ds_read_b64_tr_b16 v[174:175], v238 offset:14016
    s_waitcnt lgkmcnt(6)
    v_mfma_f32_16x16x32_bf16 v[64:67], v[160:163], v[144:147], v[64:67]
    v_mfma_f32_16x16x32_bf16 v[68:71], v[160:163], v[148:151], v[68:71]
    v_mfma_f32_16x16x32_bf16 v[72:75], v[160:163], v[152:155], v[72:75]
    v_mfma_f32_16x16x32_bf16 v[76:79], v[160:163], v[156:159], v[76:79]
    v_mfma_f32_16x16x32_bf16 v[220:223], v[144:147], v[144:147], v[220:223]
    v_mfma_f32_16x16x32_bf16 v[224:227], v[148:151], v[148:151], v[224:227]
    ds_read_b128 v[128:131], v235 offset:0
    ds_read_b128 v[132:135], v235 offset:2048
    ds_read_b128 v[136:139], v235 offset:4096
    ds_read_b128 v[140:143], v235 offset:6144
    ds_read_b64_tr_b16 v[176:177], v238 offset:18432
    ds_read_b64_tr_b16 v[178:179], v238 offset:23040
    s_waitcnt lgkmcnt(10)
    v_mfma_f32_16x16x32_bf16 v[80:83], v[164:167], v[144:147], v[80:83]
    v_mfma_f32_16x16x32_bf16 v[84:87], v[164:167], v[148:151], v[84:87]
    v_mfma_f32_16x16x32_bf16 v[88:91], v[164:167], v[152:155], v[88:91]
    v_mfma_f32_16x16x32_bf16 v[92:95], v[164:167], v[156:159], v[92:95]
    ds_read_b128 v[184:187], v240 offset:640
    ds_read_b64_tr_b16 v[192:193], v239 offset:18432
    ds_read_b64_tr_b16 v[194:195], v239 offset:23040
    ds_read_b64_tr_b16 v[180:181], v238 offset:18464
    ds_read_b64_tr_b16 v[182:183], v238 offset:23072
    s_waitcnt lgkmcnt(13)
    v_mfma_f32_16x16x32_bf16 v[96:99], v[168:171], v[144:147], v[96:99]
    v_mfma_f32_16x16x32_bf16 v[100:103], v[168:171], v[148:151], v[100:103]
    v_mfma_f32_16x16x32_bf16 v[104:107], v[168:171], v[152:155], v[104:107]
    v_mfma_f32_16x16x32_bf16 v[108:111], v[168:171], v[156:159], v[108:111]
    ds_read_b64_tr_b16 v[160:161], v238 offset:18496
    ds_read_b64_tr_b16 v[162:163], v238 offset:23104
    s_waitcnt lgkmcnt(13)
    v_mfma_f32_16x16x32_bf16 v[112:115], v[172:175], v[144:147], v[112:115]
    v_mfma_f32_16x16x32_bf16 v[116:119], v[172:175], v[148:151], v[116:119]
    v_mfma_f32_16x16x32_bf16 v[120:123], v[172:175], v[152:155], v[120:123]
    v_mfma_f32_16x16x32_bf16 v[124:127], v[172:175], v[156:159], v[124:127]
    ds_read_b64_tr_b16 v[164:165], v238 offset:18528
    ds_read_b64_tr_b16 v[166:167], v238 offset:23136
    s_waitcnt vmcnt(2)
    s_barrier
    s_waitcnt lgkmcnt(9)
    v_mfma_f32_16x16x32_bf16 v[16:19], v[176:179], v[128:131], v[16:19]
    v_mfma_f32_16x16x32_bf16 v[20:23], v[176:179], v[132:135], v[20:23]
    v_mfma_f32_16x16x32_bf16 v[24:27], v[176:179], v[136:139], v[24:27]
    v_mfma_f32_16x16x32_bf16 v[28:31], v[176:179], v[140:143], v[28:31]
    ds_read_b64_tr_b16 v[168:169], v238 offset:18560
    ds_read_b64_tr_b16 v[170:171], v238 offset:23168
    s_add_u32 m0, s53, 32768
    s_nop 0
    buffer_load_dwordx4 v228, s[4:7], s49 offen lds
    s_waitcnt lgkmcnt(6)
    v_mfma_f32_16x16x32_bf16 v[32:35], v[180:183], v[128:131], v[32:35]
    v_mfma_f32_16x16x32_bf16 v[36:39], v[180:183], v[132:135], v[36:39]
    v_mfma_f32_16x16x32_bf16 v[40:43], v[180:183], v[136:139], v[40:43]
    v_mfma_f32_16x16x32_bf16 v[44:47], v[180:183], v[140:143], v[44:47]
    v_mfma_f32_16x16x32_bf16 v[200:203], v[184:187], v[128:131], v[200:203]
    v_mfma_f32_16x16x32_bf16 v[204:207], v[184:187], v[132:135], v[204:207]
    ds_read_b64_tr_b16 v[172:173], v238 offset:18592
    ds_read_b64_tr_b16 v[174:175], v238 offset:23200
    s_add_u32 m0, s53, 33792
    s_nop 0
    buffer_load_dwordx4 v229, s[4:7], s49 offen lds
    s_waitcnt lgkmcnt(6)
    v_mfma_f32_16x16x32_bf16 v[48:51], v[160:163], v[128:131], v[48:51]
    v_mfma_f32_16x16x32_bf16 v[52:55], v[160:163], v[132:135], v[52:55]
    v_mfma_f32_16x16x32_bf16 v[56:59], v[160:163], v[136:139], v[56:59]
    v_mfma_f32_16x16x32_bf16 v[60:63], v[160:163], v[140:143], v[60:63]
    v_mfma_f32_16x16x32_bf16 v[208:211], v[192:195], v[216:219], v[208:211]
    ds_read_b64_tr_b16 v[176:177], v238 offset:18624
    ds_read_b64_tr_b16 v[178:179], v238 offset:23232
    s_add_u32 m0, s53, 34816
    s_nop 0
    buffer_load_dwordx4 v230, s[4:7], s49 offen lds
    s_waitcnt lgkmcnt(6)
    v_mfma_f32_16x16x32_bf16 v[64:67], v[164:167], v[128:131], v[64:67]
    v_mfma_f32_16x16x32_bf16 v[68:71], v[164:167], v[132:135], v[68:71]
    v_mfma_f32_16x16x32_bf16 v[72:75], v[164:167], v[136:139], v[72:75]
    v_mfma_f32_16x16x32_bf16 v[76:79], v[164:167], v[140:143], v[76:79]
    v_mfma_f32_16x16x32_bf16 v[220:223], v[128:131], v[128:131], v[220:223]
    v_mfma_f32_16x16x32_bf16 v[224:227], v[132:135], v[132:135], v[224:227]
    ds_read_b128 v[144:147], v237 offset:0
    ds_read_b128 v[148:151], v237 offset:2048
    ds_read_b128 v[152:155], v237 offset:4096
    ds_read_b128 v[156:159], v237 offset:6144
    ds_read_b64_tr_b16 v[180:181], v238 offset:27648
    ds_read_b64_tr_b16 v[182:183], v238 offset:32256
    s_add_u32 m0, s53, 35840
    s_nop 0
    buffer_load_dwordx4 v231, s[4:7], s49 offen lds
    s_add_u32 s49, s49, 128
    s_waitcnt lgkmcnt(10)
    v_mfma_f32_16x16x32_bf16 v[80:83], v[168:171], v[128:131], v[80:83]
    v_mfma_f32_16x16x32_bf16 v[84:87], v[168:171], v[132:135], v[84:87]
    v_mfma_f32_16x16x32_bf16 v[88:91], v[168:171], v[136:139], v[88:91]
    v_mfma_f32_16x16x32_bf16 v[92:95], v[168:171], v[140:143], v[92:95]
    ds_read_b128 v[188:191], v240 offset:704
    ds_read_b64_tr_b16 v[196:197], v239 offset:27648
    ds_read_b64_tr_b16 v[198:199], v239 offset:32256
    ds_read_b64_tr_b16 v[160:161], v238 offset:27680
    ds_read_b64_tr_b16 v[162:163], v238 offset:32288
    s_add_u32 m0, s54, 9216
    s_nop 0
    buffer_load_dwordx4 v232, s[8:11], s50 offen lds
    s_add_u32 s50, s50, 294912
    s_waitcnt lgkmcnt(13)
    v_mfma_f32_16x16x32_bf16 v[96:99], v[172:175], v[128:131], v[96:99]
    v_mfma_f32_16x16x32_bf16 v[100:103], v[172:175], v[132:135], v[100:103]
    v_mfma_f32_16x16x32_bf16 v[104:107], v[172:175], v[136:139], v[104:107]
    v_mfma_f32_16x16x32_bf16 v[108:111], v[172:175], v[140:143], v[108:111]
    ds_read_b64_tr_b16 v[164:165], v238 offset:27712
    ds_read_b64_tr_b16 v[166:167], v238 offset:32320
    s_mov_b32 m0, s65
    s_nop 0
    buffer_load_dwordx4 v233, s[12:15], s51 offen lds
    s_add_u32 s51, s51, s52
    s_waitcnt lgkmcnt(13)
    v_mfma_f32_16x16x32_bf16 v[112:115], v[176:179], v[128:131], v[112:115]
    v_mfma_f32_16x16x32_bf16 v[116:119], v[176:179], v[132:135], v[116:119]
    v_mfma_f32_16x16x32_bf16 v[120:123], v[176:179], v[136:139], v[120:123]
    v_mfma_f32_16x16x32_bf16 v[124:127], v[176:179], v[140:143], v[124:127]
    ds_read_b64_tr_b16 v[168:169], v238 offset:27744
    ds_read_b64_tr_b16 v[170:171], v238 offset:32352
    s_waitcnt vmcnt(6)
    s_barrier
    s_waitcnt lgkmcnt(9)
    v_mfma_f32_16x16x32_bf16 v[16:19], v[180:183], v[144:147], v[16:19]
    v_mfma_f32_16x16x32_bf16 v[20:23], v[180:183], v[148:151], v[20:23]
    v_mfma_f32_16x16x32_bf16 v[24:27], v[180:183], v[152:155], v[24:27]
    v_mfma_f32_16x16x32_bf16 v[28:31], v[180:183], v[156:159], v[28:31]
    ds_read_b64_tr_b16 v[172:173], v238 offset:27776
    ds_read_b64_tr_b16 v[174:175], v238 offset:32384
    s_add_u32 m0, s54, 18432
    s_nop 0
    buffer_load_dwordx4 v232, s[8:11], s50 offen lds
    s_add_u32 s50, s50, 294912
    s_waitcnt lgkmcnt(6)
    v_mfma_f32_16x16x32_bf16 v[32:35], v[160:163], v[144:147], v[32:35]
    v_mfma_f32_16x16x32_bf16 v[36:39], v[160:163], v[148:151], v[36:39]
    v_mfma_f32_16x16x32_bf16 v[40:43], v[160:163], v[152:155], v[40:43]
    v_mfma_f32_16x16x32_bf16 v[44:47], v[160:163], v[156:159], v[44:47]
    v_mfma_f32_16x16x32_bf16 v[200:203], v[188:191], v[144:147], v[200:203]
    v_mfma_f32_16x16x32_bf16 v[204:207], v[188:191], v[148:151], v[204:207]
    ds_read_b64_tr_b16 v[176:177], v238 offset:27808
    ds_read_b64_tr_b16 v[178:179], v238 offset:32416
    s_mov_b32 m0, s66
    s_nop 0
    buffer_load_dwordx4 v233, s[12:15], s51 offen lds
    s_add_u32 s51, s51, s52
    s_waitcnt lgkmcnt(6)
    v_mfma_f32_16x16x32_bf16 v[48:51], v[164:167], v[144:147], v[48:51]
    v_mfma_f32_16x16x32_bf16 v[52:55], v[164:167], v[148:151], v[52:55]
    v_mfma_f32_16x16x32_bf16 v[56:59], v[164:167], v[152:155], v[56:59]
    v_mfma_f32_16x16x32_bf16 v[60:63], v[164:167], v[156:159], v[60:63]
    v_mfma_f32_16x16x32_bf16 v[208:211], v[196:199], v[216:219], v[208:211]
    ds_read_b64_tr_b16 v[180:181], v238 offset:27840
    ds_read_b64_tr_b16 v[182:183], v238 offset:32448
    s_waitcnt lgkmcnt(6)
    v_mfma_f32_16x16x32_bf16 v[64:67], v[168:171], v[144:147], v[64:67]
    v_mfma_f32_16x16x32_bf16 v[68:71], v[168:171], v[148:151], v[68:71]
    v_mfma_f32_16x16x32_bf16 v[72:75], v[168:171], v[152:155], v[72:75]
    v_mfma_f32_16x16x32_bf16 v[76:79], v[168:171], v[156:159], v[76:79]
    v_mfma_f32_16x16x32_bf16 v[220:223], v[144:147], v[144:147], v[220:223]
    v_mfma_f32_16x16x32_bf16 v[224:227], v[148:151], v[148:151], v[224:227]
    ds_read_b128 v[128:131], v234 offset:0
    ds_read_b128 v[132:135], v234 offset:2048
    ds_read_b128 v[136:139], v234 offset:4096
    ds_read_b128 v[140:143], v234 offset:6144
    ds_read_b64_tr_b16 v[160:161], v238 offset:0
    ds_read_b64_tr_b16 v[162:163], v238 offset:4608
    s_waitcnt lgkmcnt(10)
    v_mfma_f32_16x16x32_bf16 v[80:83], v[172:175], v[144:147], v[80:83]
    v_mfma_f32_16x16x32_bf16 v[84:87], v[172:175], v[148:151], v[84:87]
    v_mfma_f32_16x16x32_bf16 v[88:91], v[172:175], v[152:155], v[88:91]
    v_mfma_f32_16x16x32_bf16 v[92:95], v[172:175], v[156:159], v[92:95]
    ds_read_b128 v[184:187], v240 offset:768
    ds_read_b64_tr_b16 v[192:193], v239 offset:0
    ds_read_b64_tr_b16 v[194:195], v239 offset:4608
    ds_read_b64_tr_b16 v[164:165], v238 offset:32
    ds_read_b64_tr_b16 v[166:167], v238 offset:4640
    s_waitcnt lgkmcnt(13)
    v_mfma_f32_16x16x32_bf16 v[96:99], v[176:179], v[144:147], v[96:99]
    v_mfma_f32_16x16x32_bf16 v[100:103], v[176:179], v[148:151], v[100:103]
    v_mfma_f32_16x16x32_bf16 v[104:107], v[176:179], v[152:155], v[104:107]
    v_mfma_f32_16x16x32_bf16 v[108:111], v[176:179], v[156:159], v[108:111]
    ds_read_b64_tr_b16 v[168:169], v238 offset:64
    ds_read_b64_tr_b16 v[170:171], v238 offset:4672
    s_waitcnt lgkmcnt(13)
    v_mfma_f32_16x16x32_bf16 v[112:115], v[180:183], v[144:147], v[112:115]
    v_mfma_f32_16x16x32_bf16 v[116:119], v[180:183], v[148:151], v[116:119]
    v_mfma_f32_16x16x32_bf16 v[120:123], v[180:183], v[152:155], v[120:123]
    v_mfma_f32_16x16x32_bf16 v[124:127], v[180:183], v[156:159], v[124:127]
    ds_read_b64_tr_b16 v[172:173], v238 offset:96
    ds_read_b64_tr_b16 v[174:175], v238 offset:4704
    s_waitcnt vmcnt(2)
    s_barrier
    s_waitcnt lgkmcnt(9)
    v_mfma_f32_16x16x32_bf16 v[16:19], v[160:163], v[128:131], v[16:19]
    v_mfma_f32_16x16x32_bf16 v[20:23], v[160:163], v[132:135], v[20:23]
    v_mfma_f32_16x16x32_bf16 v[24:27], v[160:163], v[136:139], v[24:27]
    v_mfma_f32_16x16x32_bf16 v[28:31], v[160:163], v[140:143], v[28:31]
    ds_read_b64_tr_b16 v[176:177], v238 offset:128
    ds_read_b64_tr_b16 v[178:179], v238 offset:4736
    s_add_u32 m0, s53, 65536
    s_nop 0
    buffer_load_dwordx4 v228, s[4:7], s49 offen lds
    s_waitcnt lgkmcnt(6)
    v_mfma_f32_16x16x32_bf16 v[32:35], v[164:167], v[128:131], v[32:35]
    v_mfma_f32_16x16x32_bf16 v[36:39], v[164:167], v[132:135], v[36:39]
    v_mfma_f32_16x16x32_bf16 v[40:43], v[164:167], v[136:139], v[40:43]
    v_mfma_f32_16x16x32_bf16 v[44:47], v[164:167], v[140:143], v[44:47]
    v_mfma_f32_16x16x32_bf16 v[200:203], v[184:187], v[128:131], v[200:203]
    v_mfma_f32_16x16x32_bf16 v[204:207], v[184:187], v[132:135], v[204:207]
    ds_read_b64_tr_b16 v[180:181], v238 offset:160
    ds_read_b64_tr_b16 v[182:183], v238 offset:4768
    s_add_u32 m0, s53, 66560
    s_nop 0
    buffer_load_dwordx4 v229, s[4:7], s49 offen lds
    s_waitcnt lgkmcnt(6)
    v_mfma_f32_16x16x32_bf16 v[48:51], v[168:171], v[128:131], v[48:51]
    v_mfma_f32_16x16x32_bf16 v[52:55], v[168:171], v[132:135], v[52:55]
    v_mfma_f32_16x16x32_bf16 v[56:59], v[168:171], v[136:139], v[56:59]
    v_mfma_f32_16x16x32_bf16 v[60:63], v[168:171], v[140:143], v[60:63]
    v_mfma_f32_16x16x32_bf16 v[208:211], v[192:195], v[216:219], v[208:211]
    ds_read_b64_tr_b16 v[160:161], v238 offset:192
    ds_read_b64_tr_b16 v[162:163], v238 offset:4800
    s_add_u32 m0, s53, 67584
    s_nop 0
    buffer_load_dwordx4 v230, s[4:7], s49 offen lds
    s_waitcnt lgkmcnt(6)
    v_mfma_f32_16x16x32_bf16 v[64:67], v[172:175], v[128:131], v[64:67]
    v_mfma_f32_16x16x32_bf16 v[68:71], v[172:175], v[132:135], v[68:71]
    v_mfma_f32_16x16x32_bf16 v[72:75], v[172:175], v[136:139], v[72:75]
    v_mfma_f32_16x16x32_bf16 v[76:79], v[172:175], v[140:143], v[76:79]
    v_mfma_f32_16x16x32_bf16 v[220:223], v[128:131], v[128:131], v[220:223]
    v_mfma_f32_16x16x32_bf16 v[224:227], v[132:135], v[132:135], v[224:227]
    ds_read_b128 v[144:147], v236 offset:0
    ds_read_b128 v[148:151], v236 offset:2048
    ds_read_b128 v[152:155], v236 offset:4096
    ds_read_b128 v[156:159], v236 offset:6144
    ds_read_b64_tr_b16 v[164:165], v238 offset:9216
    ds_read_b64_tr_b16 v[166:167], v238 offset:13824
    s_add_u32 m0, s53, 68608
    s_nop 0
    buffer_load_dwordx4 v231, s[4:7], s49 offen lds
    s_add_u32 s49, s49, 128
    s_waitcnt lgkmcnt(10)
    v_mfma_f32_16x16x32_bf16 v[80:83], v[176:179], v[128:131], v[80:83]
    v_mfma_f32_16x16x32_bf16 v[84:87], v[176:179], v[132:135], v[84:87]
    v_mfma_f32_16x16x32_bf16 v[88:91], v[176:179], v[136:139], v[88:91]
    v_mfma_f32_16x16x32_bf16 v[92:95], v[176:179], v[140:143], v[92:95]
    ds_read_b128 v[188:191], v240 offset:832
    ds_read_b64_tr_b16 v[196:197], v239 offset:9216
    ds_read_b64_tr_b16 v[198:199], v239 offset:13824
    ds_read_b64_tr_b16 v[168:169], v238 offset:9248
    ds_read_b64_tr_b16 v[170:171], v238 offset:13856
    s_add_u32 m0, s54, 27648
    s_nop 0
    buffer_load_dwordx4 v232, s[8:11], s50 offen lds
    s_add_u32 s50, s50, 294912
    s_waitcnt lgkmcnt(13)
    v_mfma_f32_16x16x32_bf16 v[96:99], v[180:183], v[128:131], v[96:99]
    v_mfma_f32_16x16x32_bf16 v[100:103], v[180:183], v[132:135], v[100:103]
    v_mfma_f32_16x16x32_bf16 v[104:107], v[180:183], v[136:139], v[104:107]
    v_mfma_f32_16x16x32_bf16 v[108:111], v[180:183], v[140:143], v[108:111]
    ds_read_b64_tr_b16 v[172:173], v238 offset:9280
    ds_read_b64_tr_b16 v[174:175], v238 offset:13888
    s_mov_b32 m0, s67
    s_nop 0
    buffer_load_dwordx4 v233, s[12:15], s51 offen lds
    s_add_u32 s51, s51, s52
    s_waitcnt lgkmcnt(13)
    v_mfma_f32_16x16x32_bf16 v[112:115], v[160:163], v[128:131], v[112:115]
    v_mfma_f32_16x16x32_bf16 v[116:119], v[160:163], v[132:135], v[116:119]
    v_mfma_f32_16x16x32_bf16 v[120:123], v[160:163], v[136:139], v[120:123]
    v_mfma_f32_16x16x32_bf16 v[124:127], v[160:163], v[140:143], v[124:127]
    ds_read_b64_tr_b16 v[176:177], v238 offset:9312
    ds_read_b64_tr_b16 v[178:179], v238 offset:13920
    s_waitcnt vmcnt(6)
    s_barrier
    s_waitcnt lgkmcnt(9)
    v_mfma_f32_16x16x32_bf16 v[16:19], v[164:167], v[144:147], v[16:19]
    v_mfma_f32_16x16x32_bf16 v[20:23], v[164:167], v[148:151], v[20:23]
    v_mfma_f32_16x16x32_bf16 v[24:27], v[164:167], v[152:155], v[24:27]
    v_mfma_f32_16x16x32_bf16 v[28:31], v[164:167], v[156:159], v[28:31]
    ds_read_b64_tr_b16 v[180:181], v238 offset:9344
    ds_read_b64_tr_b16 v[182:183], v238 offset:13952
    s_add_u32 m0, s54, 0
    s_nop 0
    buffer_load_dwordx4 v232, s[8:11], s50 offen lds
    s_add_u32 s50, s50, 294912
    s_waitcnt lgkmcnt(6)
    v_mfma_f32_16x16x32_bf16 v[32:35], v[168:171], v[144:147], v[32:35]
    v_mfma_f32_16x16x32_bf16 v[36:39], v[168:171], v[148:151], v[36:39]
    v_mfma_f32_16x16x32_bf16 v[40:43], v[168:171], v[152:155], v[40:43]
    v_mfma_f32_16x16x32_bf16 v[44:47], v[168:171], v[156:159], v[44:47]
    v_mfma_f32_16x16x32_bf16 v[200:203], v[188:191], v[144:147], v[200:203]
    v_mfma_f32_16x16x32_bf16 v[204:207], v[188:191], v[148:151], v[204:207]
    ds_read_b64_tr_b16 v[160:161], v238 offset:9376
    ds_read_b64_tr_b16 v[162:163], v238 offset:13984
    s_mov_b32 m0, s64
    s_nop 0
    buffer_load_dwordx4 v233, s[12:15], s51 offen lds
    s_add_u32 s51, s51, s52
    s_waitcnt lgkmcnt(6)
    v_mfma_f32_16x16x32_bf16 v[48:51], v[172:175], v[144:147], v[48:51]
    v_mfma_f32_16x16x32_bf16 v[52:55], v[172:175], v[148:151], v[52:55]
    v_mfma_f32_16x16x32_bf16 v[56:59], v[172:175], v[152:155], v[56:59]
    v_mfma_f32_16x16x32_bf16 v[60:63], v[172:175], v[156:159], v[60:63]
    v_mfma_f32_16x16x32_bf16 v[208:211], v[196:199], v[216:219], v[208:211]
    ds_read_b64_tr_b16 v[164:165], v238 offset:9408
    ds_read_b64_tr_b16 v[166:167], v238 offset:14016
    s_waitcnt lgkmcnt(6)
    v_mfma_f32_16x16x32_bf16 v[64:67], v[176:179], v[144:147], v[64:67]
    v_mfma_f32_16x16x32_bf16 v[68:71], v[176:179], v[148:151], v[68:71]
    v_mfma_f32_16x16x32_bf16 v[72:75], v[176:179], v[152:155], v[72:75]
    v_mfma_f32_16x16x32_bf16 v[76:79], v[176:179], v[156:159], v[76:79]
    v_mfma_f32_16x16x32_bf16 v[220:223], v[144:147], v[144:147], v[220:223]
    v_mfma_f32_16x16x32_bf16 v[224:227], v[148:151], v[148:151], v[224:227]
    ds_read_b128 v[128:131], v234 offset:32768
    ds_read_b128 v[132:135], v234 offset:34816
    ds_read_b128 v[136:139], v234 offset:36864
    ds_read_b128 v[140:143], v234 offset:38912
    ds_read_b64_tr_b16 v[168:169], v238 offset:18432
    ds_read_b64_tr_b16 v[170:171], v238 offset:23040
    s_waitcnt lgkmcnt(10)
    v_mfma_f32_16x16x32_bf16 v[80:83], v[180:183], v[144:147], v[80:83]
    v_mfma_f32_16x16x32_bf16 v[84:87], v[180:183], v[148:151], v[84:87]
    v_mfma_f32_16x16x32_bf16 v[88:91], v[180:183], v[152:155], v[88:91]
    v_mfma_f32_16x16x32_bf16 v[92:95], v[180:183], v[156:159], v[92:95]
    ds_read_b128 v[184:187], v240 offset:896
    ds_read_b64_tr_b16 v[192:193], v239 offset:18432
    ds_read_b64_tr_b16 v[194:195], v239 offset:23040
    ds_read_b64_tr_b16 v[172:173], v238 offset:18464
    ds_read_b64_tr_b16 v[174:175], v238 offset:23072
    s_waitcnt lgkmcnt(13)
    v_mfma_f32_16x16x32_bf16 v[96:99], v[160:163], v[144:147], v[96:99]
    v_mfma_f32_16x16x32_bf16 v[100:103], v[160:163], v[148:151], v[100:103]
    v_mfma_f32_16x16x32_bf16 v[104:107], v[160:163], v[152:155], v[104:107]
    v_mfma_f32_16x16x32_bf16 v[108:111], v[160:163], v[156:159], v[108:111]
    ds_read_b64_tr_b16 v[176:177], v238 offset:18496
    ds_read_b64_tr_b16 v[178:179], v238 offset:23104
    s_waitcnt lgkmcnt(13)
    v_mfma_f32_16x16x32_bf16 v[112:115], v[164:167], v[144:147], v[112:115]
    v_mfma_f32_16x16x32_bf16 v[116:119], v[164:167], v[148:151], v[116:119]
    v_mfma_f32_16x16x32_bf16 v[120:123], v[164:167], v[152:155], v[120:123]
    v_mfma_f32_16x16x32_bf16 v[124:127], v[164:167], v[156:159], v[124:127]
    ds_read_b64_tr_b16 v[180:181], v238 offset:18528
    ds_read_b64_tr_b16 v[182:183], v238 offset:23136
    s_waitcnt vmcnt(2)
    s_barrier
    s_waitcnt lgkmcnt(9)
    v_mfma_f32_16x16x32_bf16 v[16:19], v[168:171], v[128:131], v[16:19]
    v_mfma_f32_16x16x32_bf16 v[20:23], v[168:171], v[132:135], v[20:23]
    v_mfma_f32_16x16x32_bf16 v[24:27], v[168:171], v[136:139], v[24:27]
    v_mfma_f32_16x16x32_bf16 v[28:31], v[168:171], v[140:143], v[28:31]
    ds_read_b64_tr_b16 v[160:161], v238 offset:18560
    ds_read_b64_tr_b16 v[162:163], v238 offset:23168
    s_add_u32 m0, s54, 9216
    s_nop 0
    buffer_load_dwordx4 v232, s[8:11], s50 offen lds
    s_add_u32 s50, s50, 294912
    s_waitcnt lgkmcnt(6)
    v_mfma_f32_16x16x32_bf16 v[32:35], v[172:175], v[128:131], v[32:35]
    v_mfma_f32_16x16x32_bf16 v[36:39], v[172:175], v[132:135], v[36:39]
    v_mfma_f32_16x16x32_bf16 v[40:43], v[172:175], v[136:139], v[40:43]
    v_mfma_f32_16x16x32_bf16 v[44:47], v[172:175], v[140:143], v[44:47]
    v_mfma_f32_16x16x32_bf16 v[200:203], v[184:187], v[128:131], v[200:203]
    v_mfma_f32_16x16x32_bf16 v[204:207], v[184:187], v[132:135], v[204:207]
    ds_read_b64_tr_b16 v[164:165], v238 offset:18592
    ds_read_b64_tr_b16 v[166:167], v238 offset:23200
    s_mov_b32 m0, s65
    s_nop 0
    buffer_load_dwordx4 v233, s[12:15], s51 offen lds
    s_add_u32 s51, s51, s52
    s_waitcnt lgkmcnt(6)
    v_mfma_f32_16x16x32_bf16 v[48:51], v[176:179], v[128:131], v[48:51]
    v_mfma_f32_16x16x32_bf16 v[52:55], v[176:179], v[132:135], v[52:55]
    v_mfma_f32_16x16x32_bf16 v[56:59], v[176:179], v[136:139], v[56:59]
    v_mfma_f32_16x16x32_bf16 v[60:63], v[176:179], v[140:143], v[60:63]
    v_mfma_f32_16x16x32_bf16 v[208:211], v[192:195], v[216:219], v[208:211]
    ds_read_b64_tr_b16 v[168:169], v238 offset:18624
    ds_read_b64_tr_b16 v[170:171], v238 offset:23232
    s_waitcnt lgkmcnt(6)
    v_mfma_f32_16x16x32_bf16 v[64:67], v[180:183], v[128:131], v[64:67]
    v_mfma_f32_16x16x32_bf16 v[68:71], v[180:183], v[132:135], v[68:71]
    v_mfma_f32_16x16x32_bf16 v[72:75], v[180:183], v[136:139], v[72:75]
    v_mfma_f32_16x16x32_bf16 v[76:79], v[180:183], v[140:143], v[76:79]
    v_mfma_f32_16x16x32_bf16 v[220:223], v[128:131], v[128:131], v[220:223]
    v_mfma_f32_16x16x32_bf16 v[224:227], v[132:135], v[132:135], v[224:227]
    ds_read_b128 v[144:147], v236 offset:32768
    ds_read_b128 v[148:151], v236 offset:34816
    ds_read_b128 v[152:155], v236 offset:36864
    ds_read_b128 v[156:159], v236 offset:38912
    ds_read_b64_tr_b16 v[172:173], v238 offset:27648
    ds_read_b64_tr_b16 v[174:175], v238 offset:32256
    s_waitcnt lgkmcnt(10)
    v_mfma_f32_16x16x32_bf16 v[80:83], v[160:163], v[128:131], v[80:83]
    v_mfma_f32_16x16x32_bf16 v[84:87], v[160:163], v[132:135], v[84:87]
    v_mfma_f32_16x16x32_bf16 v[88:91], v[160:163], v[136:139], v[88:91]
    v_mfma_f32_16x16x32_bf16 v[92:95], v[160:163], v[140:143], v[92:95]
    ds_read_b128 v[188:191], v240 offset:960
    ds_read_b64_tr_b16 v[196:197], v239 offset:27648
    ds_read_b64_tr_b16 v[198:199], v239 offset:32256
    ds_read_b64_tr_b16 v[176:177], v238 offset:27680
    ds_read_b64_tr_b16 v[178:179], v238 offset:32288
    s_waitcnt lgkmcnt(13)
    v_mfma_f32_16x16x32_bf16 v[96:99], v[164:167], v[128:131], v[96:99]
    v_mfma_f32_16x16x32_bf16 v[100:103], v[164:167], v[132:135], v[100:103]
    v_mfma_f32_16x16x32_bf16 v[104:107], v[164:167], v[136:139], v[104:107]
    v_mfma_f32_16x16x32_bf16 v[108:111], v[164:167], v[140:143], v[108:111]
    ds_read_b64_tr_b16 v[180:181], v238 offset:27712
    ds_read_b64_tr_b16 v[182:183], v238 offset:32320
    s_waitcnt lgkmcnt(13)
    v_mfma_f32_16x16x32_bf16 v[112:115], v[168:171], v[128:131], v[112:115]
    v_mfma_f32_16x16x32_bf16 v[116:119], v[168:171], v[132:135], v[116:119]
    v_mfma_f32_16x16x32_bf16 v[120:123], v[168:171], v[136:139], v[120:123]
    v_mfma_f32_16x16x32_bf16 v[124:127], v[168:171], v[140:143], v[124:127]
    ds_read_b64_tr_b16 v[160:161], v238 offset:27744
    ds_read_b64_tr_b16 v[162:163], v238 offset:32352
    s_waitcnt vmcnt(2)
    s_barrier
    s_waitcnt lgkmcnt(9)
    v_mfma_f32_16x16x32_bf16 v[16:19], v[172:175], v[144:147], v[16:19]
    v_mfma_f32_16x16x32_bf16 v[20:23], v[172:175], v[148:151], v[20:23]
    v_mfma_f32_16x16x32_bf16 v[24:27], v[172:175], v[152:155], v[24:27]
    v_mfma_f32_16x16x32_bf16 v[28:31], v[172:175], v[156:159], v[28:31]
    ds_read_b64_tr_b16 v[164:165], v238 offset:27776
    ds_read_b64_tr_b16 v[166:167], v238 offset:32384
    s_waitcnt lgkmcnt(6)
    v_mfma_f32_16x16x32_bf16 v[32:35], v[176:179], v[144:147], v[32:35]
    v_mfma_f32_16x16x32_bf16 v[36:39], v[176:179], v[148:151], v[36:39]
    v_mfma_f32_16x16x32_bf16 v[40:43], v[176:179], v[152:155], v[40:43]
    v_mfma_f32_16x16x32_bf16 v[44:47], v[176:179], v[156:159], v[44:47]
    v_mfma_f32_16x16x32_bf16 v[200:203], v[188:191], v[144:147], v[200:203]
    v_mfma_f32_16x16x32_bf16 v[204:207], v[188:191], v[148:151], v[204:207]
    ds_read_b64_tr_b16 v[168:169], v238 offset:27808
    ds_read_b64_tr_b16 v[170:171], v238 offset:32416
    s_waitcnt lgkmcnt(6)
    v_mfma_f32_16x16x32_bf16 v[48:51], v[180:183], v[144:147], v[48:51]
    v_mfma_f32_16x16x32_bf16 v[52:55], v[180:183], v[148:151], v[52:55]
    v_mfma_f32_16x16x32_bf16 v[56:59], v[180:183], v[152:155], v[56:59]
    v_mfma_f32_16x16x32_bf16 v[60:63], v[180:183], v[156:159], v[60:63]
    v_mfma_f32_16x16x32_bf16 v[208:211], v[196:199], v[216:219], v[208:211]
    ds_read_b64_tr_b16 v[172:173], v238 offset:27840
    ds_read_b64_tr_b16 v[174:175], v238 offset:32448
    s_waitcnt lgkmcnt(6)
    v_mfma_f32_16x16x32_bf16 v[64:67], v[160:163], v[144:147], v[64:67]
    v_mfma_f32_16x16x32_bf16 v[68:71], v[160:163], v[148:151], v[68:71]
    v_mfma_f32_16x16x32_bf16 v[72:75], v[160:163], v[152:155], v[72:75]
    v_mfma_f32_16x16x32_bf16 v[76:79], v[160:163], v[156:159], v[76:79]
    v_mfma_f32_16x16x32_bf16 v[220:223], v[144:147], v[144:147], v[220:223]
    v_mfma_f32_16x16x32_bf16 v[224:227], v[148:151], v[148:151], v[224:227]
    ds_read_b128 v[128:131], v235 offset:0
    ds_read_b128 v[132:135], v235 offset:2048
    ds_read_b128 v[136:139], v235 offset:4096
    ds_read_b128 v[140:143], v235 offset:6144
    ds_read_b64_tr_b16 v[176:177], v238 offset:0
    ds_read_b64_tr_b16 v[178:179], v238 offset:4608
    s_waitcnt lgkmcnt(10)
    v_mfma_f32_16x16x32_bf16 v[80:83], v[164:167], v[144:147], v[80:83]
    v_mfma_f32_16x16x32_bf16 v[84:87], v[164:167], v[148:151], v[84:87]
    v_mfma_f32_16x16x32_bf16 v[88:91], v[164:167], v[152:155], v[88:91]
    v_mfma_f32_16x16x32_bf16 v[92:95], v[164:167], v[156:159], v[92:95]
    ds_read_b128 v[184:187], v240 offset:1024
    ds_read_b64_tr_b16 v[192:193], v239 offset:0
    ds_read_b64_tr_b16 v[194:195], v239 offset:4608
    ds_read_b64_tr_b16 v[180:181], v238 offset:32
    ds_read_b64_tr_b16 v[182:183], v238 offset:4640
    s_waitcnt lgkmcnt(13)
    v_mfma_f32_16x16x32_bf16 v[96:99], v[168:171], v[144:147], v[96:99]
    v_mfma_f32_16x16x32_bf16 v[100:103], v[168:171], v[148:151], v[100:103]
    v_mfma_f32_16x16x32_bf16 v[104:107], v[168:171], v[152:155], v[104:107]
    v_mfma_f32_16x16x32_bf16 v[108:111], v[168:171], v[156:159], v[108:111]
    ds_read_b64_tr_b16 v[160:161], v238 offset:64
    ds_read_b64_tr_b16 v[162:163], v238 offset:4672
    s_waitcnt lgkmcnt(13)
    v_mfma_f32_16x16x32_bf16 v[112:115], v[172:175], v[144:147], v[112:115]
    v_mfma_f32_16x16x32_bf16 v[116:119], v[172:175], v[148:151], v[116:119]
    v_mfma_f32_16x16x32_bf16 v[120:123], v[172:175], v[152:155], v[120:123]
    v_mfma_f32_16x16x32_bf16 v[124:127], v[172:175], v[156:159], v[124:127]
    ds_read_b64_tr_b16 v[164:165], v238 offset:96
    ds_read_b64_tr_b16 v[166:167], v238 offset:4704
    s_waitcnt vmcnt(0)
    s_barrier
    s_lshl_b32 s55, s2, 3
    s_add_u32 s55, s55, s44
    s_mul_i32 s56, s55, 21
    v_add_u32 v3, s56, v1
    v_lshlrev_b32 v3, 7, v3
    s_mul_i32 s56, s55, 3
    v_add_u32 v4, s56, v1
    v_lshlrev_b32 v4, 7, v4
    s_mov_b64 exec, 0x1fffff
    buffer_load_dword v228, v3, s[96:99], 0 offen
    s_mov_b64 exec, 7
    buffer_load_dword v229, v4, s[92:95], 0 offen
    s_mov_b64 exec, -1
    s_waitcnt lgkmcnt(9)
    v_mfma_f32_16x16x32_bf16 v[16:19], v[176:179], v[128:131], v[16:19]
    v_mfma_f32_16x16x32_bf16 v[20:23], v[176:179], v[132:135], v[20:23]
    v_mfma_f32_16x16x32_bf16 v[24:27], v[176:179], v[136:139], v[24:27]
    v_mfma_f32_16x16x32_bf16 v[28:31], v[176:179], v[140:143], v[28:31]
    ds_read_b64_tr_b16 v[168:169], v238 offset:128
    ds_read_b64_tr_b16 v[170:171], v238 offset:4736
    s_waitcnt lgkmcnt(6)
    v_mfma_f32_16x16x32_bf16 v[32:35], v[180:183], v[128:131], v[32:35]
    v_mfma_f32_16x16x32_bf16 v[36:39], v[180:183], v[132:135], v[36:39]
    v_mfma_f32_16x16x32_bf16 v[40:43], v[180:183], v[136:139], v[40:43]
    v_mfma_f32_16x16x32_bf16 v[44:47], v[180:183], v[140:143], v[44:47]
    v_mfma_f32_16x16x32_bf16 v[200:203], v[184:187], v[128:131], v[200:203]
    v_mfma_f32_16x16x32_bf16 v[204:207], v[184:187], v[132:135], v[204:207]
    ds_read_b64_tr_b16 v[172:173], v238 offset:160
    ds_read_b64_tr_b16 v[174:175], v238 offset:4768
    s_waitcnt lgkmcnt(6)
    v_mfma_f32_16x16x32_bf16 v[48:51], v[160:163], v[128:131], v[48:51]
    v_mfma_f32_16x16x32_bf16 v[52:55], v[160:163], v[132:135], v[52:55]
    v_mfma_f32_16x16x32_bf16 v[56:59], v[160:163], v[136:139], v[56:59]
    v_mfma_f32_16x16x32_bf16 v[60:63], v[160:163], v[140:143], v[60:63]
    v_mfma_f32_16x16x32_bf16 v[208:211], v[192:195], v[216:219], v[208:211]
    ds_read_b64_tr_b16 v[176:177], v238 offset:192
    ds_read_b64_tr_b16 v[178:179], v238 offset:4800
    s_waitcnt lgkmcnt(6)
    v_mfma_f32_16x16x32_bf16 v[64:67], v[164:167], v[128:131], v[64:67]
    v_mfma_f32_16x16x32_bf16 v[68:71], v[164:167], v[132:135], v[68:71]
    v_mfma_f32_16x16x32_bf16 v[72:75], v[164:167], v[136:139], v[72:75]
    v_mfma_f32_16x16x32_bf16 v[76:79], v[164:167], v[140:143], v[76:79]
    v_mfma_f32_16x16x32_bf16 v[220:223], v[128:131], v[128:131], v[220:223]
    v_mfma_f32_16x16x32_bf16 v[224:227], v[132:135], v[132:135], v[224:227]
    ds_read_b128 v[144:147], v237 offset:0
    ds_read_b128 v[148:151], v237 offset:2048
    ds_read_b128 v[152:155], v237 offset:4096
    ds_read_b128 v[156:159], v237 offset:6144
    ds_read_b64_tr_b16 v[180:181], v238 offset:9216
    ds_read_b64_tr_b16 v[182:183], v238 offset:13824
    s_waitcnt lgkmcnt(10)
    v_mfma_f32_16x16x32_bf16 v[80:83], v[168:171], v[128:131], v[80:83]
    v_mfma_f32_16x16x32_bf16 v[84:87], v[168:171], v[132:135], v[84:87]
    v_mfma_f32_16x16x32_bf16 v[88:91], v[168:171], v[136:139], v[88:91]
    v_mfma_f32_16x16x32_bf16 v[92:95], v[168:171], v[140:143], v[92:95]
    ds_read_b128 v[188:191], v240 offset:1088
    ds_read_b64_tr_b16 v[196:197], v239 offset:9216
    ds_read_b64_tr_b16 v[198:199], v239 offset:13824
    ds_read_b64_tr_b16 v[160:161], v238 offset:9248
    ds_read_b64_tr_b16 v[162:163], v238 offset:13856
    s_waitcnt lgkmcnt(13)
    v_mfma_f32_16x16x32_bf16 v[96:99], v[172:175], v[128:131], v[96:99]
    v_mfma_f32_16x16x32_bf16 v[100:103], v[172:175], v[132:135], v[100:103]
    v_mfma_f32_16x16x32_bf16 v[104:107], v[172:175], v[136:139], v[104:107]
    v_mfma_f32_16x16x32_bf16 v[108:111], v[172:175], v[140:143], v[108:111]
    ds_read_b64_tr_b16 v[164:165], v238 offset:9280
    ds_read_b64_tr_b16 v[166:167], v238 offset:13888
    s_waitcnt lgkmcnt(13)
    v_mfma_f32_16x16x32_bf16 v[112:115], v[176:179], v[128:131], v[112:115]
    v_mfma_f32_16x16x32_bf16 v[116:119], v[176:179], v[132:135], v[116:119]
    v_mfma_f32_16x16x32_bf16 v[120:123], v[176:179], v[136:139], v[120:123]
    v_mfma_f32_16x16x32_bf16 v[124:127], v[176:179], v[140:143], v[124:127]
    ds_read_b64_tr_b16 v[168:169], v238 offset:9312
    ds_read_b64_tr_b16 v[170:171], v238 offset:13920
    s_waitcnt vmcnt(2)
    s_barrier
    s_waitcnt lgkmcnt(9)
    v_mfma_f32_16x16x32_bf16 v[16:19], v[180:183], v[144:147], v[16:19]
    v_mfma_f32_16x16x32_bf16 v[20:23], v[180:183], v[148:151], v[20:23]
    v_mfma_f32_16x16x32_bf16 v[24:27], v[180:183], v[152:155], v[24:27]
    v_mfma_f32_16x16x32_bf16 v[28:31], v[180:183], v[156:159], v[28:31]
    ds_read_b64_tr_b16 v[172:173], v238 offset:9344
    ds_read_b64_tr_b16 v[174:175], v238 offset:13952
    s_waitcnt lgkmcnt(6)
    v_mfma_f32_16x16x32_bf16 v[32:35], v[160:163], v[144:147], v[32:35]
    v_mfma_f32_16x16x32_bf16 v[36:39], v[160:163], v[148:151], v[36:39]
    v_mfma_f32_16x16x32_bf16 v[40:43], v[160:163], v[152:155], v[40:43]
    v_mfma_f32_16x16x32_bf16 v[44:47], v[160:163], v[156:159], v[44:47]
    v_mfma_f32_16x16x32_bf16 v[200:203], v[188:191], v[144:147], v[200:203]
    v_mfma_f32_16x16x32_bf16 v[204:207], v[188:191], v[148:151], v[204:207]
    ds_read_b64_tr_b16 v[176:177], v238 offset:9376
    ds_read_b64_tr_b16 v[178:179], v238 offset:13984
    s_waitcnt lgkmcnt(6)
    v_mfma_f32_16x16x32_bf16 v[48:51], v[164:167], v[144:147], v[48:51]
    v_mfma_f32_16x16x32_bf16 v[52:55], v[164:167], v[148:151], v[52:55]
    v_mfma_f32_16x16x32_bf16 v[56:59], v[164:167], v[152:155], v[56:59]
    v_mfma_f32_16x16x32_bf16 v[60:63], v[164:167], v[156:159], v[60:63]
    v_mfma_f32_16x16x32_bf16 v[208:211], v[196:199], v[216:219], v[208:211]
    ds_read_b64_tr_b16 v[180:181], v238 offset:9408
    ds_read_b64_tr_b16 v[182:183], v238 offset:14016
    s_waitcnt lgkmcnt(6)
    v_mfma_f32_16x16x32_bf16 v[64:67], v[168:171], v[144:147], v[64:67]
    v_mfma_f32_16x16x32_bf16 v[68:71], v[168:171], v[148:151], v[68:71]
    v_mfma_f32_16x16x32_bf16 v[72:75], v[168:171], v[152:155], v[72:75]
    v_mfma_f32_16x16x32_bf16 v[76:79], v[168:171], v[156:159], v[76:79]
    v_mfma_f32_16x16x32_bf16 v[220:223], v[144:147], v[144:147], v[220:223]
    v_mfma_f32_16x16x32_bf16 v[224:227], v[148:151], v[148:151], v[224:227]
    s_waitcnt lgkmcnt(4)
    v_mfma_f32_16x16x32_bf16 v[80:83], v[172:175], v[144:147], v[80:83]
    v_mfma_f32_16x16x32_bf16 v[84:87], v[172:175], v[148:151], v[84:87]
    v_mfma_f32_16x16x32_bf16 v[88:91], v[172:175], v[152:155], v[88:91]
    v_mfma_f32_16x16x32_bf16 v[92:95], v[172:175], v[156:159], v[92:95]
    s_waitcnt lgkmcnt(2)
    v_mfma_f32_16x16x32_bf16 v[96:99], v[176:179], v[144:147], v[96:99]
    v_mfma_f32_16x16x32_bf16 v[100:103], v[176:179], v[148:151], v[100:103]
    v_mfma_f32_16x16x32_bf16 v[104:107], v[176:179], v[152:155], v[104:107]
    v_mfma_f32_16x16x32_bf16 v[108:111], v[176:179], v[156:159], v[108:111]
    s_waitcnt lgkmcnt(0)
    v_mfma_f32_16x16x32_bf16 v[112:115], v[180:183], v[144:147], v[112:115]
    v_mfma_f32_16x16x32_bf16 v[116:119], v[180:183], v[148:151], v[116:119]
    v_mfma_f32_16x16x32_bf16 v[120:123], v[180:183], v[152:155], v[120:123]
    v_mfma_f32_16x16x32_bf16 v[124:127], v[180:183], v[156:159], v[124:127]
    s_nop 7
    v_and_b32 v3, 3, v1
    v_bfe_u32 v4, v1, 2, 2
    v_lshrrev_b32 v5, 4, v1
    v_cmp_eq_u32 s[92:93], v4, v5
    v_cmp_eq_u32 vcc, 1, v3
    s_nop 1
    v_cndmask_b32 v220, v220, v221, vcc
    v_cndmask_b32 v224, v224, v225, vcc
    v_cmp_eq_u32 vcc, 2, v3
    s_nop 1
    v_cndmask_b32 v220, v220, v222, vcc
    v_cndmask_b32 v224, v224, v226, vcc
    v_cmp_eq_u32 vcc, 3, v3
    s_nop 1
    v_cndmask_b32 v220, v220, v223, vcc
    v_cndmask_b32 v224, v224, v227, vcc
    v_mov_b32 v4, 0
    v_cndmask_b32 v220, v4, v220, s[92:93]
    v_cndmask_b32 v221, v4, v224, s[92:93]
    v_mov_b32 v128, v220
    v_mov_b32 v129, v221
    s_nop 1
    v_permlane32_swap_b32 v128, v220
    v_permlane32_swap_b32 v129, v221
    s_nop 1
    v_add_f32 v220, v220, v128
    v_add_f32 v221, v221, v129
    v_mov_b32 v128, v220
    v_mov_b32 v129, v221
    s_nop 1
    v_permlane16_swap_b32 v128, v220
    v_permlane16_swap_b32 v129, v221
    s_nop 1
    v_add_f32 v220, v220, v128
    v_add_f32 v221, v221, v129
    s_nop 3
    v_mul_f32 v200, 0x3ae38e39, v200
    v_mul_f32 v132, v200, v200
    v_mul_f32 v133, 0x3ae38e39, v220
    v_sub_f32 v132, v133, v132
    v_max_f32 v132, 0, v132
    v_add_f32 v132, 0x3727c5ac, v132
    v_rsq_f32 v128, v132
    v_mul_f32 v201, 0xbfb8aa3b, v201
    v_exp_f32 v201, v201
    v_mul_f32 v129, v200, v128
    v_sub_f32 v129, 0, v129
    v_add_f32 v201, 1.0, v201
    v_rcp_f32 v201, v201
    v_mul_f32 v204, 0x3ae38e39, v204
    v_mul_f32 v132, v204, v204
    v_mul_f32 v133, 0x3ae38e39, v221
    v_sub_f32 v132, v133, v132
    v_max_f32 v132, 0, v132
    v_add_f32 v132, 0x3727c5ac, v132
    v_rsq_f32 v130, v132
    v_mul_f32 v205, 0xbfb8aa3b, v205
    v_exp_f32 v205, v205
    v_mul_f32 v131, v204, v130
    v_sub_f32 v131, 0, v131
    v_add_f32 v205, 1.0, v205
    v_rcp_f32 v205, v205
    v_and_b32 v3, 15, v1
    v_lshrrev_b32 v4, 4, v1
    s_lshl_b32 s55, s59, 6
    v_add_u32 v5, s55, v3
    v_lshlrev_b32 v6, 3, v5
    s_lshl_b32 s55, s44, 6
    v_lshl_add_u32 v7, v4, 4, s55
    ds_write_b128 v7, v[208:211] offset:2048
    s_mov_b64 exec, 0xffff
    ds_write_b64 v6, v[128:129] offset:0
    ds_write_b64 v6, v[130:131] offset:128
    s_and_b32 s3, s2, 31
    s_cbranch_scc1 l1_nog00
    v_add_u32 v7, s45, v5
    v_lshlrev_b32 v7, 2, v7
    buffer_store_dword v201, v7, s[28:31], 0 offen offset:0
    buffer_store_dword v205, v7, s[28:31], 0 offen offset:64
l1_nog00:
    s_mov_b64 exec, -1
    s_waitcnt lgkmcnt(0)
    s_barrier
    ds_read_b64 v[128:129], v6 offset:0
    ds_read_b64 v[130:131], v6 offset:128
    ds_read_b64 v[132:133], v6 offset:256
    ds_read_b64 v[134:135], v6 offset:384
    v_lshlrev_b32 v7, 4, v4
    v_lshlrev_b32 v8, 3, v4
    v_add_u32 v8, 160768, v8
    ds_read_b128 v[136:139], v7 offset:2048
    ds_read_b64 v[164:165], v8 offset:0
    ds_read_b128 v[140:143], v7 offset:2112
    ds_read_b64 v[166:167], v8 offset:32
    ds_read_b128 v[144:147], v7 offset:2176
    ds_read_b64 v[168:169], v8 offset:64
    ds_read_b128 v[148:151], v7 offset:2240
    ds_read_b64 v[170:171], v8 offset:96
    ds_read_b128 v[152:155], v7 offset:2304
    ds_read_b64 v[172:173], v8 offset:128
    ds_read_b128 v[156:159], v7 offset:2368
    ds_read_b64 v[174:175], v8 offset:160
    ds_read_b128 v[160:163], v7 offset:2432
    ds_read_b64 v[176:177], v8 offset:192
    v_add_u32 v5, s45, v5
    v_lshrrev_b32 v6, 4, v5
    v_mul_u32_u24 v6, 147456, v6
    v_and_b32 v5, 15, v5
    v_lshl_add_u32 v5, v5, 4, v6
    s_lshl_b32 s55, s46, 5
    s_add_u32 s55, s55, 0
    v_add_u32 v5, s55, v5
    v_and_b32 v8, 1, v4
    v_lshrrev_b32 v6, 1, v4
    v_lshl_add_u32 v5, v6, 8, v5
    v_mul_u32_u24 v9, 147456, v8
    v_add_u32 v9, v9, v5
    v_lshl_add_u32 v5, v8, 9, v5
    v_mov_b32 v6, 0xc0135761
    v_mov_b32 v7, 0xc0135761
    v_mov_b32 v10, 0xbdd2d3e8
    v_mov_b32 v11, 0xbdd2d3e8
    v_mov_b32 v12, 1.0
    v_mov_b32 v13, 1.0
    s_waitcnt lgkmcnt(0)
    v_lshlrev_b32 v180, 16, v164
    v_and_b32 v181, 0xffff0000, v164
    v_lshlrev_b32 v182, 16, v165
    v_and_b32 v183, 0xffff0000, v165
    v_pk_fma_f32 v[184:185], v[136:137], v[128:129], v[180:181] op_sel:[0,1,0] op_sel_hi:[1,1,1]
    v_pk_fma_f32 v[186:187], v[138:139], v[128:129], v[182:183] op_sel:[0,1,0] op_sel_hi:[1,1,1]
    v_pk_fma_f32 v[188:189], v[136:137], v[130:131], v[180:181] op_sel:[0,1,0] op_sel_hi:[1,1,1]
    v_pk_fma_f32 v[190:191], v[138:139], v[130:131], v[182:183] op_sel:[0,1,0] op_sel_hi:[1,1,1]
    v_pk_fma_f32 v[16:17], v[16:17], v[128:129], v[184:185] op_sel:[0,0,0] op_sel_hi:[1,0,1]
    v_pk_fma_f32 v[18:19], v[18:19], v[128:129], v[186:187] op_sel:[0,0,0] op_sel_hi:[1,0,1]
    v_pk_fma_f32 v[20:21], v[20:21], v[130:131], v[188:189] op_sel:[0,0,0] op_sel_hi:[1,0,1]
    v_pk_fma_f32 v[22:23], v[22:23], v[130:131], v[190:191] op_sel:[0,0,0] op_sel_hi:[1,0,1]
    v_pk_mul_f32 v[184:185], v[16:17], v[16:17]
    v_pk_mul_f32 v[186:187], v[18:19], v[18:19]
    v_pk_mul_f32 v[188:189], v[20:21], v[20:21]
    v_pk_mul_f32 v[190:191], v[22:23], v[22:23]
    v_pk_fma_f32 v[184:185], v[184:185], v[10:11], v[6:7]
    v_pk_fma_f32 v[186:187], v[186:187], v[10:11], v[6:7]
    v_pk_fma_f32 v[188:189], v[188:189], v[10:11], v[6:7]
    v_pk_fma_f32 v[190:191], v[190:191], v[10:11], v[6:7]
    v_pk_mul_f32 v[184:185], v[184:185], v[16:17]
    v_pk_mul_f32 v[186:187], v[186:187], v[18:19]
    v_pk_mul_f32 v[188:189], v[188:189], v[20:21]
    v_pk_mul_f32 v[190:191], v[190:191], v[22:23]
    v_exp_f32 v184, v184
    v_exp_f32 v185, v185
    v_exp_f32 v186, v186
    v_exp_f32 v187, v187
    v_exp_f32 v188, v188
    v_exp_f32 v189, v189
    v_exp_f32 v190, v190
    v_exp_f32 v191, v191
    v_pk_add_f32 v[184:185], v[184:185], v[12:13]
    v_pk_add_f32 v[186:187], v[186:187], v[12:13]
    v_pk_add_f32 v[188:189], v[188:189], v[12:13]
    v_pk_add_f32 v[190:191], v[190:191], v[12:13]
    v_rcp_f32 v184, v184
    v_rcp_f32 v185, v185
    v_rcp_f32 v186, v186
    v_rcp_f32 v187, v187
    v_rcp_f32 v188, v188
    v_rcp_f32 v189, v189
    v_rcp_f32 v190, v190
    v_rcp_f32 v191, v191
    v_pk_mul_f32 v[16:17], v[16:17], v[184:185]
    v_pk_mul_f32 v[18:19], v[18:19], v[186:187]
    v_pk_mul_f32 v[20:21], v[20:21], v[188:189]
    v_pk_mul_f32 v[22:23], v[22:23], v[190:191]
    v_lshlrev_b32 v180, 16, v166
    v_and_b32 v181, 0xffff0000, v166
    v_lshlrev_b32 v182, 16, v167
    v_and_b32 v183, 0xffff0000, v167
    v_pk_fma_f32 v[184:185], v[140:141], v[128:129], v[180:181] op_sel:[0,1,0] op_sel_hi:[1,1,1]
    v_pk_fma_f32 v[186:187], v[142:143], v[128:129], v[182:183] op_sel:[0,1,0] op_sel_hi:[1,1,1]
    v_pk_fma_f32 v[188:189], v[140:141], v[130:131], v[180:181] op_sel:[0,1,0] op_sel_hi:[1,1,1]
    v_pk_fma_f32 v[190:191], v[142:143], v[130:131], v[182:183] op_sel:[0,1,0] op_sel_hi:[1,1,1]
    v_pk_fma_f32 v[32:33], v[32:33], v[128:129], v[184:185] op_sel:[0,0,0] op_sel_hi:[1,0,1]
    v_pk_fma_f32 v[34:35], v[34:35], v[128:129], v[186:187] op_sel:[0,0,0] op_sel_hi:[1,0,1]
    v_pk_fma_f32 v[36:37], v[36:37], v[130:131], v[188:189] op_sel:[0,0,0] op_sel_hi:[1,0,1]
    v_pk_fma_f32 v[38:39], v[38:39], v[130:131], v[190:191] op_sel:[0,0,0] op_sel_hi:[1,0,1]
    v_pk_mul_f32 v[184:185], v[32:33], v[32:33]
    v_pk_mul_f32 v[186:187], v[34:35], v[34:35]
    v_pk_mul_f32 v[188:189], v[36:37], v[36:37]
    v_pk_mul_f32 v[190:191], v[38:39], v[38:39]
    v_pk_fma_f32 v[184:185], v[184:185], v[10:11], v[6:7]
    v_pk_fma_f32 v[186:187], v[186:187], v[10:11], v[6:7]
    v_pk_fma_f32 v[188:189], v[188:189], v[10:11], v[6:7]
    v_pk_fma_f32 v[190:191], v[190:191], v[10:11], v[6:7]
    v_pk_mul_f32 v[184:185], v[184:185], v[32:33]
    v_pk_mul_f32 v[186:187], v[186:187], v[34:35]
    v_pk_mul_f32 v[188:189], v[188:189], v[36:37]
    v_pk_mul_f32 v[190:191], v[190:191], v[38:39]
    v_exp_f32 v184, v184
    v_exp_f32 v185, v185
    v_exp_f32 v186, v186
    v_exp_f32 v187, v187
    v_exp_f32 v188, v188
    v_exp_f32 v189, v189
    v_exp_f32 v190, v190
    v_exp_f32 v191, v191
    v_pk_add_f32 v[184:185], v[184:185], v[12:13]
    v_pk_add_f32 v[186:187], v[186:187], v[12:13]
    v_pk_add_f32 v[188:189], v[188:189], v[12:13]
    v_pk_add_f32 v[190:191], v[190:191], v[12:13]
    v_rcp_f32 v184, v184
    v_rcp_f32 v185, v185
    v_rcp_f32 v186, v186
    v_rcp_f32 v187, v187
    v_rcp_f32 v188, v188
    v_rcp_f32 v189, v189
    v_rcp_f32 v190, v190
    v_rcp_f32 v191, v191
    v_pk_mul_f32 v[32:33], v[32:33], v[184:185]
    v_pk_mul_f32 v[34:35], v[34:35], v[186:187]
    v_pk_mul_f32 v[36:37], v[36:37], v[188:189]
    v_pk_mul_f32 v[38:39], v[38:39], v[190:191]
    v_cvt_pk_bf16_f32 v16, v16, v17
    v_cvt_pk_bf16_f32 v17, v18, v19
    v_cvt_pk_bf16_f32 v18, v32, v33
    v_cvt_pk_bf16_f32 v19, v34, v35
    s_nop 1
    v_permlane16_swap_b32 v16, v18
    v_permlane16_swap_b32 v17, v19
    s_nop 0
    buffer_store_dwordx4 v[16:19], v5, s[16:19], s68 offen offset:0
    v_cvt_pk_bf16_f32 v20, v20, v21
    v_cvt_pk_bf16_f32 v21, v22, v23
    v_cvt_pk_bf16_f32 v22, v36, v37
    v_cvt_pk_bf16_f32 v23, v38, v39
    s_nop 1
    v_permlane16_swap_b32 v20, v22
    v_permlane16_swap_b32 v21, v23
    s_nop 0
    buffer_store_dwordx4 v[20:23], v5, s[16:19], s69 offen offset:0
    v_lshlrev_b32 v180, 16, v164
    v_and_b32 v181, 0xffff0000, v164
    v_lshlrev_b32 v182, 16, v165
    v_and_b32 v183, 0xffff0000, v165
    v_pk_fma_f32 v[184:185], v[136:137], v[132:133], v[180:181] op_sel:[0,1,0] op_sel_hi:[1,1,1]
    v_pk_fma_f32 v[186:187], v[138:139], v[132:133], v[182:183] op_sel:[0,1,0] op_sel_hi:[1,1,1]
    v_pk_fma_f32 v[188:189], v[136:137], v[134:135], v[180:181] op_sel:[0,1,0] op_sel_hi:[1,1,1]
    v_pk_fma_f32 v[190:191], v[138:139], v[134:135], v[182:183] op_sel:[0,1,0] op_sel_hi:[1,1,1]
    v_pk_fma_f32 v[24:25], v[24:25], v[132:133], v[184:185] op_sel:[0,0,0] op_sel_hi:[1,0,1]
    v_pk_fma_f32 v[26:27], v[26:27], v[132:133], v[186:187] op_sel:[0,0,0] op_sel_hi:[1,0,1]
    v_pk_fma_f32 v[28:29], v[28:29], v[134:135], v[188:189] op_sel:[0,0,0] op_sel_hi:[1,0,1]
    v_pk_fma_f32 v[30:31], v[30:31], v[134:135], v[190:191] op_sel:[0,0,0] op_sel_hi:[1,0,1]
    v_pk_mul_f32 v[184:185], v[24:25], v[24:25]
    v_pk_mul_f32 v[186:187], v[26:27], v[26:27]
    v_pk_mul_f32 v[188:189], v[28:29], v[28:29]
    v_pk_mul_f32 v[190:191], v[30:31], v[30:31]
    v_pk_fma_f32 v[184:185], v[184:185], v[10:11], v[6:7]
    v_pk_fma_f32 v[186:187], v[186:187], v[10:11], v[6:7]
    v_pk_fma_f32 v[188:189], v[188:189], v[10:11], v[6:7]
    v_pk_fma_f32 v[190:191], v[190:191], v[10:11], v[6:7]
    v_pk_mul_f32 v[184:185], v[184:185], v[24:25]
    v_pk_mul_f32 v[186:187], v[186:187], v[26:27]
    v_pk_mul_f32 v[188:189], v[188:189], v[28:29]
    v_pk_mul_f32 v[190:191], v[190:191], v[30:31]
    v_exp_f32 v184, v184
    v_exp_f32 v185, v185
    v_exp_f32 v186, v186
    v_exp_f32 v187, v187
    v_exp_f32 v188, v188
    v_exp_f32 v189, v189
    v_exp_f32 v190, v190
    v_exp_f32 v191, v191
    v_pk_add_f32 v[184:185], v[184:185], v[12:13]
    v_pk_add_f32 v[186:187], v[186:187], v[12:13]
    v_pk_add_f32 v[188:189], v[188:189], v[12:13]
    v_pk_add_f32 v[190:191], v[190:191], v[12:13]
    v_rcp_f32 v184, v184
    v_rcp_f32 v185, v185
    v_rcp_f32 v186, v186
    v_rcp_f32 v187, v187
    v_rcp_f32 v188, v188
    v_rcp_f32 v189, v189
    v_rcp_f32 v190, v190
    v_rcp_f32 v191, v191
    v_pk_mul_f32 v[24:25], v[24:25], v[184:185]
    v_pk_mul_f32 v[26:27], v[26:27], v[186:187]
    v_pk_mul_f32 v[28:29], v[28:29], v[188:189]
    v_pk_mul_f32 v[30:31], v[30:31], v[190:191]
    v_lshlrev_b32 v180, 16, v166
    v_and_b32 v181, 0xffff0000, v166
    v_lshlrev_b32 v182, 16, v167
    v_and_b32 v183, 0xffff0000, v167
    v_pk_fma_f32 v[184:185], v[140:141], v[132:133], v[180:181] op_sel:[0,1,0] op_sel_hi:[1,1,1]
    v_pk_fma_f32 v[186:187], v[142:143], v[132:133], v[182:183] op_sel:[0,1,0] op_sel_hi:[1,1,1]
    v_pk_fma_f32 v[188:189], v[140:141], v[134:135], v[180:181] op_sel:[0,1,0] op_sel_hi:[1,1,1]
    v_pk_fma_f32 v[190:191], v[142:143], v[134:135], v[182:183] op_sel:[0,1,0] op_sel_hi:[1,1,1]
    v_pk_fma_f32 v[40:41], v[40:41], v[132:133], v[184:185] op_sel:[0,0,0] op_sel_hi:[1,0,1]
    v_pk_fma_f32 v[42:43], v[42:43], v[132:133], v[186:187] op_sel:[0,0,0] op_sel_hi:[1,0,1]
    v_pk_fma_f32 v[44:45], v[44:45], v[134:135], v[188:189] op_sel:[0,0,0] op_sel_hi:[1,0,1]
    v_pk_fma_f32 v[46:47], v[46:47], v[134:135], v[190:191] op_sel:[0,0,0] op_sel_hi:[1,0,1]
    v_pk_mul_f32 v[184:185], v[40:41], v[40:41]
    v_pk_mul_f32 v[186:187], v[42:43], v[42:43]
    v_pk_mul_f32 v[188:189], v[44:45], v[44:45]
    v_pk_mul_f32 v[190:191], v[46:47], v[46:47]
    v_pk_fma_f32 v[184:185], v[184:185], v[10:11], v[6:7]
    v_pk_fma_f32 v[186:187], v[186:187], v[10:11], v[6:7]
    v_pk_fma_f32 v[188:189], v[188:189], v[10:11], v[6:7]
    v_pk_fma_f32 v[190:191], v[190:191], v[10:11], v[6:7]
    v_pk_mul_f32 v[184:185], v[184:185], v[40:41]
    v_pk_mul_f32 v[186:187], v[186:187], v[42:43]
    v_pk_mul_f32 v[188:189], v[188:189], v[44:45]
    v_pk_mul_f32 v[190:191], v[190:191], v[46:47]
    v_exp_f32 v184, v184
    v_exp_f32 v185, v185
    v_exp_f32 v186, v186
    v_exp_f32 v187, v187
    v_exp_f32 v188, v188
    v_exp_f32 v189, v189
    v_exp_f32 v190, v190
    v_exp_f32 v191, v191
    v_pk_add_f32 v[184:185], v[184:185], v[12:13]
    v_pk_add_f32 v[186:187], v[186:187], v[12:13]
    v_pk_add_f32 v[188:189], v[188:189], v[12:13]
    v_pk_add_f32 v[190:191], v[190:191], v[12:13]
    v_rcp_f32 v184, v184
    v_rcp_f32 v185, v185
    v_rcp_f32 v186, v186
    v_rcp_f32 v187, v187
    v_rcp_f32 v188, v188
    v_rcp_f32 v189, v189
    v_rcp_f32 v190, v190
    v_rcp_f32 v191, v191
    v_pk_mul_f32 v[40:41], v[40:41], v[184:185]
    v_pk_mul_f32 v[42:43], v[42:43], v[186:187]
    v_pk_mul_f32 v[44:45], v[44:45], v[188:189]
    v_pk_mul_f32 v[46:47], v[46:47], v[190:191]
    v_cvt_pk_bf16_f32 v24, v24, v25
    v_cvt_pk_bf16_f32 v25, v26, v27
    v_cvt_pk_bf16_f32 v26, v40, v41
    v_cvt_pk_bf16_f32 v27, v42, v43
    s_nop 1
    v_permlane16_swap_b32 v24, v26
    v_permlane16_swap_b32 v25, v27
    s_nop 0
    buffer_store_dwordx4 v[24:27], v5, s[16:19], s70 offen offset:0
    v_cvt_pk_bf16_f32 v28, v28, v29
    v_cvt_pk_bf16_f32 v29, v30, v31
    v_cvt_pk_bf16_f32 v30, v44, v45
    v_cvt_pk_bf16_f32 v31, v46, v47
    s_nop 1
    v_permlane16_swap_b32 v28, v30
    v_permlane16_swap_b32 v29, v31
    s_nop 0
    buffer_store_dwordx4 v[28:31], v5, s[16:19], s71 offen offset:0
    v_lshlrev_b32 v180, 16, v168
    v_and_b32 v181, 0xffff0000, v168
    v_lshlrev_b32 v182, 16, v169
    v_and_b32 v183, 0xffff0000, v169
    v_pk_fma_f32 v[184:185], v[144:145], v[128:129], v[180:181] op_sel:[0,1,0] op_sel_hi:[1,1,1]
    v_pk_fma_f32 v[186:187], v[146:147], v[128:129], v[182:183] op_sel:[0,1,0] op_sel_hi:[1,1,1]
    v_pk_fma_f32 v[188:189], v[144:145], v[130:131], v[180:181] op_sel:[0,1,0] op_sel_hi:[1,1,1]
    v_pk_fma_f32 v[190:191], v[146:147], v[130:131], v[182:183] op_sel:[0,1,0] op_sel_hi:[1,1,1]
    v_pk_fma_f32 v[48:49], v[48:49], v[128:129], v[184:185] op_sel:[0,0,0] op_sel_hi:[1,0,1]
    v_pk_fma_f32 v[50:51], v[50:51], v[128:129], v[186:187] op_sel:[0,0,0] op_sel_hi:[1,0,1]
    v_pk_fma_f32 v[52:53], v[52:53], v[130:131], v[188:189] op_sel:[0,0,0] op_sel_hi:[1,0,1]
    v_pk_fma_f32 v[54:55], v[54:55], v[130:131], v[190:191] op_sel:[0,0,0] op_sel_hi:[1,0,1]
    v_pk_mul_f32 v[184:185], v[48:49], v[48:49]
    v_pk_mul_f32 v[186:187], v[50:51], v[50:51]
    v_pk_mul_f32 v[188:189], v[52:53], v[52:53]
    v_pk_mul_f32 v[190:191], v[54:55], v[54:55]
    v_pk_fma_f32 v[184:185], v[184:185], v[10:11], v[6:7]
    v_pk_fma_f32 v[186:187], v[186:187], v[10:11], v[6:7]
    v_pk_fma_f32 v[188:189], v[188:189], v[10:11], v[6:7]
    v_pk_fma_f32 v[190:191], v[190:191], v[10:11], v[6:7]
    v_pk_mul_f32 v[184:185], v[184:185], v[48:49]
    v_pk_mul_f32 v[186:187], v[186:187], v[50:51]
    v_pk_mul_f32 v[188:189], v[188:189], v[52:53]
    v_pk_mul_f32 v[190:191], v[190:191], v[54:55]
    v_exp_f32 v184, v184
    v_exp_f32 v185, v185
    v_exp_f32 v186, v186
    v_exp_f32 v187, v187
    v_exp_f32 v188, v188
    v_exp_f32 v189, v189
    v_exp_f32 v190, v190
    v_exp_f32 v191, v191
    v_pk_add_f32 v[184:185], v[184:185], v[12:13]
    v_pk_add_f32 v[186:187], v[186:187], v[12:13]
    v_pk_add_f32 v[188:189], v[188:189], v[12:13]
    v_pk_add_f32 v[190:191], v[190:191], v[12:13]
    v_rcp_f32 v184, v184
    v_rcp_f32 v185, v185
    v_rcp_f32 v186, v186
    v_rcp_f32 v187, v187
    v_rcp_f32 v188, v188
    v_rcp_f32 v189, v189
    v_rcp_f32 v190, v190
    v_rcp_f32 v191, v191
    v_pk_mul_f32 v[48:49], v[48:49], v[184:185]
    v_pk_mul_f32 v[50:51], v[50:51], v[186:187]
    v_pk_mul_f32 v[52:53], v[52:53], v[188:189]
    v_pk_mul_f32 v[54:55], v[54:55], v[190:191]
    v_lshlrev_b32 v180, 16, v170
    v_and_b32 v181, 0xffff0000, v170
    v_lshlrev_b32 v182, 16, v171
    v_and_b32 v183, 0xffff0000, v171
    v_pk_fma_f32 v[184:185], v[148:149], v[128:129], v[180:181] op_sel:[0,1,0] op_sel_hi:[1,1,1]
    v_pk_fma_f32 v[186:187], v[150:151], v[128:129], v[182:183] op_sel:[0,1,0] op_sel_hi:[1,1,1]
    v_pk_fma_f32 v[188:189], v[148:149], v[130:131], v[180:181] op_sel:[0,1,0] op_sel_hi:[1,1,1]
    v_pk_fma_f32 v[190:191], v[150:151], v[130:131], v[182:183] op_sel:[0,1,0] op_sel_hi:[1,1,1]
    v_pk_fma_f32 v[64:65], v[64:65], v[128:129], v[184:185] op_sel:[0,0,0] op_sel_hi:[1,0,1]
    v_pk_fma_f32 v[66:67], v[66:67], v[128:129], v[186:187] op_sel:[0,0,0] op_sel_hi:[1,0,1]
    v_pk_fma_f32 v[68:69], v[68:69], v[130:131], v[188:189] op_sel:[0,0,0] op_sel_hi:[1,0,1]
    v_pk_fma_f32 v[70:71], v[70:71], v[130:131], v[190:191] op_sel:[0,0,0] op_sel_hi:[1,0,1]
    v_pk_mul_f32 v[184:185], v[64:65], v[64:65]
    v_pk_mul_f32 v[186:187], v[66:67], v[66:67]
    v_pk_mul_f32 v[188:189], v[68:69], v[68:69]
    v_pk_mul_f32 v[190:191], v[70:71], v[70:71]
    v_pk_fma_f32 v[184:185], v[184:185], v[10:11], v[6:7]
    v_pk_fma_f32 v[186:187], v[186:187], v[10:11], v[6:7]
    v_pk_fma_f32 v[188:189], v[188:189], v[10:11], v[6:7]
    v_pk_fma_f32 v[190:191], v[190:191], v[10:11], v[6:7]
    v_pk_mul_f32 v[184:185], v[184:185], v[64:65]
    v_pk_mul_f32 v[186:187], v[186:187], v[66:67]
    v_pk_mul_f32 v[188:189], v[188:189], v[68:69]
    v_pk_mul_f32 v[190:191], v[190:191], v[70:71]
    v_exp_f32 v184, v184
    v_exp_f32 v185, v185
    v_exp_f32 v186, v186
    v_exp_f32 v187, v187
    v_exp_f32 v188, v188
    v_exp_f32 v189, v189
    v_exp_f32 v190, v190
    v_exp_f32 v191, v191
    v_pk_add_f32 v[184:185], v[184:185], v[12:13]
    v_pk_add_f32 v[186:187], v[186:187], v[12:13]
    v_pk_add_f32 v[188:189], v[188:189], v[12:13]
    v_pk_add_f32 v[190:191], v[190:191], v[12:13]
    v_rcp_f32 v184, v184
    v_rcp_f32 v185, v185
    v_rcp_f32 v186, v186
    v_rcp_f32 v187, v187
    v_rcp_f32 v188, v188
    v_rcp_f32 v189, v189
    v_rcp_f32 v190, v190
    v_rcp_f32 v191, v191
    v_pk_mul_f32 v[64:65], v[64:65], v[184:185]
    v_pk_mul_f32 v[66:67], v[66:67], v[186:187]
    v_pk_mul_f32 v[68:69], v[68:69], v[188:189]
    v_pk_mul_f32 v[70:71], v[70:71], v[190:191]
    v_cvt_pk_bf16_f32 v48, v48, v49
    v_cvt_pk_bf16_f32 v49, v50, v51
    v_cvt_pk_bf16_f32 v50, v64, v65
    v_cvt_pk_bf16_f32 v51, v66, v67
    s_nop 1
    v_permlane16_swap_b32 v48, v50
    v_permlane16_swap_b32 v49, v51
    s_nop 0
    buffer_store_dwordx4 v[48:51], v5, s[16:19], s68 offen offset:1024
    v_cvt_pk_bf16_f32 v52, v52, v53
    v_cvt_pk_bf16_f32 v53, v54, v55
    v_cvt_pk_bf16_f32 v54, v68, v69
    v_cvt_pk_bf16_f32 v55, v70, v71
    s_nop 1
    v_permlane16_swap_b32 v52, v54
    v_permlane16_swap_b32 v53, v55
    s_nop 0
    buffer_store_dwordx4 v[52:55], v5, s[16:19], s69 offen offset:1024
    v_lshlrev_b32 v180, 16, v168
    v_and_b32 v181, 0xffff0000, v168
    v_lshlrev_b32 v182, 16, v169
    v_and_b32 v183, 0xffff0000, v169
    v_pk_fma_f32 v[184:185], v[144:145], v[132:133], v[180:181] op_sel:[0,1,0] op_sel_hi:[1,1,1]
    v_pk_fma_f32 v[186:187], v[146:147], v[132:133], v[182:183] op_sel:[0,1,0] op_sel_hi:[1,1,1]
    v_pk_fma_f32 v[188:189], v[144:145], v[134:135], v[180:181] op_sel:[0,1,0] op_sel_hi:[1,1,1]
    v_pk_fma_f32 v[190:191], v[146:147], v[134:135], v[182:183] op_sel:[0,1,0] op_sel_hi:[1,1,1]
    v_pk_fma_f32 v[56:57], v[56:57], v[132:133], v[184:185] op_sel:[0,0,0] op_sel_hi:[1,0,1]
    v_pk_fma_f32 v[58:59], v[58:59], v[132:133], v[186:187] op_sel:[0,0,0] op_sel_hi:[1,0,1]
    v_pk_fma_f32 v[60:61], v[60:61], v[134:135], v[188:189] op_sel:[0,0,0] op_sel_hi:[1,0,1]
    v_pk_fma_f32 v[62:63], v[62:63], v[134:135], v[190:191] op_sel:[0,0,0] op_sel_hi:[1,0,1]
    v_pk_mul_f32 v[184:185], v[56:57], v[56:57]
    v_pk_mul_f32 v[186:187], v[58:59], v[58:59]
    v_pk_mul_f32 v[188:189], v[60:61], v[60:61]
    v_pk_mul_f32 v[190:191], v[62:63], v[62:63]
    v_pk_fma_f32 v[184:185], v[184:185], v[10:11], v[6:7]
    v_pk_fma_f32 v[186:187], v[186:187], v[10:11], v[6:7]
    v_pk_fma_f32 v[188:189], v[188:189], v[10:11], v[6:7]
    v_pk_fma_f32 v[190:191], v[190:191], v[10:11], v[6:7]
    v_pk_mul_f32 v[184:185], v[184:185], v[56:57]
    v_pk_mul_f32 v[186:187], v[186:187], v[58:59]
    v_pk_mul_f32 v[188:189], v[188:189], v[60:61]
    v_pk_mul_f32 v[190:191], v[190:191], v[62:63]
    v_exp_f32 v184, v184
    v_exp_f32 v185, v185
    v_exp_f32 v186, v186
    v_exp_f32 v187, v187
    v_exp_f32 v188, v188
    v_exp_f32 v189, v189
    v_exp_f32 v190, v190
    v_exp_f32 v191, v191
    v_pk_add_f32 v[184:185], v[184:185], v[12:13]
    v_pk_add_f32 v[186:187], v[186:187], v[12:13]
    v_pk_add_f32 v[188:189], v[188:189], v[12:13]
    v_pk_add_f32 v[190:191], v[190:191], v[12:13]
    v_rcp_f32 v184, v184
    v_rcp_f32 v185, v185
    v_rcp_f32 v186, v186
    v_rcp_f32 v187, v187
    v_rcp_f32 v188, v188
    v_rcp_f32 v189, v189
    v_rcp_f32 v190, v190
    v_rcp_f32 v191, v191
    v_pk_mul_f32 v[56:57], v[56:57], v[184:185]
    v_pk_mul_f32 v[58:59], v[58:59], v[186:187]
    v_pk_mul_f32 v[60:61], v[60:61], v[188:189]
    v_pk_mul_f32 v[62:63], v[62:63], v[190:191]
    v_lshlrev_b32 v180, 16, v170
    v_and_b32 v181, 0xffff0000, v170
    v_lshlrev_b32 v182, 16, v171
    v_and_b32 v183, 0xffff0000, v171
    v_pk_fma_f32 v[184:185], v[148:149], v[132:133], v[180:181] op_sel:[0,1,0] op_sel_hi:[1,1,1]
    v_pk_fma_f32 v[186:187], v[150:151], v[132:133], v[182:183] op_sel:[0,1,0] op_sel_hi:[1,1,1]
    v_pk_fma_f32 v[188:189], v[148:149], v[134:135], v[180:181] op_sel:[0,1,0] op_sel_hi:[1,1,1]
    v_pk_fma_f32 v[190:191], v[150:151], v[134:135], v[182:183] op_sel:[0,1,0] op_sel_hi:[1,1,1]
    v_pk_fma_f32 v[72:73], v[72:73], v[132:133], v[184:185] op_sel:[0,0,0] op_sel_hi:[1,0,1]
    v_pk_fma_f32 v[74:75], v[74:75], v[132:133], v[186:187] op_sel:[0,0,0] op_sel_hi:[1,0,1]
    v_pk_fma_f32 v[76:77], v[76:77], v[134:135], v[188:189] op_sel:[0,0,0] op_sel_hi:[1,0,1]
    v_pk_fma_f32 v[78:79], v[78:79], v[134:135], v[190:191] op_sel:[0,0,0] op_sel_hi:[1,0,1]
    v_pk_mul_f32 v[184:185], v[72:73], v[72:73]
    v_pk_mul_f32 v[186:187], v[74:75], v[74:75]
    v_pk_mul_f32 v[188:189], v[76:77], v[76:77]
    v_pk_mul_f32 v[190:191], v[78:79], v[78:79]
    v_pk_fma_f32 v[184:185], v[184:185], v[10:11], v[6:7]
    v_pk_fma_f32 v[186:187], v[186:187], v[10:11], v[6:7]
    v_pk_fma_f32 v[188:189], v[188:189], v[10:11], v[6:7]
    v_pk_fma_f32 v[190:191], v[190:191], v[10:11], v[6:7]
    v_pk_mul_f32 v[184:185], v[184:185], v[72:73]
    v_pk_mul_f32 v[186:187], v[186:187], v[74:75]
    v_pk_mul_f32 v[188:189], v[188:189], v[76:77]
    v_pk_mul_f32 v[190:191], v[190:191], v[78:79]
    v_exp_f32 v184, v184
    v_exp_f32 v185, v185
    v_exp_f32 v186, v186
    v_exp_f32 v187, v187
    v_exp_f32 v188, v188
    v_exp_f32 v189, v189
    v_exp_f32 v190, v190
    v_exp_f32 v191, v191
    v_pk_add_f32 v[184:185], v[184:185], v[12:13]
    v_pk_add_f32 v[186:187], v[186:187], v[12:13]
    v_pk_add_f32 v[188:189], v[188:189], v[12:13]
    v_pk_add_f32 v[190:191], v[190:191], v[12:13]
    v_rcp_f32 v184, v184
    v_rcp_f32 v185, v185
    v_rcp_f32 v186, v186
    v_rcp_f32 v187, v187
    v_rcp_f32 v188, v188
    v_rcp_f32 v189, v189
    v_rcp_f32 v190, v190
    v_rcp_f32 v191, v191
    v_pk_mul_f32 v[72:73], v[72:73], v[184:185]
    v_pk_mul_f32 v[74:75], v[74:75], v[186:187]
    v_pk_mul_f32 v[76:77], v[76:77], v[188:189]
    v_pk_mul_f32 v[78:79], v[78:79], v[190:191]
    v_cvt_pk_bf16_f32 v56, v56, v57
    v_cvt_pk_bf16_f32 v57, v58, v59
    v_cvt_pk_bf16_f32 v58, v72, v73
    v_cvt_pk_bf16_f32 v59, v74, v75
    s_nop 1
    v_permlane16_swap_b32 v56, v58
    v_permlane16_swap_b32 v57, v59
    s_nop 0
    buffer_store_dwordx4 v[56:59], v5, s[16:19], s70 offen offset:1024
    v_cvt_pk_bf16_f32 v60, v60, v61
    v_cvt_pk_bf16_f32 v61, v62, v63
    v_cvt_pk_bf16_f32 v62, v76, v77
    v_cvt_pk_bf16_f32 v63, v78, v79
    s_nop 1
    v_permlane16_swap_b32 v60, v62
    v_permlane16_swap_b32 v61, v63
    s_nop 0
    buffer_store_dwordx4 v[60:63], v5, s[16:19], s71 offen offset:1024
    v_lshlrev_b32 v180, 16, v172
    v_and_b32 v181, 0xffff0000, v172
    v_lshlrev_b32 v182, 16, v173
    v_and_b32 v183, 0xffff0000, v173
    v_pk_fma_f32 v[184:185], v[152:153], v[128:129], v[180:181] op_sel:[0,1,0] op_sel_hi:[1,1,1]
    v_pk_fma_f32 v[186:187], v[154:155], v[128:129], v[182:183] op_sel:[0,1,0] op_sel_hi:[1,1,1]
    v_pk_fma_f32 v[188:189], v[152:153], v[130:131], v[180:181] op_sel:[0,1,0] op_sel_hi:[1,1,1]
    v_pk_fma_f32 v[190:191], v[154:155], v[130:131], v[182:183] op_sel:[0,1,0] op_sel_hi:[1,1,1]
    v_pk_fma_f32 v[80:81], v[80:81], v[128:129], v[184:185] op_sel:[0,0,0] op_sel_hi:[1,0,1]
    v_pk_fma_f32 v[82:83], v[82:83], v[128:129], v[186:187] op_sel:[0,0,0] op_sel_hi:[1,0,1]
    v_pk_fma_f32 v[84:85], v[84:85], v[130:131], v[188:189] op_sel:[0,0,0] op_sel_hi:[1,0,1]
    v_pk_fma_f32 v[86:87], v[86:87], v[130:131], v[190:191] op_sel:[0,0,0] op_sel_hi:[1,0,1]
    v_pk_mul_f32 v[184:185], v[80:81], v[80:81]
    v_pk_mul_f32 v[186:187], v[82:83], v[82:83]
    v_pk_mul_f32 v[188:189], v[84:85], v[84:85]
    v_pk_mul_f32 v[190:191], v[86:87], v[86:87]
    v_pk_fma_f32 v[184:185], v[184:185], v[10:11], v[6:7]
    v_pk_fma_f32 v[186:187], v[186:187], v[10:11], v[6:7]
    v_pk_fma_f32 v[188:189], v[188:189], v[10:11], v[6:7]
    v_pk_fma_f32 v[190:191], v[190:191], v[10:11], v[6:7]
    v_pk_mul_f32 v[184:185], v[184:185], v[80:81]
    v_pk_mul_f32 v[186:187], v[186:187], v[82:83]
    v_pk_mul_f32 v[188:189], v[188:189], v[84:85]
    v_pk_mul_f32 v[190:191], v[190:191], v[86:87]
    v_exp_f32 v184, v184
    v_exp_f32 v185, v185
    v_exp_f32 v186, v186
    v_exp_f32 v187, v187
    v_exp_f32 v188, v188
    v_exp_f32 v189, v189
    v_exp_f32 v190, v190
    v_exp_f32 v191, v191
    v_pk_add_f32 v[184:185], v[184:185], v[12:13]
    v_pk_add_f32 v[186:187], v[186:187], v[12:13]
    v_pk_add_f32 v[188:189], v[188:189], v[12:13]
    v_pk_add_f32 v[190:191], v[190:191], v[12:13]
    v_rcp_f32 v184, v184
    v_rcp_f32 v185, v185
    v_rcp_f32 v186, v186
    v_rcp_f32 v187, v187
    v_rcp_f32 v188, v188
    v_rcp_f32 v189, v189
    v_rcp_f32 v190, v190
    v_rcp_f32 v191, v191
    v_pk_mul_f32 v[80:81], v[80:81], v[184:185]
    v_pk_mul_f32 v[82:83], v[82:83], v[186:187]
    v_pk_mul_f32 v[84:85], v[84:85], v[188:189]
    v_pk_mul_f32 v[86:87], v[86:87], v[190:191]
    v_lshlrev_b32 v180, 16, v174
    v_and_b32 v181, 0xffff0000, v174
    v_lshlrev_b32 v182, 16, v175
    v_and_b32 v183, 0xffff0000, v175
    v_pk_fma_f32 v[184:185], v[156:157], v[128:129], v[180:181] op_sel:[0,1,0] op_sel_hi:[1,1,1]
    v_pk_fma_f32 v[186:187], v[158:159], v[128:129], v[182:183] op_sel:[0,1,0] op_sel_hi:[1,1,1]
    v_pk_fma_f32 v[188:189], v[156:157], v[130:131], v[180:181] op_sel:[0,1,0] op_sel_hi:[1,1,1]
    v_pk_fma_f32 v[190:191], v[158:159], v[130:131], v[182:183] op_sel:[0,1,0] op_sel_hi:[1,1,1]
    v_pk_fma_f32 v[96:97], v[96:97], v[128:129], v[184:185] op_sel:[0,0,0] op_sel_hi:[1,0,1]
    v_pk_fma_f32 v[98:99], v[98:99], v[128:129], v[186:187] op_sel:[0,0,0] op_sel_hi:[1,0,1]
    v_pk_fma_f32 v[100:101], v[100:101], v[130:131], v[188:189] op_sel:[0,0,0] op_sel_hi:[1,0,1]
    v_pk_fma_f32 v[102:103], v[102:103], v[130:131], v[190:191] op_sel:[0,0,0] op_sel_hi:[1,0,1]
    v_pk_mul_f32 v[184:185], v[96:97], v[96:97]
    v_pk_mul_f32 v[186:187], v[98:99], v[98:99]
    v_pk_mul_f32 v[188:189], v[100:101], v[100:101]
    v_pk_mul_f32 v[190:191], v[102:103], v[102:103]
    v_pk_fma_f32 v[184:185], v[184:185], v[10:11], v[6:7]
    v_pk_fma_f32 v[186:187], v[186:187], v[10:11], v[6:7]
    v_pk_fma_f32 v[188:189], v[188:189], v[10:11], v[6:7]
    v_pk_fma_f32 v[190:191], v[190:191], v[10:11], v[6:7]
    v_pk_mul_f32 v[184:185], v[184:185], v[96:97]
    v_pk_mul_f32 v[186:187], v[186:187], v[98:99]
    v_pk_mul_f32 v[188:189], v[188:189], v[100:101]
    v_pk_mul_f32 v[190:191], v[190:191], v[102:103]
    v_exp_f32 v184, v184
    v_exp_f32 v185, v185
    v_exp_f32 v186, v186
    v_exp_f32 v187, v187
    v_exp_f32 v188, v188
    v_exp_f32 v189, v189
    v_exp_f32 v190, v190
    v_exp_f32 v191, v191
    v_pk_add_f32 v[184:185], v[184:185], v[12:13]
    v_pk_add_f32 v[186:187], v[186:187], v[12:13]
    v_pk_add_f32 v[188:189], v[188:189], v[12:13]
    v_pk_add_f32 v[190:191], v[190:191], v[12:13]
    v_rcp_f32 v184, v184
    v_rcp_f32 v185, v185
    v_rcp_f32 v186, v186
    v_rcp_f32 v187, v187
    v_rcp_f32 v188, v188
    v_rcp_f32 v189, v189
    v_rcp_f32 v190, v190
    v_rcp_f32 v191, v191
    v_pk_mul_f32 v[96:97], v[96:97], v[184:185]
    v_pk_mul_f32 v[98:99], v[98:99], v[186:187]
    v_pk_mul_f32 v[100:101], v[100:101], v[188:189]
    v_pk_mul_f32 v[102:103], v[102:103], v[190:191]
    v_cvt_pk_bf16_f32 v80, v80, v81
    v_cvt_pk_bf16_f32 v81, v82, v83
    v_cvt_pk_bf16_f32 v82, v96, v97
    v_cvt_pk_bf16_f32 v83, v98, v99
    s_nop 1
    v_permlane16_swap_b32 v80, v82
    v_permlane16_swap_b32 v81, v83
    s_nop 0
    buffer_store_dwordx4 v[80:83], v5, s[16:19], s68 offen offset:2048
    v_cvt_pk_bf16_f32 v84, v84, v85
    v_cvt_pk_bf16_f32 v85, v86, v87
    v_cvt_pk_bf16_f32 v86, v100, v101
    v_cvt_pk_bf16_f32 v87, v102, v103
    s_nop 1
    v_permlane16_swap_b32 v84, v86
    v_permlane16_swap_b32 v85, v87
    s_nop 0
    buffer_store_dwordx4 v[84:87], v5, s[16:19], s69 offen offset:2048
    v_lshlrev_b32 v180, 16, v172
    v_and_b32 v181, 0xffff0000, v172
    v_lshlrev_b32 v182, 16, v173
    v_and_b32 v183, 0xffff0000, v173
    v_pk_fma_f32 v[184:185], v[152:153], v[132:133], v[180:181] op_sel:[0,1,0] op_sel_hi:[1,1,1]
    v_pk_fma_f32 v[186:187], v[154:155], v[132:133], v[182:183] op_sel:[0,1,0] op_sel_hi:[1,1,1]
    v_pk_fma_f32 v[188:189], v[152:153], v[134:135], v[180:181] op_sel:[0,1,0] op_sel_hi:[1,1,1]
    v_pk_fma_f32 v[190:191], v[154:155], v[134:135], v[182:183] op_sel:[0,1,0] op_sel_hi:[1,1,1]
    v_pk_fma_f32 v[88:89], v[88:89], v[132:133], v[184:185] op_sel:[0,0,0] op_sel_hi:[1,0,1]
    v_pk_fma_f32 v[90:91], v[90:91], v[132:133], v[186:187] op_sel:[0,0,0] op_sel_hi:[1,0,1]
    v_pk_fma_f32 v[92:93], v[92:93], v[134:135], v[188:189] op_sel:[0,0,0] op_sel_hi:[1,0,1]
    v_pk_fma_f32 v[94:95], v[94:95], v[134:135], v[190:191] op_sel:[0,0,0] op_sel_hi:[1,0,1]
    v_pk_mul_f32 v[184:185], v[88:89], v[88:89]
    v_pk_mul_f32 v[186:187], v[90:91], v[90:91]
    v_pk_mul_f32 v[188:189], v[92:93], v[92:93]
    v_pk_mul_f32 v[190:191], v[94:95], v[94:95]
    v_pk_fma_f32 v[184:185], v[184:185], v[10:11], v[6:7]
    v_pk_fma_f32 v[186:187], v[186:187], v[10:11], v[6:7]
    v_pk_fma_f32 v[188:189], v[188:189], v[10:11], v[6:7]
    v_pk_fma_f32 v[190:191], v[190:191], v[10:11], v[6:7]
    v_pk_mul_f32 v[184:185], v[184:185], v[88:89]
    v_pk_mul_f32 v[186:187], v[186:187], v[90:91]
    v_pk_mul_f32 v[188:189], v[188:189], v[92:93]
    v_pk_mul_f32 v[190:191], v[190:191], v[94:95]
    v_exp_f32 v184, v184
    v_exp_f32 v185, v185
    v_exp_f32 v186, v186
    v_exp_f32 v187, v187
    v_exp_f32 v188, v188
    v_exp_f32 v189, v189
    v_exp_f32 v190, v190
    v_exp_f32 v191, v191
    v_pk_add_f32 v[184:185], v[184:185], v[12:13]
    v_pk_add_f32 v[186:187], v[186:187], v[12:13]
    v_pk_add_f32 v[188:189], v[188:189], v[12:13]
    v_pk_add_f32 v[190:191], v[190:191], v[12:13]
    v_rcp_f32 v184, v184
    v_rcp_f32 v185, v185
    v_rcp_f32 v186, v186
    v_rcp_f32 v187, v187
    v_rcp_f32 v188, v188
    v_rcp_f32 v189, v189
    v_rcp_f32 v190, v190
    v_rcp_f32 v191, v191
    v_pk_mul_f32 v[88:89], v[88:89], v[184:185]
    v_pk_mul_f32 v[90:91], v[90:91], v[186:187]
    v_pk_mul_f32 v[92:93], v[92:93], v[188:189]
    v_pk_mul_f32 v[94:95], v[94:95], v[190:191]
    v_lshlrev_b32 v180, 16, v174
    v_and_b32 v181, 0xffff0000, v174
    v_lshlrev_b32 v182, 16, v175
    v_and_b32 v183, 0xffff0000, v175
    v_pk_fma_f32 v[184:185], v[156:157], v[132:133], v[180:181] op_sel:[0,1,0] op_sel_hi:[1,1,1]
    v_pk_fma_f32 v[186:187], v[158:159], v[132:133], v[182:183] op_sel:[0,1,0] op_sel_hi:[1,1,1]
    v_pk_fma_f32 v[188:189], v[156:157], v[134:135], v[180:181] op_sel:[0,1,0] op_sel_hi:[1,1,1]
    v_pk_fma_f32 v[190:191], v[158:159], v[134:135], v[182:183] op_sel:[0,1,0] op_sel_hi:[1,1,1]
    v_pk_fma_f32 v[104:105], v[104:105], v[132:133], v[184:185] op_sel:[0,0,0] op_sel_hi:[1,0,1]
    v_pk_fma_f32 v[106:107], v[106:107], v[132:133], v[186:187] op_sel:[0,0,0] op_sel_hi:[1,0,1]
    v_pk_fma_f32 v[108:109], v[108:109], v[134:135], v[188:189] op_sel:[0,0,0] op_sel_hi:[1,0,1]
    v_pk_fma_f32 v[110:111], v[110:111], v[134:135], v[190:191] op_sel:[0,0,0] op_sel_hi:[1,0,1]
    v_pk_mul_f32 v[184:185], v[104:105], v[104:105]
    v_pk_mul_f32 v[186:187], v[106:107], v[106:107]
    v_pk_mul_f32 v[188:189], v[108:109], v[108:109]
    v_pk_mul_f32 v[190:191], v[110:111], v[110:111]
    v_pk_fma_f32 v[184:185], v[184:185], v[10:11], v[6:7]
    v_pk_fma_f32 v[186:187], v[186:187], v[10:11], v[6:7]
    v_pk_fma_f32 v[188:189], v[188:189], v[10:11], v[6:7]
    v_pk_fma_f32 v[190:191], v[190:191], v[10:11], v[6:7]
    v_pk_mul_f32 v[184:185], v[184:185], v[104:105]
    v_pk_mul_f32 v[186:187], v[186:187], v[106:107]
    v_pk_mul_f32 v[188:189], v[188:189], v[108:109]
    v_pk_mul_f32 v[190:191], v[190:191], v[110:111]
    v_exp_f32 v184, v184
    v_exp_f32 v185, v185
    v_exp_f32 v186, v186
    v_exp_f32 v187, v187
    v_exp_f32 v188, v188
    v_exp_f32 v189, v189
    v_exp_f32 v190, v190
    v_exp_f32 v191, v191
    v_pk_add_f32 v[184:185], v[184:185], v[12:13]
    v_pk_add_f32 v[186:187], v[186:187], v[12:13]
    v_pk_add_f32 v[188:189], v[188:189], v[12:13]
    v_pk_add_f32 v[190:191], v[190:191], v[12:13]
    v_rcp_f32 v184, v184
    v_rcp_f32 v185, v185
    v_rcp_f32 v186, v186
    v_rcp_f32 v187, v187
    v_rcp_f32 v188, v188
    v_rcp_f32 v189, v189
    v_rcp_f32 v190, v190
    v_rcp_f32 v191, v191
    v_pk_mul_f32 v[104:105], v[104:105], v[184:185]
    v_pk_mul_f32 v[106:107], v[106:107], v[186:187]
    v_pk_mul_f32 v[108:109], v[108:109], v[188:189]
    v_pk_mul_f32 v[110:111], v[110:111], v[190:191]
    v_cvt_pk_bf16_f32 v88, v88, v89
    v_cvt_pk_bf16_f32 v89, v90, v91
    v_cvt_pk_bf16_f32 v90, v104, v105
    v_cvt_pk_bf16_f32 v91, v106, v107
    s_nop 1
    v_permlane16_swap_b32 v88, v90
    v_permlane16_swap_b32 v89, v91
    s_nop 0
    buffer_store_dwordx4 v[88:91], v5, s[16:19], s70 offen offset:2048
    v_cvt_pk_bf16_f32 v92, v92, v93
    v_cvt_pk_bf16_f32 v93, v94, v95
    v_cvt_pk_bf16_f32 v94, v108, v109
    v_cvt_pk_bf16_f32 v95, v110, v111
    s_nop 1
    v_permlane16_swap_b32 v92, v94
    v_permlane16_swap_b32 v93, v95
    s_nop 0
    buffer_store_dwordx4 v[92:95], v5, s[16:19], s71 offen offset:2048
    v_lshlrev_b32 v180, 16, v176
    v_and_b32 v181, 0xffff0000, v176
    v_lshlrev_b32 v182, 16, v177
    v_and_b32 v183, 0xffff0000, v177
    v_pk_fma_f32 v[184:185], v[160:161], v[128:129], v[180:181] op_sel:[0,1,0] op_sel_hi:[1,1,1]
    v_pk_fma_f32 v[186:187], v[162:163], v[128:129], v[182:183] op_sel:[0,1,0] op_sel_hi:[1,1,1]
    v_pk_fma_f32 v[188:189], v[160:161], v[130:131], v[180:181] op_sel:[0,1,0] op_sel_hi:[1,1,1]
    v_pk_fma_f32 v[190:191], v[162:163], v[130:131], v[182:183] op_sel:[0,1,0] op_sel_hi:[1,1,1]
    v_pk_fma_f32 v[112:113], v[112:113], v[128:129], v[184:185] op_sel:[0,0,0] op_sel_hi:[1,0,1]
    v_pk_fma_f32 v[114:115], v[114:115], v[128:129], v[186:187] op_sel:[0,0,0] op_sel_hi:[1,0,1]
    v_pk_fma_f32 v[116:117], v[116:117], v[130:131], v[188:189] op_sel:[0,0,0] op_sel_hi:[1,0,1]
    v_pk_fma_f32 v[118:119], v[118:119], v[130:131], v[190:191] op_sel:[0,0,0] op_sel_hi:[1,0,1]
    v_pk_mul_f32 v[184:185], v[112:113], v[112:113]
    v_pk_mul_f32 v[186:187], v[114:115], v[114:115]
    v_pk_mul_f32 v[188:189], v[116:117], v[116:117]
    v_pk_mul_f32 v[190:191], v[118:119], v[118:119]
    v_pk_fma_f32 v[184:185], v[184:185], v[10:11], v[6:7]
    v_pk_fma_f32 v[186:187], v[186:187], v[10:11], v[6:7]
    v_pk_fma_f32 v[188:189], v[188:189], v[10:11], v[6:7]
    v_pk_fma_f32 v[190:191], v[190:191], v[10:11], v[6:7]
    v_pk_mul_f32 v[184:185], v[184:185], v[112:113]
    v_pk_mul_f32 v[186:187], v[186:187], v[114:115]
    v_pk_mul_f32 v[188:189], v[188:189], v[116:117]
    v_pk_mul_f32 v[190:191], v[190:191], v[118:119]
    v_exp_f32 v184, v184
    v_exp_f32 v185, v185
    v_exp_f32 v186, v186
    v_exp_f32 v187, v187
    v_exp_f32 v188, v188
    v_exp_f32 v189, v189
    v_exp_f32 v190, v190
    v_exp_f32 v191, v191
    v_pk_add_f32 v[184:185], v[184:185], v[12:13]
    v_pk_add_f32 v[186:187], v[186:187], v[12:13]
    v_pk_add_f32 v[188:189], v[188:189], v[12:13]
    v_pk_add_f32 v[190:191], v[190:191], v[12:13]
    v_rcp_f32 v184, v184
    v_rcp_f32 v185, v185
    v_rcp_f32 v186, v186
    v_rcp_f32 v187, v187
    v_rcp_f32 v188, v188
    v_rcp_f32 v189, v189
    v_rcp_f32 v190, v190
    v_rcp_f32 v191, v191
    v_pk_mul_f32 v[112:113], v[112:113], v[184:185]
    v_pk_mul_f32 v[114:115], v[114:115], v[186:187]
    v_pk_mul_f32 v[116:117], v[116:117], v[188:189]
    v_pk_mul_f32 v[118:119], v[118:119], v[190:191]
    v_cvt_pk_bf16_f32 v112, v112, v113
    v_cvt_pk_bf16_f32 v113, v114, v115
    v_cvt_pk_bf16_f32 v114, v116, v117
    v_cvt_pk_bf16_f32 v115, v118, v119
    s_nop 1
    v_permlane16_swap_b32 v112, v114
    v_permlane16_swap_b32 v113, v115
    s_nop 0
    buffer_store_dwordx4 v[112:115], v9, s[16:19], s68 offen offset:3072
    v_lshlrev_b32 v180, 16, v176
    v_and_b32 v181, 0xffff0000, v176
    v_lshlrev_b32 v182, 16, v177
    v_and_b32 v183, 0xffff0000, v177
    v_pk_fma_f32 v[184:185], v[160:161], v[132:133], v[180:181] op_sel:[0,1,0] op_sel_hi:[1,1,1]
    v_pk_fma_f32 v[186:187], v[162:163], v[132:133], v[182:183] op_sel:[0,1,0] op_sel_hi:[1,1,1]
    v_pk_fma_f32 v[188:189], v[160:161], v[134:135], v[180:181] op_sel:[0,1,0] op_sel_hi:[1,1,1]
    v_pk_fma_f32 v[190:191], v[162:163], v[134:135], v[182:183] op_sel:[0,1,0] op_sel_hi:[1,1,1]
    v_pk_fma_f32 v[120:121], v[120:121], v[132:133], v[184:185] op_sel:[0,0,0] op_sel_hi:[1,0,1]
    v_pk_fma_f32 v[122:123], v[122:123], v[132:133], v[186:187] op_sel:[0,0,0] op_sel_hi:[1,0,1]
    v_pk_fma_f32 v[124:125], v[124:125], v[134:135], v[188:189] op_sel:[0,0,0] op_sel_hi:[1,0,1]
    v_pk_fma_f32 v[126:127], v[126:127], v[134:135], v[190:191] op_sel:[0,0,0] op_sel_hi:[1,0,1]
    v_pk_mul_f32 v[184:185], v[120:121], v[120:121]
    v_pk_mul_f32 v[186:187], v[122:123], v[122:123]
    v_pk_mul_f32 v[188:189], v[124:125], v[124:125]
    v_pk_mul_f32 v[190:191], v[126:127], v[126:127]
    v_pk_fma_f32 v[184:185], v[184:185], v[10:11], v[6:7]
    v_pk_fma_f32 v[186:187], v[186:187], v[10:11], v[6:7]
    v_pk_fma_f32 v[188:189], v[188:189], v[10:11], v[6:7]
    v_pk_fma_f32 v[190:191], v[190:191], v[10:11], v[6:7]
    v_pk_mul_f32 v[184:185], v[184:185], v[120:121]
    v_pk_mul_f32 v[186:187], v[186:187], v[122:123]
    v_pk_mul_f32 v[188:189], v[188:189], v[124:125]
    v_pk_mul_f32 v[190:191], v[190:191], v[126:127]
    v_exp_f32 v184, v184
    v_exp_f32 v185, v185
    v_exp_f32 v186, v186
    v_exp_f32 v187, v187
    v_exp_f32 v188, v188
    v_exp_f32 v189, v189
    v_exp_f32 v190, v190
    v_exp_f32 v191, v191
    v_pk_add_f32 v[184:185], v[184:185], v[12:13]
    v_pk_add_f32 v[186:187], v[186:187], v[12:13]
    v_pk_add_f32 v[188:189], v[188:189], v[12:13]
    v_pk_add_f32 v[190:191], v[190:191], v[12:13]
    v_rcp_f32 v184, v184
    v_rcp_f32 v185, v185
    v_rcp_f32 v186, v186
    v_rcp_f32 v187, v187
    v_rcp_f32 v188, v188
    v_rcp_f32 v189, v189
    v_rcp_f32 v190, v190
    v_rcp_f32 v191, v191
    v_pk_mul_f32 v[120:121], v[120:121], v[184:185]
    v_pk_mul_f32 v[122:123], v[122:123], v[186:187]
    v_pk_mul_f32 v[124:125], v[124:125], v[188:189]
    v_pk_mul_f32 v[126:127], v[126:127], v[190:191]
    v_cvt_pk_bf16_f32 v120, v120, v121
    v_cvt_pk_bf16_f32 v121, v122, v123
    v_cvt_pk_bf16_f32 v122, v124, v125
    v_cvt_pk_bf16_f32 v123, v126, v127
    s_nop 1
    v_permlane16_swap_b32 v120, v122
    v_permlane16_swap_b32 v121, v123
    s_nop 0
    buffer_store_dwordx4 v[120:123], v9, s[16:19], s70 offen offset:3072
    s_endpgm
l1_ty1:
    s_cmp_eq_u32 s48, 3
    s_cbranch_scc1 l1_v
    ds_read_b128 v[128:131], v234 offset:0
    ds_read_b128 v[132:135], v234 offset:2048
    ds_read_b128 v[136:139], v234 offset:4096
    ds_read_b128 v[140:143], v234 offset:6144
    ds_read_b64_tr_b16 v[160:161], v238 offset:224
    ds_read_b64_tr_b16 v[162:163], v238 offset:4832
    ds_read_b128 v[184:187], v240 offset:0
    ds_read_b64_tr_b16 v[192:193], v239 offset:0
    ds_read_b64_tr_b16 v[194:195], v239 offset:4608
    ds_read_b64_tr_b16 v[112:113], v242 offset:0
    ds_read_b64_tr_b16 v[114:115], v242 offset:2560
    ds_read_b64_tr_b16 v[164:165], v241 offset:0
    ds_read_b64_tr_b16 v[166:167], v241 offset:2560
    ds_read_b64_tr_b16 v[168:169], v241 offset:32
    ds_read_b64_tr_b16 v[170:171], v241 offset:2592
    ds_read_b64_tr_b16 v[172:173], v241 offset:64
    ds_read_b64_tr_b16 v[174:175], v241 offset:2624
    s_waitcnt lgkmcnt(11)
    v_mfma_f32_16x16x32_bf16 v[16:19], v[160:163], v[128:131], 0
    v_mfma_f32_16x16x32_bf16 v[20:23], v[160:163], v[132:135], 0
    v_mfma_f32_16x16x32_bf16 v[24:27], v[160:163], v[136:139], 0
    v_mfma_f32_16x16x32_bf16 v[28:31], v[160:163], v[140:143], 0
    ds_read_b64_tr_b16 v[176:177], v241 offset:96
    ds_read_b64_tr_b16 v[178:179], v241 offset:2656
    s_add_u32 m0, s53, 65536
    s_nop 0
    buffer_load_dwordx4 v228, s[4:7], s49 offen lds
    s_waitcnt lgkmcnt(6)
    v_mfma_f32_16x16x32_bf16 v[32:35], v[164:167], v[128:131], 0
    v_mfma_f32_16x16x32_bf16 v[36:39], v[164:167], v[132:135], 0
    v_mfma_f32_16x16x32_bf16 v[40:43], v[164:167], v[136:139], 0
    v_mfma_f32_16x16x32_bf16 v[44:47], v[164:167], v[140:143], 0
    v_mfma_f32_16x16x32_bf16 v[200:203], v[184:187], v[136:139], 0
    v_mfma_f32_16x16x32_bf16 v[204:207], v[184:187], v[140:143], 0
    ds_read_b64_tr_b16 v[180:181], v241 offset:128
    ds_read_b64_tr_b16 v[182:183], v241 offset:2688
    s_add_u32 m0, s53, 66560
    s_nop 0
    buffer_load_dwordx4 v229, s[4:7], s49 offen lds
    s_waitcnt lgkmcnt(6)
    v_mfma_f32_16x16x32_bf16 v[48:51], v[168:171], v[128:131], 0
    v_mfma_f32_16x16x32_bf16 v[52:55], v[168:171], v[132:135], 0
    v_mfma_f32_16x16x32_bf16 v[56:59], v[168:171], v[136:139], 0
    v_mfma_f32_16x16x32_bf16 v[60:63], v[168:171], v[140:143], 0
    v_mfma_f32_16x16x32_bf16 v[208:211], v[192:195], v[216:219], 0
    ds_read_b128 v[144:147], v236 offset:0
    ds_read_b128 v[148:151], v236 offset:2048
    ds_read_b128 v[152:155], v236 offset:4096
    ds_read_b128 v[156:159], v236 offset:6144
    ds_read_b64_tr_b16 v[160:161], v238 offset:9440
    ds_read_b64_tr_b16 v[162:163], v238 offset:14048
    s_add_u32 m0, s53, 67584
    s_nop 0
    buffer_load_dwordx4 v230, s[4:7], s49 offen lds
    s_waitcnt lgkmcnt(10)
    v_mfma_f32_16x16x32_bf16 v[64:67], v[172:175], v[128:131], 0
    v_mfma_f32_16x16x32_bf16 v[68:71], v[172:175], v[132:135], 0
    v_mfma_f32_16x16x32_bf16 v[72:75], v[172:175], v[136:139], 0
    v_mfma_f32_16x16x32_bf16 v[76:79], v[172:175], v[140:143], 0
    v_mfma_f32_16x16x32_bf16 v[220:223], v[136:139], v[136:139], 0
    v_mfma_f32_16x16x32_bf16 v[224:227], v[140:143], v[140:143], 0
    ds_read_b128 v[188:191], v240 offset:64
    ds_read_b64_tr_b16 v[196:197], v239 offset:9216
    ds_read_b64_tr_b16 v[198:199], v239 offset:13824
    ds_read_b64_tr_b16 v[116:117], v242 offset:5120
    ds_read_b64_tr_b16 v[118:119], v242 offset:7680
    ds_read_b64_tr_b16 v[164:165], v241 offset:5120
    ds_read_b64_tr_b16 v[166:167], v241 offset:7680
    s_add_u32 m0, s53, 68608
    s_nop 0
    buffer_load_dwordx4 v231, s[4:7], s49 offen lds
    s_add_u32 s49, s49, 128
    s_waitcnt lgkmcnt(15)
    v_mfma_f32_16x16x32_bf16 v[80:83], v[176:179], v[128:131], 0
    v_mfma_f32_16x16x32_bf16 v[84:87], v[176:179], v[132:135], 0
    v_mfma_f32_16x16x32_bf16 v[88:91], v[176:179], v[136:139], 0
    v_mfma_f32_16x16x32_bf16 v[92:95], v[176:179], v[140:143], 0
    v_mfma_f32_16x16x32_bf16 v[212:215], v[112:115], v[216:219], 0
    ds_read_b64_tr_b16 v[168:169], v241 offset:5152
    ds_read_b64_tr_b16 v[170:171], v241 offset:7712
    s_add_u32 m0, s54, 27648
    s_nop 0
    buffer_load_dwordx4 v232, s[8:11], s50 offen lds
    s_add_u32 s50, s50, 294912
    s_waitcnt lgkmcnt(15)
    v_mfma_f32_16x16x32_bf16 v[96:99], v[180:183], v[128:131], 0
    v_mfma_f32_16x16x32_bf16 v[100:103], v[180:183], v[132:135], 0
    v_mfma_f32_16x16x32_bf16 v[104:107], v[180:183], v[136:139], 0
    v_mfma_f32_16x16x32_bf16 v[108:111], v[180:183], v[140:143], 0
    ds_read_b64_tr_b16 v[172:173], v241 offset:5184
    ds_read_b64_tr_b16 v[174:175], v241 offset:7744
    s_mov_b32 m0, s67
    s_nop 0
    buffer_load_dwordx4 v233, s[12:15], s51 offen lds
    s_add_u32 s51, s51, s52
    s_waitcnt vmcnt(6)
    s_barrier
    s_waitcnt lgkmcnt(11)
    v_mfma_f32_16x16x32_bf16 v[16:19], v[160:163], v[144:147], v[16:19]
    v_mfma_f32_16x16x32_bf16 v[20:23], v[160:163], v[148:151], v[20:23]
    v_mfma_f32_16x16x32_bf16 v[24:27], v[160:163], v[152:155], v[24:27]
    v_mfma_f32_16x16x32_bf16 v[28:31], v[160:163], v[156:159], v[28:31]
    ds_read_b64_tr_b16 v[176:177], v241 offset:5216
    ds_read_b64_tr_b16 v[178:179], v241 offset:7776
    s_add_u32 m0, s54, 0
    s_nop 0
    buffer_load_dwordx4 v232, s[8:11], s50 offen lds
    s_add_u32 s50, s50, 294912
    s_waitcnt lgkmcnt(6)
    v_mfma_f32_16x16x32_bf16 v[32:35], v[164:167], v[144:147], v[32:35]
    v_mfma_f32_16x16x32_bf16 v[36:39], v[164:167], v[148:151], v[36:39]
    v_mfma_f32_16x16x32_bf16 v[40:43], v[164:167], v[152:155], v[40:43]
    v_mfma_f32_16x16x32_bf16 v[44:47], v[164:167], v[156:159], v[44:47]
    v_mfma_f32_16x16x32_bf16 v[200:203], v[188:191], v[152:155], v[200:203]
    v_mfma_f32_16x16x32_bf16 v[204:207], v[188:191], v[156:159], v[204:207]
    ds_read_b64_tr_b16 v[180:181], v241 offset:5248
    ds_read_b64_tr_b16 v[182:183], v241 offset:7808
    s_mov_b32 m0, s64
    s_nop 0
    buffer_load_dwordx4 v233, s[12:15], s51 offen lds
    s_add_u32 s51, s51, s52
    s_waitcnt lgkmcnt(6)
    v_mfma_f32_16x16x32_bf16 v[48:51], v[168:171], v[144:147], v[48:51]
    v_mfma_f32_16x16x32_bf16 v[52:55], v[168:171], v[148:151], v[52:55]
    v_mfma_f32_16x16x32_bf16 v[56:59], v[168:171], v[152:155], v[56:59]
    v_mfma_f32_16x16x32_bf16 v[60:63], v[168:171], v[156:159], v[60:63]
    v_mfma_f32_16x16x32_bf16 v[208:211], v[196:199], v[216:219], v[208:211]
    ds_read_b128 v[128:131], v234 offset:32768
    ds_read_b128 v[132:135], v234 offset:34816
    ds_read_b128 v[136:139], v234 offset:36864
    ds_read_b128 v[140:143], v234 offset:38912
    ds_read_b64_tr_b16 v[160:161], v238 offset:18656
    ds_read_b64_tr_b16 v[162:163], v238 offset:23264
    s_waitcnt lgkmcnt(10)
    v_mfma_f32_16x16x32_bf16 v[64:67], v[172:175], v[144:147], v[64:67]
    v_mfma_f32_16x16x32_bf16 v[68:71], v[172:175], v[148:151], v[68:71]
    v_mfma_f32_16x16x32_bf16 v[72:75], v[172:175], v[152:155], v[72:75]
    v_mfma_f32_16x16x32_bf16 v[76:79], v[172:175], v[156:159], v[76:79]
    v_mfma_f32_16x16x32_bf16 v[220:223], v[152:155], v[152:155], v[220:223]
    v_mfma_f32_16x16x32_bf16 v[224:227], v[156:159], v[156:159], v[224:227]
    ds_read_b128 v[184:187], v240 offset:128
    ds_read_b64_tr_b16 v[192:193], v239 offset:18432
    ds_read_b64_tr_b16 v[194:195], v239 offset:23040
    ds_read_b64_tr_b16 v[112:113], v242 offset:10240
    ds_read_b64_tr_b16 v[114:115], v242 offset:12800
    ds_read_b64_tr_b16 v[164:165], v241 offset:10240
    ds_read_b64_tr_b16 v[166:167], v241 offset:12800
    s_waitcnt lgkmcnt(15)
    v_mfma_f32_16x16x32_bf16 v[80:83], v[176:179], v[144:147], v[80:83]
    v_mfma_f32_16x16x32_bf16 v[84:87], v[176:179], v[148:151], v[84:87]
    v_mfma_f32_16x16x32_bf16 v[88:91], v[176:179], v[152:155], v[88:91]
    v_mfma_f32_16x16x32_bf16 v[92:95], v[176:179], v[156:159], v[92:95]
    v_mfma_f32_16x16x32_bf16 v[212:215], v[116:119], v[216:219], v[212:215]
    ds_read_b64_tr_b16 v[168:169], v241 offset:10272
    ds_read_b64_tr_b16 v[170:171], v241 offset:12832
    s_waitcnt lgkmcnt(15)
    v_mfma_f32_16x16x32_bf16 v[96:99], v[180:183], v[144:147], v[96:99]
    v_mfma_f32_16x16x32_bf16 v[100:103], v[180:183], v[148:151], v[100:103]
    v_mfma_f32_16x16x32_bf16 v[104:107], v[180:183], v[152:155], v[104:107]
    v_mfma_f32_16x16x32_bf16 v[108:111], v[180:183], v[156:159], v[108:111]
    ds_read_b64_tr_b16 v[172:173], v241 offset:10304
    ds_read_b64_tr_b16 v[174:175], v241 offset:12864
    s_waitcnt vmcnt(2)
    s_barrier
    s_waitcnt lgkmcnt(11)
    v_mfma_f32_16x16x32_bf16 v[16:19], v[160:163], v[128:131], v[16:19]
    v_mfma_f32_16x16x32_bf16 v[20:23], v[160:163], v[132:135], v[20:23]
    v_mfma_f32_16x16x32_bf16 v[24:27], v[160:163], v[136:139], v[24:27]
    v_mfma_f32_16x16x32_bf16 v[28:31], v[160:163], v[140:143], v[28:31]
    ds_read_b64_tr_b16 v[176:177], v241 offset:10336
    ds_read_b64_tr_b16 v[178:179], v241 offset:12896
    s_add_u32 m0, s53, 0
    s_nop 0
    buffer_load_dwordx4 v228, s[4:7], s49 offen lds
    s_waitcnt lgkmcnt(6)
    v_mfma_f32_16x16x32_bf16 v[32:35], v[164:167], v[128:131], v[32:35]
    v_mfma_f32_16x16x32_bf16 v[36:39], v[164:167], v[132:135], v[36:39]
    v_mfma_f32_16x16x32_bf16 v[40:43], v[164:167], v[136:139], v[40:43]
    v_mfma_f32_16x16x32_bf16 v[44:47], v[164:167], v[140:143], v[44:47]
    v_mfma_f32_16x16x32_bf16 v[200:203], v[184:187], v[136:139], v[200:203]
    v_mfma_f32_16x16x32_bf16 v[204:207], v[184:187], v[140:143], v[204:207]
    ds_read_b64_tr_b16 v[180:181], v241 offset:10368
    ds_read_b64_tr_b16 v[182:183], v241 offset:12928
    s_add_u32 m0, s53, 1024
    s_nop 0
    buffer_load_dwordx4 v229, s[4:7], s49 offen lds
    s_waitcnt lgkmcnt(6)
    v_mfma_f32_16x16x32_bf16 v[48:51], v[168:171], v[128:131], v[48:51]
    v_mfma_f32_16x16x32_bf16 v[52:55], v[168:171], v[132:135], v[52:55]
    v_mfma_f32_16x16x32_bf16 v[56:59], v[168:171], v[136:139], v[56:59]
    v_mfma_f32_16x16x32_bf16 v[60:63], v[168:171], v[140:143], v[60:63]
    v_mfma_f32_16x16x32_bf16 v[208:211], v[192:195], v[216:219], v[208:211]
    ds_read_b128 v[144:147], v236 offset:32768
    ds_read_b128 v[148:151], v236 offset:34816
    ds_read_b128 v[152:155], v236 offset:36864
    ds_read_b128 v[156:159], v236 offset:38912
    ds_read_b64_tr_b16 v[160:161], v238 offset:27872
    ds_read_b64_tr_b16 v[162:163], v238 offset:32480
    s_add_u32 m0, s53, 2048
    s_nop 0
    buffer_load_dwordx4 v230, s[4:7], s49 offen lds
    s_waitcnt lgkmcnt(10)
    v_mfma_f32_16x16x32_bf16 v[64:67], v[172:175], v[128:131], v[64:67]
    v_mfma_f32_16x16x32_bf16 v[68:71], v[172:175], v[132:135], v[68:71]
    v_mfma_f32_16x16x32_bf16 v[72:75], v[172:175], v[136:139], v[72:75]
    v_mfma_f32_16x16x32_bf16 v[76:79], v[172:175], v[140:143], v[76:79]
    v_mfma_f32_16x16x32_bf16 v[220:223], v[136:139], v[136:139], v[220:223]
    v_mfma_f32_16x16x32_bf16 v[224:227], v[140:143], v[140:143], v[224:227]
    ds_read_b128 v[188:191], v240 offset:192
    ds_read_b64_tr_b16 v[196:197], v239 offset:27648
    ds_read_b64_tr_b16 v[198:199], v239 offset:32256
    ds_read_b64_tr_b16 v[116:117], v242 offset:15360
    ds_read_b64_tr_b16 v[118:119], v242 offset:17920
    ds_read_b64_tr_b16 v[164:165], v241 offset:15360
    ds_read_b64_tr_b16 v[166:167], v241 offset:17920
    s_add_u32 m0, s53, 3072
    s_nop 0
    buffer_load_dwordx4 v231, s[4:7], s49 offen lds
    s_add_u32 s49, s49, 128
    s_waitcnt lgkmcnt(15)
    v_mfma_f32_16x16x32_bf16 v[80:83], v[176:179], v[128:131], v[80:83]
    v_mfma_f32_16x16x32_bf16 v[84:87], v[176:179], v[132:135], v[84:87]
    v_mfma_f32_16x16x32_bf16 v[88:91], v[176:179], v[136:139], v[88:91]
    v_mfma_f32_16x16x32_bf16 v[92:95], v[176:179], v[140:143], v[92:95]
    v_mfma_f32_16x16x32_bf16 v[212:215], v[112:115], v[216:219], v[212:215]
    ds_read_b64_tr_b16 v[168:169], v241 offset:15392
    ds_read_b64_tr_b16 v[170:171], v241 offset:17952
    s_add_u32 m0, s54, 9216
    s_nop 0
    buffer_load_dwordx4 v232, s[8:11], s50 offen lds
    s_add_u32 s50, s50, 294912
    s_waitcnt lgkmcnt(15)
    v_mfma_f32_16x16x32_bf16 v[96:99], v[180:183], v[128:131], v[96:99]
    v_mfma_f32_16x16x32_bf16 v[100:103], v[180:183], v[132:135], v[100:103]
    v_mfma_f32_16x16x32_bf16 v[104:107], v[180:183], v[136:139], v[104:107]
    v_mfma_f32_16x16x32_bf16 v[108:111], v[180:183], v[140:143], v[108:111]
    ds_read_b64_tr_b16 v[172:173], v241 offset:15424
    ds_read_b64_tr_b16 v[174:175], v241 offset:17984
    s_mov_b32 m0, s65
    s_nop 0
    buffer_load_dwordx4 v233, s[12:15], s51 offen lds
    s_add_u32 s51, s51, s52
    s_waitcnt vmcnt(6)
    s_barrier
    s_waitcnt lgkmcnt(11)
    v_mfma_f32_16x16x32_bf16 v[16:19], v[160:163], v[144:147], v[16:19]
    v_mfma_f32_16x16x32_bf16 v[20:23], v[160:163], v[148:151], v[20:23]
    v_mfma_f32_16x16x32_bf16 v[24:27], v[160:163], v[152:155], v[24:27]
    v_mfma_f32_16x16x32_bf16 v[28:31], v[160:163], v[156:159], v[28:31]
    ds_read_b64_tr_b16 v[176:177], v241 offset:15456
    ds_read_b64_tr_b16 v[178:179], v241 offset:18016
    s_add_u32 m0, s54, 18432
    s_nop 0
    buffer_load_dwordx4 v232, s[8:11], s50 offen lds
    s_add_u32 s50, s50, 294912
    s_waitcnt lgkmcnt(6)
    v_mfma_f32_16x16x32_bf16 v[32:35], v[164:167], v[144:147], v[32:35]
    v_mfma_f32_16x16x32_bf16 v[36:39], v[164:167], v[148:151], v[36:39]
    v_mfma_f32_16x16x32_bf16 v[40:43], v[164:167], v[152:155], v[40:43]
    v_mfma_f32_16x16x32_bf16 v[44:47], v[164:167], v[156:159], v[44:47]
    v_mfma_f32_16x16x32_bf16 v[200:203], v[188:191], v[152:155], v[200:203]
    v_mfma_f32_16x16x32_bf16 v[204:207], v[188:191], v[156:159], v[204:207]
    ds_read_b64_tr_b16 v[180:181], v241 offset:15488
    ds_read_b64_tr_b16 v[182:183], v241 offset:18048
    s_mov_b32 m0, s66
    s_nop 0
    buffer_load_dwordx4 v233, s[12:15], s51 offen lds
    s_add_u32 s51, s51, s52
    s_waitcnt lgkmcnt(6)
    v_mfma_f32_16x16x32_bf16 v[48:51], v[168:171], v[144:147], v[48:51]
    v_mfma_f32_16x16x32_bf16 v[52:55], v[168:171], v[148:151], v[52:55]
    v_mfma_f32_16x16x32_bf16 v[56:59], v[168:171], v[152:155], v[56:59]
    v_mfma_f32_16x16x32_bf16 v[60:63], v[168:171], v[156:159], v[60:63]
    v_mfma_f32_16x16x32_bf16 v[208:211], v[196:199], v[216:219], v[208:211]
    ds_read_b128 v[128:131], v235 offset:0
    ds_read_b128 v[132:135], v235 offset:2048
    ds_read_b128 v[136:139], v235 offset:4096
    ds_read_b128 v[140:143], v235 offset:6144
    ds_read_b64_tr_b16 v[160:161], v238 offset:224
    ds_read_b64_tr_b16 v[162:163], v238 offset:4832
    s_waitcnt lgkmcnt(10)
    v_mfma_f32_16x16x32_bf16 v[64:67], v[172:175], v[144:147], v[64:67]
    v_mfma_f32_16x16x32_bf16 v[68:71], v[172:175], v[148:151], v[68:71]
    v_mfma_f32_16x16x32_bf16 v[72:75], v[172:175], v[152:155], v[72:75]
    v_mfma_f32_16x16x32_bf16 v[76:79], v[172:175], v[156:159], v[76:79]
    v_mfma_f32_16x16x32_bf16 v[220:223], v[152:155], v[152:155], v[220:223]
    v_mfma_f32_16x16x32_bf16 v[224:227], v[156:159], v[156:159], v[224:227]
    ds_read_b128 v[184:187], v240 offset:256
    ds_read_b64_tr_b16 v[192:193], v239 offset:0
    ds_read_b64_tr_b16 v[194:195], v239 offset:4608
    ds_read_b64_tr_b16 v[112:113], v242 offset:0
    ds_read_b64_tr_b16 v[114:115], v242 offset:2560
    ds_read_b64_tr_b16 v[164:165], v241 offset:0
    ds_read_b64_tr_b16 v[166:167], v241 offset:2560
    s_waitcnt lgkmcnt(15)
    v_mfma_f32_16x16x32_bf16 v[80:83], v[176:179], v[144:147], v[80:83]
    v_mfma_f32_16x16x32_bf16 v[84:87], v[176:179], v[148:151], v[84:87]
    v_mfma_f32_16x16x32_bf16 v[88:91], v[176:179], v[152:155], v[88:91]
    v_mfma_f32_16x16x32_bf16 v[92:95], v[176:179], v[156:159], v[92:95]
    v_mfma_f32_16x16x32_bf16 v[212:215], v[116:119], v[216:219], v[212:215]
    ds_read_b64_tr_b16 v[168:169], v241 offset:32
    ds_read_b64_tr_b16 v[170:171], v241 offset:2592
    s_waitcnt lgkmcnt(15)
    v_mfma_f32_16x16x32_bf16 v[96:99], v[180:183], v[144:147], v[96:99]
    v_mfma_f32_16x16x32_bf16 v[100:103], v[180:183], v[148:151], v[100:103]
    v_mfma_f32_16x16x32_bf16 v[104:107], v[180:183], v[152:155], v[104:107]
    v_mfma_f32_16x16x32_bf16 v[108:111], v[180:183], v[156:159], v[108:111]
    ds_read_b64_tr_b16 v[172:173], v241 offset:64
    ds_read_b64_tr_b16 v[174:175], v241 offset:2624
    s_waitcnt vmcnt(2)
    s_barrier
    s_waitcnt lgkmcnt(11)
    v_mfma_f32_16x16x32_bf16 v[16:19], v[160:163], v[128:131], v[16:19]
    v_mfma_f32_16x16x32_bf16 v[20:23], v[160:163], v[132:135], v[20:23]
    v_mfma_f32_16x16x32_bf16 v[24:27], v[160:163], v[136:139], v[24:27]
    v_mfma_f32_16x16x32_bf16 v[28:31], v[160:163], v[140:143], v[28:31]
    ds_read_b64_tr_b16 v[176:177], v241 offset:96
    ds_read_b64_tr_b16 v[178:179], v241 offset:2656
    s_add_u32 m0, s53, 32768
    s_nop 0
    buffer_load_dwordx4 v228, s[4:7], s49 offen lds
    s_waitcnt lgkmcnt(6)
    v_mfma_f32_16x16x32_bf16 v[32:35], v[164:167], v[128:131], v[32:35]
    v_mfma_f32_16x16x32_bf16 v[36:39], v[164:167], v[132:135], v[36:39]
    v_mfma_f32_16x16x32_bf16 v[40:43], v[164:167], v[136:139], v[40:43]
    v_mfma_f32_16x16x32_bf16 v[44:47], v[164:167], v[140:143], v[44:47]
    v_mfma_f32_16x16x32_bf16 v[200:203], v[184:187], v[136:139], v[200:203]
    v_mfma_f32_16x16x32_bf16 v[204:207], v[184:187], v[140:143], v[204:207]
    ds_read_b64_tr_b16 v[180:181], v241 offset:128
    ds_read_b64_tr_b16 v[182:183], v241 offset:2688
    s_add_u32 m0, s53, 33792
    s_nop 0
    buffer_load_dwordx4 v229, s[4:7], s49 offen lds
    s_waitcnt lgkmcnt(6)
    v_mfma_f32_16x16x32_bf16 v[48:51], v[168:171], v[128:131], v[48:51]
    v_mfma_f32_16x16x32_bf16 v[52:55], v[168:171], v[132:135], v[52:55]
    v_mfma_f32_16x16x32_bf16 v[56:59], v[168:171], v[136:139], v[56:59]
    v_mfma_f32_16x16x32_bf16 v[60:63], v[168:171], v[140:143], v[60:63]
    v_mfma_f32_16x16x32_bf16 v[208:211], v[192:195], v[216:219], v[208:211]
    ds_read_b128 v[144:147], v237 offset:0
    ds_read_b128 v[148:151], v237 offset:2048
    ds_read_b128 v[152:155], v237 offset:4096
    ds_read_b128 v[156:159], v237 offset:6144
    ds_read_b64_tr_b16 v[160:161], v238 offset:9440
    ds_read_b64_tr_b16 v[162:163], v238 offset:14048
    s_add_u32 m0, s53, 34816
    s_nop 0
    buffer_load_dwordx4 v230, s[4:7], s49 offen lds
    s_waitcnt lgkmcnt(10)
    v_mfma_f32_16x16x32_bf16 v[64:67], v[172:175], v[128:131], v[64:67]
    v_mfma_f32_16x16x32_bf16 v[68:71], v[172:175], v[132:135], v[68:71]
    v_mfma_f32_16x16x32_bf16 v[72:75], v[172:175], v[136:139], v[72:75]
    v_mfma_f32_16x16x32_bf16 v[76:79], v[172:175], v[140:143], v[76:79]
    v_mfma_f32_16x16x32_bf16 v[220:223], v[136:139], v[136:139], v[220:223]
    v_mfma_f32_16x16x32_bf16 v[224:227], v[140:143], v[140:143], v[224:227]
    ds_read_b128 v[188:191], v240 offset:320
    ds_read_b64_tr_b16 v[196:197], v239 offset:9216
    ds_read_b64_tr_b16 v[198:199], v239 offset:13824
    ds_read_b64_tr_b16 v[116:117], v242 offset:5120
    ds_read_b64_tr_b16 v[118:119], v242 offset:7680
    ds_read_b64_tr_b16 v[164:165], v241 offset:5120
    ds_read_b64_tr_b16 v[166:167], v241 offset:7680
    s_add_u32 m0, s53, 35840
    s_nop 0
    buffer_load_dwordx4 v231, s[4:7], s49 offen lds
    s_add_u32 s49, s49, 128
    s_waitcnt lgkmcnt(15)
    v_mfma_f32_16x16x32_bf16 v[80:83], v[176:179], v[128:131], v[80:83]
    v_mfma_f32_16x16x32_bf16 v[84:87], v[176:179], v[132:135], v[84:87]
    v_mfma_f32_16x16x32_bf16 v[88:91], v[176:179], v[136:139], v[88:91]
    v_mfma_f32_16x16x32_bf16 v[92:95], v[176:179], v[140:143], v[92:95]
    v_mfma_f32_16x16x32_bf16 v[212:215], v[112:115], v[216:219], v[212:215]
    ds_read_b64_tr_b16 v[168:169], v241 offset:5152
    ds_read_b64_tr_b16 v[170:171], v241 offset:7712
    s_add_u32 m0, s54, 27648
    s_nop 0
    buffer_load_dwordx4 v232, s[8:11], s50 offen lds
    s_add_u32 s50, s50, 294912
    s_waitcnt lgkmcnt(15)
    v_mfma_f32_16x16x32_bf16 v[96:99], v[180:183], v[128:131], v[96:99]
    v_mfma_f32_16x16x32_bf16 v[100:103], v[180:183], v[132:135], v[100:103]
    v_mfma_f32_16x16x32_bf16 v[104:107], v[180:183], v[136:139], v[104:107]
    v_mfma_f32_16x16x32_bf16 v[108:111], v[180:183], v[140:143], v[108:111]
    ds_read_b64_tr_b16 v[172:173], v241 offset:5184
    ds_read_b64_tr_b16 v[174:175], v241 offset:7744
    s_mov_b32 m0, s67
    s_nop 0
    buffer_load_dwordx4 v233, s[12:15], s51 offen lds
    s_add_u32 s51, s51, s52
    s_waitcnt vmcnt(6)
    s_barrier
    s_waitcnt lgkmcnt(11)
    v_mfma_f32_16x16x32_bf16 v[16:19], v[160:163], v[144:147], v[16:19]
    v_mfma_f32_16x16x32_bf16 v[20:23], v[160:163], v[148:151], v[20:23]
    v_mfma_f32_16x16x32_bf16 v[24:27], v[160:163], v[152:155], v[24:27]
    v_mfma_f32_16x16x32_bf16 v[28:31], v[160:163], v[156:159], v[28:31]
    ds_read_b64_tr_b16 v[176:177], v241 offset:5216
    ds_read_b64_tr_b16 v[178:179], v241 offset:7776
    s_add_u32 m0, s54, 0
    s_nop 0
    buffer_load_dwordx4 v232, s[8:11], s50 offen lds
    s_add_u32 s50, s50, 294912
    s_waitcnt lgkmcnt(6)
    v_mfma_f32_16x16x32_bf16 v[32:35], v[164:167], v[144:147], v[32:35]
    v_mfma_f32_16x16x32_bf16 v[36:39], v[164:167], v[148:151], v[36:39]
    v_mfma_f32_16x16x32_bf16 v[40:43], v[164:167], v[152:155], v[40:43]
    v_mfma_f32_16x16x32_bf16 v[44:47], v[164:167], v[156:159], v[44:47]
    v_mfma_f32_16x16x32_bf16 v[200:203], v[188:191], v[152:155], v[200:203]
    v_mfma_f32_16x16x32_bf16 v[204:207], v[188:191], v[156:159], v[204:207]
    ds_read_b64_tr_b16 v[180:181], v241 offset:5248
    ds_read_b64_tr_b16 v[182:183], v241 offset:7808
    s_mov_b32 m0, s64
    s_nop 0
    buffer_load_dwordx4 v233, s[12:15], s51 offen lds
    s_add_u32 s51, s51, s52
    s_waitcnt lgkmcnt(6)
    v_mfma_f32_16x16x32_bf16 v[48:51], v[168:171], v[144:147], v[48:51]
    v_mfma_f32_16x16x32_bf16 v[52:55], v[168:171], v[148:151], v[52:55]
    v_mfma_f32_16x16x32_bf16 v[56:59], v[168:171], v[152:155], v[56:59]
    v_mfma_f32_16x16x32_bf16 v[60:63], v[168:171], v[156:159], v[60:63]
    v_mfma_f32_16x16x32_bf16 v[208:211], v[196:199], v[216:219], v[208:211]
    ds_read_b128 v[128:131], v234 offset:0
    ds_read_b128 v[132:135], v234 offset:2048
    ds_read_b128 v[136:139], v234 offset:4096
    ds_read_b128 v[140:143], v234 offset:6144
    ds_read_b64_tr_b16 v[160:161], v238 offset:18656
    ds_read_b64_tr_b16 v[162:163], v238 offset:23264
    s_waitcnt lgkmcnt(10)
    v_mfma_f32_16x16x32_bf16 v[64:67], v[172:175], v[144:147], v[64:67]
    v_mfma_f32_16x16x32_bf16 v[68:71], v[172:175], v[148:151], v[68:71]
    v_mfma_f32_16x16x32_bf16 v[72:75], v[172:175], v[152:155], v[72:75]
    v_mfma_f32_16x16x32_bf16 v[76:79], v[172:175], v[156:159], v[76:79]
    v_mfma_f32_16x16x32_bf16 v[220:223], v[152:155], v[152:155], v[220:223]
    v_mfma_f32_16x16x32_bf16 v[224:227], v[156:159], v[156:159], v[224:227]
    ds_read_b128 v[184:187], v240 offset:384
    ds_read_b64_tr_b16 v[192:193], v239 offset:18432
    ds_read_b64_tr_b16 v[194:195], v239 offset:23040
    ds_read_b64_tr_b16 v[112:113], v242 offset:10240
    ds_read_b64_tr_b16 v[114:115], v242 offset:12800
    ds_read_b64_tr_b16 v[164:165], v241 offset:10240
    ds_read_b64_tr_b16 v[166:167], v241 offset:12800
    s_waitcnt lgkmcnt(15)
    v_mfma_f32_16x16x32_bf16 v[80:83], v[176:179], v[144:147], v[80:83]
    v_mfma_f32_16x16x32_bf16 v[84:87], v[176:179], v[148:151], v[84:87]
    v_mfma_f32_16x16x32_bf16 v[88:91], v[176:179], v[152:155], v[88:91]
    v_mfma_f32_16x16x32_bf16 v[92:95], v[176:179], v[156:159], v[92:95]
    v_mfma_f32_16x16x32_bf16 v[212:215], v[116:119], v[216:219], v[212:215]
    ds_read_b64_tr_b16 v[168:169], v241 offset:10272
    ds_read_b64_tr_b16 v[170:171], v241 offset:12832
    s_waitcnt lgkmcnt(15)
    v_mfma_f32_16x16x32_bf16 v[96:99], v[180:183], v[144:147], v[96:99]
    v_mfma_f32_16x16x32_bf16 v[100:103], v[180:183], v[148:151], v[100:103]
    v_mfma_f32_16x16x32_bf16 v[104:107], v[180:183], v[152:155], v[104:107]
    v_mfma_f32_16x16x32_bf16 v[108:111], v[180:183], v[156:159], v[108:111]
    ds_read_b64_tr_b16 v[172:173], v241 offset:10304
    ds_read_b64_tr_b16 v[174:175], v241 offset:12864
    s_waitcnt vmcnt(2)
    s_barrier
    s_waitcnt lgkmcnt(11)
    v_mfma_f32_16x16x32_bf16 v[16:19], v[160:163], v[128:131], v[16:19]
    v_mfma_f32_16x16x32_bf16 v[20:23], v[160:163], v[132:135], v[20:23]
    v_mfma_f32_16x16x32_bf16 v[24:27], v[160:163], v[136:139], v[24:27]
    v_mfma_f32_16x16x32_bf16 v[28:31], v[160:163], v[140:143], v[28:31]
    ds_read_b64_tr_b16 v[176:177], v241 offset:10336
    ds_read_b64_tr_b16 v[178:179], v241 offset:12896
    s_add_u32 m0, s53, 65536
    s_nop 0
    buffer_load_dwordx4 v228, s[4:7], s49 offen lds
    s_waitcnt lgkmcnt(6)
    v_mfma_f32_16x16x32_bf16 v[32:35], v[164:167], v[128:131], v[32:35]
    v_mfma_f32_16x16x32_bf16 v[36:39], v[164:167], v[132:135], v[36:39]
    v_mfma_f32_16x16x32_bf16 v[40:43], v[164:167], v[136:139], v[40:43]
    v_mfma_f32_16x16x32_bf16 v[44:47], v[164:167], v[140:143], v[44:47]
    v_mfma_f32_16x16x32_bf16 v[200:203], v[184:187], v[136:139], v[200:203]
    v_mfma_f32_16x16x32_bf16 v[204:207], v[184:187], v[140:143], v[204:207]
    ds_read_b64_tr_b16 v[180:181], v241 offset:10368
    ds_read_b64_tr_b16 v[182:183], v241 offset:12928
    s_add_u32 m0, s53, 66560
    s_nop 0
    buffer_load_dwordx4 v229, s[4:7], s49 offen lds
    s_waitcnt lgkmcnt(6)
    v_mfma_f32_16x16x32_bf16 v[48:51], v[168:171], v[128:131], v[48:51]
    v_mfma_f32_16x16x32_bf16 v[52:55], v[168:171], v[132:135], v[52:55]
    v_mfma_f32_16x16x32_bf16 v[56:59], v[168:171], v[136:139], v[56:59]
    v_mfma_f32_16x16x32_bf16 v[60:63], v[168:171], v[140:143], v[60:63]
    v_mfma_f32_16x16x32_bf16 v[208:211], v[192:195], v[216:219], v[208:211]
    ds_read_b128 v[144:147], v236 offset:0
    ds_read_b128 v[148:151], v236 offset:2048
    ds_read_b128 v[152:155], v236 offset:4096
    ds_read_b128 v[156:159], v236 offset:6144
    ds_read_b64_tr_b16 v[160:161], v238 offset:27872
    ds_read_b64_tr_b16 v[162:163], v238 offset:32480
    s_add_u32 m0, s53, 67584
    s_nop 0
    buffer_load_dwordx4 v230, s[4:7], s49 offen lds
    s_waitcnt lgkmcnt(10)
    v_mfma_f32_16x16x32_bf16 v[64:67], v[172:175], v[128:131], v[64:67]
    v_mfma_f32_16x16x32_bf16 v[68:71], v[172:175], v[132:135], v[68:71]
    v_mfma_f32_16x16x32_bf16 v[72:75], v[172:175], v[136:139], v[72:75]
    v_mfma_f32_16x16x32_bf16 v[76:79], v[172:175], v[140:143], v[76:79]
    v_mfma_f32_16x16x32_bf16 v[220:223], v[136:139], v[136:139], v[220:223]
    v_mfma_f32_16x16x32_bf16 v[224:227], v[140:143], v[140:143], v[224:227]
    ds_read_b128 v[188:191], v240 offset:448
    ds_read_b64_tr_b16 v[196:197], v239 offset:27648
    ds_read_b64_tr_b16 v[198:199], v239 offset:32256
    ds_read_b64_tr_b16 v[116:117], v242 offset:15360
    ds_read_b64_tr_b16 v[118:119], v242 offset:17920
    ds_read_b64_tr_b16 v[164:165], v241 offset:15360
    ds_read_b64_tr_b16 v[166:167], v241 offset:17920
    s_add_u32 m0, s53, 68608
    s_nop 0
    buffer_load_dwordx4 v231, s[4:7], s49 offen lds
    s_add_u32 s49, s49, 128
    s_waitcnt lgkmcnt(15)
    v_mfma_f32_16x16x32_bf16 v[80:83], v[176:179], v[128:131], v[80:83]
    v_mfma_f32_16x16x32_bf16 v[84:87], v[176:179], v[132:135], v[84:87]
    v_mfma_f32_16x16x32_bf16 v[88:91], v[176:179], v[136:139], v[88:91]
    v_mfma_f32_16x16x32_bf16 v[92:95], v[176:179], v[140:143], v[92:95]
    v_mfma_f32_16x16x32_bf16 v[212:215], v[112:115], v[216:219], v[212:215]
    ds_read_b64_tr_b16 v[168:169], v241 offset:15392
    ds_read_b64_tr_b16 v[170:171], v241 offset:17952
    s_add_u32 m0, s54, 9216
    s_nop 0
    buffer_load_dwordx4 v232, s[8:11], s50 offen lds
    s_add_u32 s50, s50, 294912
    s_waitcnt lgkmcnt(15)
    v_mfma_f32_16x16x32_bf16 v[96:99], v[180:183], v[128:131], v[96:99]
    v_mfma_f32_16x16x32_bf16 v[100:103], v[180:183], v[132:135], v[100:103]
    v_mfma_f32_16x16x32_bf16 v[104:107], v[180:183], v[136:139], v[104:107]
    v_mfma_f32_16x16x32_bf16 v[108:111], v[180:183], v[140:143], v[108:111]
    ds_read_b64_tr_b16 v[172:173], v241 offset:15424
    ds_read_b64_tr_b16 v[174:175], v241 offset:17984
    s_mov_b32 m0, s65
    s_nop 0
    buffer_load_dwordx4 v233, s[12:15], s51 offen lds
    s_add_u32 s51, s51, s52
    s_waitcnt vmcnt(6)
    s_barrier
    s_waitcnt lgkmcnt(11)
    v_mfma_f32_16x16x32_bf16 v[16:19], v[160:163], v[144:147], v[16:19]
    v_mfma_f32_16x16x32_bf16 v[20:23], v[160:163], v[148:151], v[20:23]
    v_mfma_f32_16x16x32_bf16 v[24:27], v[160:163], v[152:155], v[24:27]
    v_mfma_f32_16x16x32_bf16 v[28:31], v[160:163], v[156:159], v[28:31]
    ds_read_b64_tr_b16 v[176:177], v241 offset:15456
    ds_read_b64_tr_b16 v[178:179], v241 offset:18016
    s_add_u32 m0, s54, 18432
    s_nop 0
    buffer_load_dwordx4 v232, s[8:11], s50 offen lds
    s_add_u32 s50, s50, 294912
    s_waitcnt lgkmcnt(6)
    v_mfma_f32_16x16x32_bf16 v[32:35], v[164:167], v[144:147], v[32:35]
    v_mfma_f32_16x16x32_bf16 v[36:39], v[164:167], v[148:151], v[36:39]
    v_mfma_f32_16x16x32_bf16 v[40:43], v[164:167], v[152:155], v[40:43]
    v_mfma_f32_16x16x32_bf16 v[44:47], v[164:167], v[156:159], v[44:47]
    v_mfma_f32_16x16x32_bf16 v[200:203], v[188:191], v[152:155], v[200:203]
    v_mfma_f32_16x16x32_bf16 v[204:207], v[188:191], v[156:159], v[204:207]
    ds_read_b64_tr_b16 v[180:181], v241 offset:15488
    ds_read_b64_tr_b16 v[182:183], v241 offset:18048
    s_mov_b32 m0, s66
    s_nop 0
    buffer_load_dwordx4 v233, s[12:15], s51 offen lds
    s_add_u32 s51, s51, s52
    s_waitcnt lgkmcnt(6)
    v_mfma_f32_16x16x32_bf16 v[48:51], v[168:171], v[144:147], v[48:51]
    v_mfma_f32_16x16x32_bf16 v[52:55], v[168:171], v[148:151], v[52:55]
    v_mfma_f32_16x16x32_bf16 v[56:59], v[168:171], v[152:155], v[56:59]
    v_mfma_f32_16x16x32_bf16 v[60:63], v[168:171], v[156:159], v[60:63]
    v_mfma_f32_16x16x32_bf16 v[208:211], v[196:199], v[216:219], v[208:211]
    ds_read_b128 v[128:131], v234 offset:32768
    ds_read_b128 v[132:135], v234 offset:34816
    ds_read_b128 v[136:139], v234 offset:36864
    ds_read_b128 v[140:143], v234 offset:38912
    ds_read_b64_tr_b16 v[160:161], v238 offset:224
    ds_read_b64_tr_b16 v[162:163], v238 offset:4832
    s_waitcnt lgkmcnt(10)
    v_mfma_f32_16x16x32_bf16 v[64:67], v[172:175], v[144:147], v[64:67]
    v_mfma_f32_16x16x32_bf16 v[68:71], v[172:175], v[148:151], v[68:71]
    v_mfma_f32_16x16x32_bf16 v[72:75], v[172:175], v[152:155], v[72:75]
    v_mfma_f32_16x16x32_bf16 v[76:79], v[172:175], v[156:159], v[76:79]
    v_mfma_f32_16x16x32_bf16 v[220:223], v[152:155], v[152:155], v[220:223]
    v_mfma_f32_16x16x32_bf16 v[224:227], v[156:159], v[156:159], v[224:227]
    ds_read_b128 v[184:187], v240 offset:512
    ds_read_b64_tr_b16 v[192:193], v239 offset:0
    ds_read_b64_tr_b16 v[194:195], v239 offset:4608
    ds_read_b64_tr_b16 v[112:113], v242 offset:0
    ds_read_b64_tr_b16 v[114:115], v242 offset:2560
    ds_read_b64_tr_b16 v[164:165], v241 offset:0
    ds_read_b64_tr_b16 v[166:167], v241 offset:2560
    s_waitcnt lgkmcnt(15)
    v_mfma_f32_16x16x32_bf16 v[80:83], v[176:179], v[144:147], v[80:83]
    v_mfma_f32_16x16x32_bf16 v[84:87], v[176:179], v[148:151], v[84:87]
    v_mfma_f32_16x16x32_bf16 v[88:91], v[176:179], v[152:155], v[88:91]
    v_mfma_f32_16x16x32_bf16 v[92:95], v[176:179], v[156:159], v[92:95]
    v_mfma_f32_16x16x32_bf16 v[212:215], v[116:119], v[216:219], v[212:215]
    ds_read_b64_tr_b16 v[168:169], v241 offset:32
    ds_read_b64_tr_b16 v[170:171], v241 offset:2592
    s_waitcnt lgkmcnt(15)
    v_mfma_f32_16x16x32_bf16 v[96:99], v[180:183], v[144:147], v[96:99]
    v_mfma_f32_16x16x32_bf16 v[100:103], v[180:183], v[148:151], v[100:103]
    v_mfma_f32_16x16x32_bf16 v[104:107], v[180:183], v[152:155], v[104:107]
    v_mfma_f32_16x16x32_bf16 v[108:111], v[180:183], v[156:159], v[108:111]
    ds_read_b64_tr_b16 v[172:173], v241 offset:64
    ds_read_b64_tr_b16 v[174:175], v241 offset:2624
    s_waitcnt vmcnt(2)
    s_barrier
    s_waitcnt lgkmcnt(11)
    v_mfma_f32_16x16x32_bf16 v[16:19], v[160:163], v[128:131], v[16:19]
    v_mfma_f32_16x16x32_bf16 v[20:23], v[160:163], v[132:135], v[20:23]
    v_mfma_f32_16x16x32_bf16 v[24:27], v[160:163], v[136:139], v[24:27]
    v_mfma_f32_16x16x32_bf16 v[28:31], v[160:163], v[140:143], v[28:31]
    ds_read_b64_tr_b16 v[176:177], v241 offset:96
    ds_read_b64_tr_b16 v[178:179], v241 offset:2656
    s_add_u32 m0, s53, 0
    s_nop 0
    buffer_load_dwordx4 v228, s[4:7], s49 offen lds
    s_waitcnt lgkmcnt(6)
    v_mfma_f32_16x16x32_bf16 v[32:35], v[164:167], v[128:131], v[32:35]
    v_mfma_f32_16x16x32_bf16 v[36:39], v[164:167], v[132:135], v[36:39]
    v_mfma_f32_16x16x32_bf16 v[40:43], v[164:167], v[136:139], v[40:43]
    v_mfma_f32_16x16x32_bf16 v[44:47], v[164:167], v[140:143], v[44:47]
    v_mfma_f32_16x16x32_bf16 v[200:203], v[184:187], v[136:139], v[200:203]
    v_mfma_f32_16x16x32_bf16 v[204:207], v[184:187], v[140:143], v[204:207]
    ds_read_b64_tr_b16 v[180:181], v241 offset:128
    ds_read_b64_tr_b16 v[182:183], v241 offset:2688
    s_add_u32 m0, s53, 1024
    s_nop 0
    buffer_load_dwordx4 v229, s[4:7], s49 offen lds
    s_waitcnt lgkmcnt(6)
    v_mfma_f32_16x16x32_bf16 v[48:51], v[168:171], v[128:131], v[48:51]
    v_mfma_f32_16x16x32_bf16 v[52:55], v[168:171], v[132:135], v[52:55]
    v_mfma_f32_16x16x32_bf16 v[56:59], v[168:171], v[136:139], v[56:59]
    v_mfma_f32_16x16x32_bf16 v[60:63], v[168:171], v[140:143], v[60:63]
    v_mfma_f32_16x16x32_bf16 v[208:211], v[192:195], v[216:219], v[208:211]
    ds_read_b128 v[144:147], v236 offset:32768
    ds_read_b128 v[148:151], v236 offset:34816
    ds_read_b128 v[152:155], v236 offset:36864
    ds_read_b128 v[156:159], v236 offset:38912
    ds_read_b64_tr_b16 v[160:161], v238 offset:9440
    ds_read_b64_tr_b16 v[162:163], v238 offset:14048
    s_add_u32 m0, s53, 2048
    s_nop 0
    buffer_load_dwordx4 v230, s[4:7], s49 offen lds
    s_waitcnt lgkmcnt(10)
    v_mfma_f32_16x16x32_bf16 v[64:67], v[172:175], v[128:131], v[64:67]
    v_mfma_f32_16x16x32_bf16 v[68:71], v[172:175], v[132:135], v[68:71]
    v_mfma_f32_16x16x32_bf16 v[72:75], v[172:175], v[136:139], v[72:75]
    v_mfma_f32_16x16x32_bf16 v[76:79], v[172:175], v[140:143], v[76:79]
    v_mfma_f32_16x16x32_bf16 v[220:223], v[136:139], v[136:139], v[220:223]
    v_mfma_f32_16x16x32_bf16 v[224:227], v[140:143], v[140:143], v[224:227]
    ds_read_b128 v[188:191], v240 offset:576
    ds_read_b64_tr_b16 v[196:197], v239 offset:9216
    ds_read_b64_tr_b16 v[198:199], v239 offset:13824
    ds_read_b64_tr_b16 v[116:117], v242 offset:5120
    ds_read_b64_tr_b16 v[118:119], v242 offset:7680
    ds_read_b64_tr_b16 v[164:165], v241 offset:5120
    ds_read_b64_tr_b16 v[166:167], v241 offset:7680
    s_add_u32 m0, s53, 3072
    s_nop 0
    buffer_load_dwordx4 v231, s[4:7], s49 offen lds
    s_add_u32 s49, s49, 128
    s_waitcnt lgkmcnt(15)
    v_mfma_f32_16x16x32_bf16 v[80:83], v[176:179], v[128:131], v[80:83]
    v_mfma_f32_16x16x32_bf16 v[84:87], v[176:179], v[132:135], v[84:87]
    v_mfma_f32_16x16x32_bf16 v[88:91], v[176:179], v[136:139], v[88:91]
    v_mfma_f32_16x16x32_bf16 v[92:95], v[176:179], v[140:143], v[92:95]
    v_mfma_f32_16x16x32_bf16 v[212:215], v[112:115], v[216:219], v[212:215]
    ds_read_b64_tr_b16 v[168:169], v241 offset:5152
    ds_read_b64_tr_b16 v[170:171], v241 offset:7712
    s_add_u32 m0, s54, 27648
    s_nop 0
    buffer_load_dwordx4 v232, s[8:11], s50 offen lds
    s_add_u32 s50, s50, 294912
    s_waitcnt lgkmcnt(15)
    v_mfma_f32_16x16x32_bf16 v[96:99], v[180:183], v[128:131], v[96:99]
    v_mfma_f32_16x16x32_bf16 v[100:103], v[180:183], v[132:135], v[100:103]
    v_mfma_f32_16x16x32_bf16 v[104:107], v[180:183], v[136:139], v[104:107]
    v_mfma_f32_16x16x32_bf16 v[108:111], v[180:183], v[140:143], v[108:111]
    ds_read_b64_tr_b16 v[172:173], v241 offset:5184
    ds_read_b64_tr_b16 v[174:175], v241 offset:7744
    s_mov_b32 m0, s67
    s_nop 0
    buffer_load_dwordx4 v233, s[12:15], s51 offen lds
    s_add_u32 s51, s51, s52
    s_waitcnt vmcnt(6)
    s_barrier
    s_waitcnt lgkmcnt(11)
    v_mfma_f32_16x16x32_bf16 v[16:19], v[160:163], v[144:147], v[16:19]
    v_mfma_f32_16x16x32_bf16 v[20:23], v[160:163], v[148:151], v[20:23]
    v_mfma_f32_16x16x32_bf16 v[24:27], v[160:163], v[152:155], v[24:27]
    v_mfma_f32_16x16x32_bf16 v[28:31], v[160:163], v[156:159], v[28:31]
    ds_read_b64_tr_b16 v[176:177], v241 offset:5216
    ds_read_b64_tr_b16 v[178:179], v241 offset:7776
    s_add_u32 m0, s54, 0
    s_nop 0
    buffer_load_dwordx4 v232, s[8:11], s50 offen lds
    s_add_u32 s50, s50, 294912
    s_waitcnt lgkmcnt(6)
    v_mfma_f32_16x16x32_bf16 v[32:35], v[164:167], v[144:147], v[32:35]
    v_mfma_f32_16x16x32_bf16 v[36:39], v[164:167], v[148:151], v[36:39]
    v_mfma_f32_16x16x32_bf16 v[40:43], v[164:167], v[152:155], v[40:43]
    v_mfma_f32_16x16x32_bf16 v[44:47], v[164:167], v[156:159], v[44:47]
    v_mfma_f32_16x16x32_bf16 v[200:203], v[188:191], v[152:155], v[200:203]
    v_mfma_f32_16x16x32_bf16 v[204:207], v[188:191], v[156:159], v[204:207]
    ds_read_b64_tr_b16 v[180:181], v241 offset:5248
    ds_read_b64_tr_b16 v[182:183], v241 offset:7808
    s_mov_b32 m0, s64
    s_nop 0
    buffer_load_dwordx4 v233, s[12:15], s51 offen lds
    s_add_u32 s51, s51, s52
    s_waitcnt lgkmcnt(6)
    v_mfma_f32_16x16x32_bf16 v[48:51], v[168:171], v[144:147], v[48:51]
    v_mfma_f32_16x16x32_bf16 v[52:55], v[168:171], v[148:151], v[52:55]
    v_mfma_f32_16x16x32_bf16 v[56:59], v[168:171], v[152:155], v[56:59]
    v_mfma_f32_16x16x32_bf16 v[60:63], v[168:171], v[156:159], v[60:63]
    v_mfma_f32_16x16x32_bf16 v[208:211], v[196:199], v[216:219], v[208:211]
    ds_read_b128 v[128:131], v235 offset:0
    ds_read_b128 v[132:135], v235 offset:2048
    ds_read_b128 v[136:139], v235 offset:4096
    ds_read_b128 v[140:143], v235 offset:6144
    ds_read_b64_tr_b16 v[160:161], v238 offset:18656
    ds_read_b64_tr_b16 v[162:163], v238 offset:23264
    s_waitcnt lgkmcnt(10)
    v_mfma_f32_16x16x32_bf16 v[64:67], v[172:175], v[144:147], v[64:67]
    v_mfma_f32_16x16x32_bf16 v[68:71], v[172:175], v[148:151], v[68:71]
    v_mfma_f32_16x16x32_bf16 v[72:75], v[172:175], v[152:155], v[72:75]
    v_mfma_f32_16x16x32_bf16 v[76:79], v[172:175], v[156:159], v[76:79]
    v_mfma_f32_16x16x32_bf16 v[220:223], v[152:155], v[152:155], v[220:223]
    v_mfma_f32_16x16x32_bf16 v[224:227], v[156:159], v[156:159], v[224:227]
    ds_read_b128 v[184:187], v240 offset:640
    ds_read_b64_tr_b16 v[192:193], v239 offset:18432
    ds_read_b64_tr_b16 v[194:195], v239 offset:23040
    ds_read_b64_tr_b16 v[112:113], v242 offset:10240
    ds_read_b64_tr_b16 v[114:115], v242 offset:12800
    ds_read_b64_tr_b16 v[164:165], v241 offset:10240
    ds_read_b64_tr_b16 v[166:167], v241 offset:12800
    s_waitcnt lgkmcnt(15)
    v_mfma_f32_16x16x32_bf16 v[80:83], v[176:179], v[144:147], v[80:83]
    v_mfma_f32_16x16x32_bf16 v[84:87], v[176:179], v[148:151], v[84:87]
    v_mfma_f32_16x16x32_bf16 v[88:91], v[176:179], v[152:155], v[88:91]
    v_mfma_f32_16x16x32_bf16 v[92:95], v[176:179], v[156:159], v[92:95]
    v_mfma_f32_16x16x32_bf16 v[212:215], v[116:119], v[216:219], v[212:215]
    ds_read_b64_tr_b16 v[168:169], v241 offset:10272
    ds_read_b64_tr_b16 v[170:171], v241 offset:12832
    s_waitcnt lgkmcnt(15)
    v_mfma_f32_16x16x32_bf16 v[96:99], v[180:183], v[144:147], v[96:99]
    v_mfma_f32_16x16x32_bf16 v[100:103], v[180:183], v[148:151], v[100:103]
    v_mfma_f32_16x16x32_bf16 v[104:107], v[180:183], v[152:155], v[104:107]
    v_mfma_f32_16x16x32_bf16 v[108:111], v[180:183], v[156:159], v[108:111]
    ds_read_b64_tr_b16 v[172:173], v241 offset:10304
    ds_read_b64_tr_b16 v[174:175], v241 offset:12864
    s_waitcnt vmcnt(2)
    s_barrier
    s_waitcnt lgkmcnt(11)
    v_mfma_f32_16x16x32_bf16 v[16:19], v[160:163], v[128:131], v[16:19]
    v_mfma_f32_16x16x32_bf16 v[20:23], v[160:163], v[132:135], v[20:23]
    v_mfma_f32_16x16x32_bf16 v[24:27], v[160:163], v[136:139], v[24:27]
    v_mfma_f32_16x16x32_bf16 v[28:31], v[160:163], v[140:143], v[28:31]
    ds_read_b64_tr_b16 v[176:177], v241 offset:10336
    ds_read_b64_tr_b16 v[178:179], v241 offset:12896
    s_add_u32 m0, s53, 32768
    s_nop 0
    buffer_load_dwordx4 v228, s[4:7], s49 offen lds
    s_waitcnt lgkmcnt(6)
    v_mfma_f32_16x16x32_bf16 v[32:35], v[164:167], v[128:131], v[32:35]
    v_mfma_f32_16x16x32_bf16 v[36:39], v[164:167], v[132:135], v[36:39]
    v_mfma_f32_16x16x32_bf16 v[40:43], v[164:167], v[136:139], v[40:43]
    v_mfma_f32_16x16x32_bf16 v[44:47], v[164:167], v[140:143], v[44:47]
    v_mfma_f32_16x16x32_bf16 v[200:203], v[184:187], v[136:139], v[200:203]
    v_mfma_f32_16x16x32_bf16 v[204:207], v[184:187], v[140:143], v[204:207]
    ds_read_b64_tr_b16 v[180:181], v241 offset:10368
    ds_read_b64_tr_b16 v[182:183], v241 offset:12928
    s_add_u32 m0, s53, 33792
    s_nop 0
    buffer_load_dwordx4 v229, s[4:7], s49 offen lds
    s_waitcnt lgkmcnt(6)
    v_mfma_f32_16x16x32_bf16 v[48:51], v[168:171], v[128:131], v[48:51]
    v_mfma_f32_16x16x32_bf16 v[52:55], v[168:171], v[132:135], v[52:55]
    v_mfma_f32_16x16x32_bf16 v[56:59], v[168:171], v[136:139], v[56:59]
    v_mfma_f32_16x16x32_bf16 v[60:63], v[168:171], v[140:143], v[60:63]
    v_mfma_f32_16x16x32_bf16 v[208:211], v[192:195], v[216:219], v[208:211]
    ds_read_b128 v[144:147], v237 offset:0
    ds_read_b128 v[148:151], v237 offset:2048
    ds_read_b128 v[152:155], v237 offset:4096
    ds_read_b128 v[156:159], v237 offset:6144
    ds_read_b64_tr_b16 v[160:161], v238 offset:27872
    ds_read_b64_tr_b16 v[162:163], v238 offset:32480
    s_add_u32 m0, s53, 34816
    s_nop 0
    buffer_load_dwordx4 v230, s[4:7], s49 offen lds
    s_waitcnt lgkmcnt(10)
    v_mfma_f32_16x16x32_bf16 v[64:67], v[172:175], v[128:131], v[64:67]
    v_mfma_f32_16x16x32_bf16 v[68:71], v[172:175], v[132:135], v[68:71]
    v_mfma_f32_16x16x32_bf16 v[72:75], v[172:175], v[136:139], v[72:75]
    v_mfma_f32_16x16x32_bf16 v[76:79], v[172:175], v[140:143], v[76:79]
    v_mfma_f32_16x16x32_bf16 v[220:223], v[136:139], v[136:139], v[220:223]
    v_mfma_f32_16x16x32_bf16 v[224:227], v[140:143], v[140:143], v[224:227]
    ds_read_b128 v[188:191], v240 offset:704
    ds_read_b64_tr_b16 v[196:197], v239 offset:27648
    ds_read_b64_tr_b16 v[198:199], v239 offset:32256
    ds_read_b64_tr_b16 v[116:117], v242 offset:15360
    ds_read_b64_tr_b16 v[118:119], v242 offset:17920
    ds_read_b64_tr_b16 v[164:165], v241 offset:15360
    ds_read_b64_tr_b16 v[166:167], v241 offset:17920
    s_add_u32 m0, s53, 35840
    s_nop 0
    buffer_load_dwordx4 v231, s[4:7], s49 offen lds
    s_add_u32 s49, s49, 128
    s_waitcnt lgkmcnt(15)
    v_mfma_f32_16x16x32_bf16 v[80:83], v[176:179], v[128:131], v[80:83]
    v_mfma_f32_16x16x32_bf16 v[84:87], v[176:179], v[132:135], v[84:87]
    v_mfma_f32_16x16x32_bf16 v[88:91], v[176:179], v[136:139], v[88:91]
    v_mfma_f32_16x16x32_bf16 v[92:95], v[176:179], v[140:143], v[92:95]
    v_mfma_f32_16x16x32_bf16 v[212:215], v[112:115], v[216:219], v[212:215]
    ds_read_b64_tr_b16 v[168:169], v241 offset:15392
    ds_read_b64_tr_b16 v[170:171], v241 offset:17952
    s_add_u32 m0, s54, 9216
    s_nop 0
    buffer_load_dwordx4 v232, s[8:11], s50 offen lds
    s_add_u32 s50, s50, 294912
    s_waitcnt lgkmcnt(15)
    v_mfma_f32_16x16x32_bf16 v[96:99], v[180:183], v[128:131], v[96:99]
    v_mfma_f32_16x16x32_bf16 v[100:103], v[180:183], v[132:135], v[100:103]
    v_mfma_f32_16x16x32_bf16 v[104:107], v[180:183], v[136:139], v[104:107]
    v_mfma_f32_16x16x32_bf16 v[108:111], v[180:183], v[140:143], v[108:111]
    ds_read_b64_tr_b16 v[172:173], v241 offset:15424
    ds_read_b64_tr_b16 v[174:175], v241 offset:17984
    s_mov_b32 m0, s65
    s_nop 0
    buffer_load_dwordx4 v233, s[12:15], s51 offen lds
    s_add_u32 s51, s51, s52
    s_waitcnt vmcnt(6)
    s_barrier
    s_waitcnt lgkmcnt(11)
    v_mfma_f32_16x16x32_bf16 v[16:19], v[160:163], v[144:147], v[16:19]
    v_mfma_f32_16x16x32_bf16 v[20:23], v[160:163], v[148:151], v[20:23]
    v_mfma_f32_16x16x32_bf16 v[24:27], v[160:163], v[152:155], v[24:27]
    v_mfma_f32_16x16x32_bf16 v[28:31], v[160:163], v[156:159], v[28:31]
    ds_read_b64_tr_b16 v[176:177], v241 offset:15456
    ds_read_b64_tr_b16 v[178:179], v241 offset:18016
    s_add_u32 m0, s54, 18432
    s_nop 0
    buffer_load_dwordx4 v232, s[8:11], s50 offen lds
    s_add_u32 s50, s50, 294912
    s_waitcnt lgkmcnt(6)
    v_mfma_f32_16x16x32_bf16 v[32:35], v[164:167], v[144:147], v[32:35]
    v_mfma_f32_16x16x32_bf16 v[36:39], v[164:167], v[148:151], v[36:39]
    v_mfma_f32_16x16x32_bf16 v[40:43], v[164:167], v[152:155], v[40:43]
    v_mfma_f32_16x16x32_bf16 v[44:47], v[164:167], v[156:159], v[44:47]
    v_mfma_f32_16x16x32_bf16 v[200:203], v[188:191], v[152:155], v[200:203]
    v_mfma_f32_16x16x32_bf16 v[204:207], v[188:191], v[156:159], v[204:207]
    ds_read_b64_tr_b16 v[180:181], v241 offset:15488
    ds_read_b64_tr_b16 v[182:183], v241 offset:18048
    s_mov_b32 m0, s66
    s_nop 0
    buffer_load_dwordx4 v233, s[12:15], s51 offen lds
    s_add_u32 s51, s51, s52
    s_waitcnt lgkmcnt(6)
    v_mfma_f32_16x16x32_bf16 v[48:51], v[168:171], v[144:147], v[48:51]
    v_mfma_f32_16x16x32_bf16 v[52:55], v[168:171], v[148:151], v[52:55]
    v_mfma_f32_16x16x32_bf16 v[56:59], v[168:171], v[152:155], v[56:59]
    v_mfma_f32_16x16x32_bf16 v[60:63], v[168:171], v[156:159], v[60:63]
    v_mfma_f32_16x16x32_bf16 v[208:211], v[196:199], v[216:219], v[208:211]
    ds_read_b128 v[128:131], v234 offset:0
    ds_read_b128 v[132:135], v234 offset:2048
    ds_read_b128 v[136:139], v234 offset:4096
    ds_read_b128 v[140:143], v234 offset:6144
    ds_read_b64_tr_b16 v[160:161], v238 offset:224
    ds_read_b64_tr_b16 v[162:163], v238 offset:4832
    s_waitcnt lgkmcnt(10)
    v_mfma_f32_16x16x32_bf16 v[64:67], v[172:175], v[144:147], v[64:67]
    v_mfma_f32_16x16x32_bf16 v[68:71], v[172:175], v[148:151], v[68:71]
    v_mfma_f32_16x16x32_bf16 v[72:75], v[172:175], v[152:155], v[72:75]
    v_mfma_f32_16x16x32_bf16 v[76:79], v[172:175], v[156:159], v[76:79]
    v_mfma_f32_16x16x32_bf16 v[220:223], v[152:155], v[152:155], v[220:223]
    v_mfma_f32_16x16x32_bf16 v[224:227], v[156:159], v[156:159], v[224:227]
    ds_read_b128 v[184:187], v240 offset:768
    ds_read_b64_tr_b16 v[192:193], v239 offset:0
    ds_read_b64_tr_b16 v[194:195], v239 offset:4608
    ds_read_b64_tr_b16 v[112:113], v242 offset:0
    ds_read_b64_tr_b16 v[114:115], v242 offset:2560
    ds_read_b64_tr_b16 v[164:165], v241 offset:0
    ds_read_b64_tr_b16 v[166:167], v241 offset:2560
    s_waitcnt lgkmcnt(15)
    v_mfma_f32_16x16x32_bf16 v[80:83], v[176:179], v[144:147], v[80:83]
    v_mfma_f32_16x16x32_bf16 v[84:87], v[176:179], v[148:151], v[84:87]
    v_mfma_f32_16x16x32_bf16 v[88:91], v[176:179], v[152:155], v[88:91]
    v_mfma_f32_16x16x32_bf16 v[92:95], v[176:179], v[156:159], v[92:95]
    v_mfma_f32_16x16x32_bf16 v[212:215], v[116:119], v[216:219], v[212:215]
    ds_read_b64_tr_b16 v[168:169], v241 offset:32
    ds_read_b64_tr_b16 v[170:171], v241 offset:2592
    s_waitcnt lgkmcnt(15)
    v_mfma_f32_16x16x32_bf16 v[96:99], v[180:183], v[144:147], v[96:99]
    v_mfma_f32_16x16x32_bf16 v[100:103], v[180:183], v[148:151], v[100:103]
    v_mfma_f32_16x16x32_bf16 v[104:107], v[180:183], v[152:155], v[104:107]
    v_mfma_f32_16x16x32_bf16 v[108:111], v[180:183], v[156:159], v[108:111]
    ds_read_b64_tr_b16 v[172:173], v241 offset:64
    ds_read_b64_tr_b16 v[174:175], v241 offset:2624
    s_waitcnt vmcnt(2)
    s_barrier
    s_waitcnt lgkmcnt(11)
    v_mfma_f32_16x16x32_bf16 v[16:19], v[160:163], v[128:131], v[16:19]
    v_mfma_f32_16x16x32_bf16 v[20:23], v[160:163], v[132:135], v[20:23]
    v_mfma_f32_16x16x32_bf16 v[24:27], v[160:163], v[136:139], v[24:27]
    v_mfma_f32_16x16x32_bf16 v[28:31], v[160:163], v[140:143], v[28:31]
    ds_read_b64_tr_b16 v[176:177], v241 offset:96
    ds_read_b64_tr_b16 v[178:179], v241 offset:2656
    s_add_u32 m0, s53, 65536
    s_nop 0
    buffer_load_dwordx4 v228, s[4:7], s49 offen lds
    s_waitcnt lgkmcnt(6)
    v_mfma_f32_16x16x32_bf16 v[32:35], v[164:167], v[128:131], v[32:35]
    v_mfma_f32_16x16x32_bf16 v[36:39], v[164:167], v[132:135], v[36:39]
    v_mfma_f32_16x16x32_bf16 v[40:43], v[164:167], v[136:139], v[40:43]
    v_mfma_f32_16x16x32_bf16 v[44:47], v[164:167], v[140:143], v[44:47]
    v_mfma_f32_16x16x32_bf16 v[200:203], v[184:187], v[136:139], v[200:203]
    v_mfma_f32_16x16x32_bf16 v[204:207], v[184:187], v[140:143], v[204:207]
    ds_read_b64_tr_b16 v[180:181], v241 offset:128
    ds_read_b64_tr_b16 v[182:183], v241 offset:2688
    s_add_u32 m0, s53, 66560
    s_nop 0
    buffer_load_dwordx4 v229, s[4:7], s49 offen lds
    s_waitcnt lgkmcnt(6)
    v_mfma_f32_16x16x32_bf16 v[48:51], v[168:171], v[128:131], v[48:51]
    v_mfma_f32_16x16x32_bf16 v[52:55], v[168:171], v[132:135], v[52:55]
    v_mfma_f32_16x16x32_bf16 v[56:59], v[168:171], v[136:139], v[56:59]
    v_mfma_f32_16x16x32_bf16 v[60:63], v[168:171], v[140:143], v[60:63]
    v_mfma_f32_16x16x32_bf16 v[208:211], v[192:195], v[216:219], v[208:211]
    ds_read_b128 v[144:147], v236 offset:0
    ds_read_b128 v[148:151], v236 offset:2048
    ds_read_b128 v[152:155], v236 offset:4096
    ds_read_b128 v[156:159], v236 offset:6144
    ds_read_b64_tr_b16 v[160:161], v238 offset:9440
    ds_read_b64_tr_b16 v[162:163], v238 offset:14048
    s_add_u32 m0, s53, 67584
    s_nop 0
    buffer_load_dwordx4 v230, s[4:7], s49 offen lds
    s_waitcnt lgkmcnt(10)
    v_mfma_f32_16x16x32_bf16 v[64:67], v[172:175], v[128:131], v[64:67]
    v_mfma_f32_16x16x32_bf16 v[68:71], v[172:175], v[132:135], v[68:71]
    v_mfma_f32_16x16x32_bf16 v[72:75], v[172:175], v[136:139], v[72:75]
    v_mfma_f32_16x16x32_bf16 v[76:79], v[172:175], v[140:143], v[76:79]
    v_mfma_f32_16x16x32_bf16 v[220:223], v[136:139], v[136:139], v[220:223]
    v_mfma_f32_16x16x32_bf16 v[224:227], v[140:143], v[140:143], v[224:227]
    ds_read_b128 v[188:191], v240 offset:832
    ds_read_b64_tr_b16 v[196:197], v239 offset:9216
    ds_read_b64_tr_b16 v[198:199], v239 offset:13824
    ds_read_b64_tr_b16 v[116:117], v242 offset:5120
    ds_read_b64_tr_b16 v[118:119], v242 offset:7680
    ds_read_b64_tr_b16 v[164:165], v241 offset:5120
    ds_read_b64_tr_b16 v[166:167], v241 offset:7680
    s_add_u32 m0, s53, 68608
    s_nop 0
    buffer_load_dwordx4 v231, s[4:7], s49 offen lds
    s_add_u32 s49, s49, 128
    s_waitcnt lgkmcnt(15)
    v_mfma_f32_16x16x32_bf16 v[80:83], v[176:179], v[128:131], v[80:83]
    v_mfma_f32_16x16x32_bf16 v[84:87], v[176:179], v[132:135], v[84:87]
    v_mfma_f32_16x16x32_bf16 v[88:91], v[176:179], v[136:139], v[88:91]
    v_mfma_f32_16x16x32_bf16 v[92:95], v[176:179], v[140:143], v[92:95]
    v_mfma_f32_16x16x32_bf16 v[212:215], v[112:115], v[216:219], v[212:215]
    ds_read_b64_tr_b16 v[168:169], v241 offset:5152
    ds_read_b64_tr_b16 v[170:171], v241 offset:7712
    s_add_u32 m0, s54, 27648
    s_nop 0
    buffer_load_dwordx4 v232, s[8:11], s50 offen lds
    s_add_u32 s50, s50, 294912
    s_waitcnt lgkmcnt(15)
    v_mfma_f32_16x16x32_bf16 v[96:99], v[180:183], v[128:131], v[96:99]
    v_mfma_f32_16x16x32_bf16 v[100:103], v[180:183], v[132:135], v[100:103]
    v_mfma_f32_16x16x32_bf16 v[104:107], v[180:183], v[136:139], v[104:107]
    v_mfma_f32_16x16x32_bf16 v[108:111], v[180:183], v[140:143], v[108:111]
    ds_read_b64_tr_b16 v[172:173], v241 offset:5184
    ds_read_b64_tr_b16 v[174:175], v241 offset:7744
    s_mov_b32 m0, s67
    s_nop 0
    buffer_load_dwordx4 v233, s[12:15], s51 offen lds
    s_add_u32 s51, s51, s52
    s_waitcnt vmcnt(6)
    s_barrier
    s_waitcnt lgkmcnt(11)
    v_mfma_f32_16x16x32_bf16 v[16:19], v[160:163], v[144:147], v[16:19]
    v_mfma_f32_16x16x32_bf16 v[20:23], v[160:163], v[148:151], v[20:23]
    v_mfma_f32_16x16x32_bf16 v[24:27], v[160:163], v[152:155], v[24:27]
    v_mfma_f32_16x16x32_bf16 v[28:31], v[160:163], v[156:159], v[28:31]
    ds_read_b64_tr_b16 v[176:177], v241 offset:5216
    ds_read_b64_tr_b16 v[178:179], v241 offset:7776
    s_add_u32 m0, s54, 0
    s_nop 0
    buffer_load_dwordx4 v232, s[8:11], s50 offen lds
    s_add_u32 s50, s50, 294912
    s_waitcnt lgkmcnt(6)
    v_mfma_f32_16x16x32_bf16 v[32:35], v[164:167], v[144:147], v[32:35]
    v_mfma_f32_16x16x32_bf16 v[36:39], v[164:167], v[148:151], v[36:39]
    v_mfma_f32_16x16x32_bf16 v[40:43], v[164:167], v[152:155], v[40:43]
    v_mfma_f32_16x16x32_bf16 v[44:47], v[164:167], v[156:159], v[44:47]
    v_mfma_f32_16x16x32_bf16 v[200:203], v[188:191], v[152:155], v[200:203]
    v_mfma_f32_16x16x32_bf16 v[204:207], v[188:191], v[156:159], v[204:207]
    ds_read_b64_tr_b16 v[180:181], v241 offset:5248
    ds_read_b64_tr_b16 v[182:183], v241 offset:7808
    s_mov_b32 m0, s64
    s_nop 0
    buffer_load_dwordx4 v233, s[12:15], s51 offen lds
    s_add_u32 s51, s51, s52
    s_waitcnt lgkmcnt(6)
    v_mfma_f32_16x16x32_bf16 v[48:51], v[168:171], v[144:147], v[48:51]
    v_mfma_f32_16x16x32_bf16 v[52:55], v[168:171], v[148:151], v[52:55]
    v_mfma_f32_16x16x32_bf16 v[56:59], v[168:171], v[152:155], v[56:59]
    v_mfma_f32_16x16x32_bf16 v[60:63], v[168:171], v[156:159], v[60:63]
    v_mfma_f32_16x16x32_bf16 v[208:211], v[196:199], v[216:219], v[208:211]
    ds_read_b128 v[128:131], v234 offset:32768
    ds_read_b128 v[132:135], v234 offset:34816
    ds_read_b128 v[136:139], v234 offset:36864
    ds_read_b128 v[140:143], v234 offset:38912
    ds_read_b64_tr_b16 v[160:161], v238 offset:18656
    ds_read_b64_tr_b16 v[162:163], v238 offset:23264
    s_waitcnt lgkmcnt(10)
    v_mfma_f32_16x16x32_bf16 v[64:67], v[172:175], v[144:147], v[64:67]
    v_mfma_f32_16x16x32_bf16 v[68:71], v[172:175], v[148:151], v[68:71]
    v_mfma_f32_16x16x32_bf16 v[72:75], v[172:175], v[152:155], v[72:75]
    v_mfma_f32_16x16x32_bf16 v[76:79], v[172:175], v[156:159], v[76:79]
    v_mfma_f32_16x16x32_bf16 v[220:223], v[152:155], v[152:155], v[220:223]
    v_mfma_f32_16x16x32_bf16 v[224:227], v[156:159], v[156:159], v[224:227]
    ds_read_b128 v[184:187], v240 offset:896
    ds_read_b64_tr_b16 v[192:193], v239 offset:18432
    ds_read_b64_tr_b16 v[194:195], v239 offset:23040
    ds_read_b64_tr_b16 v[112:113], v242 offset:10240
    ds_read_b64_tr_b16 v[114:115], v242 offset:12800
    ds_read_b64_tr_b16 v[164:165], v241 offset:10240
    ds_read_b64_tr_b16 v[166:167], v241 offset:12800
    s_waitcnt lgkmcnt(15)
    v_mfma_f32_16x16x32_bf16 v[80:83], v[176:179], v[144:147], v[80:83]
    v_mfma_f32_16x16x32_bf16 v[84:87], v[176:179], v[148:151], v[84:87]
    v_mfma_f32_16x16x32_bf16 v[88:91], v[176:179], v[152:155], v[88:91]
    v_mfma_f32_16x16x32_bf16 v[92:95], v[176:179], v[156:159], v[92:95]
    v_mfma_f32_16x16x32_bf16 v[212:215], v[116:119], v[216:219], v[212:215]
    ds_read_b64_tr_b16 v[168:169], v241 offset:10272
    ds_read_b64_tr_b16 v[170:171], v241 offset:12832
    s_waitcnt lgkmcnt(15)
    v_mfma_f32_16x16x32_bf16 v[96:99], v[180:183], v[144:147], v[96:99]
    v_mfma_f32_16x16x32_bf16 v[100:103], v[180:183], v[148:151], v[100:103]
    v_mfma_f32_16x16x32_bf16 v[104:107], v[180:183], v[152:155], v[104:107]
    v_mfma_f32_16x16x32_bf16 v[108:111], v[180:183], v[156:159], v[108:111]
    ds_read_b64_tr_b16 v[172:173], v241 offset:10304
    ds_read_b64_tr_b16 v[174:175], v241 offset:12864
    s_waitcnt vmcnt(2)
    s_barrier
    s_waitcnt lgkmcnt(11)
    v_mfma_f32_16x16x32_bf16 v[16:19], v[160:163], v[128:131], v[16:19]
    v_mfma_f32_16x16x32_bf16 v[20:23], v[160:163], v[132:135], v[20:23]
    v_mfma_f32_16x16x32_bf16 v[24:27], v[160:163], v[136:139], v[24:27]
    v_mfma_f32_16x16x32_bf16 v[28:31], v[160:163], v[140:143], v[28:31]
    ds_read_b64_tr_b16 v[176:177], v241 offset:10336
    ds_read_b64_tr_b16 v[178:179], v241 offset:12896
    s_add_u32 m0, s54, 9216
    s_nop 0
    buffer_load_dwordx4 v232, s[8:11], s50 offen lds
    s_add_u32 s50, s50, 294912
    s_waitcnt lgkmcnt(6)
    v_mfma_f32_16x16x32_bf16 v[32:35], v[164:167], v[128:131], v[32:35]
    v_mfma_f32_16x16x32_bf16 v[36:39], v[164:167], v[132:135], v[36:39]
    v_mfma_f32_16x16x32_bf16 v[40:43], v[164:167], v[136:139], v[40:43]
    v_mfma_f32_16x16x32_bf16 v[44:47], v[164:167], v[140:143], v[44:47]
    v_mfma_f32_16x16x32_bf16 v[200:203], v[184:187], v[136:139], v[200:203]
    v_mfma_f32_16x16x32_bf16 v[204:207], v[184:187], v[140:143], v[204:207]
    ds_read_b64_tr_b16 v[180:181], v241 offset:10368
    ds_read_b64_tr_b16 v[182:183], v241 offset:12928
    s_mov_b32 m0, s65
    s_nop 0
    buffer_load_dwordx4 v233, s[12:15], s51 offen lds
    s_add_u32 s51, s51, s52
    s_waitcnt lgkmcnt(6)
    v_mfma_f32_16x16x32_bf16 v[48:51], v[168:171], v[128:131], v[48:51]
    v_mfma_f32_16x16x32_bf16 v[52:55], v[168:171], v[132:135], v[52:55]
    v_mfma_f32_16x16x32_bf16 v[56:59], v[168:171], v[136:139], v[56:59]
    v_mfma_f32_16x16x32_bf16 v[60:63], v[168:171], v[140:143], v[60:63]
    v_mfma_f32_16x16x32_bf16 v[208:211], v[192:195], v[216:219], v[208:211]
    ds_read_b128 v[144:147], v236 offset:32768
    ds_read_b128 v[148:151], v236 offset:34816
    ds_read_b128 v[152:155], v236 offset:36864
    ds_read_b128 v[156:159], v236 offset:38912
    ds_read_b64_tr_b16 v[160:161], v238 offset:27872
    ds_read_b64_tr_b16 v[162:163], v238 offset:32480
    s_waitcnt lgkmcnt(10)
    v_mfma_f32_16x16x32_bf16 v[64:67], v[172:175], v[128:131], v[64:67]
    v_mfma_f32_16x16x32_bf16 v[68:71], v[172:175], v[132:135], v[68:71]
    v_mfma_f32_16x16x32_bf16 v[72:75], v[172:175], v[136:139], v[72:75]
    v_mfma_f32_16x16x32_bf16 v[76:79], v[172:175], v[140:143], v[76:79]
    v_mfma_f32_16x16x32_bf16 v[220:223], v[136:139], v[136:139], v[220:223]
    v_mfma_f32_16x16x32_bf16 v[224:227], v[140:143], v[140:143], v[224:227]
    ds_read_b128 v[188:191], v240 offset:960
    ds_read_b64_tr_b16 v[196:197], v239 offset:27648
    ds_read_b64_tr_b16 v[198:199], v239 offset:32256
    ds_read_b64_tr_b16 v[116:117], v242 offset:15360
    ds_read_b64_tr_b16 v[118:119], v242 offset:17920
    ds_read_b64_tr_b16 v[164:165], v241 offset:15360
    ds_read_b64_tr_b16 v[166:167], v241 offset:17920
    s_waitcnt lgkmcnt(15)
    v_mfma_f32_16x16x32_bf16 v[80:83], v[176:179], v[128:131], v[80:83]
    v_mfma_f32_16x16x32_bf16 v[84:87], v[176:179], v[132:135], v[84:87]
    v_mfma_f32_16x16x32_bf16 v[88:91], v[176:179], v[136:139], v[88:91]
    v_mfma_f32_16x16x32_bf16 v[92:95], v[176:179], v[140:143], v[92:95]
    v_mfma_f32_16x16x32_bf16 v[212:215], v[112:115], v[216:219], v[212:215]
    ds_read_b64_tr_b16 v[168:169], v241 offset:15392
    ds_read_b64_tr_b16 v[170:171], v241 offset:17952
    s_waitcnt lgkmcnt(15)
    v_mfma_f32_16x16x32_bf16 v[96:99], v[180:183], v[128:131], v[96:99]
    v_mfma_f32_16x16x32_bf16 v[100:103], v[180:183], v[132:135], v[100:103]
    v_mfma_f32_16x16x32_bf16 v[104:107], v[180:183], v[136:139], v[104:107]
    v_mfma_f32_16x16x32_bf16 v[108:111], v[180:183], v[140:143], v[108:111]
    ds_read_b64_tr_b16 v[172:173], v241 offset:15424
    ds_read_b64_tr_b16 v[174:175], v241 offset:17984
    s_waitcnt vmcnt(2)
    s_barrier
    s_waitcnt lgkmcnt(11)
    v_mfma_f32_16x16x32_bf16 v[16:19], v[160:163], v[144:147], v[16:19]
    v_mfma_f32_16x16x32_bf16 v[20:23], v[160:163], v[148:151], v[20:23]
    v_mfma_f32_16x16x32_bf16 v[24:27], v[160:163], v[152:155], v[24:27]
    v_mfma_f32_16x16x32_bf16 v[28:31], v[160:163], v[156:159], v[28:31]
    ds_read_b64_tr_b16 v[176:177], v241 offset:15456
    ds_read_b64_tr_b16 v[178:179], v241 offset:18016
    s_waitcnt lgkmcnt(6)
    v_mfma_f32_16x16x32_bf16 v[32:35], v[164:167], v[144:147], v[32:35]
    v_mfma_f32_16x16x32_bf16 v[36:39], v[164:167], v[148:151], v[36:39]
    v_mfma_f32_16x16x32_bf16 v[40:43], v[164:167], v[152:155], v[40:43]
    v_mfma_f32_16x16x32_bf16 v[44:47], v[164:167], v[156:159], v[44:47]
    v_mfma_f32_16x16x32_bf16 v[200:203], v[188:191], v[152:155], v[200:203]
    v_mfma_f32_16x16x32_bf16 v[204:207], v[188:191], v[156:159], v[204:207]
    ds_read_b64_tr_b16 v[180:181], v241 offset:15488
    ds_read_b64_tr_b16 v[182:183], v241 offset:18048
    s_waitcnt lgkmcnt(6)
    v_mfma_f32_16x16x32_bf16 v[48:51], v[168:171], v[144:147], v[48:51]
    v_mfma_f32_16x16x32_bf16 v[52:55], v[168:171], v[148:151], v[52:55]
    v_mfma_f32_16x16x32_bf16 v[56:59], v[168:171], v[152:155], v[56:59]
    v_mfma_f32_16x16x32_bf16 v[60:63], v[168:171], v[156:159], v[60:63]
    v_mfma_f32_16x16x32_bf16 v[208:211], v[196:199], v[216:219], v[208:211]
    ds_read_b128 v[128:131], v235 offset:0
    ds_read_b128 v[132:135], v235 offset:2048
    ds_read_b128 v[136:139], v235 offset:4096
    ds_read_b128 v[140:143], v235 offset:6144
    ds_read_b64_tr_b16 v[160:161], v238 offset:224
    ds_read_b64_tr_b16 v[162:163], v238 offset:4832
    s_waitcnt lgkmcnt(10)
    v_mfma_f32_16x16x32_bf16 v[64:67], v[172:175], v[144:147], v[64:67]
    v_mfma_f32_16x16x32_bf16 v[68:71], v[172:175], v[148:151], v[68:71]
    v_mfma_f32_16x16x32_bf16 v[72:75], v[172:175], v[152:155], v[72:75]
    v_mfma_f32_16x16x32_bf16 v[76:79], v[172:175], v[156:159], v[76:79]
    v_mfma_f32_16x16x32_bf16 v[220:223], v[152:155], v[152:155], v[220:223]
    v_mfma_f32_16x16x32_bf16 v[224:227], v[156:159], v[156:159], v[224:227]
    ds_read_b128 v[184:187], v240 offset:1024
    ds_read_b64_tr_b16 v[192:193], v239 offset:0
    ds_read_b64_tr_b16 v[194:195], v239 offset:4608
    ds_read_b64_tr_b16 v[112:113], v242 offset:0
    ds_read_b64_tr_b16 v[114:115], v242 offset:2560
    ds_read_b64_tr_b16 v[164:165], v241 offset:0
    ds_read_b64_tr_b16 v[166:167], v241 offset:2560
    s_waitcnt lgkmcnt(15)
    v_mfma_f32_16x16x32_bf16 v[80:83], v[176:179], v[144:147], v[80:83]
    v_mfma_f32_16x16x32_bf16 v[84:87], v[176:179], v[148:151], v[84:87]
    v_mfma_f32_16x16x32_bf16 v[88:91], v[176:179], v[152:155], v[88:91]
    v_mfma_f32_16x16x32_bf16 v[92:95], v[176:179], v[156:159], v[92:95]
    v_mfma_f32_16x16x32_bf16 v[212:215], v[116:119], v[216:219], v[212:215]
    ds_read_b64_tr_b16 v[168:169], v241 offset:32
    ds_read_b64_tr_b16 v[170:171], v241 offset:2592
    s_waitcnt lgkmcnt(15)
    v_mfma_f32_16x16x32_bf16 v[96:99], v[180:183], v[144:147], v[96:99]
    v_mfma_f32_16x16x32_bf16 v[100:103], v[180:183], v[148:151], v[100:103]
    v_mfma_f32_16x16x32_bf16 v[104:107], v[180:183], v[152:155], v[104:107]
    v_mfma_f32_16x16x32_bf16 v[108:111], v[180:183], v[156:159], v[108:111]
    ds_read_b64_tr_b16 v[172:173], v241 offset:64
    ds_read_b64_tr_b16 v[174:175], v241 offset:2624
    s_waitcnt vmcnt(0)
    s_barrier
    s_lshl_b32 s55, s2, 3
    s_add_u32 s55, s55, s44
    s_mul_i32 s56, s55, 21
    v_add_u32 v3, s56, v1
    v_lshlrev_b32 v3, 7, v3
    s_mul_i32 s56, s55, 3
    v_add_u32 v4, s56, v1
    v_lshlrev_b32 v4, 7, v4
    s_mov_b64 exec, 0x1fffff
    buffer_load_dword v228, v3, s[96:99], 0 offen
    s_mov_b64 exec, 7
    buffer_load_dword v229, v4, s[92:95], 0 offen
    s_mov_b64 exec, -1
    s_waitcnt lgkmcnt(11)
    v_mfma_f32_16x16x32_bf16 v[16:19], v[160:163], v[128:131], v[16:19]
    v_mfma_f32_16x16x32_bf16 v[20:23], v[160:163], v[132:135], v[20:23]
    v_mfma_f32_16x16x32_bf16 v[24:27], v[160:163], v[136:139], v[24:27]
    v_mfma_f32_16x16x32_bf16 v[28:31], v[160:163], v[140:143], v[28:31]
    ds_read_b64_tr_b16 v[176:177], v241 offset:96
    ds_read_b64_tr_b16 v[178:179], v241 offset:2656
    s_waitcnt lgkmcnt(6)
    v_mfma_f32_16x16x32_bf16 v[32:35], v[164:167], v[128:131], v[32:35]
    v_mfma_f32_16x16x32_bf16 v[36:39], v[164:167], v[132:135], v[36:39]
    v_mfma_f32_16x16x32_bf16 v[40:43], v[164:167], v[136:139], v[40:43]
    v_mfma_f32_16x16x32_bf16 v[44:47], v[164:167], v[140:143], v[44:47]
    v_mfma_f32_16x16x32_bf16 v[200:203], v[184:187], v[136:139], v[200:203]
    v_mfma_f32_16x16x32_bf16 v[204:207], v[184:187], v[140:143], v[204:207]
    ds_read_b64_tr_b16 v[180:181], v241 offset:128
    ds_read_b64_tr_b16 v[182:183], v241 offset:2688
    s_waitcnt lgkmcnt(6)
    v_mfma_f32_16x16x32_bf16 v[48:51], v[168:171], v[128:131], v[48:51]
    v_mfma_f32_16x16x32_bf16 v[52:55], v[168:171], v[132:135], v[52:55]
    v_mfma_f32_16x16x32_bf16 v[56:59], v[168:171], v[136:139], v[56:59]
    v_mfma_f32_16x16x32_bf16 v[60:63], v[168:171], v[140:143], v[60:63]
    v_mfma_f32_16x16x32_bf16 v[208:211], v[192:195], v[216:219], v[208:211]
    ds_read_b128 v[144:147], v237 offset:0
    ds_read_b128 v[148:151], v237 offset:2048
    ds_read_b128 v[152:155], v237 offset:4096
    ds_read_b128 v[156:159], v237 offset:6144
    ds_read_b64_tr_b16 v[160:161], v238 offset:9440
    ds_read_b64_tr_b16 v[162:163], v238 offset:14048
    s_waitcnt lgkmcnt(10)
    v_mfma_f32_16x16x32_bf16 v[64:67], v[172:175], v[128:131], v[64:67]
    v_mfma_f32_16x16x32_bf16 v[68:71], v[172:175], v[132:135], v[68:71]
    v_mfma_f32_16x16x32_bf16 v[72:75], v[172:175], v[136:139], v[72:75]
    v_mfma_f32_16x16x32_bf16 v[76:79], v[172:175], v[140:143], v[76:79]
    v_mfma_f32_16x16x32_bf16 v[220:223], v[136:139], v[136:139], v[220:223]
    v_mfma_f32_16x16x32_bf16 v[224:227], v[140:143], v[140:143], v[224:227]
    ds_read_b128 v[188:191], v240 offset:1088
    ds_read_b64_tr_b16 v[196:197], v239 offset:9216
    ds_read_b64_tr_b16 v[198:199], v239 offset:13824
    ds_read_b64_tr_b16 v[116:117], v242 offset:5120
    ds_read_b64_tr_b16 v[118:119], v242 offset:7680
    ds_read_b64_tr_b16 v[164:165], v241 offset:5120
    ds_read_b64_tr_b16 v[166:167], v241 offset:7680
    s_waitcnt lgkmcnt(15)
    v_mfma_f32_16x16x32_bf16 v[80:83], v[176:179], v[128:131], v[80:83]
    v_mfma_f32_16x16x32_bf16 v[84:87], v[176:179], v[132:135], v[84:87]
    v_mfma_f32_16x16x32_bf16 v[88:91], v[176:179], v[136:139], v[88:91]
    v_mfma_f32_16x16x32_bf16 v[92:95], v[176:179], v[140:143], v[92:95]
    v_mfma_f32_16x16x32_bf16 v[212:215], v[112:115], v[216:219], v[212:215]
    ds_read_b64_tr_b16 v[168:169], v241 offset:5152
    ds_read_b64_tr_b16 v[170:171], v241 offset:7712
    s_waitcnt lgkmcnt(15)
    v_mfma_f32_16x16x32_bf16 v[96:99], v[180:183], v[128:131], v[96:99]
    v_mfma_f32_16x16x32_bf16 v[100:103], v[180:183], v[132:135], v[100:103]
    v_mfma_f32_16x16x32_bf16 v[104:107], v[180:183], v[136:139], v[104:107]
    v_mfma_f32_16x16x32_bf16 v[108:111], v[180:183], v[140:143], v[108:111]
    ds_read_b64_tr_b16 v[172:173], v241 offset:5184
    ds_read_b64_tr_b16 v[174:175], v241 offset:7744
    s_waitcnt vmcnt(2)
    s_barrier
    s_waitcnt lgkmcnt(11)
    v_mfma_f32_16x16x32_bf16 v[16:19], v[160:163], v[144:147], v[16:19]
    v_mfma_f32_16x16x32_bf16 v[20:23], v[160:163], v[148:151], v[20:23]
    v_mfma_f32_16x16x32_bf16 v[24:27], v[160:163], v[152:155], v[24:27]
    v_mfma_f32_16x16x32_bf16 v[28:31], v[160:163], v[156:159], v[28:31]
    ds_read_b64_tr_b16 v[176:177], v241 offset:5216
    ds_read_b64_tr_b16 v[178:179], v241 offset:7776
    s_waitcnt lgkmcnt(6)
    v_mfma_f32_16x16x32_bf16 v[32:35], v[164:167], v[144:147], v[32:35]
    v_mfma_f32_16x16x32_bf16 v[36:39], v[164:167], v[148:151], v[36:39]
    v_mfma_f32_16x16x32_bf16 v[40:43], v[164:167], v[152:155], v[40:43]
    v_mfma_f32_16x16x32_bf16 v[44:47], v[164:167], v[156:159], v[44:47]
    v_mfma_f32_16x16x32_bf16 v[200:203], v[188:191], v[152:155], v[200:203]
    v_mfma_f32_16x16x32_bf16 v[204:207], v[188:191], v[156:159], v[204:207]
    ds_read_b64_tr_b16 v[180:181], v241 offset:5248
    ds_read_b64_tr_b16 v[182:183], v241 offset:7808
    s_waitcnt lgkmcnt(6)
    v_mfma_f32_16x16x32_bf16 v[48:51], v[168:171], v[144:147], v[48:51]
    v_mfma_f32_16x16x32_bf16 v[52:55], v[168:171], v[148:151], v[52:55]
    v_mfma_f32_16x16x32_bf16 v[56:59], v[168:171], v[152:155], v[56:59]
    v_mfma_f32_16x16x32_bf16 v[60:63], v[168:171], v[156:159], v[60:63]
    v_mfma_f32_16x16x32_bf16 v[208:211], v[196:199], v[216:219], v[208:211]
    s_waitcnt lgkmcnt(4)
    v_mfma_f32_16x16x32_bf16 v[64:67], v[172:175], v[144:147], v[64:67]
    v_mfma_f32_16x16x32_bf16 v[68:71], v[172:175], v[148:151], v[68:71]
    v_mfma_f32_16x16x32_bf16 v[72:75], v[172:175], v[152:155], v[72:75]
    v_mfma_f32_16x16x32_bf16 v[76:79], v[172:175], v[156:159], v[76:79]
    v_mfma_f32_16x16x32_bf16 v[220:223], v[152:155], v[152:155], v[220:223]
    v_mfma_f32_16x16x32_bf16 v[224:227], v[156:159], v[156:159], v[224:227]
    s_waitcnt lgkmcnt(2)
    v_mfma_f32_16x16x32_bf16 v[80:83], v[176:179], v[144:147], v[80:83]
    v_mfma_f32_16x16x32_bf16 v[84:87], v[176:179], v[148:151], v[84:87]
    v_mfma_f32_16x16x32_bf16 v[88:91], v[176:179], v[152:155], v[88:91]
    v_mfma_f32_16x16x32_bf16 v[92:95], v[176:179], v[156:159], v[92:95]
    v_mfma_f32_16x16x32_bf16 v[212:215], v[116:119], v[216:219], v[212:215]
    s_waitcnt lgkmcnt(0)
    v_mfma_f32_16x16x32_bf16 v[96:99], v[180:183], v[144:147], v[96:99]
    v_mfma_f32_16x16x32_bf16 v[100:103], v[180:183], v[148:151], v[100:103]
    v_mfma_f32_16x16x32_bf16 v[104:107], v[180:183], v[152:155], v[104:107]
    v_mfma_f32_16x16x32_bf16 v[108:111], v[180:183], v[156:159], v[108:111]
    s_nop 7
    v_and_b32 v3, 3, v1
    v_bfe_u32 v4, v1, 2, 2
    v_lshrrev_b32 v5, 4, v1
    v_cmp_eq_u32 s[92:93], v4, v5
    v_cmp_eq_u32 vcc, 1, v3
    s_nop 1
    v_cndmask_b32 v220, v220, v221, vcc
    v_cndmask_b32 v224, v224, v225, vcc
    v_cmp_eq_u32 vcc, 2, v3
    s_nop 1
    v_cndmask_b32 v220, v220, v222, vcc
    v_cndmask_b32 v224, v224, v226, vcc
    v_cmp_eq_u32 vcc, 3, v3
    s_nop 1
    v_cndmask_b32 v220, v220, v223, vcc
    v_cndmask_b32 v224, v224, v227, vcc
    v_mov_b32 v4, 0
    v_cndmask_b32 v220, v4, v220, s[92:93]
    v_cndmask_b32 v221, v4, v224, s[92:93]
    v_mov_b32 v128, v220
    v_mov_b32 v129, v221
    s_nop 1
    v_permlane32_swap_b32 v128, v220
    v_permlane32_swap_b32 v129, v221
    s_nop 1
    v_add_f32 v220, v220, v128
    v_add_f32 v221, v221, v129
    v_mov_b32 v128, v220
    v_mov_b32 v129, v221
    s_nop 1
    v_permlane16_swap_b32 v128, v220
    v_permlane16_swap_b32 v129, v221
    s_nop 1
    v_add_f32 v220, v220, v128
    v_add_f32 v221, v221, v129
    s_nop 3
    v_mul_f32 v200, 0x3ae38e39, v200
    v_mul_f32 v132, v200, v200
    v_mul_f32 v133, 0x3ae38e39, v220
    v_sub_f32 v132, v133, v132
    v_max_f32 v132, 0, v132
    v_add_f32 v132, 0x3727c5ac, v132
    v_rsq_f32 v128, v132
    v_mul_f32 v201, 0xbfb8aa3b, v201
    v_exp_f32 v201, v201
    v_mul_f32 v129, v200, v128
    v_sub_f32 v129, 0, v129
    v_add_f32 v201, 1.0, v201
    v_rcp_f32 v201, v201
    v_mul_f32 v204, 0x3ae38e39, v204
    v_mul_f32 v132, v204, v204
    v_mul_f32 v133, 0x3ae38e39, v221
    v_sub_f32 v132, v133, v132
    v_max_f32 v132, 0, v132
    v_add_f32 v132, 0x3727c5ac, v132
    v_rsq_f32 v130, v132
    v_mul_f32 v205, 0xbfb8aa3b, v205
    v_exp_f32 v205, v205
    v_mul_f32 v131, v204, v130
    v_sub_f32 v131, 0, v131
    v_add_f32 v205, 1.0, v205
    v_rcp_f32 v205, v205
    v_and_b32 v3, 15, v1
    v_lshrrev_b32 v4, 4, v1
    s_lshl_b32 s55, s59, 6
    v_add_u32 v5, s55, v3
    v_lshlrev_b32 v6, 3, v5
    s_lshl_b32 s55, s44, 6
    v_lshl_add_u32 v7, v4, 4, s55
    ds_write_b128 v7, v[208:211] offset:2048
    ds_write_b128 v7, v[212:215] offset:2304
    s_mov_b64 exec, 0xffff
    ds_write_b64 v6, v[128:129] offset:256
    ds_write_b64 v6, v[130:131] offset:384
    s_and_b32 s3, s2, 31
    s_cbranch_scc1 l1_nog10
    v_add_u32 v7, s45, v5
    v_lshlrev_b32 v7, 2, v7
    buffer_store_dword v201, v7, s[28:31], 0 offen offset:128
    buffer_store_dword v205, v7, s[28:31], 0 offen offset:192
l1_nog10:
    s_mov_b64 exec, -1
    s_waitcnt lgkmcnt(0)
    s_barrier
    s_cmp_eq_u32 s48, 0
    s_cbranch_scc0 l1_qk
    ds_read_b64 v[128:129], v6 offset:0
    ds_read_b64 v[130:131], v6 offset:128
    ds_read_b64 v[132:133], v6 offset:256
    ds_read_b64 v[134:135], v6 offset:384
    v_lshlrev_b32 v7, 4, v4
    v_lshlrev_b32 v8, 3, v4
    v_add_u32 v8, 160768, v8
    ds_read_b128 v[136:139], v7 offset:2496
    ds_read_b64 v[156:157], v8 offset:224
    ds_read_b128 v[140:143], v7 offset:2560
    ds_read_b64 v[158:159], v8 offset:256
    ds_read_b128 v[144:147], v7 offset:2624
    ds_read_b64 v[160:161], v8 offset:288
    ds_read_b128 v[148:151], v7 offset:2688
    ds_read_b64 v[162:163], v8 offset:320
    ds_read_b128 v[152:155], v7 offset:2752
    ds_read_b64 v[164:165], v8 offset:352
    v_add_u32 v5, s45, v5
    v_lshrrev_b32 v6, 4, v5
    v_mul_u32_u24 v6, 147456, v6
    v_and_b32 v5, 15, v5
    v_lshl_add_u32 v5, v5, 4, v6
    s_lshl_b32 s55, s46, 5
    s_add_u32 s55, s55, 3584
    v_add_u32 v5, s55, v5
    v_and_b32 v8, 1, v4
    v_lshrrev_b32 v6, 1, v4
    v_lshl_add_u32 v5, v6, 8, v5
    v_mul_u32_u24 v9, 147456, v8
    v_add_u32 v9, v9, v5
    v_lshl_add_u32 v5, v8, 9, v5
    v_mov_b32 v6, 0xc0135761
    v_mov_b32 v7, 0xc0135761
    v_mov_b32 v10, 0xbdd2d3e8
    v_mov_b32 v11, 0xbdd2d3e8
    v_mov_b32 v12, 1.0
    v_mov_b32 v13, 1.0
    s_waitcnt lgkmcnt(0)
    v_lshlrev_b32 v168, 16, v156
    v_and_b32 v169, 0xffff0000, v156
    v_lshlrev_b32 v170, 16, v157
    v_and_b32 v171, 0xffff0000, v157
    v_pk_fma_f32 v[172:173], v[136:137], v[128:129], v[168:169] op_sel:[0,1,0] op_sel_hi:[1,1,1]
    v_pk_fma_f32 v[174:175], v[138:139], v[128:129], v[170:171] op_sel:[0,1,0] op_sel_hi:[1,1,1]
    v_pk_fma_f32 v[176:177], v[136:137], v[130:131], v[168:169] op_sel:[0,1,0] op_sel_hi:[1,1,1]
    v_pk_fma_f32 v[178:179], v[138:139], v[130:131], v[170:171] op_sel:[0,1,0] op_sel_hi:[1,1,1]
    v_pk_fma_f32 v[16:17], v[16:17], v[128:129], v[172:173] op_sel:[0,0,0] op_sel_hi:[1,0,1]
    v_pk_fma_f32 v[18:19], v[18:19], v[128:129], v[174:175] op_sel:[0,0,0] op_sel_hi:[1,0,1]
    v_pk_fma_f32 v[20:21], v[20:21], v[130:131], v[176:177] op_sel:[0,0,0] op_sel_hi:[1,0,1]
    v_pk_fma_f32 v[22:23], v[22:23], v[130:131], v[178:179] op_sel:[0,0,0] op_sel_hi:[1,0,1]
    v_pk_mul_f32 v[172:173], v[16:17], v[16:17]
    v_pk_mul_f32 v[174:175], v[18:19], v[18:19]
    v_pk_mul_f32 v[176:177], v[20:21], v[20:21]
    v_pk_mul_f32 v[178:179], v[22:23], v[22:23]
    v_pk_fma_f32 v[172:173], v[172:173], v[10:11], v[6:7]
    v_pk_fma_f32 v[174:175], v[174:175], v[10:11], v[6:7]
    v_pk_fma_f32 v[176:177], v[176:177], v[10:11], v[6:7]
    v_pk_fma_f32 v[178:179], v[178:179], v[10:11], v[6:7]
    v_pk_mul_f32 v[172:173], v[172:173], v[16:17]
    v_pk_mul_f32 v[174:175], v[174:175], v[18:19]
    v_pk_mul_f32 v[176:177], v[176:177], v[20:21]
    v_pk_mul_f32 v[178:179], v[178:179], v[22:23]
    v_exp_f32 v172, v172
    v_exp_f32 v173, v173
    v_exp_f32 v174, v174
    v_exp_f32 v175, v175
    v_exp_f32 v176, v176
    v_exp_f32 v177, v177
    v_exp_f32 v178, v178
    v_exp_f32 v179, v179
    v_pk_add_f32 v[172:173], v[172:173], v[12:13]
    v_pk_add_f32 v[174:175], v[174:175], v[12:13]
    v_pk_add_f32 v[176:177], v[176:177], v[12:13]
    v_pk_add_f32 v[178:179], v[178:179], v[12:13]
    v_rcp_f32 v172, v172
    v_rcp_f32 v173, v173
    v_rcp_f32 v174, v174
    v_rcp_f32 v175, v175
    v_rcp_f32 v176, v176
    v_rcp_f32 v177, v177
    v_rcp_f32 v178, v178
    v_rcp_f32 v179, v179
    v_pk_mul_f32 v[16:17], v[16:17], v[172:173]
    v_pk_mul_f32 v[18:19], v[18:19], v[174:175]
    v_pk_mul_f32 v[20:21], v[20:21], v[176:177]
    v_pk_mul_f32 v[22:23], v[22:23], v[178:179]
    v_lshlrev_b32 v168, 16, v158
    v_and_b32 v169, 0xffff0000, v158
    v_lshlrev_b32 v170, 16, v159
    v_and_b32 v171, 0xffff0000, v159
    v_pk_fma_f32 v[172:173], v[140:141], v[128:129], v[168:169] op_sel:[0,1,0] op_sel_hi:[1,1,1]
    v_pk_fma_f32 v[174:175], v[142:143], v[128:129], v[170:171] op_sel:[0,1,0] op_sel_hi:[1,1,1]
    v_pk_fma_f32 v[176:177], v[140:141], v[130:131], v[168:169] op_sel:[0,1,0] op_sel_hi:[1,1,1]
    v_pk_fma_f32 v[178:179], v[142:143], v[130:131], v[170:171] op_sel:[0,1,0] op_sel_hi:[1,1,1]
    v_pk_fma_f32 v[32:33], v[32:33], v[128:129], v[172:173] op_sel:[0,0,0] op_sel_hi:[1,0,1]
    v_pk_fma_f32 v[34:35], v[34:35], v[128:129], v[174:175] op_sel:[0,0,0] op_sel_hi:[1,0,1]
    v_pk_fma_f32 v[36:37], v[36:37], v[130:131], v[176:177] op_sel:[0,0,0] op_sel_hi:[1,0,1]
    v_pk_fma_f32 v[38:39], v[38:39], v[130:131], v[178:179] op_sel:[0,0,0] op_sel_hi:[1,0,1]
    v_pk_mul_f32 v[172:173], v[32:33], v[32:33]
    v_pk_mul_f32 v[174:175], v[34:35], v[34:35]
    v_pk_mul_f32 v[176:177], v[36:37], v[36:37]
    v_pk_mul_f32 v[178:179], v[38:39], v[38:39]
    v_pk_fma_f32 v[172:173], v[172:173], v[10:11], v[6:7]
    v_pk_fma_f32 v[174:175], v[174:175], v[10:11], v[6:7]
    v_pk_fma_f32 v[176:177], v[176:177], v[10:11], v[6:7]
    v_pk_fma_f32 v[178:179], v[178:179], v[10:11], v[6:7]
    v_pk_mul_f32 v[172:173], v[172:173], v[32:33]
    v_pk_mul_f32 v[174:175], v[174:175], v[34:35]
    v_pk_mul_f32 v[176:177], v[176:177], v[36:37]
    v_pk_mul_f32 v[178:179], v[178:179], v[38:39]
    v_exp_f32 v172, v172
    v_exp_f32 v173, v173
    v_exp_f32 v174, v174
    v_exp_f32 v175, v175
    v_exp_f32 v176, v176
    v_exp_f32 v177, v177
    v_exp_f32 v178, v178
    v_exp_f32 v179, v179
    v_pk_add_f32 v[172:173], v[172:173], v[12:13]
    v_pk_add_f32 v[174:175], v[174:175], v[12:13]
    v_pk_add_f32 v[176:177], v[176:177], v[12:13]
    v_pk_add_f32 v[178:179], v[178:179], v[12:13]
    v_rcp_f32 v172, v172
    v_rcp_f32 v173, v173
    v_rcp_f32 v174, v174
    v_rcp_f32 v175, v175
    v_rcp_f32 v176, v176
    v_rcp_f32 v177, v177
    v_rcp_f32 v178, v178
    v_rcp_f32 v179, v179
    v_pk_mul_f32 v[32:33], v[32:33], v[172:173]
    v_pk_mul_f32 v[34:35], v[34:35], v[174:175]
    v_pk_mul_f32 v[36:37], v[36:37], v[176:177]
    v_pk_mul_f32 v[38:39], v[38:39], v[178:179]
    v_cvt_pk_bf16_f32 v16, v16, v17
    v_cvt_pk_bf16_f32 v17, v18, v19
    v_cvt_pk_bf16_f32 v18, v32, v33
    v_cvt_pk_bf16_f32 v19, v34, v35
    s_nop 1
    v_permlane16_swap_b32 v16, v18
    v_permlane16_swap_b32 v17, v19
    s_nop 0
    buffer_store_dwordx4 v[16:19], v5, s[16:19], s68 offen offset:0
    v_cvt_pk_bf16_f32 v20, v20, v21
    v_cvt_pk_bf16_f32 v21, v22, v23
    v_cvt_pk_bf16_f32 v22, v36, v37
    v_cvt_pk_bf16_f32 v23, v38, v39
    s_nop 1
    v_permlane16_swap_b32 v20, v22
    v_permlane16_swap_b32 v21, v23
    s_nop 0
    buffer_store_dwordx4 v[20:23], v5, s[16:19], s69 offen offset:0
    v_lshlrev_b32 v168, 16, v156
    v_and_b32 v169, 0xffff0000, v156
    v_lshlrev_b32 v170, 16, v157
    v_and_b32 v171, 0xffff0000, v157
    v_pk_fma_f32 v[172:173], v[136:137], v[132:133], v[168:169] op_sel:[0,1,0] op_sel_hi:[1,1,1]
    v_pk_fma_f32 v[174:175], v[138:139], v[132:133], v[170:171] op_sel:[0,1,0] op_sel_hi:[1,1,1]
    v_pk_fma_f32 v[176:177], v[136:137], v[134:135], v[168:169] op_sel:[0,1,0] op_sel_hi:[1,1,1]
    v_pk_fma_f32 v[178:179], v[138:139], v[134:135], v[170:171] op_sel:[0,1,0] op_sel_hi:[1,1,1]
    v_pk_fma_f32 v[24:25], v[24:25], v[132:133], v[172:173] op_sel:[0,0,0] op_sel_hi:[1,0,1]
    v_pk_fma_f32 v[26:27], v[26:27], v[132:133], v[174:175] op_sel:[0,0,0] op_sel_hi:[1,0,1]
    v_pk_fma_f32 v[28:29], v[28:29], v[134:135], v[176:177] op_sel:[0,0,0] op_sel_hi:[1,0,1]
    v_pk_fma_f32 v[30:31], v[30:31], v[134:135], v[178:179] op_sel:[0,0,0] op_sel_hi:[1,0,1]
    v_pk_mul_f32 v[172:173], v[24:25], v[24:25]
    v_pk_mul_f32 v[174:175], v[26:27], v[26:27]
    v_pk_mul_f32 v[176:177], v[28:29], v[28:29]
    v_pk_mul_f32 v[178:179], v[30:31], v[30:31]
    v_pk_fma_f32 v[172:173], v[172:173], v[10:11], v[6:7]
    v_pk_fma_f32 v[174:175], v[174:175], v[10:11], v[6:7]
    v_pk_fma_f32 v[176:177], v[176:177], v[10:11], v[6:7]
    v_pk_fma_f32 v[178:179], v[178:179], v[10:11], v[6:7]
    v_pk_mul_f32 v[172:173], v[172:173], v[24:25]
    v_pk_mul_f32 v[174:175], v[174:175], v[26:27]
    v_pk_mul_f32 v[176:177], v[176:177], v[28:29]
    v_pk_mul_f32 v[178:179], v[178:179], v[30:31]
    v_exp_f32 v172, v172
    v_exp_f32 v173, v173
    v_exp_f32 v174, v174
    v_exp_f32 v175, v175
    v_exp_f32 v176, v176
    v_exp_f32 v177, v177
    v_exp_f32 v178, v178
    v_exp_f32 v179, v179
    v_pk_add_f32 v[172:173], v[172:173], v[12:13]
    v_pk_add_f32 v[174:175], v[174:175], v[12:13]
    v_pk_add_f32 v[176:177], v[176:177], v[12:13]
    v_pk_add_f32 v[178:179], v[178:179], v[12:13]
    v_rcp_f32 v172, v172
    v_rcp_f32 v173, v173
    v_rcp_f32 v174, v174
    v_rcp_f32 v175, v175
    v_rcp_f32 v176, v176
    v_rcp_f32 v177, v177
    v_rcp_f32 v178, v178
    v_rcp_f32 v179, v179
    v_pk_mul_f32 v[24:25], v[24:25], v[172:173]
    v_pk_mul_f32 v[26:27], v[26:27], v[174:175]
    v_pk_mul_f32 v[28:29], v[28:29], v[176:177]
    v_pk_mul_f32 v[30:31], v[30:31], v[178:179]
    v_lshlrev_b32 v168, 16, v158
    v_and_b32 v169, 0xffff0000, v158
    v_lshlrev_b32 v170, 16, v159
    v_and_b32 v171, 0xffff0000, v159
    v_pk_fma_f32 v[172:173], v[140:141], v[132:133], v[168:169] op_sel:[0,1,0] op_sel_hi:[1,1,1]
    v_pk_fma_f32 v[174:175], v[142:143], v[132:133], v[170:171] op_sel:[0,1,0] op_sel_hi:[1,1,1]
    v_pk_fma_f32 v[176:177], v[140:141], v[134:135], v[168:169] op_sel:[0,1,0] op_sel_hi:[1,1,1]
    v_pk_fma_f32 v[178:179], v[142:143], v[134:135], v[170:171] op_sel:[0,1,0] op_sel_hi:[1,1,1]
    v_pk_fma_f32 v[40:41], v[40:41], v[132:133], v[172:173] op_sel:[0,0,0] op_sel_hi:[1,0,1]
    v_pk_fma_f32 v[42:43], v[42:43], v[132:133], v[174:175] op_sel:[0,0,0] op_sel_hi:[1,0,1]
    v_pk_fma_f32 v[44:45], v[44:45], v[134:135], v[176:177] op_sel:[0,0,0] op_sel_hi:[1,0,1]
    v_pk_fma_f32 v[46:47], v[46:47], v[134:135], v[178:179] op_sel:[0,0,0] op_sel_hi:[1,0,1]
    v_pk_mul_f32 v[172:173], v[40:41], v[40:41]
    v_pk_mul_f32 v[174:175], v[42:43], v[42:43]
    v_pk_mul_f32 v[176:177], v[44:45], v[44:45]
    v_pk_mul_f32 v[178:179], v[46:47], v[46:47]
    v_pk_fma_f32 v[172:173], v[172:173], v[10:11], v[6:7]
    v_pk_fma_f32 v[174:175], v[174:175], v[10:11], v[6:7]
    v_pk_fma_f32 v[176:177], v[176:177], v[10:11], v[6:7]
    v_pk_fma_f32 v[178:179], v[178:179], v[10:11], v[6:7]
    v_pk_mul_f32 v[172:173], v[172:173], v[40:41]
    v_pk_mul_f32 v[174:175], v[174:175], v[42:43]
    v_pk_mul_f32 v[176:177], v[176:177], v[44:45]
    v_pk_mul_f32 v[178:179], v[178:179], v[46:47]
    v_exp_f32 v172, v172
    v_exp_f32 v173, v173
    v_exp_f32 v174, v174
    v_exp_f32 v175, v175
    v_exp_f32 v176, v176
    v_exp_f32 v177, v177
    v_exp_f32 v178, v178
    v_exp_f32 v179, v179
    v_pk_add_f32 v[172:173], v[172:173], v[12:13]
    v_pk_add_f32 v[174:175], v[174:175], v[12:13]
    v_pk_add_f32 v[176:177], v[176:177], v[12:13]
    v_pk_add_f32 v[178:179], v[178:179], v[12:13]
    v_rcp_f32 v172, v172
    v_rcp_f32 v173, v173
    v_rcp_f32 v174, v174
    v_rcp_f32 v175, v175
    v_rcp_f32 v176, v176
    v_rcp_f32 v177, v177
    v_rcp_f32 v178, v178
    v_rcp_f32 v179, v179
    v_pk_mul_f32 v[40:41], v[40:41], v[172:173]
    v_pk_mul_f32 v[42:43], v[42:43], v[174:175]
    v_pk_mul_f32 v[44:45], v[44:45], v[176:177]
    v_pk_mul_f32 v[46:47], v[46:47], v[178:179]
    v_cvt_pk_bf16_f32 v24, v24, v25
    v_cvt_pk_bf16_f32 v25, v26, v27
    v_cvt_pk_bf16_f32 v26, v40, v41
    v_cvt_pk_bf16_f32 v27, v42, v43
    s_nop 1
    v_permlane16_swap_b32 v24, v26
    v_permlane16_swap_b32 v25, v27
    s_nop 0
    buffer_store_dwordx4 v[24:27], v5, s[16:19], s70 offen offset:0
    v_cvt_pk_bf16_f32 v28, v28, v29
    v_cvt_pk_bf16_f32 v29, v30, v31
    v_cvt_pk_bf16_f32 v30, v44, v45
    v_cvt_pk_bf16_f32 v31, v46, v47
    s_nop 1
    v_permlane16_swap_b32 v28, v30
    v_permlane16_swap_b32 v29, v31
    s_nop 0
    buffer_store_dwordx4 v[28:31], v5, s[16:19], s71 offen offset:0
    v_lshlrev_b32 v168, 16, v160
    v_and_b32 v169, 0xffff0000, v160
    v_lshlrev_b32 v170, 16, v161
    v_and_b32 v171, 0xffff0000, v161
    v_pk_fma_f32 v[172:173], v[144:145], v[128:129], v[168:169] op_sel:[0,1,0] op_sel_hi:[1,1,1]
    v_pk_fma_f32 v[174:175], v[146:147], v[128:129], v[170:171] op_sel:[0,1,0] op_sel_hi:[1,1,1]
    v_pk_fma_f32 v[176:177], v[144:145], v[130:131], v[168:169] op_sel:[0,1,0] op_sel_hi:[1,1,1]
    v_pk_fma_f32 v[178:179], v[146:147], v[130:131], v[170:171] op_sel:[0,1,0] op_sel_hi:[1,1,1]
    v_pk_fma_f32 v[48:49], v[48:49], v[128:129], v[172:173] op_sel:[0,0,0] op_sel_hi:[1,0,1]
    v_pk_fma_f32 v[50:51], v[50:51], v[128:129], v[174:175] op_sel:[0,0,0] op_sel_hi:[1,0,1]
    v_pk_fma_f32 v[52:53], v[52:53], v[130:131], v[176:177] op_sel:[0,0,0] op_sel_hi:[1,0,1]
    v_pk_fma_f32 v[54:55], v[54:55], v[130:131], v[178:179] op_sel:[0,0,0] op_sel_hi:[1,0,1]
    v_pk_mul_f32 v[172:173], v[48:49], v[48:49]
    v_pk_mul_f32 v[174:175], v[50:51], v[50:51]
    v_pk_mul_f32 v[176:177], v[52:53], v[52:53]
    v_pk_mul_f32 v[178:179], v[54:55], v[54:55]
    v_pk_fma_f32 v[172:173], v[172:173], v[10:11], v[6:7]
    v_pk_fma_f32 v[174:175], v[174:175], v[10:11], v[6:7]
    v_pk_fma_f32 v[176:177], v[176:177], v[10:11], v[6:7]
    v_pk_fma_f32 v[178:179], v[178:179], v[10:11], v[6:7]
    v_pk_mul_f32 v[172:173], v[172:173], v[48:49]
    v_pk_mul_f32 v[174:175], v[174:175], v[50:51]
    v_pk_mul_f32 v[176:177], v[176:177], v[52:53]
    v_pk_mul_f32 v[178:179], v[178:179], v[54:55]
    v_exp_f32 v172, v172
    v_exp_f32 v173, v173
    v_exp_f32 v174, v174
    v_exp_f32 v175, v175
    v_exp_f32 v176, v176
    v_exp_f32 v177, v177
    v_exp_f32 v178, v178
    v_exp_f32 v179, v179
    v_pk_add_f32 v[172:173], v[172:173], v[12:13]
    v_pk_add_f32 v[174:175], v[174:175], v[12:13]
    v_pk_add_f32 v[176:177], v[176:177], v[12:13]
    v_pk_add_f32 v[178:179], v[178:179], v[12:13]
    v_rcp_f32 v172, v172
    v_rcp_f32 v173, v173
    v_rcp_f32 v174, v174
    v_rcp_f32 v175, v175
    v_rcp_f32 v176, v176
    v_rcp_f32 v177, v177
    v_rcp_f32 v178, v178
    v_rcp_f32 v179, v179
    v_pk_mul_f32 v[48:49], v[48:49], v[172:173]
    v_pk_mul_f32 v[50:51], v[50:51], v[174:175]
    v_pk_mul_f32 v[52:53], v[52:53], v[176:177]
    v_pk_mul_f32 v[54:55], v[54:55], v[178:179]
    v_lshlrev_b32 v168, 16, v162
    v_and_b32 v169, 0xffff0000, v162
    v_lshlrev_b32 v170, 16, v163
    v_and_b32 v171, 0xffff0000, v163
    v_pk_fma_f32 v[172:173], v[148:149], v[128:129], v[168:169] op_sel:[0,1,0] op_sel_hi:[1,1,1]
    v_pk_fma_f32 v[174:175], v[150:151], v[128:129], v[170:171] op_sel:[0,1,0] op_sel_hi:[1,1,1]
    v_pk_fma_f32 v[176:177], v[148:149], v[130:131], v[168:169] op_sel:[0,1,0] op_sel_hi:[1,1,1]
    v_pk_fma_f32 v[178:179], v[150:151], v[130:131], v[170:171] op_sel:[0,1,0] op_sel_hi:[1,1,1]
    v_pk_fma_f32 v[64:65], v[64:65], v[128:129], v[172:173] op_sel:[0,0,0] op_sel_hi:[1,0,1]
    v_pk_fma_f32 v[66:67], v[66:67], v[128:129], v[174:175] op_sel:[0,0,0] op_sel_hi:[1,0,1]
    v_pk_fma_f32 v[68:69], v[68:69], v[130:131], v[176:177] op_sel:[0,0,0] op_sel_hi:[1,0,1]
    v_pk_fma_f32 v[70:71], v[70:71], v[130:131], v[178:179] op_sel:[0,0,0] op_sel_hi:[1,0,1]
    v_pk_mul_f32 v[172:173], v[64:65], v[64:65]
    v_pk_mul_f32 v[174:175], v[66:67], v[66:67]
    v_pk_mul_f32 v[176:177], v[68:69], v[68:69]
    v_pk_mul_f32 v[178:179], v[70:71], v[70:71]
    v_pk_fma_f32 v[172:173], v[172:173], v[10:11], v[6:7]
    v_pk_fma_f32 v[174:175], v[174:175], v[10:11], v[6:7]
    v_pk_fma_f32 v[176:177], v[176:177], v[10:11], v[6:7]
    v_pk_fma_f32 v[178:179], v[178:179], v[10:11], v[6:7]
    v_pk_mul_f32 v[172:173], v[172:173], v[64:65]
    v_pk_mul_f32 v[174:175], v[174:175], v[66:67]
    v_pk_mul_f32 v[176:177], v[176:177], v[68:69]
    v_pk_mul_f32 v[178:179], v[178:179], v[70:71]
    v_exp_f32 v172, v172
    v_exp_f32 v173, v173
    v_exp_f32 v174, v174
    v_exp_f32 v175, v175
    v_exp_f32 v176, v176
    v_exp_f32 v177, v177
    v_exp_f32 v178, v178
    v_exp_f32 v179, v179
    v_pk_add_f32 v[172:173], v[172:173], v[12:13]
    v_pk_add_f32 v[174:175], v[174:175], v[12:13]
    v_pk_add_f32 v[176:177], v[176:177], v[12:13]
    v_pk_add_f32 v[178:179], v[178:179], v[12:13]
    v_rcp_f32 v172, v172
    v_rcp_f32 v173, v173
    v_rcp_f32 v174, v174
    v_rcp_f32 v175, v175
    v_rcp_f32 v176, v176
    v_rcp_f32 v177, v177
    v_rcp_f32 v178, v178
    v_rcp_f32 v179, v179
    v_pk_mul_f32 v[64:65], v[64:65], v[172:173]
    v_pk_mul_f32 v[66:67], v[66:67], v[174:175]
    v_pk_mul_f32 v[68:69], v[68:69], v[176:177]
    v_pk_mul_f32 v[70:71], v[70:71], v[178:179]
    v_cvt_pk_bf16_f32 v48, v48, v49
    v_cvt_pk_bf16_f32 v49, v50, v51
    v_cvt_pk_bf16_f32 v50, v64, v65
    v_cvt_pk_bf16_f32 v51, v66, v67
    s_nop 1
    v_permlane16_swap_b32 v48, v50
    v_permlane16_swap_b32 v49, v51
    s_nop 0
    buffer_store_dwordx4 v[48:51], v5, s[16:19], s68 offen offset:1024
    v_cvt_pk_bf16_f32 v52, v52, v53
    v_cvt_pk_bf16_f32 v53, v54, v55
    v_cvt_pk_bf16_f32 v54, v68, v69
    v_cvt_pk_bf16_f32 v55, v70, v71
    s_nop 1
    v_permlane16_swap_b32 v52, v54
    v_permlane16_swap_b32 v53, v55
    s_nop 0
    buffer_store_dwordx4 v[52:55], v5, s[16:19], s69 offen offset:1024
    v_lshlrev_b32 v168, 16, v160
    v_and_b32 v169, 0xffff0000, v160
    v_lshlrev_b32 v170, 16, v161
    v_and_b32 v171, 0xffff0000, v161
    v_pk_fma_f32 v[172:173], v[144:145], v[132:133], v[168:169] op_sel:[0,1,0] op_sel_hi:[1,1,1]
    v_pk_fma_f32 v[174:175], v[146:147], v[132:133], v[170:171] op_sel:[0,1,0] op_sel_hi:[1,1,1]
    v_pk_fma_f32 v[176:177], v[144:145], v[134:135], v[168:169] op_sel:[0,1,0] op_sel_hi:[1,1,1]
    v_pk_fma_f32 v[178:179], v[146:147], v[134:135], v[170:171] op_sel:[0,1,0] op_sel_hi:[1,1,1]
    v_pk_fma_f32 v[56:57], v[56:57], v[132:133], v[172:173] op_sel:[0,0,0] op_sel_hi:[1,0,1]
    v_pk_fma_f32 v[58:59], v[58:59], v[132:133], v[174:175] op_sel:[0,0,0] op_sel_hi:[1,0,1]
    v_pk_fma_f32 v[60:61], v[60:61], v[134:135], v[176:177] op_sel:[0,0,0] op_sel_hi:[1,0,1]
    v_pk_fma_f32 v[62:63], v[62:63], v[134:135], v[178:179] op_sel:[0,0,0] op_sel_hi:[1,0,1]
    v_pk_mul_f32 v[172:173], v[56:57], v[56:57]
    v_pk_mul_f32 v[174:175], v[58:59], v[58:59]
    v_pk_mul_f32 v[176:177], v[60:61], v[60:61]
    v_pk_mul_f32 v[178:179], v[62:63], v[62:63]
    v_pk_fma_f32 v[172:173], v[172:173], v[10:11], v[6:7]
    v_pk_fma_f32 v[174:175], v[174:175], v[10:11], v[6:7]
    v_pk_fma_f32 v[176:177], v[176:177], v[10:11], v[6:7]
    v_pk_fma_f32 v[178:179], v[178:179], v[10:11], v[6:7]
    v_pk_mul_f32 v[172:173], v[172:173], v[56:57]
    v_pk_mul_f32 v[174:175], v[174:175], v[58:59]
    v_pk_mul_f32 v[176:177], v[176:177], v[60:61]
    v_pk_mul_f32 v[178:179], v[178:179], v[62:63]
    v_exp_f32 v172, v172
    v_exp_f32 v173, v173
    v_exp_f32 v174, v174
    v_exp_f32 v175, v175
    v_exp_f32 v176, v176
    v_exp_f32 v177, v177
    v_exp_f32 v178, v178
    v_exp_f32 v179, v179
    v_pk_add_f32 v[172:173], v[172:173], v[12:13]
    v_pk_add_f32 v[174:175], v[174:175], v[12:13]
    v_pk_add_f32 v[176:177], v[176:177], v[12:13]
    v_pk_add_f32 v[178:179], v[178:179], v[12:13]
    v_rcp_f32 v172, v172
    v_rcp_f32 v173, v173
    v_rcp_f32 v174, v174
    v_rcp_f32 v175, v175
    v_rcp_f32 v176, v176
    v_rcp_f32 v177, v177
    v_rcp_f32 v178, v178
    v_rcp_f32 v179, v179
    v_pk_mul_f32 v[56:57], v[56:57], v[172:173]
    v_pk_mul_f32 v[58:59], v[58:59], v[174:175]
    v_pk_mul_f32 v[60:61], v[60:61], v[176:177]
    v_pk_mul_f32 v[62:63], v[62:63], v[178:179]
    v_lshlrev_b32 v168, 16, v162
    v_and_b32 v169, 0xffff0000, v162
    v_lshlrev_b32 v170, 16, v163
    v_and_b32 v171, 0xffff0000, v163
    v_pk_fma_f32 v[172:173], v[148:149], v[132:133], v[168:169] op_sel:[0,1,0] op_sel_hi:[1,1,1]
    v_pk_fma_f32 v[174:175], v[150:151], v[132:133], v[170:171] op_sel:[0,1,0] op_sel_hi:[1,1,1]
    v_pk_fma_f32 v[176:177], v[148:149], v[134:135], v[168:169] op_sel:[0,1,0] op_sel_hi:[1,1,1]
    v_pk_fma_f32 v[178:179], v[150:151], v[134:135], v[170:171] op_sel:[0,1,0] op_sel_hi:[1,1,1]
    v_pk_fma_f32 v[72:73], v[72:73], v[132:133], v[172:173] op_sel:[0,0,0] op_sel_hi:[1,0,1]
    v_pk_fma_f32 v[74:75], v[74:75], v[132:133], v[174:175] op_sel:[0,0,0] op_sel_hi:[1,0,1]
    v_pk_fma_f32 v[76:77], v[76:77], v[134:135], v[176:177] op_sel:[0,0,0] op_sel_hi:[1,0,1]
    v_pk_fma_f32 v[78:79], v[78:79], v[134:135], v[178:179] op_sel:[0,0,0] op_sel_hi:[1,0,1]
    v_pk_mul_f32 v[172:173], v[72:73], v[72:73]
    v_pk_mul_f32 v[174:175], v[74:75], v[74:75]
    v_pk_mul_f32 v[176:177], v[76:77], v[76:77]
    v_pk_mul_f32 v[178:179], v[78:79], v[78:79]
    v_pk_fma_f32 v[172:173], v[172:173], v[10:11], v[6:7]
    v_pk_fma_f32 v[174:175], v[174:175], v[10:11], v[6:7]
    v_pk_fma_f32 v[176:177], v[176:177], v[10:11], v[6:7]
    v_pk_fma_f32 v[178:179], v[178:179], v[10:11], v[6:7]
    v_pk_mul_f32 v[172:173], v[172:173], v[72:73]
    v_pk_mul_f32 v[174:175], v[174:175], v[74:75]
    v_pk_mul_f32 v[176:177], v[176:177], v[76:77]
    v_pk_mul_f32 v[178:179], v[178:179], v[78:79]
    v_exp_f32 v172, v172
    v_exp_f32 v173, v173
    v_exp_f32 v174, v174
    v_exp_f32 v175, v175
    v_exp_f32 v176, v176
    v_exp_f32 v177, v177
    v_exp_f32 v178, v178
    v_exp_f32 v179, v179
    v_pk_add_f32 v[172:173], v[172:173], v[12:13]
    v_pk_add_f32 v[174:175], v[174:175], v[12:13]
    v_pk_add_f32 v[176:177], v[176:177], v[12:13]
    v_pk_add_f32 v[178:179], v[178:179], v[12:13]
    v_rcp_f32 v172, v172
    v_rcp_f32 v173, v173
    v_rcp_f32 v174, v174
    v_rcp_f32 v175, v175
    v_rcp_f32 v176, v176
    v_rcp_f32 v177, v177
    v_rcp_f32 v178, v178
    v_rcp_f32 v179, v179
    v_pk_mul_f32 v[72:73], v[72:73], v[172:173]
    v_pk_mul_f32 v[74:75], v[74:75], v[174:175]
    v_pk_mul_f32 v[76:77], v[76:77], v[176:177]
    v_pk_mul_f32 v[78:79], v[78:79], v[178:179]
    v_cvt_pk_bf16_f32 v56, v56, v57
    v_cvt_pk_bf16_f32 v57, v58, v59
    v_cvt_pk_bf16_f32 v58, v72, v73
    v_cvt_pk_bf16_f32 v59, v74, v75
    s_nop 1
    v_permlane16_swap_b32 v56, v58
    v_permlane16_swap_b32 v57, v59
    s_nop 0
    buffer_store_dwordx4 v[56:59], v5, s[16:19], s70 offen offset:1024
    v_cvt_pk_bf16_f32 v60, v60, v61
    v_cvt_pk_bf16_f32 v61, v62, v63
    v_cvt_pk_bf16_f32 v62, v76, v77
    v_cvt_pk_bf16_f32 v63, v78, v79
    s_nop 1
    v_permlane16_swap_b32 v60, v62
    v_permlane16_swap_b32 v61, v63
    s_nop 0
    buffer_store_dwordx4 v[60:63], v5, s[16:19], s71 offen offset:1024
    v_lshlrev_b32 v168, 16, v164
    v_and_b32 v169, 0xffff0000, v164
    v_lshlrev_b32 v170, 16, v165
    v_and_b32 v171, 0xffff0000, v165
    v_pk_fma_f32 v[172:173], v[152:153], v[128:129], v[168:169] op_sel:[0,1,0] op_sel_hi:[1,1,1]
    v_pk_fma_f32 v[174:175], v[154:155], v[128:129], v[170:171] op_sel:[0,1,0] op_sel_hi:[1,1,1]
    v_pk_fma_f32 v[176:177], v[152:153], v[130:131], v[168:169] op_sel:[0,1,0] op_sel_hi:[1,1,1]
    v_pk_fma_f32 v[178:179], v[154:155], v[130:131], v[170:171] op_sel:[0,1,0] op_sel_hi:[1,1,1]
    v_pk_fma_f32 v[80:81], v[80:81], v[128:129], v[172:173] op_sel:[0,0,0] op_sel_hi:[1,0,1]
    v_pk_fma_f32 v[82:83], v[82:83], v[128:129], v[174:175] op_sel:[0,0,0] op_sel_hi:[1,0,1]
    v_pk_fma_f32 v[84:85], v[84:85], v[130:131], v[176:177] op_sel:[0,0,0] op_sel_hi:[1,0,1]
    v_pk_fma_f32 v[86:87], v[86:87], v[130:131], v[178:179] op_sel:[0,0,0] op_sel_hi:[1,0,1]
    v_pk_mul_f32 v[172:173], v[80:81], v[80:81]
    v_pk_mul_f32 v[174:175], v[82:83], v[82:83]
    v_pk_mul_f32 v[176:177], v[84:85], v[84:85]
    v_pk_mul_f32 v[178:179], v[86:87], v[86:87]
    v_pk_fma_f32 v[172:173], v[172:173], v[10:11], v[6:7]
    v_pk_fma_f32 v[174:175], v[174:175], v[10:11], v[6:7]
    v_pk_fma_f32 v[176:177], v[176:177], v[10:11], v[6:7]
    v_pk_fma_f32 v[178:179], v[178:179], v[10:11], v[6:7]
    v_pk_mul_f32 v[172:173], v[172:173], v[80:81]
    v_pk_mul_f32 v[174:175], v[174:175], v[82:83]
    v_pk_mul_f32 v[176:177], v[176:177], v[84:85]
    v_pk_mul_f32 v[178:179], v[178:179], v[86:87]
    v_exp_f32 v172, v172
    v_exp_f32 v173, v173
    v_exp_f32 v174, v174
    v_exp_f32 v175, v175
    v_exp_f32 v176, v176
    v_exp_f32 v177, v177
    v_exp_f32 v178, v178
    v_exp_f32 v179, v179
    v_pk_add_f32 v[172:173], v[172:173], v[12:13]
    v_pk_add_f32 v[174:175], v[174:175], v[12:13]
    v_pk_add_f32 v[176:177], v[176:177], v[12:13]
    v_pk_add_f32 v[178:179], v[178:179], v[12:13]
    v_rcp_f32 v172, v172
    v_rcp_f32 v173, v173
    v_rcp_f32 v174, v174
    v_rcp_f32 v175, v175
    v_rcp_f32 v176, v176
    v_rcp_f32 v177, v177
    v_rcp_f32 v178, v178
    v_rcp_f32 v179, v179
    v_pk_mul_f32 v[80:81], v[80:81], v[172:173]
    v_pk_mul_f32 v[82:83], v[82:83], v[174:175]
    v_pk_mul_f32 v[84:85], v[84:85], v[176:177]
    v_pk_mul_f32 v[86:87], v[86:87], v[178:179]
    v_cvt_pk_bf16_f32 v80, v80, v81
    v_cvt_pk_bf16_f32 v81, v82, v83
    v_cvt_pk_bf16_f32 v82, v84, v85
    v_cvt_pk_bf16_f32 v83, v86, v87
    s_nop 1
    v_permlane16_swap_b32 v80, v82
    v_permlane16_swap_b32 v81, v83
    s_nop 0
    buffer_store_dwordx4 v[80:83], v9, s[16:19], s68 offen offset:2048
    v_lshlrev_b32 v168, 16, v164
    v_and_b32 v169, 0xffff0000, v164
    v_lshlrev_b32 v170, 16, v165
    v_and_b32 v171, 0xffff0000, v165
    v_pk_fma_f32 v[172:173], v[152:153], v[132:133], v[168:169] op_sel:[0,1,0] op_sel_hi:[1,1,1]
    v_pk_fma_f32 v[174:175], v[154:155], v[132:133], v[170:171] op_sel:[0,1,0] op_sel_hi:[1,1,1]
    v_pk_fma_f32 v[176:177], v[152:153], v[134:135], v[168:169] op_sel:[0,1,0] op_sel_hi:[1,1,1]
    v_pk_fma_f32 v[178:179], v[154:155], v[134:135], v[170:171] op_sel:[0,1,0] op_sel_hi:[1,1,1]
    v_pk_fma_f32 v[88:89], v[88:89], v[132:133], v[172:173] op_sel:[0,0,0] op_sel_hi:[1,0,1]
    v_pk_fma_f32 v[90:91], v[90:91], v[132:133], v[174:175] op_sel:[0,0,0] op_sel_hi:[1,0,1]
    v_pk_fma_f32 v[92:93], v[92:93], v[134:135], v[176:177] op_sel:[0,0,0] op_sel_hi:[1,0,1]
    v_pk_fma_f32 v[94:95], v[94:95], v[134:135], v[178:179] op_sel:[0,0,0] op_sel_hi:[1,0,1]
    v_pk_mul_f32 v[172:173], v[88:89], v[88:89]
    v_pk_mul_f32 v[174:175], v[90:91], v[90:91]
    v_pk_mul_f32 v[176:177], v[92:93], v[92:93]
    v_pk_mul_f32 v[178:179], v[94:95], v[94:95]
    v_pk_fma_f32 v[172:173], v[172:173], v[10:11], v[6:7]
    v_pk_fma_f32 v[174:175], v[174:175], v[10:11], v[6:7]
    v_pk_fma_f32 v[176:177], v[176:177], v[10:11], v[6:7]
    v_pk_fma_f32 v[178:179], v[178:179], v[10:11], v[6:7]
    v_pk_mul_f32 v[172:173], v[172:173], v[88:89]
    v_pk_mul_f32 v[174:175], v[174:175], v[90:91]
    v_pk_mul_f32 v[176:177], v[176:177], v[92:93]
    v_pk_mul_f32 v[178:179], v[178:179], v[94:95]
    v_exp_f32 v172, v172
    v_exp_f32 v173, v173
    v_exp_f32 v174, v174
    v_exp_f32 v175, v175
    v_exp_f32 v176, v176
    v_exp_f32 v177, v177
    v_exp_f32 v178, v178
    v_exp_f32 v179, v179
    v_pk_add_f32 v[172:173], v[172:173], v[12:13]
    v_pk_add_f32 v[174:175], v[174:175], v[12:13]
    v_pk_add_f32 v[176:177], v[176:177], v[12:13]
    v_pk_add_f32 v[178:179], v[178:179], v[12:13]
    v_rcp_f32 v172, v172
    v_rcp_f32 v173, v173
    v_rcp_f32 v174, v174
    v_rcp_f32 v175, v175
    v_rcp_f32 v176, v176
    v_rcp_f32 v177, v177
    v_rcp_f32 v178, v178
    v_rcp_f32 v179, v179
    v_pk_mul_f32 v[88:89], v[88:89], v[172:173]
    v_pk_mul_f32 v[90:91], v[90:91], v[174:175]
    v_pk_mul_f32 v[92:93], v[92:93], v[176:177]
    v_pk_mul_f32 v[94:95], v[94:95], v[178:179]
    v_cvt_pk_bf16_f32 v88, v88, v89
    v_cvt_pk_bf16_f32 v89, v90, v91
    v_cvt_pk_bf16_f32 v90, v92, v93
    v_cvt_pk_bf16_f32 v91, v94, v95
    s_nop 1
    v_permlane16_swap_b32 v88, v90
    v_permlane16_swap_b32 v89, v91
    s_nop 0
    buffer_store_dwordx4 v[88:91], v9, s[16:19], s70 offen offset:2048
    s_endpgm
l1_qk:
    ds_read_b64 v[128:129], v6 offset:0
    ds_read_b64 v[130:131], v6 offset:128
    ds_read_b64 v[132:133], v6 offset:256
    ds_read_b64 v[134:135], v6 offset:384
    v_lshlrev_b32 v7, 4, v4
    v_lshlrev_b32 v8, 3, v4
    v_add_u32 v8, 160768, v8
    ds_read_b128 v[136:139], v7 offset:2496
    ds_read_b64 v[140:141], v8 offset:224
    v_add_u32 v5, s45, v5
    v_lshrrev_b32 v6, 4, v5
    v_mul_u32_u24 v6, 147456, v6
    v_and_b32 v5, 15, v5
    v_lshl_add_u32 v5, v5, 4, v6
    s_lshl_b32 s55, s46, 5
    s_add_u32 s55, s55, 3584
    v_add_u32 v5, s55, v5
    v_and_b32 v8, 1, v4
    v_lshrrev_b32 v6, 1, v4
    v_lshl_add_u32 v5, v6, 8, v5
    v_mul_u32_u24 v9, 147456, v8
    v_add_u32 v9, v9, v5
    v_lshl_add_u32 v5, v8, 9, v5
    v_mov_b32 v6, 0xc0135761
    v_mov_b32 v7, 0xc0135761
    v_mov_b32 v10, 0xbdd2d3e8
    v_mov_b32 v11, 0xbdd2d3e8
    v_mov_b32 v12, 1.0
    v_mov_b32 v13, 1.0
    s_waitcnt lgkmcnt(0)
    v_and_b32 v168, 15, v1
    v_lshrrev_b32 v169, 4, v1
    s_mul_i32 s55, s59, 12288
    s_add_u32 s55, s55, 4096
    v_mul_u32_u24 v168, 48, v168
    v_add_u32 v168, s55, v168
    v_lshlrev_b32 v169, 2, v169
    s_mov_b32 s56, 1.0
    s_cmp_eq_u32 s48, 1
    s_cselect_b32 s56, 0x3eae1a93, s56
    s_cselect_b32 s57, 0, 3145728
    v_mul_u32_u24 v170, 48, v1
    v_add_u32 v170, s55, v170
    v_mov_b32 v172, 0
    v_mov_b32 v173, 0
    v_mov_b32 v174, 0
    ds_write_b32 v170, v172 offset:36
    ds_write_b64 v170, v[172:173] offset:40
    ds_write_b32 v170, v172 offset:3108
    ds_write_b64 v170, v[172:173] offset:3112
    ds_write_b32 v170, v172 offset:6180
    ds_write_b64 v170, v[172:173] offset:6184
    ds_write_b32 v170, v172 offset:9252
    ds_write_b64 v170, v[172:173] offset:9256
    v_add_u32 v171, 0, v169
    v_mul_u32_u24 v14, 3641, v171
    v_lshrrev_b32 v14, 16, v14
    v_mul_u32_u24 v15, 18, v14
    v_sub_u32 v15, v171, v15
    v_mul_u32_u24 v14, 3072, v14
    v_lshl_add_u32 v14, v15, 1, v14
    v_add_u32 v14, v14, v168
    v_mul_f32 v32, s56, v32
    v_mul_f32 v33, s56, v33
    v_cvt_pk_bf16_f32 v32, v32, v33
    ds_write_b32 v14, v32 offset:0
    v_mul_f32 v36, s56, v36
    v_mul_f32 v37, s56, v37
    v_cvt_pk_bf16_f32 v36, v36, v37
    ds_write_b32 v14, v36 offset:768
    v_mul_f32 v40, s56, v40
    v_mul_f32 v41, s56, v41
    v_cvt_pk_bf16_f32 v40, v40, v41
    ds_write_b32 v14, v40 offset:1536
    v_mul_f32 v44, s56, v44
    v_mul_f32 v45, s56, v45
    v_cvt_pk_bf16_f32 v44, v44, v45
    ds_write_b32 v14, v44 offset:2304
    v_add_u32 v171, 2, v169
    v_mul_u32_u24 v14, 3641, v171
    v_lshrrev_b32 v14, 16, v14
    v_mul_u32_u24 v15, 18, v14
    v_sub_u32 v15, v171, v15
    v_mul_u32_u24 v14, 3072, v14
    v_lshl_add_u32 v14, v15, 1, v14
    v_add_u32 v14, v14, v168
    v_mul_f32 v34, s56, v34
    v_mul_f32 v35, s56, v35
    v_cvt_pk_bf16_f32 v34, v34, v35
    ds_write_b32 v14, v34 offset:0
    v_mul_f32 v38, s56, v38
    v_mul_f32 v39, s56, v39
    v_cvt_pk_bf16_f32 v38, v38, v39
    ds_write_b32 v14, v38 offset:768
    v_mul_f32 v42, s56, v42
    v_mul_f32 v43, s56, v43
    v_cvt_pk_bf16_f32 v42, v42, v43
    ds_write_b32 v14, v42 offset:1536
    v_mul_f32 v46, s56, v46
    v_mul_f32 v47, s56, v47
    v_cvt_pk_bf16_f32 v46, v46, v47
    ds_write_b32 v14, v46 offset:2304
    v_add_u32 v171, 16, v169
    v_mul_u32_u24 v14, 3641, v171
    v_lshrrev_b32 v14, 16, v14
    v_mul_u32_u24 v15, 18, v14
    v_sub_u32 v15, v171, v15
    v_mul_u32_u24 v14, 3072, v14
    v_lshl_add_u32 v14, v15, 1, v14
    v_add_u32 v14, v14, v168
    v_mul_f32 v48, s56, v48
    v_mul_f32 v49, s56, v49
    v_cvt_pk_bf16_f32 v48, v48, v49
    ds_write_b32 v14, v48 offset:0
    v_mul_f32 v52, s56, v52
    v_mul_f32 v53, s56, v53
    v_cvt_pk_bf16_f32 v52, v52, v53
    ds_write_b32 v14, v52 offset:768
    v_mul_f32 v56, s56, v56
    v_mul_f32 v57, s56, v57
    v_cvt_pk_bf16_f32 v56, v56, v57
    ds_write_b32 v14, v56 offset:1536
    v_mul_f32 v60, s56, v60
    v_mul_f32 v61, s56, v61
    v_cvt_pk_bf16_f32 v60, v60, v61
    ds_write_b32 v14, v60 offset:2304
    v_add_u32 v171, 18, v169
    v_mul_u32_u24 v14, 3641, v171
    v_lshrrev_b32 v14, 16, v14
    v_mul_u32_u24 v15, 18, v14
    v_sub_u32 v15, v171, v15
    v_mul_u32_u24 v14, 3072, v14
    v_lshl_add_u32 v14, v15, 1, v14
    v_add_u32 v14, v14, v168
    v_mul_f32 v50, s56, v50
    v_mul_f32 v51, s56, v51
    v_cvt_pk_bf16_f32 v50, v50, v51
    ds_write_b32 v14, v50 offset:0
    v_mul_f32 v54, s56, v54
    v_mul_f32 v55, s56, v55
    v_cvt_pk_bf16_f32 v54, v54, v55
    ds_write_b32 v14, v54 offset:768
    v_mul_f32 v58, s56, v58
    v_mul_f32 v59, s56, v59
    v_cvt_pk_bf16_f32 v58, v58, v59
    ds_write_b32 v14, v58 offset:1536
    v_mul_f32 v62, s56, v62
    v_mul_f32 v63, s56, v63
    v_cvt_pk_bf16_f32 v62, v62, v63
    ds_write_b32 v14, v62 offset:2304
    v_add_u32 v171, 32, v169
    v_mul_u32_u24 v14, 3641, v171
    v_lshrrev_b32 v14, 16, v14
    v_mul_u32_u24 v15, 18, v14
    v_sub_u32 v15, v171, v15
    v_mul_u32_u24 v14, 3072, v14
    v_lshl_add_u32 v14, v15, 1, v14
    v_add_u32 v14, v14, v168
    v_mul_f32 v64, s56, v64
    v_mul_f32 v65, s56, v65
    v_cvt_pk_bf16_f32 v64, v64, v65
    ds_write_b32 v14, v64 offset:0
    v_mul_f32 v68, s56, v68
    v_mul_f32 v69, s56, v69
    v_cvt_pk_bf16_f32 v68, v68, v69
    ds_write_b32 v14, v68 offset:768
    v_mul_f32 v72, s56, v72
    v_mul_f32 v73, s56, v73
    v_cvt_pk_bf16_f32 v72, v72, v73
    ds_write_b32 v14, v72 offset:1536
    v_mul_f32 v76, s56, v76
    v_mul_f32 v77, s56, v77
    v_cvt_pk_bf16_f32 v76, v76, v77
    ds_write_b32 v14, v76 offset:2304
    v_add_u32 v171, 34, v169
    v_mul_u32_u24 v14, 3641, v171
    v_lshrrev_b32 v14, 16, v14
    v_mul_u32_u24 v15, 18, v14
    v_sub_u32 v15, v171, v15
    v_mul_u32_u24 v14, 3072, v14
    v_lshl_add_u32 v14, v15, 1, v14
    v_add_u32 v14, v14, v168
    v_mul_f32 v66, s56, v66
    v_mul_f32 v67, s56, v67
    v_cvt_pk_bf16_f32 v66, v66, v67
    ds_write_b32 v14, v66 offset:0
    v_mul_f32 v70, s56, v70
    v_mul_f32 v71, s56, v71
    v_cvt_pk_bf16_f32 v70, v70, v71
    ds_write_b32 v14, v70 offset:768
    v_mul_f32 v74, s56, v74
    v_mul_f32 v75, s56, v75
    v_cvt_pk_bf16_f32 v74, v74, v75
    ds_write_b32 v14, v74 offset:1536
    v_mul_f32 v78, s56, v78
    v_mul_f32 v79, s56, v79
    v_cvt_pk_bf16_f32 v78, v78, v79
    ds_write_b32 v14, v78 offset:2304
    v_add_u32 v171, 48, v169
    v_mul_u32_u24 v14, 3641, v171
    v_lshrrev_b32 v14, 16, v14
    v_mul_u32_u24 v15, 18, v14
    v_sub_u32 v15, v171, v15
    v_mul_u32_u24 v14, 3072, v14
    v_lshl_add_u32 v14, v15, 1, v14
    v_add_u32 v14, v14, v168
    v_mul_f32 v80, s56, v80
    v_mul_f32 v81, s56, v81
    v_cvt_pk_bf16_f32 v80, v80, v81
    ds_write_b32 v14, v80 offset:0
    v_mul_f32 v84, s56, v84
    v_mul_f32 v85, s56, v85
    v_cvt_pk_bf16_f32 v84, v84, v85
    ds_write_b32 v14, v84 offset:768
    v_mul_f32 v88, s56, v88
    v_mul_f32 v89, s56, v89
    v_cvt_pk_bf16_f32 v88, v88, v89
    ds_write_b32 v14, v88 offset:1536
    v_mul_f32 v92, s56, v92
    v_mul_f32 v93, s56, v93
    v_cvt_pk_bf16_f32 v92, v92, v93
    ds_write_b32 v14, v92 offset:2304
    v_add_u32 v171, 50, v169
    v_mul_u32_u24 v14, 3641, v171
    v_lshrrev_b32 v14, 16, v14
    v_mul_u32_u24 v15, 18, v14
    v_sub_u32 v15, v171, v15
    v_mul_u32_u24 v14, 3072, v14
    v_lshl_add_u32 v14, v15, 1, v14
    v_add_u32 v14, v14, v168
    v_mul_f32 v82, s56, v82
    v_mul_f32 v83, s56, v83
    v_cvt_pk_bf16_f32 v82, v82, v83
    ds_write_b32 v14, v82 offset:0
    v_mul_f32 v86, s56, v86
    v_mul_f32 v87, s56, v87
    v_cvt_pk_bf16_f32 v86, v86, v87
    ds_write_b32 v14, v86 offset:768
    v_mul_f32 v90, s56, v90
    v_mul_f32 v91, s56, v91
    v_cvt_pk_bf16_f32 v90, v90, v91
    ds_write_b32 v14, v90 offset:1536
    v_mul_f32 v94, s56, v94
    v_mul_f32 v95, s56, v95
    v_cvt_pk_bf16_f32 v94, v94, v95
    ds_write_b32 v14, v94 offset:2304
    v_add_u32 v171, 64, v169
    v_mul_u32_u24 v14, 3641, v171
    v_lshrrev_b32 v14, 16, v14
    v_mul_u32_u24 v15, 18, v14
    v_sub_u32 v15, v171, v15
    v_mul_u32_u24 v14, 3072, v14
    v_lshl_add_u32 v14, v15, 1, v14
    v_add_u32 v14, v14, v168
    v_cmp_lt_u32 vcc, 71, v171
    v_mov_b32 v15, 155648
    s_nop 0
    v_cndmask_b32 v14, v14, v15, vcc
    v_mul_f32 v96, s56, v96
    v_mul_f32 v97, s56, v97
    v_cvt_pk_bf16_f32 v96, v96, v97
    ds_write_b32 v14, v96 offset:0
    v_mul_f32 v100, s56, v100
    v_mul_f32 v101, s56, v101
    v_cvt_pk_bf16_f32 v100, v100, v101
    ds_write_b32 v14, v100 offset:768
    v_mul_f32 v104, s56, v104
    v_mul_f32 v105, s56, v105
    v_cvt_pk_bf16_f32 v104, v104, v105
    ds_write_b32 v14, v104 offset:1536
    v_mul_f32 v108, s56, v108
    v_mul_f32 v109, s56, v109
    v_cvt_pk_bf16_f32 v108, v108, v109
    ds_write_b32 v14, v108 offset:2304
    v_add_u32 v171, 66, v169
    v_mul_u32_u24 v14, 3641, v171
    v_lshrrev_b32 v14, 16, v14
    v_mul_u32_u24 v15, 18, v14
    v_sub_u32 v15, v171, v15
    v_mul_u32_u24 v14, 3072, v14
    v_lshl_add_u32 v14, v15, 1, v14
    v_add_u32 v14, v14, v168
    v_cmp_lt_u32 vcc, 71, v171
    v_mov_b32 v15, 155648
    s_nop 0
    v_cndmask_b32 v14, v14, v15, vcc
    v_mul_f32 v98, s56, v98
    v_mul_f32 v99, s56, v99
    v_cvt_pk_bf16_f32 v98, v98, v99
    ds_write_b32 v14, v98 offset:0
    v_mul_f32 v102, s56, v102
    v_mul_f32 v103, s56, v103
    v_cvt_pk_bf16_f32 v102, v102, v103
    ds_write_b32 v14, v102 offset:768
    v_mul_f32 v106, s56, v106
    v_mul_f32 v107, s56, v107
    v_cvt_pk_bf16_f32 v106, v106, v107
    ds_write_b32 v14, v106 offset:1536
    v_mul_f32 v110, s56, v110
    v_mul_f32 v111, s56, v111
    v_cvt_pk_bf16_f32 v110, v110, v111
    ds_write_b32 v14, v110 offset:2304
    v_lshlrev_b32 v14, 4, v1
    v_add_u32 v15, s55, v14
    s_and_b32 s58, s2, 7
    s_mul_i32 s58, s58, 393216
    s_add_u32 s57, s57, s58
    s_lshl_b32 s58, s59, 6
    s_add_u32 s58, s58, s45
    s_mul_i32 s58, s58, 48
    s_add_u32 s57, s57, s58
    v_add_u32 v14, s57, v14
    s_waitcnt lgkmcnt(0)
    ds_read_b128 v[32:35], v15 offset:0
    ds_read_b128 v[36:39], v15 offset:1024
    ds_read_b128 v[40:43], v15 offset:2048
    ds_read_b128 v[44:47], v15 offset:3072
    ds_read_b128 v[48:51], v15 offset:4096
    ds_read_b128 v[52:55], v15 offset:5120
    ds_read_b128 v[56:59], v15 offset:6144
    ds_read_b128 v[60:63], v15 offset:7168
    ds_read_b128 v[64:67], v15 offset:8192
    ds_read_b128 v[68:71], v15 offset:9216
    ds_read_b128 v[72:75], v15 offset:10240
    ds_read_b128 v[76:79], v15 offset:11264
    s_waitcnt lgkmcnt(11)
    s_mov_b32 s58, 0
    buffer_store_dwordx4 v[32:35], v14, s[20:23], s58 offen offset:0
    s_waitcnt lgkmcnt(10)
    s_mov_b32 s58, 0
    buffer_store_dwordx4 v[36:39], v14, s[20:23], s58 offen offset:1024
    s_waitcnt lgkmcnt(9)
    s_mov_b32 s58, 0
    buffer_store_dwordx4 v[40:43], v14, s[20:23], s58 offen offset:2048
    s_waitcnt lgkmcnt(8)
    s_mov_b32 s58, 98304
    buffer_store_dwordx4 v[44:47], v14, s[20:23], s58 offen offset:0
    s_waitcnt lgkmcnt(7)
    s_mov_b32 s58, 98304
    buffer_store_dwordx4 v[48:51], v14, s[20:23], s58 offen offset:1024
    s_waitcnt lgkmcnt(6)
    s_mov_b32 s58, 98304
    buffer_store_dwordx4 v[52:55], v14, s[20:23], s58 offen offset:2048
    s_waitcnt lgkmcnt(5)
    s_mov_b32 s58, 196608
    buffer_store_dwordx4 v[56:59], v14, s[20:23], s58 offen offset:0
    s_waitcnt lgkmcnt(4)
    s_mov_b32 s58, 196608
    buffer_store_dwordx4 v[60:63], v14, s[20:23], s58 offen offset:1024
    s_waitcnt lgkmcnt(3)
    s_mov_b32 s58, 196608
    buffer_store_dwordx4 v[64:67], v14, s[20:23], s58 offen offset:2048
    s_waitcnt lgkmcnt(2)
    s_mov_b32 s58, 294912
    buffer_store_dwordx4 v[68:71], v14, s[20:23], s58 offen offset:0
    s_waitcnt lgkmcnt(1)
    s_mov_b32 s58, 294912
    buffer_store_dwordx4 v[72:75], v14, s[20:23], s58 offen offset:1024
    s_waitcnt lgkmcnt(0)
    s_mov_b32 s58, 294912
    buffer_store_dwordx4 v[76:79], v14, s[20:23], s58 offen offset:2048
    v_lshlrev_b32 v144, 16, v140
    v_and_b32 v145, 0xffff0000, v140
    v_lshlrev_b32 v146, 16, v141
    v_and_b32 v147, 0xffff0000, v141
    v_pk_fma_f32 v[148:149], v[136:137], v[128:129], v[144:145] op_sel:[0,1,0] op_sel_hi:[1,1,1]
    v_pk_fma_f32 v[150:151], v[138:139], v[128:129], v[146:147] op_sel:[0,1,0] op_sel_hi:[1,1,1]
    v_pk_fma_f32 v[152:153], v[136:137], v[130:131], v[144:145] op_sel:[0,1,0] op_sel_hi:[1,1,1]
    v_pk_fma_f32 v[154:155], v[138:139], v[130:131], v[146:147] op_sel:[0,1,0] op_sel_hi:[1,1,1]
    v_pk_fma_f32 v[16:17], v[16:17], v[128:129], v[148:149] op_sel:[0,0,0] op_sel_hi:[1,0,1]
    v_pk_fma_f32 v[18:19], v[18:19], v[128:129], v[150:151] op_sel:[0,0,0] op_sel_hi:[1,0,1]
    v_pk_fma_f32 v[20:21], v[20:21], v[130:131], v[152:153] op_sel:[0,0,0] op_sel_hi:[1,0,1]
    v_pk_fma_f32 v[22:23], v[22:23], v[130:131], v[154:155] op_sel:[0,0,0] op_sel_hi:[1,0,1]
    v_pk_mul_f32 v[148:149], v[16:17], v[16:17]
    v_pk_mul_f32 v[150:151], v[18:19], v[18:19]
    v_pk_mul_f32 v[152:153], v[20:21], v[20:21]
    v_pk_mul_f32 v[154:155], v[22:23], v[22:23]
    v_pk_fma_f32 v[148:149], v[148:149], v[10:11], v[6:7]
    v_pk_fma_f32 v[150:151], v[150:151], v[10:11], v[6:7]
    v_pk_fma_f32 v[152:153], v[152:153], v[10:11], v[6:7]
    v_pk_fma_f32 v[154:155], v[154:155], v[10:11], v[6:7]
    v_pk_mul_f32 v[148:149], v[148:149], v[16:17]
    v_pk_mul_f32 v[150:151], v[150:151], v[18:19]
    v_pk_mul_f32 v[152:153], v[152:153], v[20:21]
    v_pk_mul_f32 v[154:155], v[154:155], v[22:23]
    v_exp_f32 v148, v148
    v_exp_f32 v149, v149
    v_exp_f32 v150, v150
    v_exp_f32 v151, v151
    v_exp_f32 v152, v152
    v_exp_f32 v153, v153
    v_exp_f32 v154, v154
    v_exp_f32 v155, v155
    v_pk_add_f32 v[148:149], v[148:149], v[12:13]
    v_pk_add_f32 v[150:151], v[150:151], v[12:13]
    v_pk_add_f32 v[152:153], v[152:153], v[12:13]
    v_pk_add_f32 v[154:155], v[154:155], v[12:13]
    v_rcp_f32 v148, v148
    v_rcp_f32 v149, v149
    v_rcp_f32 v150, v150
    v_rcp_f32 v151, v151
    v_rcp_f32 v152, v152
    v_rcp_f32 v153, v153
    v_rcp_f32 v154, v154
    v_rcp_f32 v155, v155
    v_pk_mul_f32 v[16:17], v[16:17], v[148:149]
    v_pk_mul_f32 v[18:19], v[18:19], v[150:151]
    v_pk_mul_f32 v[20:21], v[20:21], v[152:153]
    v_pk_mul_f32 v[22:23], v[22:23], v[154:155]
    v_cvt_pk_bf16_f32 v16, v16, v17
    v_cvt_pk_bf16_f32 v17, v18, v19
    v_cvt_pk_bf16_f32 v18, v20, v21
    v_cvt_pk_bf16_f32 v19, v22, v23
    s_nop 1
    v_permlane16_swap_b32 v16, v18
    v_permlane16_swap_b32 v17, v19
    s_nop 0
    buffer_store_dwordx4 v[16:19], v9, s[16:19], s68 offen offset:0
    v_lshlrev_b32 v144, 16, v140
    v_and_b32 v145, 0xffff0000, v140
    v_lshlrev_b32 v146, 16, v141
    v_and_b32 v147, 0xffff0000, v141
    v_pk_fma_f32 v[148:149], v[136:137], v[132:133], v[144:145] op_sel:[0,1,0] op_sel_hi:[1,1,1]
    v_pk_fma_f32 v[150:151], v[138:139], v[132:133], v[146:147] op_sel:[0,1,0] op_sel_hi:[1,1,1]
    v_pk_fma_f32 v[152:153], v[136:137], v[134:135], v[144:145] op_sel:[0,1,0] op_sel_hi:[1,1,1]
    v_pk_fma_f32 v[154:155], v[138:139], v[134:135], v[146:147] op_sel:[0,1,0] op_sel_hi:[1,1,1]
    v_pk_fma_f32 v[24:25], v[24:25], v[132:133], v[148:149] op_sel:[0,0,0] op_sel_hi:[1,0,1]
    v_pk_fma_f32 v[26:27], v[26:27], v[132:133], v[150:151] op_sel:[0,0,0] op_sel_hi:[1,0,1]
    v_pk_fma_f32 v[28:29], v[28:29], v[134:135], v[152:153] op_sel:[0,0,0] op_sel_hi:[1,0,1]
    v_pk_fma_f32 v[30:31], v[30:31], v[134:135], v[154:155] op_sel:[0,0,0] op_sel_hi:[1,0,1]
    v_pk_mul_f32 v[148:149], v[24:25], v[24:25]
    v_pk_mul_f32 v[150:151], v[26:27], v[26:27]
    v_pk_mul_f32 v[152:153], v[28:29], v[28:29]
    v_pk_mul_f32 v[154:155], v[30:31], v[30:31]
    v_pk_fma_f32 v[148:149], v[148:149], v[10:11], v[6:7]
    v_pk_fma_f32 v[150:151], v[150:151], v[10:11], v[6:7]
    v_pk_fma_f32 v[152:153], v[152:153], v[10:11], v[6:7]
    v_pk_fma_f32 v[154:155], v[154:155], v[10:11], v[6:7]
    v_pk_mul_f32 v[148:149], v[148:149], v[24:25]
    v_pk_mul_f32 v[150:151], v[150:151], v[26:27]
    v_pk_mul_f32 v[152:153], v[152:153], v[28:29]
    v_pk_mul_f32 v[154:155], v[154:155], v[30:31]
    v_exp_f32 v148, v148
    v_exp_f32 v149, v149
    v_exp_f32 v150, v150
    v_exp_f32 v151, v151
    v_exp_f32 v152, v152
    v_exp_f32 v153, v153
    v_exp_f32 v154, v154
    v_exp_f32 v155, v155
    v_pk_add_f32 v[148:149], v[148:149], v[12:13]
    v_pk_add_f32 v[150:151], v[150:151], v[12:13]
    v_pk_add_f32 v[152:153], v[152:153], v[12:13]
    v_pk_add_f32 v[154:155], v[154:155], v[12:13]
    v_rcp_f32 v148, v148
    v_rcp_f32 v149, v149
    v_rcp_f32 v150, v150
    v_rcp_f32 v151, v151
    v_rcp_f32 v152, v152
    v_rcp_f32 v153, v153
    v_rcp_f32 v154, v154
    v_rcp_f32 v155, v155
    v_pk_mul_f32 v[24:25], v[24:25], v[148:149]
    v_pk_mul_f32 v[26:27], v[26:27], v[150:151]
    v_pk_mul_f32 v[28:29], v[28:29], v[152:153]
    v_pk_mul_f32 v[30:31], v[30:31], v[154:155]
    v_cvt_pk_bf16_f32 v24, v24, v25
    v_cvt_pk_bf16_f32 v25, v26, v27
    v_cvt_pk_bf16_f32 v26, v28, v29
    v_cvt_pk_bf16_f32 v27, v30, v31
    s_nop 1
    v_permlane16_swap_b32 v24, v26
    v_permlane16_swap_b32 v25, v27
    s_nop 0
    buffer_store_dwordx4 v[24:27], v9, s[16:19], s70 offen offset:0
    s_endpgm
l1_v:
    ds_read_b128 v[128:131], v234 offset:0
    ds_read_b128 v[132:135], v234 offset:2048
    ds_read_b128 v[136:139], v234 offset:4096
    ds_read_b128 v[140:143], v234 offset:6144
    ds_read_b64_tr_b16 v[160:161], v238 offset:224
    ds_read_b64_tr_b16 v[162:163], v238 offset:4832
    ds_read_b128 v[184:187], v240 offset:0
    ds_read_b64_tr_b16 v[192:193], v239 offset:0
    ds_read_b64_tr_b16 v[194:195], v239 offset:4608
    ds_read_b64_tr_b16 v[164:165], v241 offset:0
    ds_read_b64_tr_b16 v[166:167], v241 offset:2560
    ds_read_b64_tr_b16 v[168:169], v241 offset:32
    ds_read_b64_tr_b16 v[170:171], v241 offset:2592
    ds_read_b64_tr_b16 v[172:173], v241 offset:64
    ds_read_b64_tr_b16 v[174:175], v241 offset:2624
    s_waitcnt lgkmcnt(9)
    v_mfma_f32_16x16x32_bf16 v[16:19], v[160:163], v[128:131], 0
    v_mfma_f32_16x16x32_bf16 v[20:23], v[160:163], v[132:135], 0
    v_mfma_f32_16x16x32_bf16 v[24:27], v[160:163], v[136:139], 0
    v_mfma_f32_16x16x32_bf16 v[28:31], v[160:163], v[140:143], 0
    ds_read_b64_tr_b16 v[176:177], v241 offset:96
    ds_read_b64_tr_b16 v[178:179], v241 offset:2656
    s_add_u32 m0, s53, 65536
    s_nop 0
    buffer_load_dwordx4 v228, s[4:7], s49 offen lds
    s_waitcnt lgkmcnt(6)
    v_mfma_f32_16x16x32_bf16 v[32:35], v[128:131], v[164:167], 0
    v_mfma_f32_16x16x32_bf16 v[36:39], v[132:135], v[164:167], 0
    v_mfma_f32_16x16x32_bf16 v[40:43], v[136:139], v[164:167], 0
    v_mfma_f32_16x16x32_bf16 v[44:47], v[140:143], v[164:167], 0
    v_mfma_f32_16x16x32_bf16 v[200:203], v[184:187], v[136:139], 0
    v_mfma_f32_16x16x32_bf16 v[204:207], v[184:187], v[140:143], 0
    ds_read_b64_tr_b16 v[180:181], v241 offset:128
    ds_read_b64_tr_b16 v[182:183], v241 offset:2688
    s_add_u32 m0, s53, 66560
    s_nop 0
    buffer_load_dwordx4 v229, s[4:7], s49 offen lds
    s_waitcnt lgkmcnt(6)
    v_mfma_f32_16x16x32_bf16 v[48:51], v[128:131], v[168:171], 0
    v_mfma_f32_16x16x32_bf16 v[52:55], v[132:135], v[168:171], 0
    v_mfma_f32_16x16x32_bf16 v[56:59], v[136:139], v[168:171], 0
    v_mfma_f32_16x16x32_bf16 v[60:63], v[140:143], v[168:171], 0
    v_mfma_f32_16x16x32_bf16 v[208:211], v[192:195], v[216:219], 0
    ds_read_b128 v[144:147], v236 offset:0
    ds_read_b128 v[148:151], v236 offset:2048
    ds_read_b128 v[152:155], v236 offset:4096
    ds_read_b128 v[156:159], v236 offset:6144
    ds_read_b64_tr_b16 v[160:161], v238 offset:9440
    ds_read_b64_tr_b16 v[162:163], v238 offset:14048
    s_add_u32 m0, s53, 67584
    s_nop 0
    buffer_load_dwordx4 v230, s[4:7], s49 offen lds
    s_waitcnt lgkmcnt(10)
    v_mfma_f32_16x16x32_bf16 v[64:67], v[128:131], v[172:175], 0
    v_mfma_f32_16x16x32_bf16 v[68:71], v[132:135], v[172:175], 0
    v_mfma_f32_16x16x32_bf16 v[72:75], v[136:139], v[172:175], 0
    v_mfma_f32_16x16x32_bf16 v[76:79], v[140:143], v[172:175], 0
    v_mfma_f32_16x16x32_bf16 v[220:223], v[136:139], v[136:139], 0
    v_mfma_f32_16x16x32_bf16 v[224:227], v[140:143], v[140:143], 0
    ds_read_b128 v[188:191], v240 offset:64
    ds_read_b64_tr_b16 v[196:197], v239 offset:9216
    ds_read_b64_tr_b16 v[198:199], v239 offset:13824
    ds_read_b64_tr_b16 v[164:165], v241 offset:5120
    ds_read_b64_tr_b16 v[166:167], v241 offset:7680
    s_add_u32 m0, s53, 68608
    s_nop 0
    buffer_load_dwordx4 v231, s[4:7], s49 offen lds
    s_add_u32 s49, s49, 128
    s_waitcnt lgkmcnt(13)
    v_mfma_f32_16x16x32_bf16 v[80:83], v[128:131], v[176:179], 0
    v_mfma_f32_16x16x32_bf16 v[84:87], v[132:135], v[176:179], 0
    v_mfma_f32_16x16x32_bf16 v[88:91], v[136:139], v[176:179], 0
    v_mfma_f32_16x16x32_bf16 v[92:95], v[140:143], v[176:179], 0
    ds_read_b64_tr_b16 v[168:169], v241 offset:5152
    ds_read_b64_tr_b16 v[170:171], v241 offset:7712
    s_add_u32 m0, s54, 27648
    s_nop 0
    buffer_load_dwordx4 v232, s[8:11], s50 offen lds
    s_add_u32 s50, s50, 294912
    s_waitcnt lgkmcnt(13)
    v_mfma_f32_16x16x32_bf16 v[96:99], v[128:131], v[180:183], 0
    v_mfma_f32_16x16x32_bf16 v[100:103], v[132:135], v[180:183], 0
    v_mfma_f32_16x16x32_bf16 v[104:107], v[136:139], v[180:183], 0
    v_mfma_f32_16x16x32_bf16 v[108:111], v[140:143], v[180:183], 0
    ds_read_b64_tr_b16 v[172:173], v241 offset:5184
    ds_read_b64_tr_b16 v[174:175], v241 offset:7744
    s_mov_b32 m0, s67
    s_nop 0
    buffer_load_dwordx4 v233, s[12:15], s51 offen lds
    s_add_u32 s51, s51, s52
    s_waitcnt vmcnt(6)
    s_barrier
    s_waitcnt lgkmcnt(9)
    v_mfma_f32_16x16x32_bf16 v[16:19], v[160:163], v[144:147], v[16:19]
    v_mfma_f32_16x16x32_bf16 v[20:23], v[160:163], v[148:151], v[20:23]
    v_mfma_f32_16x16x32_bf16 v[24:27], v[160:163], v[152:155], v[24:27]
    v_mfma_f32_16x16x32_bf16 v[28:31], v[160:163], v[156:159], v[28:31]
    ds_read_b64_tr_b16 v[176:177], v241 offset:5216
    ds_read_b64_tr_b16 v[178:179], v241 offset:7776
    s_add_u32 m0, s54, 0
    s_nop 0
    buffer_load_dwordx4 v232, s[8:11], s50 offen lds
    s_add_u32 s50, s50, 294912
    s_waitcnt lgkmcnt(6)
    v_mfma_f32_16x16x32_bf16 v[32:35], v[144:147], v[164:167], v[32:35]
    v_mfma_f32_16x16x32_bf16 v[36:39], v[148:151], v[164:167], v[36:39]
    v_mfma_f32_16x16x32_bf16 v[40:43], v[152:155], v[164:167], v[40:43]
    v_mfma_f32_16x16x32_bf16 v[44:47], v[156:159], v[164:167], v[44:47]
    v_mfma_f32_16x16x32_bf16 v[200:203], v[188:191], v[152:155], v[200:203]
    v_mfma_f32_16x16x32_bf16 v[204:207], v[188:191], v[156:159], v[204:207]
    ds_read_b64_tr_b16 v[180:181], v241 offset:5248
    ds_read_b64_tr_b16 v[182:183], v241 offset:7808
    s_mov_b32 m0, s64
    s_nop 0
    buffer_load_dwordx4 v233, s[12:15], s51 offen lds
    s_add_u32 s51, s51, s52
    s_waitcnt lgkmcnt(6)
    v_mfma_f32_16x16x32_bf16 v[48:51], v[144:147], v[168:171], v[48:51]
    v_mfma_f32_16x16x32_bf16 v[52:55], v[148:151], v[168:171], v[52:55]
    v_mfma_f32_16x16x32_bf16 v[56:59], v[152:155], v[168:171], v[56:59]
    v_mfma_f32_16x16x32_bf16 v[60:63], v[156:159], v[168:171], v[60:63]
    v_mfma_f32_16x16x32_bf16 v[208:211], v[196:199], v[216:219], v[208:211]
    ds_read_b128 v[128:131], v234 offset:32768
    ds_read_b128 v[132:135], v234 offset:34816
    ds_read_b128 v[136:139], v234 offset:36864
    ds_read_b128 v[140:143], v234 offset:38912
    ds_read_b64_tr_b16 v[160:161], v238 offset:18656
    ds_read_b64_tr_b16 v[162:163], v238 offset:23264
    s_waitcnt lgkmcnt(10)
    v_mfma_f32_16x16x32_bf16 v[64:67], v[144:147], v[172:175], v[64:67]
    v_mfma_f32_16x16x32_bf16 v[68:71], v[148:151], v[172:175], v[68:71]
    v_mfma_f32_16x16x32_bf16 v[72:75], v[152:155], v[172:175], v[72:75]
    v_mfma_f32_16x16x32_bf16 v[76:79], v[156:159], v[172:175], v[76:79]
    v_mfma_f32_16x16x32_bf16 v[220:223], v[152:155], v[152:155], v[220:223]
    v_mfma_f32_16x16x32_bf16 v[224:227], v[156:159], v[156:159], v[224:227]
    ds_read_b128 v[184:187], v240 offset:128
    ds_read_b64_tr_b16 v[192:193], v239 offset:18432
    ds_read_b64_tr_b16 v[194:195], v239 offset:23040
    ds_read_b64_tr_b16 v[164:165], v241 offset:10240
    ds_read_b64_tr_b16 v[166:167], v241 offset:12800
    s_waitcnt lgkmcnt(13)
    v_mfma_f32_16x16x32_bf16 v[80:83], v[144:147], v[176:179], v[80:83]
    v_mfma_f32_16x16x32_bf16 v[84:87], v[148:151], v[176:179], v[84:87]
    v_mfma_f32_16x16x32_bf16 v[88:91], v[152:155], v[176:179], v[88:91]
    v_mfma_f32_16x16x32_bf16 v[92:95], v[156:159], v[176:179], v[92:95]
    ds_read_b64_tr_b16 v[168:169], v241 offset:10272
    ds_read_b64_tr_b16 v[170:171], v241 offset:12832
    s_waitcnt lgkmcnt(13)
    v_mfma_f32_16x16x32_bf16 v[96:99], v[144:147], v[180:183], v[96:99]
    v_mfma_f32_16x16x32_bf16 v[100:103], v[148:151], v[180:183], v[100:103]
    v_mfma_f32_16x16x32_bf16 v[104:107], v[152:155], v[180:183], v[104:107]
    v_mfma_f32_16x16x32_bf16 v[108:111], v[156:159], v[180:183], v[108:111]
    ds_read_b64_tr_b16 v[172:173], v241 offset:10304
    ds_read_b64_tr_b16 v[174:175], v241 offset:12864
    s_waitcnt vmcnt(2)
    s_barrier
    s_waitcnt lgkmcnt(9)
    v_mfma_f32_16x16x32_bf16 v[16:19], v[160:163], v[128:131], v[16:19]
    v_mfma_f32_16x16x32_bf16 v[20:23], v[160:163], v[132:135], v[20:23]
    v_mfma_f32_16x16x32_bf16 v[24:27], v[160:163], v[136:139], v[24:27]
    v_mfma_f32_16x16x32_bf16 v[28:31], v[160:163], v[140:143], v[28:31]
    ds_read_b64_tr_b16 v[176:177], v241 offset:10336
    ds_read_b64_tr_b16 v[178:179], v241 offset:12896
    s_add_u32 m0, s53, 0
    s_nop 0
    buffer_load_dwordx4 v228, s[4:7], s49 offen lds
    s_waitcnt lgkmcnt(6)
    v_mfma_f32_16x16x32_bf16 v[32:35], v[128:131], v[164:167], v[32:35]
    v_mfma_f32_16x16x32_bf16 v[36:39], v[132:135], v[164:167], v[36:39]
    v_mfma_f32_16x16x32_bf16 v[40:43], v[136:139], v[164:167], v[40:43]
    v_mfma_f32_16x16x32_bf16 v[44:47], v[140:143], v[164:167], v[44:47]
    v_mfma_f32_16x16x32_bf16 v[200:203], v[184:187], v[136:139], v[200:203]
    v_mfma_f32_16x16x32_bf16 v[204:207], v[184:187], v[140:143], v[204:207]
    ds_read_b64_tr_b16 v[180:181], v241 offset:10368
    ds_read_b64_tr_b16 v[182:183], v241 offset:12928
    s_add_u32 m0, s53, 1024
    s_nop 0
    buffer_load_dwordx4 v229, s[4:7], s49 offen lds
    s_waitcnt lgkmcnt(6)
    v_mfma_f32_16x16x32_bf16 v[48:51], v[128:131], v[168:171], v[48:51]
    v_mfma_f32_16x16x32_bf16 v[52:55], v[132:135], v[168:171], v[52:55]
    v_mfma_f32_16x16x32_bf16 v[56:59], v[136:139], v[168:171], v[56:59]
    v_mfma_f32_16x16x32_bf16 v[60:63], v[140:143], v[168:171], v[60:63]
    v_mfma_f32_16x16x32_bf16 v[208:211], v[192:195], v[216:219], v[208:211]
    ds_read_b128 v[144:147], v236 offset:32768
    ds_read_b128 v[148:151], v236 offset:34816
    ds_read_b128 v[152:155], v236 offset:36864
    ds_read_b128 v[156:159], v236 offset:38912
    ds_read_b64_tr_b16 v[160:161], v238 offset:27872
    ds_read_b64_tr_b16 v[162:163], v238 offset:32480
    s_add_u32 m0, s53, 2048
    s_nop 0
    buffer_load_dwordx4 v230, s[4:7], s49 offen lds
    s_waitcnt lgkmcnt(10)
    v_mfma_f32_16x16x32_bf16 v[64:67], v[128:131], v[172:175], v[64:67]
    v_mfma_f32_16x16x32_bf16 v[68:71], v[132:135], v[172:175], v[68:71]
    v_mfma_f32_16x16x32_bf16 v[72:75], v[136:139], v[172:175], v[72:75]
    v_mfma_f32_16x16x32_bf16 v[76:79], v[140:143], v[172:175], v[76:79]
    v_mfma_f32_16x16x32_bf16 v[220:223], v[136:139], v[136:139], v[220:223]
    v_mfma_f32_16x16x32_bf16 v[224:227], v[140:143], v[140:143], v[224:227]
    ds_read_b128 v[188:191], v240 offset:192
    ds_read_b64_tr_b16 v[196:197], v239 offset:27648
    ds_read_b64_tr_b16 v[198:199], v239 offset:32256
    ds_read_b64_tr_b16 v[164:165], v241 offset:15360
    ds_read_b64_tr_b16 v[166:167], v241 offset:17920
    s_add_u32 m0, s53, 3072
    s_nop 0
    buffer_load_dwordx4 v231, s[4:7], s49 offen lds
    s_add_u32 s49, s49, 128
    s_waitcnt lgkmcnt(13)
    v_mfma_f32_16x16x32_bf16 v[80:83], v[128:131], v[176:179], v[80:83]
    v_mfma_f32_16x16x32_bf16 v[84:87], v[132:135], v[176:179], v[84:87]
    v_mfma_f32_16x16x32_bf16 v[88:91], v[136:139], v[176:179], v[88:91]
    v_mfma_f32_16x16x32_bf16 v[92:95], v[140:143], v[176:179], v[92:95]
    ds_read_b64_tr_b16 v[168:169], v241 offset:15392
    ds_read_b64_tr_b16 v[170:171], v241 offset:17952
    s_add_u32 m0, s54, 9216
    s_nop 0
    buffer_load_dwordx4 v232, s[8:11], s50 offen lds
    s_add_u32 s50, s50, 294912
    s_waitcnt lgkmcnt(13)
    v_mfma_f32_16x16x32_bf16 v[96:99], v[128:131], v[180:183], v[96:99]
    v_mfma_f32_16x16x32_bf16 v[100:103], v[132:135], v[180:183], v[100:103]
    v_mfma_f32_16x16x32_bf16 v[104:107], v[136:139], v[180:183], v[104:107]
    v_mfma_f32_16x16x32_bf16 v[108:111], v[140:143], v[180:183], v[108:111]
    ds_read_b64_tr_b16 v[172:173], v241 offset:15424
    ds_read_b64_tr_b16 v[174:175], v241 offset:17984
    s_mov_b32 m0, s65
    s_nop 0
    buffer_load_dwordx4 v233, s[12:15], s51 offen lds
    s_add_u32 s51, s51, s52
    s_waitcnt vmcnt(6)
    s_barrier
    s_waitcnt lgkmcnt(9)
    v_mfma_f32_16x16x32_bf16 v[16:19], v[160:163], v[144:147], v[16:19]
    v_mfma_f32_16x16x32_bf16 v[20:23], v[160:163], v[148:151], v[20:23]
    v_mfma_f32_16x16x32_bf16 v[24:27], v[160:163], v[152:155], v[24:27]
    v_mfma_f32_16x16x32_bf16 v[28:31], v[160:163], v[156:159], v[28:31]
    ds_read_b64_tr_b16 v[176:177], v241 offset:15456
    ds_read_b64_tr_b16 v[178:179], v241 offset:18016
    s_add_u32 m0, s54, 18432
    s_nop 0
    buffer_load_dwordx4 v232, s[8:11], s50 offen lds
    s_add_u32 s50, s50, 294912
    s_waitcnt lgkmcnt(6)
    v_mfma_f32_16x16x32_bf16 v[32:35], v[144:147], v[164:167], v[32:35]
    v_mfma_f32_16x16x32_bf16 v[36:39], v[148:151], v[164:167], v[36:39]
    v_mfma_f32_16x16x32_bf16 v[40:43], v[152:155], v[164:167], v[40:43]
    v_mfma_f32_16x16x32_bf16 v[44:47], v[156:159], v[164:167], v[44:47]
    v_mfma_f32_16x16x32_bf16 v[200:203], v[188:191], v[152:155], v[200:203]
    v_mfma_f32_16x16x32_bf16 v[204:207], v[188:191], v[156:159], v[204:207]
    ds_read_b64_tr_b16 v[180:181], v241 offset:15488
    ds_read_b64_tr_b16 v[182:183], v241 offset:18048
    s_mov_b32 m0, s66
    s_nop 0
    buffer_load_dwordx4 v233, s[12:15], s51 offen lds
    s_add_u32 s51, s51, s52
    s_waitcnt lgkmcnt(6)
    v_mfma_f32_16x16x32_bf16 v[48:51], v[144:147], v[168:171], v[48:51]
    v_mfma_f32_16x16x32_bf16 v[52:55], v[148:151], v[168:171], v[52:55]
    v_mfma_f32_16x16x32_bf16 v[56:59], v[152:155], v[168:171], v[56:59]
    v_mfma_f32_16x16x32_bf16 v[60:63], v[156:159], v[168:171], v[60:63]
    v_mfma_f32_16x16x32_bf16 v[208:211], v[196:199], v[216:219], v[208:211]
    ds_read_b128 v[128:131], v235 offset:0
    ds_read_b128 v[132:135], v235 offset:2048
    ds_read_b128 v[136:139], v235 offset:4096
    ds_read_b128 v[140:143], v235 offset:6144
    ds_read_b64_tr_b16 v[160:161], v238 offset:224
    ds_read_b64_tr_b16 v[162:163], v238 offset:4832
    s_waitcnt lgkmcnt(10)
    v_mfma_f32_16x16x32_bf16 v[64:67], v[144:147], v[172:175], v[64:67]
    v_mfma_f32_16x16x32_bf16 v[68:71], v[148:151], v[172:175], v[68:71]
    v_mfma_f32_16x16x32_bf16 v[72:75], v[152:155], v[172:175], v[72:75]
    v_mfma_f32_16x16x32_bf16 v[76:79], v[156:159], v[172:175], v[76:79]
    v_mfma_f32_16x16x32_bf16 v[220:223], v[152:155], v[152:155], v[220:223]
    v_mfma_f32_16x16x32_bf16 v[224:227], v[156:159], v[156:159], v[224:227]
    ds_read_b128 v[184:187], v240 offset:256
    ds_read_b64_tr_b16 v[192:193], v239 offset:0
    ds_read_b64_tr_b16 v[194:195], v239 offset:4608
    ds_read_b64_tr_b16 v[164:165], v241 offset:0
    ds_read_b64_tr_b16 v[166:167], v241 offset:2560
    s_waitcnt lgkmcnt(13)
    v_mfma_f32_16x16x32_bf16 v[80:83], v[144:147], v[176:179], v[80:83]
    v_mfma_f32_16x16x32_bf16 v[84:87], v[148:151], v[176:179], v[84:87]
    v_mfma_f32_16x16x32_bf16 v[88:91], v[152:155], v[176:179], v[88:91]
    v_mfma_f32_16x16x32_bf16 v[92:95], v[156:159], v[176:179], v[92:95]
    ds_read_b64_tr_b16 v[168:169], v241 offset:32
    ds_read_b64_tr_b16 v[170:171], v241 offset:2592
    s_waitcnt lgkmcnt(13)
    v_mfma_f32_16x16x32_bf16 v[96:99], v[144:147], v[180:183], v[96:99]
    v_mfma_f32_16x16x32_bf16 v[100:103], v[148:151], v[180:183], v[100:103]
    v_mfma_f32_16x16x32_bf16 v[104:107], v[152:155], v[180:183], v[104:107]
    v_mfma_f32_16x16x32_bf16 v[108:111], v[156:159], v[180:183], v[108:111]
    ds_read_b64_tr_b16 v[172:173], v241 offset:64
    ds_read_b64_tr_b16 v[174:175], v241 offset:2624
    s_waitcnt vmcnt(2)
    s_barrier
    s_waitcnt lgkmcnt(9)
    v_mfma_f32_16x16x32_bf16 v[16:19], v[160:163], v[128:131], v[16:19]
    v_mfma_f32_16x16x32_bf16 v[20:23], v[160:163], v[132:135], v[20:23]
    v_mfma_f32_16x16x32_bf16 v[24:27], v[160:163], v[136:139], v[24:27]
    v_mfma_f32_16x16x32_bf16 v[28:31], v[160:163], v[140:143], v[28:31]
    ds_read_b64_tr_b16 v[176:177], v241 offset:96
    ds_read_b64_tr_b16 v[178:179], v241 offset:2656
    s_add_u32 m0, s53, 32768
    s_nop 0
    buffer_load_dwordx4 v228, s[4:7], s49 offen lds
    s_waitcnt lgkmcnt(6)
    v_mfma_f32_16x16x32_bf16 v[32:35], v[128:131], v[164:167], v[32:35]
    v_mfma_f32_16x16x32_bf16 v[36:39], v[132:135], v[164:167], v[36:39]
    v_mfma_f32_16x16x32_bf16 v[40:43], v[136:139], v[164:167], v[40:43]
    v_mfma_f32_16x16x32_bf16 v[44:47], v[140:143], v[164:167], v[44:47]
    v_mfma_f32_16x16x32_bf16 v[200:203], v[184:187], v[136:139], v[200:203]
    v_mfma_f32_16x16x32_bf16 v[204:207], v[184:187], v[140:143], v[204:207]
    ds_read_b64_tr_b16 v[180:181], v241 offset:128
    ds_read_b64_tr_b16 v[182:183], v241 offset:2688
    s_add_u32 m0, s53, 33792
    s_nop 0
    buffer_load_dwordx4 v229, s[4:7], s49 offen lds
    s_waitcnt lgkmcnt(6)
    v_mfma_f32_16x16x32_bf16 v[48:51], v[128:131], v[168:171], v[48:51]
    v_mfma_f32_16x16x32_bf16 v[52:55], v[132:135], v[168:171], v[52:55]
    v_mfma_f32_16x16x32_bf16 v[56:59], v[136:139], v[168:171], v[56:59]
    v_mfma_f32_16x16x32_bf16 v[60:63], v[140:143], v[168:171], v[60:63]
    v_mfma_f32_16x16x32_bf16 v[208:211], v[192:195], v[216:219], v[208:211]
    ds_read_b128 v[144:147], v237 offset:0
    ds_read_b128 v[148:151], v237 offset:2048
    ds_read_b128 v[152:155], v237 offset:4096
    ds_read_b128 v[156:159], v237 offset:6144
    ds_read_b64_tr_b16 v[160:161], v238 offset:9440
    ds_read_b64_tr_b16 v[162:163], v238 offset:14048
    s_add_u32 m0, s53, 34816
    s_nop 0
    buffer_load_dwordx4 v230, s[4:7], s49 offen lds
    s_waitcnt lgkmcnt(10)
    v_mfma_f32_16x16x32_bf16 v[64:67], v[128:131], v[172:175], v[64:67]
    v_mfma_f32_16x16x32_bf16 v[68:71], v[132:135], v[172:175], v[68:71]
    v_mfma_f32_16x16x32_bf16 v[72:75], v[136:139], v[172:175], v[72:75]
    v_mfma_f32_16x16x32_bf16 v[76:79], v[140:143], v[172:175], v[76:79]
    v_mfma_f32_16x16x32_bf16 v[220:223], v[136:139], v[136:139], v[220:223]
    v_mfma_f32_16x16x32_bf16 v[224:227], v[140:143], v[140:143], v[224:227]
    ds_read_b128 v[188:191], v240 offset:320
    ds_read_b64_tr_b16 v[196:197], v239 offset:9216
    ds_read_b64_tr_b16 v[198:199], v239 offset:13824
    ds_read_b64_tr_b16 v[164:165], v241 offset:5120
    ds_read_b64_tr_b16 v[166:167], v241 offset:7680
    s_add_u32 m0, s53, 35840
    s_nop 0
    buffer_load_dwordx4 v231, s[4:7], s49 offen lds
    s_add_u32 s49, s49, 128
    s_waitcnt lgkmcnt(13)
    v_mfma_f32_16x16x32_bf16 v[80:83], v[128:131], v[176:179], v[80:83]
    v_mfma_f32_16x16x32_bf16 v[84:87], v[132:135], v[176:179], v[84:87]
    v_mfma_f32_16x16x32_bf16 v[88:91], v[136:139], v[176:179], v[88:91]
    v_mfma_f32_16x16x32_bf16 v[92:95], v[140:143], v[176:179], v[92:95]
    ds_read_b64_tr_b16 v[168:169], v241 offset:5152
    ds_read_b64_tr_b16 v[170:171], v241 offset:7712
    s_add_u32 m0, s54, 27648
    s_nop 0
    buffer_load_dwordx4 v232, s[8:11], s50 offen lds
    s_add_u32 s50, s50, 294912
    s_waitcnt lgkmcnt(13)
    v_mfma_f32_16x16x32_bf16 v[96:99], v[128:131], v[180:183], v[96:99]
    v_mfma_f32_16x16x32_bf16 v[100:103], v[132:135], v[180:183], v[100:103]
    v_mfma_f32_16x16x32_bf16 v[104:107], v[136:139], v[180:183], v[104:107]
    v_mfma_f32_16x16x32_bf16 v[108:111], v[140:143], v[180:183], v[108:111]
    ds_read_b64_tr_b16 v[172:173], v241 offset:5184
    ds_read_b64_tr_b16 v[174:175], v241 offset:7744
    s_mov_b32 m0, s67
    s_nop 0
    buffer_load_dwordx4 v233, s[12:15], s51 offen lds
    s_add_u32 s51, s51, s52
    s_waitcnt vmcnt(6)
    s_barrier
    s_waitcnt lgkmcnt(9)
    v_mfma_f32_16x16x32_bf16 v[16:19], v[160:163], v[144:147], v[16:19]
    v_mfma_f32_16x16x32_bf16 v[20:23], v[160:163], v[148:151], v[20:23]
    v_mfma_f32_16x16x32_bf16 v[24:27], v[160:163], v[152:155], v[24:27]
    v_mfma_f32_16x16x32_bf16 v[28:31], v[160:163], v[156:159], v[28:31]
    ds_read_b64_tr_b16 v[176:177], v241 offset:5216
    ds_read_b64_tr_b16 v[178:179], v241 offset:7776
    s_add_u32 m0, s54, 0
    s_nop 0
    buffer_load_dwordx4 v232, s[8:11], s50 offen lds
    s_add_u32 s50, s50, 294912
    s_waitcnt lgkmcnt(6)
    v_mfma_f32_16x16x32_bf16 v[32:35], v[144:147], v[164:167], v[32:35]
    v_mfma_f32_16x16x32_bf16 v[36:39], v[148:151], v[164:167], v[36:39]
    v_mfma_f32_16x16x32_bf16 v[40:43], v[152:155], v[164:167], v[40:43]
    v_mfma_f32_16x16x32_bf16 v[44:47], v[156:159], v[164:167], v[44:47]
    v_mfma_f32_16x16x32_bf16 v[200:203], v[188:191], v[152:155], v[200:203]
    v_mfma_f32_16x16x32_bf16 v[204:207], v[188:191], v[156:159], v[204:207]
    ds_read_b64_tr_b16 v[180:181], v241 offset:5248
    ds_read_b64_tr_b16 v[182:183], v241 offset:7808
    s_mov_b32 m0, s64
    s_nop 0
    buffer_load_dwordx4 v233, s[12:15], s51 offen lds
    s_add_u32 s51, s51, s52
    s_waitcnt lgkmcnt(6)
    v_mfma_f32_16x16x32_bf16 v[48:51], v[144:147], v[168:171], v[48:51]
    v_mfma_f32_16x16x32_bf16 v[52:55], v[148:151], v[168:171], v[52:55]
    v_mfma_f32_16x16x32_bf16 v[56:59], v[152:155], v[168:171], v[56:59]
    v_mfma_f32_16x16x32_bf16 v[60:63], v[156:159], v[168:171], v[60:63]
    v_mfma_f32_16x16x32_bf16 v[208:211], v[196:199], v[216:219], v[208:211]
    ds_read_b128 v[128:131], v234 offset:0
    ds_read_b128 v[132:135], v234 offset:2048
    ds_read_b128 v[136:139], v234 offset:4096
    ds_read_b128 v[140:143], v234 offset:6144
    ds_read_b64_tr_b16 v[160:161], v238 offset:18656
    ds_read_b64_tr_b16 v[162:163], v238 offset:23264
    s_waitcnt lgkmcnt(10)
    v_mfma_f32_16x16x32_bf16 v[64:67], v[144:147], v[172:175], v[64:67]
    v_mfma_f32_16x16x32_bf16 v[68:71], v[148:151], v[172:175], v[68:71]
    v_mfma_f32_16x16x32_bf16 v[72:75], v[152:155], v[172:175], v[72:75]
    v_mfma_f32_16x16x32_bf16 v[76:79], v[156:159], v[172:175], v[76:79]
    v_mfma_f32_16x16x32_bf16 v[220:223], v[152:155], v[152:155], v[220:223]
    v_mfma_f32_16x16x32_bf16 v[224:227], v[156:159], v[156:159], v[224:227]
    ds_read_b128 v[184:187], v240 offset:384
    ds_read_b64_tr_b16 v[192:193], v239 offset:18432
    ds_read_b64_tr_b16 v[194:195], v239 offset:23040
    ds_read_b64_tr_b16 v[164:165], v241 offset:10240
    ds_read_b64_tr_b16 v[166:167], v241 offset:12800
    s_waitcnt lgkmcnt(13)
    v_mfma_f32_16x16x32_bf16 v[80:83], v[144:147], v[176:179], v[80:83]
    v_mfma_f32_16x16x32_bf16 v[84:87], v[148:151], v[176:179], v[84:87]
    v_mfma_f32_16x16x32_bf16 v[88:91], v[152:155], v[176:179], v[88:91]
    v_mfma_f32_16x16x32_bf16 v[92:95], v[156:159], v[176:179], v[92:95]
    ds_read_b64_tr_b16 v[168:169], v241 offset:10272
    ds_read_b64_tr_b16 v[170:171], v241 offset:12832
    s_waitcnt lgkmcnt(13)
    v_mfma_f32_16x16x32_bf16 v[96:99], v[144:147], v[180:183], v[96:99]
    v_mfma_f32_16x16x32_bf16 v[100:103], v[148:151], v[180:183], v[100:103]
    v_mfma_f32_16x16x32_bf16 v[104:107], v[152:155], v[180:183], v[104:107]
    v_mfma_f32_16x16x32_bf16 v[108:111], v[156:159], v[180:183], v[108:111]
    ds_read_b64_tr_b16 v[172:173], v241 offset:10304
    ds_read_b64_tr_b16 v[174:175], v241 offset:12864
    s_waitcnt vmcnt(2)
    s_barrier
    s_waitcnt lgkmcnt(9)
    v_mfma_f32_16x16x32_bf16 v[16:19], v[160:163], v[128:131], v[16:19]
    v_mfma_f32_16x16x32_bf16 v[20:23], v[160:163], v[132:135], v[20:23]
    v_mfma_f32_16x16x32_bf16 v[24:27], v[160:163], v[136:139], v[24:27]
    v_mfma_f32_16x16x32_bf16 v[28:31], v[160:163], v[140:143], v[28:31]
    ds_read_b64_tr_b16 v[176:177], v241 offset:10336
    ds_read_b64_tr_b16 v[178:179], v241 offset:12896
    s_add_u32 m0, s53, 65536
    s_nop 0
    buffer_load_dwordx4 v228, s[4:7], s49 offen lds
    s_waitcnt lgkmcnt(6)
    v_mfma_f32_16x16x32_bf16 v[32:35], v[128:131], v[164:167], v[32:35]
    v_mfma_f32_16x16x32_bf16 v[36:39], v[132:135], v[164:167], v[36:39]
    v_mfma_f32_16x16x32_bf16 v[40:43], v[136:139], v[164:167], v[40:43]
    v_mfma_f32_16x16x32_bf16 v[44:47], v[140:143], v[164:167], v[44:47]
    v_mfma_f32_16x16x32_bf16 v[200:203], v[184:187], v[136:139], v[200:203]
    v_mfma_f32_16x16x32_bf16 v[204:207], v[184:187], v[140:143], v[204:207]
    ds_read_b64_tr_b16 v[180:181], v241 offset:10368
    ds_read_b64_tr_b16 v[182:183], v241 offset:12928
    s_add_u32 m0, s53, 66560
    s_nop 0
    buffer_load_dwordx4 v229, s[4:7], s49 offen lds
    s_waitcnt lgkmcnt(6)
    v_mfma_f32_16x16x32_bf16 v[48:51], v[128:131], v[168:171], v[48:51]
    v_mfma_f32_16x16x32_bf16 v[52:55], v[132:135], v[168:171], v[52:55]
    v_mfma_f32_16x16x32_bf16 v[56:59], v[136:139], v[168:171], v[56:59]
    v_mfma_f32_16x16x32_bf16 v[60:63], v[140:143], v[168:171], v[60:63]
    v_mfma_f32_16x16x32_bf16 v[208:211], v[192:195], v[216:219], v[208:211]
    ds_read_b128 v[144:147], v236 offset:0
    ds_read_b128 v[148:151], v236 offset:2048
    ds_read_b128 v[152:155], v236 offset:4096
    ds_read_b128 v[156:159], v236 offset:6144
    ds_read_b64_tr_b16 v[160:161], v238 offset:27872
    ds_read_b64_tr_b16 v[162:163], v238 offset:32480
    s_add_u32 m0, s53, 67584
    s_nop 0
    buffer_load_dwordx4 v230, s[4:7], s49 offen lds
    s_waitcnt lgkmcnt(10)
    v_mfma_f32_16x16x32_bf16 v[64:67], v[128:131], v[172:175], v[64:67]
    v_mfma_f32_16x16x32_bf16 v[68:71], v[132:135], v[172:175], v[68:71]
    v_mfma_f32_16x16x32_bf16 v[72:75], v[136:139], v[172:175], v[72:75]
    v_mfma_f32_16x16x32_bf16 v[76:79], v[140:143], v[172:175], v[76:79]
    v_mfma_f32_16x16x32_bf16 v[220:223], v[136:139], v[136:139], v[220:223]
    v_mfma_f32_16x16x32_bf16 v[224:227], v[140:143], v[140:143], v[224:227]
    ds_read_b128 v[188:191], v240 offset:448
    ds_read_b64_tr_b16 v[196:197], v239 offset:27648
    ds_read_b64_tr_b16 v[198:199], v239 offset:32256
    ds_read_b64_tr_b16 v[164:165], v241 offset:15360
    ds_read_b64_tr_b16 v[166:167], v241 offset:17920
    s_add_u32 m0, s53, 68608
    s_nop 0
    buffer_load_dwordx4 v231, s[4:7], s49 offen lds
    s_add_u32 s49, s49, 128
    s_waitcnt lgkmcnt(13)
    v_mfma_f32_16x16x32_bf16 v[80:83], v[128:131], v[176:179], v[80:83]
    v_mfma_f32_16x16x32_bf16 v[84:87], v[132:135], v[176:179], v[84:87]
    v_mfma_f32_16x16x32_bf16 v[88:91], v[136:139], v[176:179], v[88:91]
    v_mfma_f32_16x16x32_bf16 v[92:95], v[140:143], v[176:179], v[92:95]
    ds_read_b64_tr_b16 v[168:169], v241 offset:15392
    ds_read_b64_tr_b16 v[170:171], v241 offset:17952
    s_add_u32 m0, s54, 9216
    s_nop 0
    buffer_load_dwordx4 v232, s[8:11], s50 offen lds
    s_add_u32 s50, s50, 294912
    s_waitcnt lgkmcnt(13)
    v_mfma_f32_16x16x32_bf16 v[96:99], v[128:131], v[180:183], v[96:99]
    v_mfma_f32_16x16x32_bf16 v[100:103], v[132:135], v[180:183], v[100:103]
    v_mfma_f32_16x16x32_bf16 v[104:107], v[136:139], v[180:183], v[104:107]
    v_mfma_f32_16x16x32_bf16 v[108:111], v[140:143], v[180:183], v[108:111]
    ds_read_b64_tr_b16 v[172:173], v241 offset:15424
    ds_read_b64_tr_b16 v[174:175], v241 offset:17984
    s_mov_b32 m0, s65
    s_nop 0
    buffer_load_dwordx4 v233, s[12:15], s51 offen lds
    s_add_u32 s51, s51, s52
    s_waitcnt vmcnt(6)
    s_barrier
    s_waitcnt lgkmcnt(9)
    v_mfma_f32_16x16x32_bf16 v[16:19], v[160:163], v[144:147], v[16:19]
    v_mfma_f32_16x16x32_bf16 v[20:23], v[160:163], v[148:151], v[20:23]
    v_mfma_f32_16x16x32_bf16 v[24:27], v[160:163], v[152:155], v[24:27]
    v_mfma_f32_16x16x32_bf16 v[28:31], v[160:163], v[156:159], v[28:31]
    ds_read_b64_tr_b16 v[176:177], v241 offset:15456
    ds_read_b64_tr_b16 v[178:179], v241 offset:18016
    s_add_u32 m0, s54, 18432
    s_nop 0
    buffer_load_dwordx4 v232, s[8:11], s50 offen lds
    s_add_u32 s50, s50, 294912
    s_waitcnt lgkmcnt(6)
    v_mfma_f32_16x16x32_bf16 v[32:35], v[144:147], v[164:167], v[32:35]
    v_mfma_f32_16x16x32_bf16 v[36:39], v[148:151], v[164:167], v[36:39]
    v_mfma_f32_16x16x32_bf16 v[40:43], v[152:155], v[164:167], v[40:43]
    v_mfma_f32_16x16x32_bf16 v[44:47], v[156:159], v[164:167], v[44:47]
    v_mfma_f32_16x16x32_bf16 v[200:203], v[188:191], v[152:155], v[200:203]
    v_mfma_f32_16x16x32_bf16 v[204:207], v[188:191], v[156:159], v[204:207]
    ds_read_b64_tr_b16 v[180:181], v241 offset:15488
    ds_read_b64_tr_b16 v[182:183], v241 offset:18048
    s_mov_b32 m0, s66
    s_nop 0
    buffer_load_dwordx4 v233, s[12:15], s51 offen lds
    s_add_u32 s51, s51, s52
    s_waitcnt lgkmcnt(6)
    v_mfma_f32_16x16x32_bf16 v[48:51], v[144:147], v[168:171], v[48:51]
    v_mfma_f32_16x16x32_bf16 v[52:55], v[148:151], v[168:171], v[52:55]
    v_mfma_f32_16x16x32_bf16 v[56:59], v[152:155], v[168:171], v[56:59]
    v_mfma_f32_16x16x32_bf16 v[60:63], v[156:159], v[168:171], v[60:63]
    v_mfma_f32_16x16x32_bf16 v[208:211], v[196:199], v[216:219], v[208:211]
    ds_read_b128 v[128:131], v234 offset:32768
    ds_read_b128 v[132:135], v234 offset:34816
    ds_read_b128 v[136:139], v234 offset:36864
    ds_read_b128 v[140:143], v234 offset:38912
    ds_read_b64_tr_b16 v[160:161], v238 offset:224
    ds_read_b64_tr_b16 v[162:163], v238 offset:4832
    s_waitcnt lgkmcnt(10)
    v_mfma_f32_16x16x32_bf16 v[64:67], v[144:147], v[172:175], v[64:67]
    v_mfma_f32_16x16x32_bf16 v[68:71], v[148:151], v[172:175], v[68:71]
    v_mfma_f32_16x16x32_bf16 v[72:75], v[152:155], v[172:175], v[72:75]
    v_mfma_f32_16x16x32_bf16 v[76:79], v[156:159], v[172:175], v[76:79]
    v_mfma_f32_16x16x32_bf16 v[220:223], v[152:155], v[152:155], v[220:223]
    v_mfma_f32_16x16x32_bf16 v[224:227], v[156:159], v[156:159], v[224:227]
    ds_read_b128 v[184:187], v240 offset:512
    ds_read_b64_tr_b16 v[192:193], v239 offset:0
    ds_read_b64_tr_b16 v[194:195], v239 offset:4608
    ds_read_b64_tr_b16 v[164:165], v241 offset:0
    ds_read_b64_tr_b16 v[166:167], v241 offset:2560
    s_waitcnt lgkmcnt(13)
    v_mfma_f32_16x16x32_bf16 v[80:83], v[144:147], v[176:179], v[80:83]
    v_mfma_f32_16x16x32_bf16 v[84:87], v[148:151], v[176:179], v[84:87]
    v_mfma_f32_16x16x32_bf16 v[88:91], v[152:155], v[176:179], v[88:91]
    v_mfma_f32_16x16x32_bf16 v[92:95], v[156:159], v[176:179], v[92:95]
    ds_read_b64_tr_b16 v[168:169], v241 offset:32
    ds_read_b64_tr_b16 v[170:171], v241 offset:2592
    s_waitcnt lgkmcnt(13)
    v_mfma_f32_16x16x32_bf16 v[96:99], v[144:147], v[180:183], v[96:99]
    v_mfma_f32_16x16x32_bf16 v[100:103], v[148:151], v[180:183], v[100:103]
    v_mfma_f32_16x16x32_bf16 v[104:107], v[152:155], v[180:183], v[104:107]
    v_mfma_f32_16x16x32_bf16 v[108:111], v[156:159], v[180:183], v[108:111]
    ds_read_b64_tr_b16 v[172:173], v241 offset:64
    ds_read_b64_tr_b16 v[174:175], v241 offset:2624
    s_waitcnt vmcnt(2)
    s_barrier
    s_waitcnt lgkmcnt(9)
    v_mfma_f32_16x16x32_bf16 v[16:19], v[160:163], v[128:131], v[16:19]
    v_mfma_f32_16x16x32_bf16 v[20:23], v[160:163], v[132:135], v[20:23]
    v_mfma_f32_16x16x32_bf16 v[24:27], v[160:163], v[136:139], v[24:27]
    v_mfma_f32_16x16x32_bf16 v[28:31], v[160:163], v[140:143], v[28:31]
    ds_read_b64_tr_b16 v[176:177], v241 offset:96
    ds_read_b64_tr_b16 v[178:179], v241 offset:2656
    s_add_u32 m0, s53, 0
    s_nop 0
    buffer_load_dwordx4 v228, s[4:7], s49 offen lds
    s_waitcnt lgkmcnt(6)
    v_mfma_f32_16x16x32_bf16 v[32:35], v[128:131], v[164:167], v[32:35]
    v_mfma_f32_16x16x32_bf16 v[36:39], v[132:135], v[164:167], v[36:39]
    v_mfma_f32_16x16x32_bf16 v[40:43], v[136:139], v[164:167], v[40:43]
    v_mfma_f32_16x16x32_bf16 v[44:47], v[140:143], v[164:167], v[44:47]
    v_mfma_f32_16x16x32_bf16 v[200:203], v[184:187], v[136:139], v[200:203]
    v_mfma_f32_16x16x32_bf16 v[204:207], v[184:187], v[140:143], v[204:207]
    ds_read_b64_tr_b16 v[180:181], v241 offset:128
    ds_read_b64_tr_b16 v[182:183], v241 offset:2688
    s_add_u32 m0, s53, 1024
    s_nop 0
    buffer_load_dwordx4 v229, s[4:7], s49 offen lds
    s_waitcnt lgkmcnt(6)
    v_mfma_f32_16x16x32_bf16 v[48:51], v[128:131], v[168:171], v[48:51]
    v_mfma_f32_16x16x32_bf16 v[52:55], v[132:135], v[168:171], v[52:55]
    v_mfma_f32_16x16x32_bf16 v[56:59], v[136:139], v[168:171], v[56:59]
    v_mfma_f32_16x16x32_bf16 v[60:63], v[140:143], v[168:171], v[60:63]
    v_mfma_f32_16x16x32_bf16 v[208:211], v[192:195], v[216:219], v[208:211]
    ds_read_b128 v[144:147], v236 offset:32768
    ds_read_b128 v[148:151], v236 offset:34816
    ds_read_b128 v[152:155], v236 offset:36864
    ds_read_b128 v[156:159], v236 offset:38912
    ds_read_b64_tr_b16 v[160:161], v238 offset:9440
    ds_read_b64_tr_b16 v[162:163], v238 offset:14048
    s_add_u32 m0, s53, 2048
    s_nop 0
    buffer_load_dwordx4 v230, s[4:7], s49 offen lds
    s_waitcnt lgkmcnt(10)
    v_mfma_f32_16x16x32_bf16 v[64:67], v[128:131], v[172:175], v[64:67]
    v_mfma_f32_16x16x32_bf16 v[68:71], v[132:135], v[172:175], v[68:71]
    v_mfma_f32_16x16x32_bf16 v[72:75], v[136:139], v[172:175], v[72:75]
    v_mfma_f32_16x16x32_bf16 v[76:79], v[140:143], v[172:175], v[76:79]
    v_mfma_f32_16x16x32_bf16 v[220:223], v[136:139], v[136:139], v[220:223]
    v_mfma_f32_16x16x32_bf16 v[224:227], v[140:143], v[140:143], v[224:227]
    ds_read_b128 v[188:191], v240 offset:576
    ds_read_b64_tr_b16 v[196:197], v239 offset:9216
    ds_read_b64_tr_b16 v[198:199], v239 offset:13824
    ds_read_b64_tr_b16 v[164:165], v241 offset:5120
    ds_read_b64_tr_b16 v[166:167], v241 offset:7680
    s_add_u32 m0, s53, 3072
    s_nop 0
    buffer_load_dwordx4 v231, s[4:7], s49 offen lds
    s_add_u32 s49, s49, 128
    s_waitcnt lgkmcnt(13)
    v_mfma_f32_16x16x32_bf16 v[80:83], v[128:131], v[176:179], v[80:83]
    v_mfma_f32_16x16x32_bf16 v[84:87], v[132:135], v[176:179], v[84:87]
    v_mfma_f32_16x16x32_bf16 v[88:91], v[136:139], v[176:179], v[88:91]
    v_mfma_f32_16x16x32_bf16 v[92:95], v[140:143], v[176:179], v[92:95]
    ds_read_b64_tr_b16 v[168:169], v241 offset:5152
    ds_read_b64_tr_b16 v[170:171], v241 offset:7712
    s_add_u32 m0, s54, 27648
    s_nop 0
    buffer_load_dwordx4 v232, s[8:11], s50 offen lds
    s_add_u32 s50, s50, 294912
    s_waitcnt lgkmcnt(13)
    v_mfma_f32_16x16x32_bf16 v[96:99], v[128:131], v[180:183], v[96:99]
    v_mfma_f32_16x16x32_bf16 v[100:103], v[132:135], v[180:183], v[100:103]
    v_mfma_f32_16x16x32_bf16 v[104:107], v[136:139], v[180:183], v[104:107]
    v_mfma_f32_16x16x32_bf16 v[108:111], v[140:143], v[180:183], v[108:111]
    ds_read_b64_tr_b16 v[172:173], v241 offset:5184
    ds_read_b64_tr_b16 v[174:175], v241 offset:7744
    s_mov_b32 m0, s67
    s_nop 0
    buffer_load_dwordx4 v233, s[12:15], s51 offen lds
    s_add_u32 s51, s51, s52
    s_waitcnt vmcnt(6)
    s_barrier
    s_waitcnt lgkmcnt(9)
    v_mfma_f32_16x16x32_bf16 v[16:19], v[160:163], v[144:147], v[16:19]
    v_mfma_f32_16x16x32_bf16 v[20:23], v[160:163], v[148:151], v[20:23]
    v_mfma_f32_16x16x32_bf16 v[24:27], v[160:163], v[152:155], v[24:27]
    v_mfma_f32_16x16x32_bf16 v[28:31], v[160:163], v[156:159], v[28:31]
    ds_read_b64_tr_b16 v[176:177], v241 offset:5216
    ds_read_b64_tr_b16 v[178:179], v241 offset:7776
    s_add_u32 m0, s54, 0
    s_nop 0
    buffer_load_dwordx4 v232, s[8:11], s50 offen lds
    s_add_u32 s50, s50, 294912
    s_waitcnt lgkmcnt(6)
    v_mfma_f32_16x16x32_bf16 v[32:35], v[144:147], v[164:167], v[32:35]
    v_mfma_f32_16x16x32_bf16 v[36:39], v[148:151], v[164:167], v[36:39]
    v_mfma_f32_16x16x32_bf16 v[40:43], v[152:155], v[164:167], v[40:43]
    v_mfma_f32_16x16x32_bf16 v[44:47], v[156:159], v[164:167], v[44:47]
    v_mfma_f32_16x16x32_bf16 v[200:203], v[188:191], v[152:155], v[200:203]
    v_mfma_f32_16x16x32_bf16 v[204:207], v[188:191], v[156:159], v[204:207]
    ds_read_b64_tr_b16 v[180:181], v241 offset:5248
    ds_read_b64_tr_b16 v[182:183], v241 offset:7808
    s_mov_b32 m0, s64
    s_nop 0
    buffer_load_dwordx4 v233, s[12:15], s51 offen lds
    s_add_u32 s51, s51, s52
    s_waitcnt lgkmcnt(6)
    v_mfma_f32_16x16x32_bf16 v[48:51], v[144:147], v[168:171], v[48:51]
    v_mfma_f32_16x16x32_bf16 v[52:55], v[148:151], v[168:171], v[52:55]
    v_mfma_f32_16x16x32_bf16 v[56:59], v[152:155], v[168:171], v[56:59]
    v_mfma_f32_16x16x32_bf16 v[60:63], v[156:159], v[168:171], v[60:63]
    v_mfma_f32_16x16x32_bf16 v[208:211], v[196:199], v[216:219], v[208:211]
    ds_read_b128 v[128:131], v235 offset:0
    ds_read_b128 v[132:135], v235 offset:2048
    ds_read_b128 v[136:139], v235 offset:4096
    ds_read_b128 v[140:143], v235 offset:6144
    ds_read_b64_tr_b16 v[160:161], v238 offset:18656
    ds_read_b64_tr_b16 v[162:163], v238 offset:23264
    s_waitcnt lgkmcnt(10)
    v_mfma_f32_16x16x32_bf16 v[64:67], v[144:147], v[172:175], v[64:67]
    v_mfma_f32_16x16x32_bf16 v[68:71], v[148:151], v[172:175], v[68:71]
    v_mfma_f32_16x16x32_bf16 v[72:75], v[152:155], v[172:175], v[72:75]
    v_mfma_f32_16x16x32_bf16 v[76:79], v[156:159], v[172:175], v[76:79]
    v_mfma_f32_16x16x32_bf16 v[220:223], v[152:155], v[152:155], v[220:223]
    v_mfma_f32_16x16x32_bf16 v[224:227], v[156:159], v[156:159], v[224:227]
    ds_read_b128 v[184:187], v240 offset:640
    ds_read_b64_tr_b16 v[192:193], v239 offset:18432
    ds_read_b64_tr_b16 v[194:195], v239 offset:23040
    ds_read_b64_tr_b16 v[164:165], v241 offset:10240
    ds_read_b64_tr_b16 v[166:167], v241 offset:12800
    s_waitcnt lgkmcnt(13)
    v_mfma_f32_16x16x32_bf16 v[80:83], v[144:147], v[176:179], v[80:83]
    v_mfma_f32_16x16x32_bf16 v[84:87], v[148:151], v[176:179], v[84:87]
    v_mfma_f32_16x16x32_bf16 v[88:91], v[152:155], v[176:179], v[88:91]
    v_mfma_f32_16x16x32_bf16 v[92:95], v[156:159], v[176:179], v[92:95]
    ds_read_b64_tr_b16 v[168:169], v241 offset:10272
    ds_read_b64_tr_b16 v[170:171], v241 offset:12832
    s_waitcnt lgkmcnt(13)
    v_mfma_f32_16x16x32_bf16 v[96:99], v[144:147], v[180:183], v[96:99]
    v_mfma_f32_16x16x32_bf16 v[100:103], v[148:151], v[180:183], v[100:103]
    v_mfma_f32_16x16x32_bf16 v[104:107], v[152:155], v[180:183], v[104:107]
    v_mfma_f32_16x16x32_bf16 v[108:111], v[156:159], v[180:183], v[108:111]
    ds_read_b64_tr_b16 v[172:173], v241 offset:10304
    ds_read_b64_tr_b16 v[174:175], v241 offset:12864
    s_waitcnt vmcnt(2)
    s_barrier
    s_waitcnt lgkmcnt(9)
    v_mfma_f32_16x16x32_bf16 v[16:19], v[160:163], v[128:131], v[16:19]
    v_mfma_f32_16x16x32_bf16 v[20:23], v[160:163], v[132:135], v[20:23]
    v_mfma_f32_16x16x32_bf16 v[24:27], v[160:163], v[136:139], v[24:27]
    v_mfma_f32_16x16x32_bf16 v[28:31], v[160:163], v[140:143], v[28:31]
    ds_read_b64_tr_b16 v[176:177], v241 offset:10336
    ds_read_b64_tr_b16 v[178:179], v241 offset:12896
    s_add_u32 m0, s53, 32768
    s_nop 0
    buffer_load_dwordx4 v228, s[4:7], s49 offen lds
    s_waitcnt lgkmcnt(6)
    v_mfma_f32_16x16x32_bf16 v[32:35], v[128:131], v[164:167], v[32:35]
    v_mfma_f32_16x16x32_bf16 v[36:39], v[132:135], v[164:167], v[36:39]
    v_mfma_f32_16x16x32_bf16 v[40:43], v[136:139], v[164:167], v[40:43]
    v_mfma_f32_16x16x32_bf16 v[44:47], v[140:143], v[164:167], v[44:47]
    v_mfma_f32_16x16x32_bf16 v[200:203], v[184:187], v[136:139], v[200:203]
    v_mfma_f32_16x16x32_bf16 v[204:207], v[184:187], v[140:143], v[204:207]
    ds_read_b64_tr_b16 v[180:181], v241 offset:10368
    ds_read_b64_tr_b16 v[182:183], v241 offset:12928
    s_add_u32 m0, s53, 33792
    s_nop 0
    buffer_load_dwordx4 v229, s[4:7], s49 offen lds
    s_waitcnt lgkmcnt(6)
    v_mfma_f32_16x16x32_bf16 v[48:51], v[128:131], v[168:171], v[48:51]
    v_mfma_f32_16x16x32_bf16 v[52:55], v[132:135], v[168:171], v[52:55]
    v_mfma_f32_16x16x32_bf16 v[56:59], v[136:139], v[168:171], v[56:59]
    v_mfma_f32_16x16x32_bf16 v[60:63], v[140:143], v[168:171], v[60:63]
    v_mfma_f32_16x16x32_bf16 v[208:211], v[192:195], v[216:219], v[208:211]
    ds_read_b128 v[144:147], v237 offset:0
    ds_read_b128 v[148:151], v237 offset:2048
    ds_read_b128 v[152:155], v237 offset:4096
    ds_read_b128 v[156:159], v237 offset:6144
    ds_read_b64_tr_b16 v[160:161], v238 offset:27872
    ds_read_b64_tr_b16 v[162:163], v238 offset:32480
    s_add_u32 m0, s53, 34816
    s_nop 0
    buffer_load_dwordx4 v230, s[4:7], s49 offen lds
    s_waitcnt lgkmcnt(10)
    v_mfma_f32_16x16x32_bf16 v[64:67], v[128:131], v[172:175], v[64:67]
    v_mfma_f32_16x16x32_bf16 v[68:71], v[132:135], v[172:175], v[68:71]
    v_mfma_f32_16x16x32_bf16 v[72:75], v[136:139], v[172:175], v[72:75]
    v_mfma_f32_16x16x32_bf16 v[76:79], v[140:143], v[172:175], v[76:79]
    v_mfma_f32_16x16x32_bf16 v[220:223], v[136:139], v[136:139], v[220:223]
    v_mfma_f32_16x16x32_bf16 v[224:227], v[140:143], v[140:143], v[224:227]
    ds_read_b128 v[188:191], v240 offset:704
    ds_read_b64_tr_b16 v[196:197], v239 offset:27648
    ds_read_b64_tr_b16 v[198:199], v239 offset:32256
    ds_read_b64_tr_b16 v[164:165], v241 offset:15360
    ds_read_b64_tr_b16 v[166:167], v241 offset:17920
    s_add_u32 m0, s53, 35840
    s_nop 0
    buffer_load_dwordx4 v231, s[4:7], s49 offen lds
    s_add_u32 s49, s49, 128
    s_waitcnt lgkmcnt(13)
    v_mfma_f32_16x16x32_bf16 v[80:83], v[128:131], v[176:179], v[80:83]
    v_mfma_f32_16x16x32_bf16 v[84:87], v[132:135], v[176:179], v[84:87]
    v_mfma_f32_16x16x32_bf16 v[88:91], v[136:139], v[176:179], v[88:91]
    v_mfma_f32_16x16x32_bf16 v[92:95], v[140:143], v[176:179], v[92:95]
    ds_read_b64_tr_b16 v[168:169], v241 offset:15392
    ds_read_b64_tr_b16 v[170:171], v241 offset:17952
    s_add_u32 m0, s54, 9216
    s_nop 0
    buffer_load_dwordx4 v232, s[8:11], s50 offen lds
    s_add_u32 s50, s50, 294912
    s_waitcnt lgkmcnt(13)
    v_mfma_f32_16x16x32_bf16 v[96:99], v[128:131], v[180:183], v[96:99]
    v_mfma_f32_16x16x32_bf16 v[100:103], v[132:135], v[180:183], v[100:103]
    v_mfma_f32_16x16x32_bf16 v[104:107], v[136:139], v[180:183], v[104:107]
    v_mfma_f32_16x16x32_bf16 v[108:111], v[140:143], v[180:183], v[108:111]
    ds_read_b64_tr_b16 v[172:173], v241 offset:15424
    ds_read_b64_tr_b16 v[174:175], v241 offset:17984
    s_mov_b32 m0, s65
    s_nop 0
    buffer_load_dwordx4 v233, s[12:15], s51 offen lds
    s_add_u32 s51, s51, s52
    s_waitcnt vmcnt(6)
    s_barrier
    s_waitcnt lgkmcnt(9)
    v_mfma_f32_16x16x32_bf16 v[16:19], v[160:163], v[144:147], v[16:19]
    v_mfma_f32_16x16x32_bf16 v[20:23], v[160:163], v[148:151], v[20:23]
    v_mfma_f32_16x16x32_bf16 v[24:27], v[160:163], v[152:155], v[24:27]
    v_mfma_f32_16x16x32_bf16 v[28:31], v[160:163], v[156:159], v[28:31]
    ds_read_b64_tr_b16 v[176:177], v241 offset:15456
    ds_read_b64_tr_b16 v[178:179], v241 offset:18016
    s_add_u32 m0, s54, 18432
    s_nop 0
    buffer_load_dwordx4 v232, s[8:11], s50 offen lds
    s_add_u32 s50, s50, 294912
    s_waitcnt lgkmcnt(6)
    v_mfma_f32_16x16x32_bf16 v[32:35], v[144:147], v[164:167], v[32:35]
    v_mfma_f32_16x16x32_bf16 v[36:39], v[148:151], v[164:167], v[36:39]
    v_mfma_f32_16x16x32_bf16 v[40:43], v[152:155], v[164:167], v[40:43]
    v_mfma_f32_16x16x32_bf16 v[44:47], v[156:159], v[164:167], v[44:47]
    v_mfma_f32_16x16x32_bf16 v[200:203], v[188:191], v[152:155], v[200:203]
    v_mfma_f32_16x16x32_bf16 v[204:207], v[188:191], v[156:159], v[204:207]
    ds_read_b64_tr_b16 v[180:181], v241 offset:15488
    ds_read_b64_tr_b16 v[182:183], v241 offset:18048
    s_mov_b32 m0, s66
    s_nop 0
    buffer_load_dwordx4 v233, s[12:15], s51 offen lds
    s_add_u32 s51, s51, s52
    s_waitcnt lgkmcnt(6)
    v_mfma_f32_16x16x32_bf16 v[48:51], v[144:147], v[168:171], v[48:51]
    v_mfma_f32_16x16x32_bf16 v[52:55], v[148:151], v[168:171], v[52:55]
    v_mfma_f32_16x16x32_bf16 v[56:59], v[152:155], v[168:171], v[56:59]
    v_mfma_f32_16x16x32_bf16 v[60:63], v[156:159], v[168:171], v[60:63]
    v_mfma_f32_16x16x32_bf16 v[208:211], v[196:199], v[216:219], v[208:211]
    ds_read_b128 v[128:131], v234 offset:0
    ds_read_b128 v[132:135], v234 offset:2048
    ds_read_b128 v[136:139], v234 offset:4096
    ds_read_b128 v[140:143], v234 offset:6144
    ds_read_b64_tr_b16 v[160:161], v238 offset:224
    ds_read_b64_tr_b16 v[162:163], v238 offset:4832
    s_waitcnt lgkmcnt(10)
    v_mfma_f32_16x16x32_bf16 v[64:67], v[144:147], v[172:175], v[64:67]
    v_mfma_f32_16x16x32_bf16 v[68:71], v[148:151], v[172:175], v[68:71]
    v_mfma_f32_16x16x32_bf16 v[72:75], v[152:155], v[172:175], v[72:75]
    v_mfma_f32_16x16x32_bf16 v[76:79], v[156:159], v[172:175], v[76:79]
    v_mfma_f32_16x16x32_bf16 v[220:223], v[152:155], v[152:155], v[220:223]
    v_mfma_f32_16x16x32_bf16 v[224:227], v[156:159], v[156:159], v[224:227]
    ds_read_b128 v[184:187], v240 offset:768
    ds_read_b64_tr_b16 v[192:193], v239 offset:0
    ds_read_b64_tr_b16 v[194:195], v239 offset:4608
    ds_read_b64_tr_b16 v[164:165], v241 offset:0
    ds_read_b64_tr_b16 v[166:167], v241 offset:2560
    s_waitcnt lgkmcnt(13)
    v_mfma_f32_16x16x32_bf16 v[80:83], v[144:147], v[176:179], v[80:83]
    v_mfma_f32_16x16x32_bf16 v[84:87], v[148:151], v[176:179], v[84:87]
    v_mfma_f32_16x16x32_bf16 v[88:91], v[152:155], v[176:179], v[88:91]
    v_mfma_f32_16x16x32_bf16 v[92:95], v[156:159], v[176:179], v[92:95]
    ds_read_b64_tr_b16 v[168:169], v241 offset:32
    ds_read_b64_tr_b16 v[170:171], v241 offset:2592
    s_waitcnt lgkmcnt(13)
    v_mfma_f32_16x16x32_bf16 v[96:99], v[144:147], v[180:183], v[96:99]
    v_mfma_f32_16x16x32_bf16 v[100:103], v[148:151], v[180:183], v[100:103]
    v_mfma_f32_16x16x32_bf16 v[104:107], v[152:155], v[180:183], v[104:107]
    v_mfma_f32_16x16x32_bf16 v[108:111], v[156:159], v[180:183], v[108:111]
    ds_read_b64_tr_b16 v[172:173], v241 offset:64
    ds_read_b64_tr_b16 v[174:175], v241 offset:2624
    s_waitcnt vmcnt(2)
    s_barrier
    s_waitcnt lgkmcnt(9)
    v_mfma_f32_16x16x32_bf16 v[16:19], v[160:163], v[128:131], v[16:19]
    v_mfma_f32_16x16x32_bf16 v[20:23], v[160:163], v[132:135], v[20:23]
    v_mfma_f32_16x16x32_bf16 v[24:27], v[160:163], v[136:139], v[24:27]
    v_mfma_f32_16x16x32_bf16 v[28:31], v[160:163], v[140:143], v[28:31]
    ds_read_b64_tr_b16 v[176:177], v241 offset:96
    ds_read_b64_tr_b16 v[178:179], v241 offset:2656
    s_add_u32 m0, s53, 65536
    s_nop 0
    buffer_load_dwordx4 v228, s[4:7], s49 offen lds
    s_waitcnt lgkmcnt(6)
    v_mfma_f32_16x16x32_bf16 v[32:35], v[128:131], v[164:167], v[32:35]
    v_mfma_f32_16x16x32_bf16 v[36:39], v[132:135], v[164:167], v[36:39]
    v_mfma_f32_16x16x32_bf16 v[40:43], v[136:139], v[164:167], v[40:43]
    v_mfma_f32_16x16x32_bf16 v[44:47], v[140:143], v[164:167], v[44:47]
    v_mfma_f32_16x16x32_bf16 v[200:203], v[184:187], v[136:139], v[200:203]
    v_mfma_f32_16x16x32_bf16 v[204:207], v[184:187], v[140:143], v[204:207]
    ds_read_b64_tr_b16 v[180:181], v241 offset:128
    ds_read_b64_tr_b16 v[182:183], v241 offset:2688
    s_add_u32 m0, s53, 66560
    s_nop 0
    buffer_load_dwordx4 v229, s[4:7], s49 offen lds
    s_waitcnt lgkmcnt(6)
    v_mfma_f32_16x16x32_bf16 v[48:51], v[128:131], v[168:171], v[48:51]
    v_mfma_f32_16x16x32_bf16 v[52:55], v[132:135], v[168:171], v[52:55]
    v_mfma_f32_16x16x32_bf16 v[56:59], v[136:139], v[168:171], v[56:59]
    v_mfma_f32_16x16x32_bf16 v[60:63], v[140:143], v[168:171], v[60:63]
    v_mfma_f32_16x16x32_bf16 v[208:211], v[192:195], v[216:219], v[208:211]
    ds_read_b128 v[144:147], v236 offset:0
    ds_read_b128 v[148:151], v236 offset:2048
    ds_read_b128 v[152:155], v236 offset:4096
    ds_read_b128 v[156:159], v236 offset:6144
    ds_read_b64_tr_b16 v[160:161], v238 offset:9440
    ds_read_b64_tr_b16 v[162:163], v238 offset:14048
    s_add_u32 m0, s53, 67584
    s_nop 0
    buffer_load_dwordx4 v230, s[4:7], s49 offen lds
    s_waitcnt lgkmcnt(10)
    v_mfma_f32_16x16x32_bf16 v[64:67], v[128:131], v[172:175], v[64:67]
    v_mfma_f32_16x16x32_bf16 v[68:71], v[132:135], v[172:175], v[68:71]
    v_mfma_f32_16x16x32_bf16 v[72:75], v[136:139], v[172:175], v[72:75]
    v_mfma_f32_16x16x32_bf16 v[76:79], v[140:143], v[172:175], v[76:79]
    v_mfma_f32_16x16x32_bf16 v[220:223], v[136:139], v[136:139], v[220:223]
    v_mfma_f32_16x16x32_bf16 v[224:227], v[140:143], v[140:143], v[224:227]
    ds_read_b128 v[188:191], v240 offset:832
    ds_read_b64_tr_b16 v[196:197], v239 offset:9216
    ds_read_b64_tr_b16 v[198:199], v239 offset:13824
    ds_read_b64_tr_b16 v[164:165], v241 offset:5120
    ds_read_b64_tr_b16 v[166:167], v241 offset:7680
    s_add_u32 m0, s53, 68608
    s_nop 0
    buffer_load_dwordx4 v231, s[4:7], s49 offen lds
    s_add_u32 s49, s49, 128
    s_waitcnt lgkmcnt(13)
    v_mfma_f32_16x16x32_bf16 v[80:83], v[128:131], v[176:179], v[80:83]
    v_mfma_f32_16x16x32_bf16 v[84:87], v[132:135], v[176:179], v[84:87]
    v_mfma_f32_16x16x32_bf16 v[88:91], v[136:139], v[176:179], v[88:91]
    v_mfma_f32_16x16x32_bf16 v[92:95], v[140:143], v[176:179], v[92:95]
    ds_read_b64_tr_b16 v[168:169], v241 offset:5152
    ds_read_b64_tr_b16 v[170:171], v241 offset:7712
    s_add_u32 m0, s54, 27648
    s_nop 0
    buffer_load_dwordx4 v232, s[8:11], s50 offen lds
    s_add_u32 s50, s50, 294912
    s_waitcnt lgkmcnt(13)
    v_mfma_f32_16x16x32_bf16 v[96:99], v[128:131], v[180:183], v[96:99]
    v_mfma_f32_16x16x32_bf16 v[100:103], v[132:135], v[180:183], v[100:103]
    v_mfma_f32_16x16x32_bf16 v[104:107], v[136:139], v[180:183], v[104:107]
    v_mfma_f32_16x16x32_bf16 v[108:111], v[140:143], v[180:183], v[108:111]
    ds_read_b64_tr_b16 v[172:173], v241 offset:5184
    ds_read_b64_tr_b16 v[174:175], v241 offset:7744
    s_mov_b32 m0, s67
    s_nop 0
    buffer_load_dwordx4 v233, s[12:15], s51 offen lds
    s_add_u32 s51, s51, s52
    s_waitcnt vmcnt(6)
    s_barrier
    s_waitcnt lgkmcnt(9)
    v_mfma_f32_16x16x32_bf16 v[16:19], v[160:163], v[144:147], v[16:19]
    v_mfma_f32_16x16x32_bf16 v[20:23], v[160:163], v[148:151], v[20:23]
    v_mfma_f32_16x16x32_bf16 v[24:27], v[160:163], v[152:155], v[24:27]
    v_mfma_f32_16x16x32_bf16 v[28:31], v[160:163], v[156:159], v[28:31]
    ds_read_b64_tr_b16 v[176:177], v241 offset:5216
    ds_read_b64_tr_b16 v[178:179], v241 offset:7776
    s_add_u32 m0, s54, 0
    s_nop 0
    buffer_load_dwordx4 v232, s[8:11], s50 offen lds
    s_add_u32 s50, s50, 294912
    s_waitcnt lgkmcnt(6)
    v_mfma_f32_16x16x32_bf16 v[32:35], v[144:147], v[164:167], v[32:35]
    v_mfma_f32_16x16x32_bf16 v[36:39], v[148:151], v[164:167], v[36:39]
    v_mfma_f32_16x16x32_bf16 v[40:43], v[152:155], v[164:167], v[40:43]
    v_mfma_f32_16x16x32_bf16 v[44:47], v[156:159], v[164:167], v[44:47]
    v_mfma_f32_16x16x32_bf16 v[200:203], v[188:191], v[152:155], v[200:203]
    v_mfma_f32_16x16x32_bf16 v[204:207], v[188:191], v[156:159], v[204:207]
    ds_read_b64_tr_b16 v[180:181], v241 offset:5248
    ds_read_b64_tr_b16 v[182:183], v241 offset:7808
    s_mov_b32 m0, s64
    s_nop 0
    buffer_load_dwordx4 v233, s[12:15], s51 offen lds
    s_add_u32 s51, s51, s52
    s_waitcnt lgkmcnt(6)
    v_mfma_f32_16x16x32_bf16 v[48:51], v[144:147], v[168:171], v[48:51]
    v_mfma_f32_16x16x32_bf16 v[52:55], v[148:151], v[168:171], v[52:55]
    v_mfma_f32_16x16x32_bf16 v[56:59], v[152:155], v[168:171], v[56:59]
    v_mfma_f32_16x16x32_bf16 v[60:63], v[156:159], v[168:171], v[60:63]
    v_mfma_f32_16x16x32_bf16 v[208:211], v[196:199], v[216:219], v[208:211]
    ds_read_b128 v[128:131], v234 offset:32768
    ds_read_b128 v[132:135], v234 offset:34816
    ds_read_b128 v[136:139], v234 offset:36864
    ds_read_b128 v[140:143], v234 offset:38912
    ds_read_b64_tr_b16 v[160:161], v238 offset:18656
    ds_read_b64_tr_b16 v[162:163], v238 offset:23264
    s_waitcnt lgkmcnt(10)
    v_mfma_f32_16x16x32_bf16 v[64:67], v[144:147], v[172:175], v[64:67]
    v_mfma_f32_16x16x32_bf16 v[68:71], v[148:151], v[172:175], v[68:71]
    v_mfma_f32_16x16x32_bf16 v[72:75], v[152:155], v[172:175], v[72:75]
    v_mfma_f32_16x16x32_bf16 v[76:79], v[156:159], v[172:175], v[76:79]
    v_mfma_f32_16x16x32_bf16 v[220:223], v[152:155], v[152:155], v[220:223]
    v_mfma_f32_16x16x32_bf16 v[224:227], v[156:159], v[156:159], v[224:227]
    ds_read_b128 v[184:187], v240 offset:896
    ds_read_b64_tr_b16 v[192:193], v239 offset:18432
    ds_read_b64_tr_b16 v[194:195], v239 offset:23040
    ds_read_b64_tr_b16 v[164:165], v241 offset:10240
    ds_read_b64_tr_b16 v[166:167], v241 offset:12800
    s_waitcnt lgkmcnt(13)
    v_mfma_f32_16x16x32_bf16 v[80:83], v[144:147], v[176:179], v[80:83]
    v_mfma_f32_16x16x32_bf16 v[84:87], v[148:151], v[176:179], v[84:87]
    v_mfma_f32_16x16x32_bf16 v[88:91], v[152:155], v[176:179], v[88:91]
    v_mfma_f32_16x16x32_bf16 v[92:95], v[156:159], v[176:179], v[92:95]
    ds_read_b64_tr_b16 v[168:169], v241 offset:10272
    ds_read_b64_tr_b16 v[170:171], v241 offset:12832
    s_waitcnt lgkmcnt(13)
    v_mfma_f32_16x16x32_bf16 v[96:99], v[144:147], v[180:183], v[96:99]
    v_mfma_f32_16x16x32_bf16 v[100:103], v[148:151], v[180:183], v[100:103]
    v_mfma_f32_16x16x32_bf16 v[104:107], v[152:155], v[180:183], v[104:107]
    v_mfma_f32_16x16x32_bf16 v[108:111], v[156:159], v[180:183], v[108:111]
    ds_read_b64_tr_b16 v[172:173], v241 offset:10304
    ds_read_b64_tr_b16 v[174:175], v241 offset:12864
    s_waitcnt vmcnt(2)
    s_barrier
    s_waitcnt lgkmcnt(9)
    v_mfma_f32_16x16x32_bf16 v[16:19], v[160:163], v[128:131], v[16:19]
    v_mfma_f32_16x16x32_bf16 v[20:23], v[160:163], v[132:135], v[20:23]
    v_mfma_f32_16x16x32_bf16 v[24:27], v[160:163], v[136:139], v[24:27]
    v_mfma_f32_16x16x32_bf16 v[28:31], v[160:163], v[140:143], v[28:31]
    ds_read_b64_tr_b16 v[176:177], v241 offset:10336
    ds_read_b64_tr_b16 v[178:179], v241 offset:12896
    s_add_u32 m0, s54, 9216
    s_nop 0
    buffer_load_dwordx4 v232, s[8:11], s50 offen lds
    s_add_u32 s50, s50, 294912
    s_waitcnt lgkmcnt(6)
    v_mfma_f32_16x16x32_bf16 v[32:35], v[128:131], v[164:167], v[32:35]
    v_mfma_f32_16x16x32_bf16 v[36:39], v[132:135], v[164:167], v[36:39]
    v_mfma_f32_16x16x32_bf16 v[40:43], v[136:139], v[164:167], v[40:43]
    v_mfma_f32_16x16x32_bf16 v[44:47], v[140:143], v[164:167], v[44:47]
    v_mfma_f32_16x16x32_bf16 v[200:203], v[184:187], v[136:139], v[200:203]
    v_mfma_f32_16x16x32_bf16 v[204:207], v[184:187], v[140:143], v[204:207]
    ds_read_b64_tr_b16 v[180:181], v241 offset:10368
    ds_read_b64_tr_b16 v[182:183], v241 offset:12928
    s_mov_b32 m0, s65
    s_nop 0
    buffer_load_dwordx4 v233, s[12:15], s51 offen lds
    s_add_u32 s51, s51, s52
    s_waitcnt lgkmcnt(6)
    v_mfma_f32_16x16x32_bf16 v[48:51], v[128:131], v[168:171], v[48:51]
    v_mfma_f32_16x16x32_bf16 v[52:55], v[132:135], v[168:171], v[52:55]
    v_mfma_f32_16x16x32_bf16 v[56:59], v[136:139], v[168:171], v[56:59]
    v_mfma_f32_16x16x32_bf16 v[60:63], v[140:143], v[168:171], v[60:63]
    v_mfma_f32_16x16x32_bf16 v[208:211], v[192:195], v[216:219], v[208:211]
    ds_read_b128 v[144:147], v236 offset:32768
    ds_read_b128 v[148:151], v236 offset:34816
    ds_read_b128 v[152:155], v236 offset:36864
    ds_read_b128 v[156:159], v236 offset:38912
    ds_read_b64_tr_b16 v[160:161], v238 offset:27872
    ds_read_b64_tr_b16 v[162:163], v238 offset:32480
    s_waitcnt lgkmcnt(10)
    v_mfma_f32_16x16x32_bf16 v[64:67], v[128:131], v[172:175], v[64:67]
    v_mfma_f32_16x16x32_bf16 v[68:71], v[132:135], v[172:175], v[68:71]
    v_mfma_f32_16x16x32_bf16 v[72:75], v[136:139], v[172:175], v[72:75]
    v_mfma_f32_16x16x32_bf16 v[76:79], v[140:143], v[172:175], v[76:79]
    v_mfma_f32_16x16x32_bf16 v[220:223], v[136:139], v[136:139], v[220:223]
    v_mfma_f32_16x16x32_bf16 v[224:227], v[140:143], v[140:143], v[224:227]
    ds_read_b128 v[188:191], v240 offset:960
    ds_read_b64_tr_b16 v[196:197], v239 offset:27648
    ds_read_b64_tr_b16 v[198:199], v239 offset:32256
    ds_read_b64_tr_b16 v[164:165], v241 offset:15360
    ds_read_b64_tr_b16 v[166:167], v241 offset:17920
    s_waitcnt lgkmcnt(13)
    v_mfma_f32_16x16x32_bf16 v[80:83], v[128:131], v[176:179], v[80:83]
    v_mfma_f32_16x16x32_bf16 v[84:87], v[132:135], v[176:179], v[84:87]
    v_mfma_f32_16x16x32_bf16 v[88:91], v[136:139], v[176:179], v[88:91]
    v_mfma_f32_16x16x32_bf16 v[92:95], v[140:143], v[176:179], v[92:95]
    ds_read_b64_tr_b16 v[168:169], v241 offset:15392
    ds_read_b64_tr_b16 v[170:171], v241 offset:17952
    s_waitcnt lgkmcnt(13)
    v_mfma_f32_16x16x32_bf16 v[96:99], v[128:131], v[180:183], v[96:99]
    v_mfma_f32_16x16x32_bf16 v[100:103], v[132:135], v[180:183], v[100:103]
    v_mfma_f32_16x16x32_bf16 v[104:107], v[136:139], v[180:183], v[104:107]
    v_mfma_f32_16x16x32_bf16 v[108:111], v[140:143], v[180:183], v[108:111]
    ds_read_b64_tr_b16 v[172:173], v241 offset:15424
    ds_read_b64_tr_b16 v[174:175], v241 offset:17984
    s_waitcnt vmcnt(2)
    s_barrier
    s_waitcnt lgkmcnt(9)
    v_mfma_f32_16x16x32_bf16 v[16:19], v[160:163], v[144:147], v[16:19]
    v_mfma_f32_16x16x32_bf16 v[20:23], v[160:163], v[148:151], v[20:23]
    v_mfma_f32_16x16x32_bf16 v[24:27], v[160:163], v[152:155], v[24:27]
    v_mfma_f32_16x16x32_bf16 v[28:31], v[160:163], v[156:159], v[28:31]
    ds_read_b64_tr_b16 v[176:177], v241 offset:15456
    ds_read_b64_tr_b16 v[178:179], v241 offset:18016
    s_waitcnt lgkmcnt(6)
    v_mfma_f32_16x16x32_bf16 v[32:35], v[144:147], v[164:167], v[32:35]
    v_mfma_f32_16x16x32_bf16 v[36:39], v[148:151], v[164:167], v[36:39]
    v_mfma_f32_16x16x32_bf16 v[40:43], v[152:155], v[164:167], v[40:43]
    v_mfma_f32_16x16x32_bf16 v[44:47], v[156:159], v[164:167], v[44:47]
    v_mfma_f32_16x16x32_bf16 v[200:203], v[188:191], v[152:155], v[200:203]
    v_mfma_f32_16x16x32_bf16 v[204:207], v[188:191], v[156:159], v[204:207]
    ds_read_b64_tr_b16 v[180:181], v241 offset:15488
    ds_read_b64_tr_b16 v[182:183], v241 offset:18048
    s_waitcnt lgkmcnt(6)
    v_mfma_f32_16x16x32_bf16 v[48:51], v[144:147], v[168:171], v[48:51]
    v_mfma_f32_16x16x32_bf16 v[52:55], v[148:151], v[168:171], v[52:55]
    v_mfma_f32_16x16x32_bf16 v[56:59], v[152:155], v[168:171], v[56:59]
    v_mfma_f32_16x16x32_bf16 v[60:63], v[156:159], v[168:171], v[60:63]
    v_mfma_f32_16x16x32_bf16 v[208:211], v[196:199], v[216:219], v[208:211]
    ds_read_b128 v[128:131], v235 offset:0
    ds_read_b128 v[132:135], v235 offset:2048
    ds_read_b128 v[136:139], v235 offset:4096
    ds_read_b128 v[140:143], v235 offset:6144
    ds_read_b64_tr_b16 v[160:161], v238 offset:224
    ds_read_b64_tr_b16 v[162:163], v238 offset:4832
    s_waitcnt lgkmcnt(10)
    v_mfma_f32_16x16x32_bf16 v[64:67], v[144:147], v[172:175], v[64:67]
    v_mfma_f32_16x16x32_bf16 v[68:71], v[148:151], v[172:175], v[68:71]
    v_mfma_f32_16x16x32_bf16 v[72:75], v[152:155], v[172:175], v[72:75]
    v_mfma_f32_16x16x32_bf16 v[76:79], v[156:159], v[172:175], v[76:79]
    v_mfma_f32_16x16x32_bf16 v[220:223], v[152:155], v[152:155], v[220:223]
    v_mfma_f32_16x16x32_bf16 v[224:227], v[156:159], v[156:159], v[224:227]
    ds_read_b128 v[184:187], v240 offset:1024
    ds_read_b64_tr_b16 v[192:193], v239 offset:0
    ds_read_b64_tr_b16 v[194:195], v239 offset:4608
    ds_read_b64_tr_b16 v[164:165], v241 offset:0
    ds_read_b64_tr_b16 v[166:167], v241 offset:2560
    s_waitcnt lgkmcnt(13)
    v_mfma_f32_16x16x32_bf16 v[80:83], v[144:147], v[176:179], v[80:83]
    v_mfma_f32_16x16x32_bf16 v[84:87], v[148:151], v[176:179], v[84:87]
    v_mfma_f32_16x16x32_bf16 v[88:91], v[152:155], v[176:179], v[88:91]
    v_mfma_f32_16x16x32_bf16 v[92:95], v[156:159], v[176:179], v[92:95]
    ds_read_b64_tr_b16 v[168:169], v241 offset:32
    ds_read_b64_tr_b16 v[170:171], v241 offset:2592
    s_waitcnt lgkmcnt(13)
    v_mfma_f32_16x16x32_bf16 v[96:99], v[144:147], v[180:183], v[96:99]
    v_mfma_f32_16x16x32_bf16 v[100:103], v[148:151], v[180:183], v[100:103]
    v_mfma_f32_16x16x32_bf16 v[104:107], v[152:155], v[180:183], v[104:107]
    v_mfma_f32_16x16x32_bf16 v[108:111], v[156:159], v[180:183], v[108:111]
    ds_read_b64_tr_b16 v[172:173], v241 offset:64
    ds_read_b64_tr_b16 v[174:175], v241 offset:2624
    s_waitcnt vmcnt(0)
    s_barrier
    s_lshl_b32 s55, s2, 3
    s_add_u32 s55, s55, s44
    s_mul_i32 s56, s55, 21
    v_add_u32 v3, s56, v1
    v_lshlrev_b32 v3, 7, v3
    s_mul_i32 s56, s55, 3
    v_add_u32 v4, s56, v1
    v_lshlrev_b32 v4, 7, v4
    s_mov_b64 exec, 0x1fffff
    buffer_load_dword v228, v3, s[96:99], 0 offen
    s_mov_b64 exec, 7
    buffer_load_dword v229, v4, s[92:95], 0 offen
    s_mov_b64 exec, -1
    s_waitcnt lgkmcnt(9)
    v_mfma_f32_16x16x32_bf16 v[16:19], v[160:163], v[128:131], v[16:19]
    v_mfma_f32_16x16x32_bf16 v[20:23], v[160:163], v[132:135], v[20:23]
    v_mfma_f32_16x16x32_bf16 v[24:27], v[160:163], v[136:139], v[24:27]
    v_mfma_f32_16x16x32_bf16 v[28:31], v[160:163], v[140:143], v[28:31]
    ds_read_b64_tr_b16 v[176:177], v241 offset:96
    ds_read_b64_tr_b16 v[178:179], v241 offset:2656
    s_waitcnt lgkmcnt(6)
    v_mfma_f32_16x16x32_bf16 v[32:35], v[128:131], v[164:167], v[32:35]
    v_mfma_f32_16x16x32_bf16 v[36:39], v[132:135], v[164:167], v[36:39]
    v_mfma_f32_16x16x32_bf16 v[40:43], v[136:139], v[164:167], v[40:43]
    v_mfma_f32_16x16x32_bf16 v[44:47], v[140:143], v[164:167], v[44:47]
    v_mfma_f32_16x16x32_bf16 v[200:203], v[184:187], v[136:139], v[200:203]
    v_mfma_f32_16x16x32_bf16 v[204:207], v[184:187], v[140:143], v[204:207]
    ds_read_b64_tr_b16 v[180:181], v241 offset:128
    ds_read_b64_tr_b16 v[182:183], v241 offset:2688
    s_waitcnt lgkmcnt(6)
    v_mfma_f32_16x16x32_bf16 v[48:51], v[128:131], v[168:171], v[48:51]
    v_mfma_f32_16x16x32_bf16 v[52:55], v[132:135], v[168:171], v[52:55]
    v_mfma_f32_16x16x32_bf16 v[56:59], v[136:139], v[168:171], v[56:59]
    v_mfma_f32_16x16x32_bf16 v[60:63], v[140:143], v[168:171], v[60:63]
    v_mfma_f32_16x16x32_bf16 v[208:211], v[192:195], v[216:219], v[208:211]
    ds_read_b128 v[144:147], v237 offset:0
    ds_read_b128 v[148:151], v237 offset:2048
    ds_read_b128 v[152:155], v237 offset:4096
    ds_read_b128 v[156:159], v237 offset:6144
    ds_read_b64_tr_b16 v[160:161], v238 offset:9440
    ds_read_b64_tr_b16 v[162:163], v238 offset:14048
    s_waitcnt lgkmcnt(10)
    v_mfma_f32_16x16x32_bf16 v[64:67], v[128:131], v[172:175], v[64:67]
    v_mfma_f32_16x16x32_bf16 v[68:71], v[132:135], v[172:175], v[68:71]
    v_mfma_f32_16x16x32_bf16 v[72:75], v[136:139], v[172:175], v[72:75]
    v_mfma_f32_16x16x32_bf16 v[76:79], v[140:143], v[172:175], v[76:79]
    v_mfma_f32_16x16x32_bf16 v[220:223], v[136:139], v[136:139], v[220:223]
    v_mfma_f32_16x16x32_bf16 v[224:227], v[140:143], v[140:143], v[224:227]
    ds_read_b128 v[188:191], v240 offset:1088
    ds_read_b64_tr_b16 v[196:197], v239 offset:9216
    ds_read_b64_tr_b16 v[198:199], v239 offset:13824
    ds_read_b64_tr_b16 v[164:165], v241 offset:5120
    ds_read_b64_tr_b16 v[166:167], v241 offset:7680
    s_waitcnt lgkmcnt(13)
    v_mfma_f32_16x16x32_bf16 v[80:83], v[128:131], v[176:179], v[80:83]
    v_mfma_f32_16x16x32_bf16 v[84:87], v[132:135], v[176:179], v[84:87]
    v_mfma_f32_16x16x32_bf16 v[88:91], v[136:139], v[176:179], v[88:91]
    v_mfma_f32_16x16x32_bf16 v[92:95], v[140:143], v[176:179], v[92:95]
    ds_read_b64_tr_b16 v[168:169], v241 offset:5152
    ds_read_b64_tr_b16 v[170:171], v241 offset:7712
    s_waitcnt lgkmcnt(13)
    v_mfma_f32_16x16x32_bf16 v[96:99], v[128:131], v[180:183], v[96:99]
    v_mfma_f32_16x16x32_bf16 v[100:103], v[132:135], v[180:183], v[100:103]
    v_mfma_f32_16x16x32_bf16 v[104:107], v[136:139], v[180:183], v[104:107]
    v_mfma_f32_16x16x32_bf16 v[108:111], v[140:143], v[180:183], v[108:111]
    ds_read_b64_tr_b16 v[172:173], v241 offset:5184
    ds_read_b64_tr_b16 v[174:175], v241 offset:7744
    s_waitcnt vmcnt(2)
    s_barrier
    s_waitcnt lgkmcnt(9)
    v_mfma_f32_16x16x32_bf16 v[16:19], v[160:163], v[144:147], v[16:19]
    v_mfma_f32_16x16x32_bf16 v[20:23], v[160:163], v[148:151], v[20:23]
    v_mfma_f32_16x16x32_bf16 v[24:27], v[160:163], v[152:155], v[24:27]
    v_mfma_f32_16x16x32_bf16 v[28:31], v[160:163], v[156:159], v[28:31]
    ds_read_b64_tr_b16 v[176:177], v241 offset:5216
    ds_read_b64_tr_b16 v[178:179], v241 offset:7776
    s_waitcnt lgkmcnt(6)
    v_mfma_f32_16x16x32_bf16 v[32:35], v[144:147], v[164:167], v[32:35]
    v_mfma_f32_16x16x32_bf16 v[36:39], v[148:151], v[164:167], v[36:39]
    v_mfma_f32_16x16x32_bf16 v[40:43], v[152:155], v[164:167], v[40:43]
    v_mfma_f32_16x16x32_bf16 v[44:47], v[156:159], v[164:167], v[44:47]
    v_mfma_f32_16x16x32_bf16 v[200:203], v[188:191], v[152:155], v[200:203]
    v_mfma_f32_16x16x32_bf16 v[204:207], v[188:191], v[156:159], v[204:207]
    ds_read_b64_tr_b16 v[180:181], v241 offset:5248
    ds_read_b64_tr_b16 v[182:183], v241 offset:7808
    s_waitcnt lgkmcnt(6)
    v_mfma_f32_16x16x32_bf16 v[48:51], v[144:147], v[168:171], v[48:51]
    v_mfma_f32_16x16x32_bf16 v[52:55], v[148:151], v[168:171], v[52:55]
    v_mfma_f32_16x16x32_bf16 v[56:59], v[152:155], v[168:171], v[56:59]
    v_mfma_f32_16x16x32_bf16 v[60:63], v[156:159], v[168:171], v[60:63]
    v_mfma_f32_16x16x32_bf16 v[208:211], v[196:199], v[216:219], v[208:211]
    s_waitcnt lgkmcnt(4)
    v_mfma_f32_16x16x32_bf16 v[64:67], v[144:147], v[172:175], v[64:67]
    v_mfma_f32_16x16x32_bf16 v[68:71], v[148:151], v[172:175], v[68:71]
    v_mfma_f32_16x16x32_bf16 v[72:75], v[152:155], v[172:175], v[72:75]
    v_mfma_f32_16x16x32_bf16 v[76:79], v[156:159], v[172:175], v[76:79]
    v_mfma_f32_16x16x32_bf16 v[220:223], v[152:155], v[152:155], v[220:223]
    v_mfma_f32_16x16x32_bf16 v[224:227], v[156:159], v[156:159], v[224:227]
    s_waitcnt lgkmcnt(2)
    v_mfma_f32_16x16x32_bf16 v[80:83], v[144:147], v[176:179], v[80:83]
    v_mfma_f32_16x16x32_bf16 v[84:87], v[148:151], v[176:179], v[84:87]
    v_mfma_f32_16x16x32_bf16 v[88:91], v[152:155], v[176:179], v[88:91]
    v_mfma_f32_16x16x32_bf16 v[92:95], v[156:159], v[176:179], v[92:95]
    s_waitcnt lgkmcnt(0)
    v_mfma_f32_16x16x32_bf16 v[96:99], v[144:147], v[180:183], v[96:99]
    v_mfma_f32_16x16x32_bf16 v[100:103], v[148:151], v[180:183], v[100:103]
    v_mfma_f32_16x16x32_bf16 v[104:107], v[152:155], v[180:183], v[104:107]
    v_mfma_f32_16x16x32_bf16 v[108:111], v[156:159], v[180:183], v[108:111]
    s_nop 7
    v_and_b32 v3, 3, v1
    v_bfe_u32 v4, v1, 2, 2
    v_lshrrev_b32 v5, 4, v1
    v_cmp_eq_u32 s[92:93], v4, v5
    v_cmp_eq_u32 vcc, 1, v3
    s_nop 1
    v_cndmask_b32 v220, v220, v221, vcc
    v_cndmask_b32 v224, v224, v225, vcc
    v_cmp_eq_u32 vcc, 2, v3
    s_nop 1
    v_cndmask_b32 v220, v220, v222, vcc
    v_cndmask_b32 v224, v224, v226, vcc
    v_cmp_eq_u32 vcc, 3, v3
    s_nop 1
    v_cndmask_b32 v220, v220, v223, vcc
    v_cndmask_b32 v224, v224, v227, vcc
    v_mov_b32 v4, 0
    v_cndmask_b32 v220, v4, v220, s[92:93]
    v_cndmask_b32 v221, v4, v224, s[92:93]
    v_mov_b32 v128, v220
    v_mov_b32 v129, v221
    s_nop 1
    v_permlane32_swap_b32 v128, v220
    v_permlane32_swap_b32 v129, v221
    s_nop 1
    v_add_f32 v220, v220, v128
    v_add_f32 v221, v221, v129
    v_mov_b32 v128, v220
    v_mov_b32 v129, v221
    s_nop 1
    v_permlane16_swap_b32 v128, v220
    v_permlane16_swap_b32 v129, v221
    s_nop 1
    v_add_f32 v220, v220, v128
    v_add_f32 v221, v221, v129
    s_nop 3
    v_mul_f32 v200, 0x3ae38e39, v200
    v_mul_f32 v132, v200, v200
    v_mul_f32 v133, 0x3ae38e39, v220
    v_sub_f32 v132, v133, v132
    v_max_f32 v132, 0, v132
    v_add_f32 v132, 0x3727c5ac, v132
    v_rsq_f32 v128, v132
    v_mul_f32 v201, 0xbfb8aa3b, v201
    v_exp_f32 v201, v201
    v_mul_f32 v129, v200, v128
    v_sub_f32 v129, 0, v129
    v_add_f32 v201, 1.0, v201
    v_rcp_f32 v201, v201
    v_mul_f32 v204, 0x3ae38e39, v204
    v_mul_f32 v132, v204, v204
    v_mul_f32 v133, 0x3ae38e39, v221
    v_sub_f32 v132, v133, v132
    v_max_f32 v132, 0, v132
    v_add_f32 v132, 0x3727c5ac, v132
    v_rsq_f32 v130, v132
    v_mul_f32 v205, 0xbfb8aa3b, v205
    v_exp_f32 v205, v205
    v_mul_f32 v131, v204, v130
    v_sub_f32 v131, 0, v131
    v_add_f32 v205, 1.0, v205
    v_rcp_f32 v205, v205
    v_and_b32 v3, 15, v1
    v_lshrrev_b32 v4, 4, v1
    s_lshl_b32 s55, s59, 6
    v_add_u32 v5, s55, v3
    v_lshlrev_b32 v6, 3, v5
    s_lshl_b32 s55, s44, 6
    v_lshl_add_u32 v7, v4, 4, s55
    ds_write_b128 v7, v[208:211] offset:2048
    s_mov_b64 exec, 0xffff
    ds_write_b64 v6, v[128:129] offset:256
    ds_write_b64 v6, v[130:131] offset:384
    s_and_b32 s3, s2, 31
    s_cbranch_scc1 l1_nog11
    v_add_u32 v7, s45, v5
    v_lshlrev_b32 v7, 2, v7
    buffer_store_dword v201, v7, s[28:31], 0 offen offset:128
    buffer_store_dword v205, v7, s[28:31], 0 offen offset:192
l1_nog11:
    s_mov_b64 exec, -1
    s_waitcnt lgkmcnt(0)
    s_barrier
    ds_read_b64 v[128:129], v6 offset:0
    ds_read_b64 v[130:131], v6 offset:128
    ds_read_b64 v[132:133], v6 offset:256
    ds_read_b64 v[134:135], v6 offset:384
    v_lshlrev_b32 v7, 4, v4
    v_lshlrev_b32 v8, 3, v4
    v_add_u32 v8, 160768, v8
    ds_read_b128 v[136:139], v7 offset:2496
    ds_read_b64 v[140:141], v8 offset:224
    v_add_u32 v5, s45, v5
    v_lshrrev_b32 v6, 4, v5
    v_mul_u32_u24 v6, 147456, v6
    v_and_b32 v5, 15, v5
    v_lshl_add_u32 v5, v5, 4, v6
    s_lshl_b32 s55, s46, 5
    s_add_u32 s55, s55, 3584
    v_add_u32 v5, s55, v5
    v_and_b32 v8, 1, v4
    v_lshrrev_b32 v6, 1, v4
    v_lshl_add_u32 v5, v6, 8, v5
    v_mul_u32_u24 v9, 147456, v8
    v_add_u32 v9, v9, v5
    v_lshl_add_u32 v5, v8, 9, v5
    v_mov_b32 v6, 0xc0135761
    v_mov_b32 v7, 0xc0135761
    v_mov_b32 v10, 0xbdd2d3e8
    v_mov_b32 v11, 0xbdd2d3e8
    v_mov_b32 v12, 1.0
    v_mov_b32 v13, 1.0
    s_waitcnt lgkmcnt(0)
    v_and_b32 v14, 15, v1
    v_lshrrev_b32 v3, 4, v1
    v_cmp_lt_u32 vcc, 7, v14
    v_add_u32 v14, s47, v14
    v_lshlrev_b32 v14, 12, v14
    v_and_b32 v4, 1, v3
    v_lshlrev_b32 v4, 3, v4
    v_lshrrev_b32 v3, 1, v3
    v_lshl_add_u32 v4, v3, 4, v4
    s_lshl_b32 s55, s59, 6
    s_add_u32 s55, s55, s45
    v_add_u32 v4, s55, v4
    v_lshl_add_u32 v14, v4, 1, v14
    v_mov_b32 v15, 0x80000000
    v_cndmask_b32 v15, v14, v15, vcc
    v_cvt_pk_bf16_f32 v32, v32, v33
    v_cvt_pk_bf16_f32 v33, v34, v35
    v_cvt_pk_bf16_f32 v34, v36, v37
    v_cvt_pk_bf16_f32 v35, v38, v39
    s_nop 1
    v_permlane32_swap_b32 v32, v34
    v_permlane32_swap_b32 v33, v35
    s_mov_b32 s58, 0
    buffer_store_dwordx4 v[32:35], v14, s[24:27], s58 offen offset:0
    v_cvt_pk_bf16_f32 v40, v40, v41
    v_cvt_pk_bf16_f32 v41, v42, v43
    v_cvt_pk_bf16_f32 v42, v44, v45
    v_cvt_pk_bf16_f32 v43, v46, v47
    s_nop 1
    v_permlane32_swap_b32 v40, v42
    v_permlane32_swap_b32 v41, v43
    s_mov_b32 s58, 0
    buffer_store_dwordx4 v[40:43], v14, s[24:27], s58 offen offset:64
    v_cvt_pk_bf16_f32 v48, v48, v49
    v_cvt_pk_bf16_f32 v49, v50, v51
    v_cvt_pk_bf16_f32 v50, v52, v53
    v_cvt_pk_bf16_f32 v51, v54, v55
    s_nop 1
    v_permlane32_swap_b32 v48, v50
    v_permlane32_swap_b32 v49, v51
    s_mov_b32 s58, 65536
    buffer_store_dwordx4 v[48:51], v14, s[24:27], s58 offen offset:0
    v_cvt_pk_bf16_f32 v56, v56, v57
    v_cvt_pk_bf16_f32 v57, v58, v59
    v_cvt_pk_bf16_f32 v58, v60, v61
    v_cvt_pk_bf16_f32 v59, v62, v63
    s_nop 1
    v_permlane32_swap_b32 v56, v58
    v_permlane32_swap_b32 v57, v59
    s_mov_b32 s58, 65536
    buffer_store_dwordx4 v[56:59], v14, s[24:27], s58 offen offset:64
    v_cvt_pk_bf16_f32 v64, v64, v65
    v_cvt_pk_bf16_f32 v65, v66, v67
    v_cvt_pk_bf16_f32 v66, v68, v69
    v_cvt_pk_bf16_f32 v67, v70, v71
    s_nop 1
    v_permlane32_swap_b32 v64, v66
    v_permlane32_swap_b32 v65, v67
    s_mov_b32 s58, 131072
    buffer_store_dwordx4 v[64:67], v14, s[24:27], s58 offen offset:0
    v_cvt_pk_bf16_f32 v72, v72, v73
    v_cvt_pk_bf16_f32 v73, v74, v75
    v_cvt_pk_bf16_f32 v74, v76, v77
    v_cvt_pk_bf16_f32 v75, v78, v79
    s_nop 1
    v_permlane32_swap_b32 v72, v74
    v_permlane32_swap_b32 v73, v75
    s_mov_b32 s58, 131072
    buffer_store_dwordx4 v[72:75], v14, s[24:27], s58 offen offset:64
    v_cvt_pk_bf16_f32 v80, v80, v81
    v_cvt_pk_bf16_f32 v81, v82, v83
    v_cvt_pk_bf16_f32 v82, v84, v85
    v_cvt_pk_bf16_f32 v83, v86, v87
    s_nop 1
    v_permlane32_swap_b32 v80, v82
    v_permlane32_swap_b32 v81, v83
    s_mov_b32 s58, 196608
    buffer_store_dwordx4 v[80:83], v14, s[24:27], s58 offen offset:0
    v_cvt_pk_bf16_f32 v88, v88, v89
    v_cvt_pk_bf16_f32 v89, v90, v91
    v_cvt_pk_bf16_f32 v90, v92, v93
    v_cvt_pk_bf16_f32 v91, v94, v95
    s_nop 1
    v_permlane32_swap_b32 v88, v90
    v_permlane32_swap_b32 v89, v91
    s_mov_b32 s58, 196608
    buffer_store_dwordx4 v[88:91], v14, s[24:27], s58 offen offset:64
    v_cvt_pk_bf16_f32 v96, v96, v97
    v_cvt_pk_bf16_f32 v97, v98, v99
    v_cvt_pk_bf16_f32 v98, v100, v101
    v_cvt_pk_bf16_f32 v99, v102, v103
    s_nop 1
    v_permlane32_swap_b32 v96, v98
    v_permlane32_swap_b32 v97, v99
    s_mov_b32 s58, 262144
    buffer_store_dwordx4 v[96:99], v15, s[24:27], s58 offen offset:0
    v_cvt_pk_bf16_f32 v104, v104, v105
    v_cvt_pk_bf16_f32 v105, v106, v107
    v_cvt_pk_bf16_f32 v106, v108, v109
    v_cvt_pk_bf16_f32 v107, v110, v111
    s_nop 1
    v_permlane32_swap_b32 v104, v106
    v_permlane32_swap_b32 v105, v107
    s_mov_b32 s58, 262144
    buffer_store_dwordx4 v[104:107], v15, s[24:27], s58 offen offset:64
    v_lshlrev_b32 v144, 16, v140
    v_and_b32 v145, 0xffff0000, v140
    v_lshlrev_b32 v146, 16, v141
    v_and_b32 v147, 0xffff0000, v141
    v_pk_fma_f32 v[148:149], v[136:137], v[128:129], v[144:145] op_sel:[0,1,0] op_sel_hi:[1,1,1]
    v_pk_fma_f32 v[150:151], v[138:139], v[128:129], v[146:147] op_sel:[0,1,0] op_sel_hi:[1,1,1]
    v_pk_fma_f32 v[152:153], v[136:137], v[130:131], v[144:145] op_sel:[0,1,0] op_sel_hi:[1,1,1]
    v_pk_fma_f32 v[154:155], v[138:139], v[130:131], v[146:147] op_sel:[0,1,0] op_sel_hi:[1,1,1]
    v_pk_fma_f32 v[16:17], v[16:17], v[128:129], v[148:149] op_sel:[0,0,0] op_sel_hi:[1,0,1]
    v_pk_fma_f32 v[18:19], v[18:19], v[128:129], v[150:151] op_sel:[0,0,0] op_sel_hi:[1,0,1]
    v_pk_fma_f32 v[20:21], v[20:21], v[130:131], v[152:153] op_sel:[0,0,0] op_sel_hi:[1,0,1]
    v_pk_fma_f32 v[22:23], v[22:23], v[130:131], v[154:155] op_sel:[0,0,0] op_sel_hi:[1,0,1]
    v_pk_mul_f32 v[148:149], v[16:17], v[16:17]
    v_pk_mul_f32 v[150:151], v[18:19], v[18:19]
    v_pk_mul_f32 v[152:153], v[20:21], v[20:21]
    v_pk_mul_f32 v[154:155], v[22:23], v[22:23]
    v_pk_fma_f32 v[148:149], v[148:149], v[10:11], v[6:7]
    v_pk_fma_f32 v[150:151], v[150:151], v[10:11], v[6:7]
    v_pk_fma_f32 v[152:153], v[152:153], v[10:11], v[6:7]
    v_pk_fma_f32 v[154:155], v[154:155], v[10:11], v[6:7]
    v_pk_mul_f32 v[148:149], v[148:149], v[16:17]
    v_pk_mul_f32 v[150:151], v[150:151], v[18:19]
    v_pk_mul_f32 v[152:153], v[152:153], v[20:21]
    v_pk_mul_f32 v[154:155], v[154:155], v[22:23]
    v_exp_f32 v148, v148
    v_exp_f32 v149, v149
    v_exp_f32 v150, v150
    v_exp_f32 v151, v151
    v_exp_f32 v152, v152
    v_exp_f32 v153, v153
    v_exp_f32 v154, v154
    v_exp_f32 v155, v155
    v_pk_add_f32 v[148:149], v[148:149], v[12:13]
    v_pk_add_f32 v[150:151], v[150:151], v[12:13]
    v_pk_add_f32 v[152:153], v[152:153], v[12:13]
    v_pk_add_f32 v[154:155], v[154:155], v[12:13]
    v_rcp_f32 v148, v148
    v_rcp_f32 v149, v149
    v_rcp_f32 v150, v150
    v_rcp_f32 v151, v151
    v_rcp_f32 v152, v152
    v_rcp_f32 v153, v153
    v_rcp_f32 v154, v154
    v_rcp_f32 v155, v155
    v_pk_mul_f32 v[16:17], v[16:17], v[148:149]
    v_pk_mul_f32 v[18:19], v[18:19], v[150:151]
    v_pk_mul_f32 v[20:21], v[20:21], v[152:153]
    v_pk_mul_f32 v[22:23], v[22:23], v[154:155]
    v_cvt_pk_bf16_f32 v16, v16, v17
    v_cvt_pk_bf16_f32 v17, v18, v19
    v_cvt_pk_bf16_f32 v18, v20, v21
    v_cvt_pk_bf16_f32 v19, v22, v23
    s_nop 1
    v_permlane16_swap_b32 v16, v18
    v_permlane16_swap_b32 v17, v19
    s_nop 0
    buffer_store_dwordx4 v[16:19], v9, s[16:19], s68 offen offset:0
    v_lshlrev_b32 v144, 16, v140
    v_and_b32 v145, 0xffff0000, v140
    v_lshlrev_b32 v146, 16, v141
    v_and_b32 v147, 0xffff0000, v141
    v_pk_fma_f32 v[148:149], v[136:137], v[132:133], v[144:145] op_sel:[0,1,0] op_sel_hi:[1,1,1]
    v_pk_fma_f32 v[150:151], v[138:139], v[132:133], v[146:147] op_sel:[0,1,0] op_sel_hi:[1,1,1]
    v_pk_fma_f32 v[152:153], v[136:137], v[134:135], v[144:145] op_sel:[0,1,0] op_sel_hi:[1,1,1]
    v_pk_fma_f32 v[154:155], v[138:139], v[134:135], v[146:147] op_sel:[0,1,0] op_sel_hi:[1,1,1]
    v_pk_fma_f32 v[24:25], v[24:25], v[132:133], v[148:149] op_sel:[0,0,0] op_sel_hi:[1,0,1]
    v_pk_fma_f32 v[26:27], v[26:27], v[132:133], v[150:151] op_sel:[0,0,0] op_sel_hi:[1,0,1]
    v_pk_fma_f32 v[28:29], v[28:29], v[134:135], v[152:153] op_sel:[0,0,0] op_sel_hi:[1,0,1]
    v_pk_fma_f32 v[30:31], v[30:31], v[134:135], v[154:155] op_sel:[0,0,0] op_sel_hi:[1,0,1]
    v_pk_mul_f32 v[148:149], v[24:25], v[24:25]
    v_pk_mul_f32 v[150:151], v[26:27], v[26:27]
    v_pk_mul_f32 v[152:153], v[28:29], v[28:29]
    v_pk_mul_f32 v[154:155], v[30:31], v[30:31]
    v_pk_fma_f32 v[148:149], v[148:149], v[10:11], v[6:7]
    v_pk_fma_f32 v[150:151], v[150:151], v[10:11], v[6:7]
    v_pk_fma_f32 v[152:153], v[152:153], v[10:11], v[6:7]
    v_pk_fma_f32 v[154:155], v[154:155], v[10:11], v[6:7]
    v_pk_mul_f32 v[148:149], v[148:149], v[24:25]
    v_pk_mul_f32 v[150:151], v[150:151], v[26:27]
    v_pk_mul_f32 v[152:153], v[152:153], v[28:29]
    v_pk_mul_f32 v[154:155], v[154:155], v[30:31]
    v_exp_f32 v148, v148
    v_exp_f32 v149, v149
    v_exp_f32 v150, v150
    v_exp_f32 v151, v151
    v_exp_f32 v152, v152
    v_exp_f32 v153, v153
    v_exp_f32 v154, v154
    v_exp_f32 v155, v155
    v_pk_add_f32 v[148:149], v[148:149], v[12:13]
    v_pk_add_f32 v[150:151], v[150:151], v[12:13]
    v_pk_add_f32 v[152:153], v[152:153], v[12:13]
    v_pk_add_f32 v[154:155], v[154:155], v[12:13]
    v_rcp_f32 v148, v148
    v_rcp_f32 v149, v149
    v_rcp_f32 v150, v150
    v_rcp_f32 v151, v151
    v_rcp_f32 v152, v152
    v_rcp_f32 v153, v153
    v_rcp_f32 v154, v154
    v_rcp_f32 v155, v155
    v_pk_mul_f32 v[24:25], v[24:25], v[148:149]
    v_pk_mul_f32 v[26:27], v[26:27], v[150:151]
    v_pk_mul_f32 v[28:29], v[28:29], v[152:153]
    v_pk_mul_f32 v[30:31], v[30:31], v[154:155]
    v_cvt_pk_bf16_f32 v24, v24, v25
    v_cvt_pk_bf16_f32 v25, v26, v27
    v_cvt_pk_bf16_f32 v26, v28, v29
    v_cvt_pk_bf16_f32 v27, v30, v31
    s_nop 1
    v_permlane16_swap_b32 v24, v26
    v_permlane16_swap_b32 v25, v27
    s_nop 0
    buffer_store_dwordx4 v[24:27], v9, s[16:19], s70 offen offset:0
l1_done:
    s_endpgm
.globl af_kernel
.p2align 8
.type af_kernel,@function
af_kernel:
    s_cmp_ge_u32 s2, 256
    s_cbranch_scc1 at_done
    v_lshrrev_b32 v2, 6, v0
    s_nop 0
    v_readfirstlane_b32 s26, v2
    s_mov_b32 s58, 0
    s_cmp_lg_u32 s26, 8
    s_cbranch_scc1 af_noinit
    v_and_b32 v2, 3, v0
    v_lshlrev_b32 v2, 4, v2
    v_add_u32 v2, 161792, v2
    v_mov_b32 v4, 0
    v_mov_b32 v5, 0
    v_mov_b32 v6, 0
    v_mov_b32 v7, 0
    ds_write_b128 v2, v[4:7]
    s_waitcnt lgkmcnt(0)
af_noinit:
    s_barrier
    s_cmp_ge_u32 s26, 8
    s_cbranch_scc1 f2_start
    s_load_dwordx2 s[4:5], s[0:1], 88
    s_load_dwordx2 s[8:9], s[0:1], 88
    s_load_dwordx2 s[12:13], s[0:1], 88
    s_load_dwordx2 s[16:17], s[0:1], 88
    s_and_b32 s24, s2, 31
    s_lshr_b32 s25, s2, 5
    s_lshl_b32 s25, s25, 8
    v_and_b32 v1, 63, v0
    v_and_b32 v2, 31, v1
    v_lshrrev_b32 v3, 5, v1
    v_mov_b32 v155, 161792
    s_waitcnt lgkmcnt(0)
    s_add_u32 s4, s4, 0x600000
    s_addc_u32 s5, s5, 0
    s_mov_b32 s6, 0x300000
    s_mov_b32 s7, 0x20000
    s_add_u32 s8, s8, 0x900000
    s_addc_u32 s9, s9, 0
    s_mov_b32 s10, 0x240000
    s_mov_b32 s11, 0x20000
    s_add_u32 s12, s12, 0x300000
    s_addc_u32 s13, s13, 0
    s_mov_b32 s14, 0x300000
    s_mov_b32 s15, 0x20000
    s_add_u32 s16, s16, 0x5000000
    s_addc_u32 s17, s17, 0
    s_mov_b32 s18, 0x240000
    s_mov_b32 s19, 0x20000
    s_lshl_b32 s31, s24, 11
    s_add_u32 s31, s31, s25
    s_lshl_b32 s33, s26, 5
    s_add_u32 s31, s31, s33
    v_add_u32 v4, s31, v2
    v_mul_u32_u24 v4, 48, v4
    v_lshl_add_u32 v5, v3, 4, v4
    buffer_load_dwordx4 v[80:83], v5, s[12:15], 0 offen
    buffer_load_dwordx4 v[84:87], v4, s[12:15], 0 offen offset:32
    s_mul_i32 s33, s26, 3072
    v_lshlrev_b32 v146, 4, v1
    v_add_u32 v146, s33, v146
    s_mul_i32 s34, s24, 18
    s_lshl_b32 s35, s26, 1
    s_and_b32 s36, s35, 15
    v_xor_b32 v4, s36, v1
    v_lshlrev_b32 v4, 4, v4
    s_add_u32 s36, s35, s34
    s_lshl_b32 s36, s36, 12
    v_add_u32 v147, s36, v4
    s_lshl_b32 s35, s26, 1
    s_add_u32 s35, s35, 1
    s_and_b32 s36, s35, 15
    v_xor_b32 v4, s36, v1
    v_lshlrev_b32 v4, 4, v4
    s_add_u32 s36, s35, s34
    s_lshl_b32 s36, s36, 12
    v_add_u32 v148, s36, v4
    s_add_u32 s35, s26, 16
    s_and_b32 s36, s35, 15
    v_xor_b32 v4, s36, v1
    v_lshlrev_b32 v4, 4, v4
    s_add_u32 s36, s35, s34
    s_lshl_b32 s36, s36, 12
    v_add_u32 v149, s36, v4
    s_mov_b32 s37, 44032
    s_mov_b32 s38, 44032
    s_mov_b32 s39, 44032
    s_mul_i32 s27, s24, 98304
    s_mov_b32 s28, 0
    s_mul_i32 s29, s26, 3072
    s_lshl_b32 s30, s26, 11
    s_add_u32 s30, s30, 24576
    s_mov_b32 m0, s29
    s_nop 0
    buffer_load_dwordx4 v146, s[4:7], s27 offen offset:0 lds
    buffer_load_dwordx4 v146, s[4:7], s27 offen offset:1024 lds
    buffer_load_dwordx4 v146, s[4:7], s27 offen offset:2048 lds
    s_mov_b32 m0, s30
    s_nop 0
    buffer_load_dwordx4 v147, s[8:11], s28 offen lds
    s_add_u32 m0, s30, 1024
    s_nop 0
    buffer_load_dwordx4 v148, s[8:11], s28 offen lds
    s_cmp_ge_u32 s26, 2
    s_cbranch_scc1 at_dskipaf
    s_lshl_b32 s33, s26, 10
    s_sub_u32 s33, s30, s33
    s_add_u32 m0, s33, 16384
    s_nop 0
    buffer_load_dwordx4 v149, s[8:11], s28 offen lds
at_dskipaf:
    s_add_u32 s27, s27, 24576
    s_add_u32 s28, s28, 1024
    s_add_u32 s29, s29, s39
    s_add_u32 s30, s30, s39
    s_sub_u32 s39, 0, s39
    s_mov_b32 m0, s29
    s_nop 0
    buffer_load_dwordx4 v146, s[4:7], s27 offen offset:0 lds
    buffer_load_dwordx4 v146, s[4:7], s27 offen offset:1024 lds
    buffer_load_dwordx4 v146, s[4:7], s27 offen offset:2048 lds
    s_mov_b32 m0, s30
    s_nop 0
    buffer_load_dwordx4 v147, s[8:11], s28 offen lds
    s_add_u32 m0, s30, 1024
    s_nop 0
    buffer_load_dwordx4 v148, s[8:11], s28 offen lds
    s_cmp_ge_u32 s26, 2
    s_cbranch_scc1 at_dskipbf
    s_lshl_b32 s33, s26, 10
    s_sub_u32 s33, s30, s33
    s_add_u32 m0, s33, 16384
    s_nop 0
    buffer_load_dwordx4 v149, s[8:11], s28 offen lds
at_dskipbf:
    s_add_u32 s27, s27, 24576
    s_add_u32 s28, s28, 1024
    s_add_u32 s29, s29, s39
    s_add_u32 s30, s30, s39
    s_sub_u32 s39, 0, s39
    v_lshlrev_b32 v4, 2, v0
    v_and_b32 v5, 1023, v4
    v_lshrrev_b32 v6, 10, v4
    v_mul_u32_u24 v6, 44032, v6
    v_add_u32 v5, v5, v6
    v_add_u32 v5, 43008, v5
    v_mov_b32 v6, 0x3f803f80
    ds_write_b32 v5, v6
    v_mul_u32_u24 v137, 48, v2
    v_lshl_add_u32 v136, v3, 4, v137
    v_add_u32 v137, 32, v137
    v_min_u32 v4, 18, v2
    v_and_b32 v5, 15, v4
    v_lshlrev_b32 v4, 10, v4
    v_add_u32 v4, 24576, v4
    v_add_u32 v6, 0, v3
    v_xor_b32 v6, v6, v5
    v_lshl_add_u32 v138, v6, 4, v4
    v_add_u32 v6, 2, v3
    v_xor_b32 v6, v6, v5
    v_lshl_add_u32 v139, v6, 4, v4
    v_add_u32 v6, 4, v3
    v_xor_b32 v6, v6, v5
    v_lshl_add_u32 v140, v6, 4, v4
    v_add_u32 v6, 6, v3
    v_xor_b32 v6, v6, v5
    v_lshl_add_u32 v141, v6, 4, v4
    v_add_u32 v6, 8, v3
    v_xor_b32 v6, v6, v5
    v_lshl_add_u32 v142, v6, 4, v4
    v_add_u32 v6, 10, v3
    v_xor_b32 v6, v6, v5
    v_lshl_add_u32 v143, v6, 4, v4
    v_add_u32 v6, 12, v3
    v_xor_b32 v6, v6, v5
    v_lshl_add_u32 v144, v6, 4, v4
    v_add_u32 v6, 14, v3
    v_xor_b32 v6, v6, v5
    v_lshl_add_u32 v145, v6, 4, v4
    v_mov_b32 v48, 0
    v_mov_b32 v64, 0
    v_mov_b32 v88, 0
    v_mov_b32 v120, 0
    v_mov_b32 v49, 0
    v_mov_b32 v65, 0
    v_mov_b32 v89, 0
    v_mov_b32 v121, 0
    v_mov_b32 v50, 0
    v_mov_b32 v66, 0
    v_mov_b32 v90, 0
    v_mov_b32 v122, 0
    v_mov_b32 v51, 0
    v_mov_b32 v67, 0
    v_mov_b32 v91, 0
    v_mov_b32 v123, 0
    v_mov_b32 v52, 0
    v_mov_b32 v68, 0
    v_mov_b32 v92, 0
    v_mov_b32 v124, 0
    v_mov_b32 v53, 0
    v_mov_b32 v69, 0
    v_mov_b32 v93, 0
    v_mov_b32 v125, 0
    v_mov_b32 v54, 0
    v_mov_b32 v70, 0
    v_mov_b32 v94, 0
    v_mov_b32 v126, 0
    v_mov_b32 v55, 0
    v_mov_b32 v71, 0
    v_mov_b32 v95, 0
    v_mov_b32 v127, 0
    v_mov_b32 v56, 0
    v_mov_b32 v72, 0
    v_mov_b32 v96, 0
    v_mov_b32 v128, 0
    v_mov_b32 v57, 0
    v_mov_b32 v73, 0
    v_mov_b32 v97, 0
    v_mov_b32 v129, 0
    v_mov_b32 v58, 0
    v_mov_b32 v74, 0
    v_mov_b32 v98, 0
    v_mov_b32 v130, 0
    v_mov_b32 v59, 0
    v_mov_b32 v75, 0
    v_mov_b32 v99, 0
    v_mov_b32 v131, 0
    v_mov_b32 v60, 0
    v_mov_b32 v76, 0
    v_mov_b32 v100, 0
    v_mov_b32 v132, 0
    v_mov_b32 v61, 0
    v_mov_b32 v77, 0
    v_mov_b32 v101, 0
    v_mov_b32 v133, 0
    v_mov_b32 v62, 0
    v_mov_b32 v78, 0
    v_mov_b32 v102, 0
    v_mov_b32 v134, 0
    v_mov_b32 v63, 0
    v_mov_b32 v79, 0
    v_mov_b32 v103, 0
    v_mov_b32 v135, 0
    s_mov_b32 s32, 0x41200000
    s_mov_b32 s56, 0x7ffff
    s_mov_b32 s57, 0x7ffff
    s_mov_b32 s54, -1
    s_mov_b32 s55, 0
    s_waitcnt vmcnt(5) lgkmcnt(0)
    v_cmp_lt_u32 vcc, 31, v1
    v_mov_b32 v4, 0
    s_nop 1
    v_cndmask_b32 v84, v84, v4, vcc
    v_cndmask_b32 v85, v85, v4, vcc
    v_cndmask_b32 v86, v86, v4, vcc
    v_cndmask_b32 v87, v87, v4, vcc
    s_add_u32 s58, s58, 8
    v_mov_b32 v156, 1
    s_mov_b64 exec, 1
    ds_add_u32 v155, v156 offset:0
sy1:
    ds_read_b32 v156, v155 offset:0
    s_waitcnt lgkmcnt(0)
    v_readfirstlane_b32 s59, v156
    s_cmp_ge_u32 s59, s58
    s_cbranch_scc1 sd1
    s_sleep 1
    s_branch sy1
sd1:
    s_mov_b64 exec, -1
    ds_read_b128 v[104:107], v136 offset:0
    ds_read_b128 v[108:111], v137 offset:0
    ds_read_b128 v[112:115], v136 offset:1536
    ds_read_b128 v[116:119], v137 offset:1536
    s_waitcnt lgkmcnt(2)
    v_mfma_f32_32x32x16_bf16 v[16:31], v[104:107], v[80:83], v[48:63]
    v_mfma_f32_32x32x16_bf16 v[16:31], v[108:111], v[84:87], v[16:31]
    s_nop 15
    s_nop 3
    v_max3_f32 v150, v16, v17, v18
    v_max3_f32 v151, v19, v20, v21
    v_max3_f32 v152, v22, v23, v24
    v_max3_f32 v153, v25, v26, v27
    v_max3_f32 v150, v150, v28, v29
    v_max3_f32 v151, v151, v30, v31
    v_max3_f32 v150, v150, v151, v152
    v_max_f32 v154, v150, v153
    v_mov_b32 v150, v154
    s_nop 1
    v_permlane32_swap_b32 v150, v154
    s_nop 1
    v_max_f32 v154, v154, v150
    v_sub_f32 v150, 0, v154
    v_mov_b32 v48, v150
    v_mov_b32 v49, v150
    v_mov_b32 v50, v150
    v_mov_b32 v51, v150
    v_mov_b32 v52, v150
    v_mov_b32 v53, v150
    v_mov_b32 v54, v150
    v_mov_b32 v55, v150
    v_mov_b32 v56, v150
    v_mov_b32 v57, v150
    v_mov_b32 v58, v150
    v_mov_b32 v59, v150
    v_mov_b32 v60, v150
    v_mov_b32 v61, v150
    v_mov_b32 v62, v150
    v_mov_b32 v63, v150
    s_nop 1
    v_mfma_f32_32x32x16_bf16 v[16:31], v[104:107], v[80:83], v[48:63]
    v_mfma_f32_32x32x16_bf16 v[16:31], v[108:111], v[84:87], v[16:31]
    s_nop 15
    s_mov_b32 s31, 0
at_chunkf:
    s_mov_b64 exec, s[56:57]
    ds_read_b128 v[120:123], v138 offset:0
    ds_read_b128 v[124:127], v139 offset:0
    s_mov_b64 exec, s[54:55]
    ds_read_b128 v[108:111], v137 offset:3072
    s_mov_b64 exec, -1
    ds_read_b128 v[104:107], v136 offset:3072
    s_waitcnt lgkmcnt(4)
    v_mfma_f32_32x32x16_bf16 v[64:79], v[128:131], v[96:99], v[64:79]
    v_exp_f32 v16, v16
    v_exp_f32 v17, v17
    v_exp_f32 v18, v18
    v_exp_f32 v19, v19
    v_mfma_f32_32x32x16_bf16 v[32:47], v[112:115], v[80:83], v[48:63]
    v_exp_f32 v20, v20
    v_exp_f32 v21, v21
    v_exp_f32 v22, v22
    v_exp_f32 v23, v23
    v_mfma_f32_32x32x16_bf16 v[64:79], v[132:135], v[100:103], v[64:79]
    v_cvt_pk_bf16_f32 v88, v16, v17
    v_cvt_pk_bf16_f32 v89, v18, v19
    v_exp_f32 v24, v24
    v_exp_f32 v25, v25
    v_exp_f32 v26, v26
    v_exp_f32 v27, v27
    v_mfma_f32_32x32x16_bf16 v[32:47], v[116:119], v[84:87], v[32:47]
    v_cvt_pk_bf16_f32 v90, v20, v21
    v_cvt_pk_bf16_f32 v91, v22, v23
    v_exp_f32 v28, v28
    v_exp_f32 v29, v29
    v_exp_f32 v30, v30
    v_exp_f32 v31, v31
    v_cvt_pk_bf16_f32 v92, v24, v25
    v_cvt_pk_bf16_f32 v93, v26, v27
    v_cvt_pk_bf16_f32 v94, v28, v29
    v_cvt_pk_bf16_f32 v95, v30, v31
    s_nop 4
    s_cmp_eq_u32 s31, 0
    s_cbranch_scc1 at_nbaf
    s_cmp_eq_u32 s31, 3
    s_cbranch_scc1 at_nbaf
    v_mov_b32 v156, 1
    s_mov_b64 exec, 1
    ds_add_u32 v155, v156 offset:0
    s_mov_b64 exec, -1
at_nbaf:
    s_mov_b64 exec, s[56:57]
    ds_read_b128 v[128:131], v140 offset:0
    ds_read_b128 v[132:135], v141 offset:0
    s_mov_b64 exec, s[54:55]
    ds_read_b128 v[116:119], v137 offset:4608
    s_mov_b64 exec, -1
    ds_read_b128 v[112:115], v136 offset:4608
    s_waitcnt lgkmcnt(4)
    v_mfma_f32_32x32x16_bf16 v[64:79], v[120:123], v[88:91], v[64:79]
    v_exp_f32 v32, v32
    v_exp_f32 v33, v33
    v_exp_f32 v34, v34
    v_exp_f32 v35, v35
    v_mfma_f32_32x32x16_bf16 v[16:31], v[104:107], v[80:83], v[48:63]
    v_exp_f32 v36, v36
    v_exp_f32 v37, v37
    v_exp_f32 v38, v38
    v_exp_f32 v39, v39
    v_mfma_f32_32x32x16_bf16 v[64:79], v[124:127], v[92:95], v[64:79]
    v_cvt_pk_bf16_f32 v96, v32, v33
    v_cvt_pk_bf16_f32 v97, v34, v35
    v_exp_f32 v40, v40
    v_exp_f32 v41, v41
    v_exp_f32 v42, v42
    v_exp_f32 v43, v43
    v_mfma_f32_32x32x16_bf16 v[16:31], v[108:111], v[84:87], v[16:31]
    v_cvt_pk_bf16_f32 v98, v36, v37
    v_cvt_pk_bf16_f32 v99, v38, v39
    v_exp_f32 v44, v44
    v_exp_f32 v45, v45
    v_exp_f32 v46, v46
    v_exp_f32 v47, v47
    v_cvt_pk_bf16_f32 v100, v40, v41
    v_cvt_pk_bf16_f32 v101, v42, v43
    v_cvt_pk_bf16_f32 v102, v44, v45
    v_cvt_pk_bf16_f32 v103, v46, v47
    s_nop 4
    s_mov_b64 exec, s[56:57]
    ds_read_b128 v[120:123], v142 offset:0
    ds_read_b128 v[124:127], v143 offset:0
    s_mov_b64 exec, s[54:55]
    ds_read_b128 v[108:111], v137 offset:6144
    s_mov_b64 exec, -1
    ds_read_b128 v[104:107], v136 offset:6144
    s_waitcnt lgkmcnt(4)
    v_mfma_f32_32x32x16_bf16 v[64:79], v[128:131], v[96:99], v[64:79]
    v_exp_f32 v16, v16
    v_exp_f32 v17, v17
    v_exp_f32 v18, v18
    v_exp_f32 v19, v19
    v_mfma_f32_32x32x16_bf16 v[32:47], v[112:115], v[80:83], v[48:63]
    v_exp_f32 v20, v20
    v_exp_f32 v21, v21
    v_exp_f32 v22, v22
    v_exp_f32 v23, v23
    v_mfma_f32_32x32x16_bf16 v[64:79], v[132:135], v[100:103], v[64:79]
    v_cvt_pk_bf16_f32 v88, v16, v17
    v_cvt_pk_bf16_f32 v89, v18, v19
    v_exp_f32 v24, v24
    v_exp_f32 v25, v25
    v_exp_f32 v26, v26
    v_exp_f32 v27, v27
    v_mfma_f32_32x32x16_bf16 v[32:47], v[116:119], v[84:87], v[32:47]
    v_cvt_pk_bf16_f32 v90, v20, v21
    v_cvt_pk_bf16_f32 v91, v22, v23
    v_exp_f32 v28, v28
    v_exp_f32 v29, v29
    v_exp_f32 v30, v30
    v_exp_f32 v31, v31
    v_cvt_pk_bf16_f32 v92, v24, v25
    v_cvt_pk_bf16_f32 v93, v26, v27
    v_cvt_pk_bf16_f32 v94, v28, v29
    v_cvt_pk_bf16_f32 v95, v30, v31
    s_nop 4
    s_mov_b64 exec, s[56:57]
    ds_read_b128 v[128:131], v144 offset:0
    ds_read_b128 v[132:135], v145 offset:0
    s_mov_b64 exec, s[54:55]
    ds_read_b128 v[116:119], v137 offset:7680
    s_mov_b64 exec, -1
    ds_read_b128 v[112:115], v136 offset:7680
    s_waitcnt lgkmcnt(4)
    v_mfma_f32_32x32x16_bf16 v[64:79], v[120:123], v[88:91], v[64:79]
    v_exp_f32 v32, v32
    v_exp_f32 v33, v33
    v_exp_f32 v34, v34
    v_exp_f32 v35, v35
    v_mfma_f32_32x32x16_bf16 v[16:31], v[104:107], v[80:83], v[48:63]
    v_exp_f32 v36, v36
    v_exp_f32 v37, v37
    v_exp_f32 v38, v38
    v_exp_f32 v39, v39
    v_mfma_f32_32x32x16_bf16 v[64:79], v[124:127], v[92:95], v[64:79]
    v_cvt_pk_bf16_f32 v96, v32, v33
    v_cvt_pk_bf16_f32 v97, v34, v35
    v_exp_f32 v40, v40
    v_exp_f32 v41, v41
    v_exp_f32 v42, v42
    v_exp_f32 v43, v43
    v_mfma_f32_32x32x16_bf16 v[16:31], v[108:111], v[84:87], v[16:31]
    v_cvt_pk_bf16_f32 v98, v36, v37
    v_cvt_pk_bf16_f32 v99, v38, v39
    v_exp_f32 v44, v44
    v_exp_f32 v45, v45
    v_exp_f32 v46, v46
    v_exp_f32 v47, v47
    v_cvt_pk_bf16_f32 v100, v40, v41
    v_cvt_pk_bf16_f32 v101, v42, v43
    v_cvt_pk_bf16_f32 v102, v44, v45
    v_cvt_pk_bf16_f32 v103, v46, v47
    s_nop 4
    s_cmp_eq_u32 s31, 0
    s_cbranch_scc1 at_nb1f
    s_cmp_eq_u32 s31, 3
    s_cbranch_scc1 at_nb1f
    s_add_u32 s58, s58, 8
sy2:
    ds_read_b32 v156, v155 offset:0
    s_waitcnt lgkmcnt(0)
    v_readfirstlane_b32 s59, v156
    s_cmp_ge_u32 s59, s58
    s_cbranch_scc1 sd2
    s_sleep 1
    s_branch sy2
sd2:
    s_mov_b32 m0, s29
    s_nop 0
    buffer_load_dwordx4 v146, s[4:7], s27 offen offset:0 lds
    buffer_load_dwordx4 v146, s[4:7], s27 offen offset:1024 lds
    buffer_load_dwordx4 v146, s[4:7], s27 offen offset:2048 lds
    s_mov_b32 m0, s30
    s_nop 0
    buffer_load_dwordx4 v147, s[8:11], s28 offen lds
    s_add_u32 m0, s30, 1024
    s_nop 0
    buffer_load_dwordx4 v148, s[8:11], s28 offen lds
    s_cmp_ge_u32 s26, 2
    s_cbranch_scc1 at_dskipcf
    s_lshl_b32 s33, s26, 10
    s_sub_u32 s33, s30, s33
    s_add_u32 m0, s33, 16384
    s_nop 0
    buffer_load_dwordx4 v149, s[8:11], s28 offen lds
at_dskipcf:
    s_add_u32 s27, s27, 24576
    s_add_u32 s28, s28, 1024
    s_add_u32 s29, s29, s39
    s_add_u32 s30, s30, s39
    s_sub_u32 s39, 0, s39
at_nb1f:
    s_mov_b64 exec, s[56:57]
    ds_read_b128 v[120:123], v138 offset:256
    ds_read_b128 v[124:127], v139 offset:256
    s_mov_b64 exec, s[54:55]
    ds_read_b128 v[108:111], v137 offset:9216
    s_mov_b64 exec, -1
    ds_read_b128 v[104:107], v136 offset:9216
    s_waitcnt lgkmcnt(4)
    v_mfma_f32_32x32x16_bf16 v[64:79], v[128:131], v[96:99], v[64:79]
    v_exp_f32 v16, v16
    v_exp_f32 v17, v17
    v_exp_f32 v18, v18
    v_exp_f32 v19, v19
    v_mfma_f32_32x32x16_bf16 v[32:47], v[112:115], v[80:83], v[48:63]
    v_exp_f32 v20, v20
    v_exp_f32 v21, v21
    v_exp_f32 v22, v22
    v_exp_f32 v23, v23
    v_mfma_f32_32x32x16_bf16 v[64:79], v[132:135], v[100:103], v[64:79]
    v_cvt_pk_bf16_f32 v88, v16, v17
    v_cvt_pk_bf16_f32 v89, v18, v19
    v_exp_f32 v24, v24
    v_exp_f32 v25, v25
    v_exp_f32 v26, v26
    v_exp_f32 v27, v27
    v_mfma_f32_32x32x16_bf16 v[32:47], v[116:119], v[84:87], v[32:47]
    v_cvt_pk_bf16_f32 v90, v20, v21
    v_cvt_pk_bf16_f32 v91, v22, v23
    v_exp_f32 v28, v28
    v_exp_f32 v29, v29
    v_exp_f32 v30, v30
    v_exp_f32 v31, v31
    v_cvt_pk_bf16_f32 v92, v24, v25
    v_cvt_pk_bf16_f32 v93, v26, v27
    v_cvt_pk_bf16_f32 v94, v28, v29
    v_cvt_pk_bf16_f32 v95, v30, v31
    s_nop 4
    s_mov_b64 exec, s[56:57]
    ds_read_b128 v[128:131], v140 offset:256
    ds_read_b128 v[132:135], v141 offset:256
    s_mov_b64 exec, s[54:55]
    ds_read_b128 v[116:119], v137 offset:10752
    s_mov_b64 exec, -1
    ds_read_b128 v[112:115], v136 offset:10752
    s_waitcnt lgkmcnt(4)
    v_mfma_f32_32x32x16_bf16 v[64:79], v[120:123], v[88:91], v[64:79]
    v_exp_f32 v32, v32
    v_exp_f32 v33, v33
    v_exp_f32 v34, v34
    v_exp_f32 v35, v35
    v_mfma_f32_32x32x16_bf16 v[16:31], v[104:107], v[80:83], v[48:63]
    v_exp_f32 v36, v36
    v_exp_f32 v37, v37
    v_exp_f32 v38, v38
    v_exp_f32 v39, v39
    v_mfma_f32_32x32x16_bf16 v[64:79], v[124:127], v[92:95], v[64:79]
    v_cvt_pk_bf16_f32 v96, v32, v33
    v_cvt_pk_bf16_f32 v97, v34, v35
    v_exp_f32 v40, v40
    v_exp_f32 v41, v41
    v_exp_f32 v42, v42
    v_exp_f32 v43, v43
    v_mfma_f32_32x32x16_bf16 v[16:31], v[108:111], v[84:87], v[16:31]
    v_cvt_pk_bf16_f32 v98, v36, v37
    v_cvt_pk_bf16_f32 v99, v38, v39
    v_exp_f32 v44, v44
    v_exp_f32 v45, v45
    v_exp_f32 v46, v46
    v_exp_f32 v47, v47
    v_cvt_pk_bf16_f32 v100, v40, v41
    v_cvt_pk_bf16_f32 v101, v42, v43
    v_cvt_pk_bf16_f32 v102, v44, v45
    v_cvt_pk_bf16_f32 v103, v46, v47
    s_nop 4
    s_mov_b64 exec, s[56:57]
    ds_read_b128 v[120:123], v142 offset:256
    ds_read_b128 v[124:127], v143 offset:256
    s_mov_b64 exec, s[54:55]
    ds_read_b128 v[108:111], v137 offset:12288
    s_mov_b64 exec, -1
    ds_read_b128 v[104:107], v136 offset:12288
    s_waitcnt lgkmcnt(4)
    v_mfma_f32_32x32x16_bf16 v[64:79], v[128:131], v[96:99], v[64:79]
    v_exp_f32 v16, v16
    v_exp_f32 v17, v17
    v_exp_f32 v18, v18
    v_exp_f32 v19, v19
    v_mfma_f32_32x32x16_bf16 v[32:47], v[112:115], v[80:83], v[48:63]
    v_exp_f32 v20, v20
    v_exp_f32 v21, v21
    v_exp_f32 v22, v22
    v_exp_f32 v23, v23
    v_mfma_f32_32x32x16_bf16 v[64:79], v[132:135], v[100:103], v[64:79]
    v_cvt_pk_bf16_f32 v88, v16, v17
    v_cvt_pk_bf16_f32 v89, v18, v19
    v_exp_f32 v24, v24
    v_exp_f32 v25, v25
    v_exp_f32 v26, v26
    v_exp_f32 v27, v27
    v_mfma_f32_32x32x16_bf16 v[32:47], v[116:119], v[84:87], v[32:47]
    v_cvt_pk_bf16_f32 v90, v20, v21
    v_cvt_pk_bf16_f32 v91, v22, v23
    v_exp_f32 v28, v28
    v_exp_f32 v29, v29
    v_exp_f32 v30, v30
    v_exp_f32 v31, v31
    v_cvt_pk_bf16_f32 v92, v24, v25
    v_cvt_pk_bf16_f32 v93, v26, v27
    v_cvt_pk_bf16_f32 v94, v28, v29
    v_cvt_pk_bf16_f32 v95, v30, v31
    s_nop 4
    s_mov_b64 exec, s[56:57]
    ds_read_b128 v[128:131], v144 offset:256
    ds_read_b128 v[132:135], v145 offset:256
    s_mov_b64 exec, s[54:55]
    ds_read_b128 v[116:119], v137 offset:13824
    s_mov_b64 exec, -1
    ds_read_b128 v[112:115], v136 offset:13824
    s_waitcnt lgkmcnt(4)
    v_mfma_f32_32x32x16_bf16 v[64:79], v[120:123], v[88:91], v[64:79]
    v_exp_f32 v32, v32
    v_exp_f32 v33, v33
    v_exp_f32 v34, v34
    v_exp_f32 v35, v35
    v_mfma_f32_32x32x16_bf16 v[16:31], v[104:107], v[80:83], v[48:63]
    v_exp_f32 v36, v36
    v_exp_f32 v37, v37
    v_exp_f32 v38, v38
    v_exp_f32 v39, v39
    v_mfma_f32_32x32x16_bf16 v[64:79], v[124:127], v[92:95], v[64:79]
    v_cvt_pk_bf16_f32 v96, v32, v33
    v_cvt_pk_bf16_f32 v97, v34, v35
    v_exp_f32 v40, v40
    v_exp_f32 v41, v41
    v_exp_f32 v42, v42
    v_exp_f32 v43, v43
    v_mfma_f32_32x32x16_bf16 v[16:31], v[108:111], v[84:87], v[16:31]
    v_cvt_pk_bf16_f32 v98, v36, v37
    v_cvt_pk_bf16_f32 v99, v38, v39
    v_exp_f32 v44, v44
    v_exp_f32 v45, v45
    v_exp_f32 v46, v46
    v_exp_f32 v47, v47
    v_cvt_pk_bf16_f32 v100, v40, v41
    v_cvt_pk_bf16_f32 v101, v42, v43
    v_cvt_pk_bf16_f32 v102, v44, v45
    v_cvt_pk_bf16_f32 v103, v46, v47
    s_nop 4
    s_mov_b64 exec, s[56:57]
    ds_read_b128 v[120:123], v138 offset:512
    ds_read_b128 v[124:127], v139 offset:512
    s_mov_b64 exec, s[54:55]
    ds_read_b128 v[108:111], v137 offset:15360
    s_mov_b64 exec, -1
    ds_read_b128 v[104:107], v136 offset:15360
    s_waitcnt lgkmcnt(4)
    v_mfma_f32_32x32x16_bf16 v[64:79], v[128:131], v[96:99], v[64:79]
    v_exp_f32 v16, v16
    v_exp_f32 v17, v17
    v_exp_f32 v18, v18
    v_exp_f32 v19, v19
    v_mfma_f32_32x32x16_bf16 v[32:47], v[112:115], v[80:83], v[48:63]
    v_exp_f32 v20, v20
    v_exp_f32 v21, v21
    v_exp_f32 v22, v22
    v_exp_f32 v23, v23
    v_mfma_f32_32x32x16_bf16 v[64:79], v[132:135], v[100:103], v[64:79]
    v_cvt_pk_bf16_f32 v88, v16, v17
    v_cvt_pk_bf16_f32 v89, v18, v19
    v_exp_f32 v24, v24
    v_exp_f32 v25, v25
    v_exp_f32 v26, v26
    v_exp_f32 v27, v27
    v_mfma_f32_32x32x16_bf16 v[32:47], v[116:119], v[84:87], v[32:47]
    v_cvt_pk_bf16_f32 v90, v20, v21
    v_cvt_pk_bf16_f32 v91, v22, v23
    v_exp_f32 v28, v28
    v_exp_f32 v29, v29
    v_exp_f32 v30, v30
    v_exp_f32 v31, v31
    v_cvt_pk_bf16_f32 v92, v24, v25
    v_cvt_pk_bf16_f32 v93, v26, v27
    v_cvt_pk_bf16_f32 v94, v28, v29
    v_cvt_pk_bf16_f32 v95, v30, v31
    s_nop 4
    s_mov_b64 exec, s[56:57]
    ds_read_b128 v[128:131], v140 offset:512
    ds_read_b128 v[132:135], v141 offset:512
    s_mov_b64 exec, s[54:55]
    ds_read_b128 v[116:119], v137 offset:16896
    s_mov_b64 exec, -1
    ds_read_b128 v[112:115], v136 offset:16896
    s_waitcnt lgkmcnt(4)
    v_mfma_f32_32x32x16_bf16 v[64:79], v[120:123], v[88:91], v[64:79]
    v_exp_f32 v32, v32
    v_exp_f32 v33, v33
    v_exp_f32 v34, v34
    v_exp_f32 v35, v35
    v_mfma_f32_32x32x16_bf16 v[16:31], v[104:107], v[80:83], v[48:63]
    v_exp_f32 v36, v36
    v_exp_f32 v37, v37
    v_exp_f32 v38, v38
    v_exp_f32 v39, v39
    v_mfma_f32_32x32x16_bf16 v[64:79], v[124:127], v[92:95], v[64:79]
    v_cvt_pk_bf16_f32 v96, v32, v33
    v_cvt_pk_bf16_f32 v97, v34, v35
    v_exp_f32 v40, v40
    v_exp_f32 v41, v41
    v_exp_f32 v42, v42
    v_exp_f32 v43, v43
    v_mfma_f32_32x32x16_bf16 v[16:31], v[108:111], v[84:87], v[16:31]
    v_cvt_pk_bf16_f32 v98, v36, v37
    v_cvt_pk_bf16_f32 v99, v38, v39
    v_exp_f32 v44, v44
    v_exp_f32 v45, v45
    v_exp_f32 v46, v46
    v_exp_f32 v47, v47
    v_cvt_pk_bf16_f32 v100, v40, v41
    v_cvt_pk_bf16_f32 v101, v42, v43
    v_cvt_pk_bf16_f32 v102, v44, v45
    v_cvt_pk_bf16_f32 v103, v46, v47
    s_nop 4
    s_mov_b64 exec, s[56:57]
    ds_read_b128 v[120:123], v142 offset:512
    ds_read_b128 v[124:127], v143 offset:512
    s_mov_b64 exec, s[54:55]
    ds_read_b128 v[108:111], v137 offset:18432
    s_mov_b64 exec, -1
    ds_read_b128 v[104:107], v136 offset:18432
    s_waitcnt lgkmcnt(4)
    v_mfma_f32_32x32x16_bf16 v[64:79], v[128:131], v[96:99], v[64:79]
    v_exp_f32 v16, v16
    v_exp_f32 v17, v17
    v_exp_f32 v18, v18
    v_exp_f32 v19, v19
    v_mfma_f32_32x32x16_bf16 v[32:47], v[112:115], v[80:83], v[48:63]
    v_exp_f32 v20, v20
    v_exp_f32 v21, v21
    v_exp_f32 v22, v22
    v_exp_f32 v23, v23
    v_mfma_f32_32x32x16_bf16 v[64:79], v[132:135], v[100:103], v[64:79]
    v_cvt_pk_bf16_f32 v88, v16, v17
    v_cvt_pk_bf16_f32 v89, v18, v19
    v_exp_f32 v24, v24
    v_exp_f32 v25, v25
    v_exp_f32 v26, v26
    v_exp_f32 v27, v27
    v_mfma_f32_32x32x16_bf16 v[32:47], v[116:119], v[84:87], v[32:47]
    v_cvt_pk_bf16_f32 v90, v20, v21
    v_cvt_pk_bf16_f32 v91, v22, v23
    v_exp_f32 v28, v28
    v_exp_f32 v29, v29
    v_exp_f32 v30, v30
    v_exp_f32 v31, v31
    v_cvt_pk_bf16_f32 v92, v24, v25
    v_cvt_pk_bf16_f32 v93, v26, v27
    v_cvt_pk_bf16_f32 v94, v28, v29
    v_cvt_pk_bf16_f32 v95, v30, v31
    s_nop 4
    s_cmp_eq_u32 s31, 3
    s_cbranch_scc1 at_nbbf
    s_waitcnt vmcnt(0)
    v_mov_b32 v156, 1
    s_mov_b64 exec, 1
    ds_add_u32 v155, v156 offset:0
    s_mov_b64 exec, -1
at_nbbf:
    s_mov_b64 exec, s[56:57]
    ds_read_b128 v[128:131], v144 offset:512
    ds_read_b128 v[132:135], v145 offset:512
    s_mov_b64 exec, s[54:55]
    ds_read_b128 v[116:119], v137 offset:19968
    s_mov_b64 exec, -1
    ds_read_b128 v[112:115], v136 offset:19968
    s_waitcnt lgkmcnt(4)
    v_mfma_f32_32x32x16_bf16 v[64:79], v[120:123], v[88:91], v[64:79]
    v_exp_f32 v32, v32
    v_exp_f32 v33, v33
    v_exp_f32 v34, v34
    v_exp_f32 v35, v35
    v_mfma_f32_32x32x16_bf16 v[16:31], v[104:107], v[80:83], v[48:63]
    v_exp_f32 v36, v36
    v_exp_f32 v37, v37
    v_exp_f32 v38, v38
    v_exp_f32 v39, v39
    v_mfma_f32_32x32x16_bf16 v[64:79], v[124:127], v[92:95], v[64:79]
    v_cvt_pk_bf16_f32 v96, v32, v33
    v_cvt_pk_bf16_f32 v97, v34, v35
    v_exp_f32 v40, v40
    v_exp_f32 v41, v41
    v_exp_f32 v42, v42
    v_exp_f32 v43, v43
    v_mfma_f32_32x32x16_bf16 v[16:31], v[108:111], v[84:87], v[16:31]
    v_cvt_pk_bf16_f32 v98, v36, v37
    v_cvt_pk_bf16_f32 v99, v38, v39
    v_exp_f32 v44, v44
    v_exp_f32 v45, v45
    v_exp_f32 v46, v46
    v_exp_f32 v47, v47
    v_cvt_pk_bf16_f32 v100, v40, v41
    v_cvt_pk_bf16_f32 v101, v42, v43
    v_cvt_pk_bf16_f32 v102, v44, v45
    v_cvt_pk_bf16_f32 v103, v46, v47
    s_nop 4
    s_mov_b64 exec, s[56:57]
    ds_read_b128 v[120:123], v138 offset:768
    ds_read_b128 v[124:127], v139 offset:768
    s_mov_b64 exec, s[54:55]
    ds_read_b128 v[108:111], v137 offset:21504
    s_mov_b64 exec, -1
    ds_read_b128 v[104:107], v136 offset:21504
    s_waitcnt lgkmcnt(4)
    v_mfma_f32_32x32x16_bf16 v[64:79], v[128:131], v[96:99], v[64:79]
    v_exp_f32 v16, v16
    v_exp_f32 v17, v17
    v_exp_f32 v18, v18
    v_exp_f32 v19, v19
    v_mfma_f32_32x32x16_bf16 v[32:47], v[112:115], v[80:83], v[48:63]
    v_exp_f32 v20, v20
    v_exp_f32 v21, v21
    v_exp_f32 v22, v22
    v_exp_f32 v23, v23
    v_mfma_f32_32x32x16_bf16 v[64:79], v[132:135], v[100:103], v[64:79]
    v_cvt_pk_bf16_f32 v88, v16, v17
    v_cvt_pk_bf16_f32 v89, v18, v19
    v_exp_f32 v24, v24
    v_exp_f32 v25, v25
    v_exp_f32 v26, v26
    v_exp_f32 v27, v27
    v_mfma_f32_32x32x16_bf16 v[32:47], v[116:119], v[84:87], v[32:47]
    v_cvt_pk_bf16_f32 v90, v20, v21
    v_cvt_pk_bf16_f32 v91, v22, v23
    v_exp_f32 v28, v28
    v_exp_f32 v29, v29
    v_exp_f32 v30, v30
    v_exp_f32 v31, v31
    v_cvt_pk_bf16_f32 v92, v24, v25
    v_cvt_pk_bf16_f32 v93, v26, v27
    v_cvt_pk_bf16_f32 v94, v28, v29
    v_cvt_pk_bf16_f32 v95, v30, v31
    s_nop 4
    s_mov_b64 exec, s[56:57]
    ds_read_b128 v[128:131], v140 offset:768
    ds_read_b128 v[132:135], v141 offset:768
    s_mov_b64 exec, s[54:55]
    ds_read_b128 v[116:119], v137 offset:23040
    s_mov_b64 exec, -1
    ds_read_b128 v[112:115], v136 offset:23040
    s_waitcnt lgkmcnt(4)
    v_mfma_f32_32x32x16_bf16 v[64:79], v[120:123], v[88:91], v[64:79]
    v_exp_f32 v32, v32
    v_exp_f32 v33, v33
    v_exp_f32 v34, v34
    v_exp_f32 v35, v35
    v_mfma_f32_32x32x16_bf16 v[16:31], v[104:107], v[80:83], v[48:63]
    v_exp_f32 v36, v36
    v_exp_f32 v37, v37
    v_exp_f32 v38, v38
    v_exp_f32 v39, v39
    v_mfma_f32_32x32x16_bf16 v[64:79], v[124:127], v[92:95], v[64:79]
    v_cvt_pk_bf16_f32 v96, v32, v33
    v_cvt_pk_bf16_f32 v97, v34, v35
    v_exp_f32 v40, v40
    v_exp_f32 v41, v41
    v_exp_f32 v42, v42
    v_exp_f32 v43, v43
    v_mfma_f32_32x32x16_bf16 v[16:31], v[108:111], v[84:87], v[16:31]
    v_cvt_pk_bf16_f32 v98, v36, v37
    v_cvt_pk_bf16_f32 v99, v38, v39
    v_exp_f32 v44, v44
    v_exp_f32 v45, v45
    v_exp_f32 v46, v46
    v_exp_f32 v47, v47
    v_cvt_pk_bf16_f32 v100, v40, v41
    v_cvt_pk_bf16_f32 v101, v42, v43
    v_cvt_pk_bf16_f32 v102, v44, v45
    v_cvt_pk_bf16_f32 v103, v46, v47
    s_nop 4
    s_cmp_eq_u32 s31, 3
    s_cbranch_scc1 at_nb14f
    s_add_u32 s58, s58, 8
sy3:
    ds_read_b32 v156, v155 offset:0
    s_waitcnt lgkmcnt(0)
    v_readfirstlane_b32 s59, v156
    s_cmp_ge_u32 s59, s58
    s_cbranch_scc1 sd3
    s_sleep 1
    s_branch sy3
sd3:
at_nb14f:
    v_add_u32 v136, s37, v136
    v_add_u32 v137, s37, v137
    s_sub_u32 s37, 0, s37
    s_mov_b64 exec, s[56:57]
    ds_read_b128 v[120:123], v142 offset:768
    ds_read_b128 v[124:127], v143 offset:768
    s_mov_b64 exec, s[54:55]
    ds_read_b128 v[108:111], v137 offset:0
    s_mov_b64 exec, -1
    ds_read_b128 v[104:107], v136 offset:0
    s_waitcnt lgkmcnt(4)
    v_mfma_f32_32x32x16_bf16 v[64:79], v[128:131], v[96:99], v[64:79]
    v_exp_f32 v16, v16
    v_exp_f32 v17, v17
    v_exp_f32 v18, v18
    v_exp_f32 v19, v19
    v_mfma_f32_32x32x16_bf16 v[32:47], v[112:115], v[80:83], v[48:63]
    v_exp_f32 v20, v20
    v_exp_f32 v21, v21
    v_exp_f32 v22, v22
    v_exp_f32 v23, v23
    v_mfma_f32_32x32x16_bf16 v[64:79], v[132:135], v[100:103], v[64:79]
    v_cvt_pk_bf16_f32 v88, v16, v17
    v_cvt_pk_bf16_f32 v89, v18, v19
    v_exp_f32 v24, v24
    v_exp_f32 v25, v25
    v_exp_f32 v26, v26
    v_exp_f32 v27, v27
    v_mfma_f32_32x32x16_bf16 v[32:47], v[116:119], v[84:87], v[32:47]
    v_cvt_pk_bf16_f32 v90, v20, v21
    v_cvt_pk_bf16_f32 v91, v22, v23
    v_exp_f32 v28, v28
    v_exp_f32 v29, v29
    v_exp_f32 v30, v30
    v_exp_f32 v31, v31
    v_cvt_pk_bf16_f32 v92, v24, v25
    v_cvt_pk_bf16_f32 v93, v26, v27
    v_cvt_pk_bf16_f32 v94, v28, v29
    v_cvt_pk_bf16_f32 v95, v30, v31
    s_nop 4
    s_mov_b64 exec, s[56:57]
    ds_read_b128 v[128:131], v144 offset:768
    ds_read_b128 v[132:135], v145 offset:768
    s_mov_b64 exec, s[54:55]
    ds_read_b128 v[116:119], v137 offset:1536
    s_mov_b64 exec, -1
    ds_read_b128 v[112:115], v136 offset:1536
    s_waitcnt lgkmcnt(4)
    v_mfma_f32_32x32x16_bf16 v[64:79], v[120:123], v[88:91], v[64:79]
    v_exp_f32 v32, v32
    v_exp_f32 v33, v33
    v_exp_f32 v34, v34
    v_exp_f32 v35, v35
    v_mfma_f32_32x32x16_bf16 v[16:31], v[104:107], v[80:83], v[48:63]
    v_exp_f32 v36, v36
    v_exp_f32 v37, v37
    v_exp_f32 v38, v38
    v_exp_f32 v39, v39
    v_mfma_f32_32x32x16_bf16 v[64:79], v[124:127], v[92:95], v[64:79]
    v_cvt_pk_bf16_f32 v96, v32, v33
    v_cvt_pk_bf16_f32 v97, v34, v35
    v_exp_f32 v40, v40
    v_exp_f32 v41, v41
    v_exp_f32 v42, v42
    v_exp_f32 v43, v43
    v_mfma_f32_32x32x16_bf16 v[16:31], v[108:111], v[84:87], v[16:31]
    v_cvt_pk_bf16_f32 v98, v36, v37
    v_cvt_pk_bf16_f32 v99, v38, v39
    v_exp_f32 v44, v44
    v_exp_f32 v45, v45
    v_exp_f32 v46, v46
    v_exp_f32 v47, v47
    v_cvt_pk_bf16_f32 v100, v40, v41
    v_cvt_pk_bf16_f32 v101, v42, v43
    v_cvt_pk_bf16_f32 v102, v44, v45
    v_cvt_pk_bf16_f32 v103, v46, v47
    s_nop 4
    v_add_u32 v138, s38, v138
    v_add_u32 v139, s38, v139
    v_add_u32 v140, s38, v140
    v_add_u32 v141, s38, v141
    v_add_u32 v142, s38, v142
    v_add_u32 v143, s38, v143
    v_add_u32 v144, s38, v144
    v_add_u32 v145, s38, v145
    s_sub_u32 s38, 0, s38
    s_add_u32 s31, s31, 1
    s_cmp_lt_u32 s31, 4
    s_cbranch_scc1 at_chunkf
    s_waitcnt lgkmcnt(0)
    v_mfma_f32_32x32x16_bf16 v[64:79], v[128:131], v[96:99], v[64:79]
    v_mfma_f32_32x32x16_bf16 v[64:79], v[132:135], v[100:103], v[64:79]
    s_nop 15
    s_nop 3
    s_mov_b64 s[40:41], 0
    v_mov_b32 v150, 0x71800000
    v_cmp_nlt_f32_e64 vcc, |v64|, v150
    s_or_b64 s[40:41], s[40:41], vcc
    v_cmp_nlt_f32_e64 vcc, |v65|, v150
    s_or_b64 s[40:41], s[40:41], vcc
    v_cmp_nlt_f32_e64 vcc, |v66|, v150
    s_or_b64 s[40:41], s[40:41], vcc
    v_cmp_nlt_f32_e64 vcc, |v67|, v150
    s_or_b64 s[40:41], s[40:41], vcc
    v_cmp_nlt_f32_e64 vcc, |v68|, v150
    s_or_b64 s[40:41], s[40:41], vcc
    v_cmp_nlt_f32_e64 vcc, |v69|, v150
    s_or_b64 s[40:41], s[40:41], vcc
    v_cmp_nlt_f32_e64 vcc, |v70|, v150
    s_or_b64 s[40:41], s[40:41], vcc
    v_cmp_nlt_f32_e64 vcc, |v71|, v150
    s_or_b64 s[40:41], s[40:41], vcc
    v_cmp_nlt_f32_e64 vcc, |v72|, v150
    s_or_b64 s[40:41], s[40:41], vcc
    v_cmp_nlt_f32_e64 vcc, |v73|, v150
    s_or_b64 s[40:41], s[40:41], vcc
    v_cmp_nlt_f32_e64 vcc, |v74|, v150
    s_or_b64 s[40:41], s[40:41], vcc
    s_cmp_eq_u64 s[40:41], 0
    s_cbranch_scc1 at_fine
    v_mov_b32 v156, 1
    ds_write_b32 v155, v156 offset:8
    s_waitcnt lgkmcnt(0)
at_fine:
    s_add_u32 s58, s58, 8
    v_mov_b32 v156, 1
    s_mov_b64 exec, 1
    ds_add_u32 v155, v156 offset:0
sy4:
    ds_read_b32 v156, v155 offset:0
    s_waitcnt lgkmcnt(0)
    v_readfirstlane_b32 s59, v156
    s_cmp_ge_u32 s59, s58
    s_cbranch_scc1 sd4
    s_sleep 1
    s_branch sy4
sd4:
    s_mov_b64 exec, -1
    ds_read_b32 v156, v155 offset:8
    s_waitcnt lgkmcnt(0)
    v_readfirstlane_b32 s59, v156
    s_cmp_eq_u32 s59, 0
    s_cbranch_scc1 at_epi
    v_and_b32 v2, 31, v1
    v_lshrrev_b32 v3, 5, v1
    s_mov_b32 s37, 44032
    s_mov_b32 s38, 44032
    s_mov_b32 s39, 44032
    s_mul_i32 s27, s24, 98304
    s_mov_b32 s28, 0
    s_mul_i32 s29, s26, 3072
    s_lshl_b32 s30, s26, 11
    s_add_u32 s30, s30, 24576
    s_mov_b32 m0, s29
    s_nop 0
    buffer_load_dwordx4 v146, s[4:7], s27 offen offset:0 lds
    buffer_load_dwordx4 v146, s[4:7], s27 offen offset:1024 lds
    buffer_load_dwordx4 v146, s[4:7], s27 offen offset:2048 lds
    s_mov_b32 m0, s30
    s_nop 0
    buffer_load_dwordx4 v147, s[8:11], s28 offen lds
    s_add_u32 m0, s30, 1024
    s_nop 0
    buffer_load_dwordx4 v148, s[8:11], s28 offen lds
    s_cmp_ge_u32 s26, 2
    s_cbranch_scc1 at_dskipas
    s_lshl_b32 s33, s26, 10
    s_sub_u32 s33, s30, s33
    s_add_u32 m0, s33, 16384
    s_nop 0
    buffer_load_dwordx4 v149, s[8:11], s28 offen lds
at_dskipas:
    s_add_u32 s27, s27, 24576
    s_add_u32 s28, s28, 1024
    s_add_u32 s29, s29, s39
    s_add_u32 s30, s30, s39
    s_sub_u32 s39, 0, s39
    s_mov_b32 m0, s29
    s_nop 0
    buffer_load_dwordx4 v146, s[4:7], s27 offen offset:0 lds
    buffer_load_dwordx4 v146, s[4:7], s27 offen offset:1024 lds
    buffer_load_dwordx4 v146, s[4:7], s27 offen offset:2048 lds
    s_mov_b32 m0, s30
    s_nop 0
    buffer_load_dwordx4 v147, s[8:11], s28 offen lds
    s_add_u32 m0, s30, 1024
    s_nop 0
    buffer_load_dwordx4 v148, s[8:11], s28 offen lds
    s_cmp_ge_u32 s26, 2
    s_cbranch_scc1 at_dskipbs
    s_lshl_b32 s33, s26, 10
    s_sub_u32 s33, s30, s33
    s_add_u32 m0, s33, 16384
    s_nop 0
    buffer_load_dwordx4 v149, s[8:11], s28 offen lds
at_dskipbs:
    s_add_u32 s27, s27, 24576
    s_add_u32 s28, s28, 1024
    s_add_u32 s29, s29, s39
    s_add_u32 s30, s30, s39
    s_sub_u32 s39, 0, s39
    v_mul_u32_u24 v137, 48, v2
    v_lshl_add_u32 v136, v3, 4, v137
    v_add_u32 v137, 32, v137
    v_min_u32 v4, 18, v2
    v_and_b32 v5, 15, v4
    v_lshlrev_b32 v4, 10, v4
    v_add_u32 v4, 24576, v4
    v_add_u32 v6, 0, v3
    v_xor_b32 v6, v6, v5
    v_lshl_add_u32 v138, v6, 4, v4
    v_add_u32 v6, 2, v3
    v_xor_b32 v6, v6, v5
    v_lshl_add_u32 v139, v6, 4, v4
    v_add_u32 v6, 4, v3
    v_xor_b32 v6, v6, v5
    v_lshl_add_u32 v140, v6, 4, v4
    v_add_u32 v6, 6, v3
    v_xor_b32 v6, v6, v5
    v_lshl_add_u32 v141, v6, 4, v4
    v_add_u32 v6, 8, v3
    v_xor_b32 v6, v6, v5
    v_lshl_add_u32 v142, v6, 4, v4
    v_add_u32 v6, 10, v3
    v_xor_b32 v6, v6, v5
    v_lshl_add_u32 v143, v6, 4, v4
    v_add_u32 v6, 12, v3
    v_xor_b32 v6, v6, v5
    v_lshl_add_u32 v144, v6, 4, v4
    v_add_u32 v6, 14, v3
    v_xor_b32 v6, v6, v5
    v_lshl_add_u32 v145, v6, 4, v4
    v_mov_b32 v48, 0
    v_mov_b32 v64, 0
    v_mov_b32 v88, 0
    v_mov_b32 v120, 0
    v_mov_b32 v49, 0
    v_mov_b32 v65, 0
    v_mov_b32 v89, 0
    v_mov_b32 v121, 0
    v_mov_b32 v50, 0
    v_mov_b32 v66, 0
    v_mov_b32 v90, 0
    v_mov_b32 v122, 0
    v_mov_b32 v51, 0
    v_mov_b32 v67, 0
    v_mov_b32 v91, 0
    v_mov_b32 v123, 0
    v_mov_b32 v52, 0
    v_mov_b32 v68, 0
    v_mov_b32 v92, 0
    v_mov_b32 v124, 0
    v_mov_b32 v53, 0
    v_mov_b32 v69, 0
    v_mov_b32 v93, 0
    v_mov_b32 v125, 0
    v_mov_b32 v54, 0
    v_mov_b32 v70, 0
    v_mov_b32 v94, 0
    v_mov_b32 v126, 0
    v_mov_b32 v55, 0
    v_mov_b32 v71, 0
    v_mov_b32 v95, 0
    v_mov_b32 v127, 0
    v_mov_b32 v56, 0
    v_mov_b32 v72, 0
    v_mov_b32 v96, 0
    v_mov_b32 v128, 0
    v_mov_b32 v57, 0
    v_mov_b32 v73, 0
    v_mov_b32 v97, 0
    v_mov_b32 v129, 0
    v_mov_b32 v58, 0
    v_mov_b32 v74, 0
    v_mov_b32 v98, 0
    v_mov_b32 v130, 0
    v_mov_b32 v59, 0
    v_mov_b32 v75, 0
    v_mov_b32 v99, 0
    v_mov_b32 v131, 0
    v_mov_b32 v60, 0
    v_mov_b32 v76, 0
    v_mov_b32 v100, 0
    v_mov_b32 v132, 0
    v_mov_b32 v61, 0
    v_mov_b32 v77, 0
    v_mov_b32 v101, 0
    v_mov_b32 v133, 0
    v_mov_b32 v62, 0
    v_mov_b32 v78, 0
    v_mov_b32 v102, 0
    v_mov_b32 v134, 0
    v_mov_b32 v63, 0
    v_mov_b32 v79, 0
    v_mov_b32 v103, 0
    v_mov_b32 v135, 0
    s_mov_b32 s32, 0x41200000
    s_mov_b32 s56, 0x7ffff
    s_mov_b32 s57, 0x7ffff
    s_mov_b32 s54, -1
    s_mov_b32 s55, 0
    s_waitcnt vmcnt(5) lgkmcnt(0)
    s_add_u32 s58, s58, 8
    v_mov_b32 v156, 1
    s_mov_b64 exec, 1
    ds_add_u32 v155, v156 offset:0
sy5:
    ds_read_b32 v156, v155 offset:0
    s_waitcnt lgkmcnt(0)
    v_readfirstlane_b32 s59, v156
    s_cmp_ge_u32 s59, s58
    s_cbranch_scc1 sd5
    s_sleep 1
    s_branch sy5
sd5:
    s_mov_b64 exec, -1
    ds_read_b128 v[104:107], v136 offset:0
    ds_read_b128 v[108:111], v137 offset:0
    ds_read_b128 v[112:115], v136 offset:1536
    ds_read_b128 v[116:119], v137 offset:1536
    s_waitcnt lgkmcnt(2)
    v_mfma_f32_32x32x16_bf16 v[16:31], v[104:107], v[80:83], v[48:63]
    v_mfma_f32_32x32x16_bf16 v[16:31], v[108:111], v[84:87], v[16:31]
    s_nop 15
    s_nop 3
    v_max3_f32 v150, v16, v17, v18
    v_max3_f32 v151, v19, v20, v21
    v_max3_f32 v152, v22, v23, v24
    v_max3_f32 v153, v25, v26, v27
    v_max3_f32 v150, v150, v28, v29
    v_max3_f32 v151, v151, v30, v31
    v_max3_f32 v150, v150, v151, v152
    v_max_f32 v154, v150, v153
    v_mov_b32 v150, v154
    s_nop 1
    v_permlane32_swap_b32 v150, v154
    s_nop 1
    v_max_f32 v154, v154, v150
    v_sub_f32 v150, 0, v154
    v_mov_b32 v48, v150
    v_mov_b32 v49, v150
    v_mov_b32 v50, v150
    v_mov_b32 v51, v150
    v_mov_b32 v52, v150
    v_mov_b32 v53, v150
    v_mov_b32 v54, v150
    v_mov_b32 v55, v150
    v_mov_b32 v56, v150
    v_mov_b32 v57, v150
    v_mov_b32 v58, v150
    v_mov_b32 v59, v150
    v_mov_b32 v60, v150
    v_mov_b32 v61, v150
    v_mov_b32 v62, v150
    v_mov_b32 v63, v150
    s_nop 1
    v_mfma_f32_32x32x16_bf16 v[16:31], v[104:107], v[80:83], v[48:63]
    v_mfma_f32_32x32x16_bf16 v[16:31], v[108:111], v[84:87], v[16:31]
    s_nop 15
    s_mov_b32 s31, 0
at_chunks:
    s_mov_b64 exec, s[56:57]
    ds_read_b128 v[120:123], v138 offset:0
    ds_read_b128 v[124:127], v139 offset:0
    s_mov_b64 exec, s[54:55]
    ds_read_b128 v[108:111], v137 offset:3072
    s_mov_b64 exec, -1
    ds_read_b128 v[104:107], v136 offset:3072
    v_max3_f32 v150, v16, v17, v18
    v_max3_f32 v151, v19, v20, v21
    v_max3_f32 v152, v22, v23, v24
    v_max3_f32 v153, v25, v26, v27
    v_max3_f32 v150, v150, v28, v29
    v_max3_f32 v151, v151, v30, v31
    v_max3_f32 v150, v150, v151, v152
    v_max_f32 v154, v150, v153
    v_cmp_lt_f32 vcc, s32, v154
    s_cbranch_vccnz at_slow0
at_back0:
    s_waitcnt lgkmcnt(4)
    v_mfma_f32_32x32x16_bf16 v[64:79], v[128:131], v[96:99], v[64:79]
    v_exp_f32 v16, v16
    v_exp_f32 v17, v17
    v_exp_f32 v18, v18
    v_exp_f32 v19, v19
    v_mfma_f32_32x32x16_bf16 v[32:47], v[112:115], v[80:83], v[48:63]
    v_exp_f32 v20, v20
    v_exp_f32 v21, v21
    v_exp_f32 v22, v22
    v_exp_f32 v23, v23
    v_mfma_f32_32x32x16_bf16 v[64:79], v[132:135], v[100:103], v[64:79]
    v_cvt_pk_bf16_f32 v88, v16, v17
    v_cvt_pk_bf16_f32 v89, v18, v19
    v_exp_f32 v24, v24
    v_exp_f32 v25, v25
    v_exp_f32 v26, v26
    v_exp_f32 v27, v27
    v_mfma_f32_32x32x16_bf16 v[32:47], v[116:119], v[84:87], v[32:47]
    v_cvt_pk_bf16_f32 v90, v20, v21
    v_cvt_pk_bf16_f32 v91, v22, v23
    v_exp_f32 v28, v28
    v_exp_f32 v29, v29
    v_exp_f32 v30, v30
    v_exp_f32 v31, v31
    v_cvt_pk_bf16_f32 v92, v24, v25
    v_cvt_pk_bf16_f32 v93, v26, v27
    v_cvt_pk_bf16_f32 v94, v28, v29
    v_cvt_pk_bf16_f32 v95, v30, v31
    s_nop 1
    s_cmp_eq_u32 s31, 0
    s_cbranch_scc1 at_nbas
    s_cmp_eq_u32 s31, 3
    s_cbranch_scc1 at_nbas
    v_mov_b32 v156, 1
    s_mov_b64 exec, 1
    ds_add_u32 v155, v156 offset:0
    s_mov_b64 exec, -1
at_nbas:
    s_mov_b64 exec, s[56:57]
    ds_read_b128 v[128:131], v140 offset:0
    ds_read_b128 v[132:135], v141 offset:0
    s_mov_b64 exec, s[54:55]
    ds_read_b128 v[116:119], v137 offset:4608
    s_mov_b64 exec, -1
    ds_read_b128 v[112:115], v136 offset:4608
    v_max3_f32 v150, v32, v33, v34
    v_max3_f32 v151, v35, v36, v37
    v_max3_f32 v152, v38, v39, v40
    v_max3_f32 v153, v41, v42, v43
    v_max3_f32 v150, v150, v44, v45
    v_max3_f32 v151, v151, v46, v47
    v_max3_f32 v150, v150, v151, v152
    v_max_f32 v154, v150, v153
    v_cmp_lt_f32 vcc, s32, v154
    s_cbranch_vccnz at_slow1
at_back1:
    s_waitcnt lgkmcnt(4)
    v_mfma_f32_32x32x16_bf16 v[64:79], v[120:123], v[88:91], v[64:79]
    v_exp_f32 v32, v32
    v_exp_f32 v33, v33
    v_exp_f32 v34, v34
    v_exp_f32 v35, v35
    v_mfma_f32_32x32x16_bf16 v[16:31], v[104:107], v[80:83], v[48:63]
    v_exp_f32 v36, v36
    v_exp_f32 v37, v37
    v_exp_f32 v38, v38
    v_exp_f32 v39, v39
    v_mfma_f32_32x32x16_bf16 v[64:79], v[124:127], v[92:95], v[64:79]
    v_cvt_pk_bf16_f32 v96, v32, v33
    v_cvt_pk_bf16_f32 v97, v34, v35
    v_exp_f32 v40, v40
    v_exp_f32 v41, v41
    v_exp_f32 v42, v42
    v_exp_f32 v43, v43
    v_mfma_f32_32x32x16_bf16 v[16:31], v[108:111], v[84:87], v[16:31]
    v_cvt_pk_bf16_f32 v98, v36, v37
    v_cvt_pk_bf16_f32 v99, v38, v39
    v_exp_f32 v44, v44
    v_exp_f32 v45, v45
    v_exp_f32 v46, v46
    v_exp_f32 v47, v47
    v_cvt_pk_bf16_f32 v100, v40, v41
    v_cvt_pk_bf16_f32 v101, v42, v43
    v_cvt_pk_bf16_f32 v102, v44, v45
    v_cvt_pk_bf16_f32 v103, v46, v47
    s_nop 1
    s_mov_b64 exec, s[56:57]
    ds_read_b128 v[120:123], v142 offset:0
    ds_read_b128 v[124:127], v143 offset:0
    s_mov_b64 exec, s[54:55]
    ds_read_b128 v[108:111], v137 offset:6144
    s_mov_b64 exec, -1
    ds_read_b128 v[104:107], v136 offset:6144
    v_max3_f32 v150, v16, v17, v18
    v_max3_f32 v151, v19, v20, v21
    v_max3_f32 v152, v22, v23, v24
    v_max3_f32 v153, v25, v26, v27
    v_max3_f32 v150, v150, v28, v29
    v_max3_f32 v151, v151, v30, v31
    v_max3_f32 v150, v150, v151, v152
    v_max_f32 v154, v150, v153
    v_cmp_lt_f32 vcc, s32, v154
    s_cbranch_vccnz at_slow2
at_back2:
    s_waitcnt lgkmcnt(4)
    v_mfma_f32_32x32x16_bf16 v[64:79], v[128:131], v[96:99], v[64:79]
    v_exp_f32 v16, v16
    v_exp_f32 v17, v17
    v_exp_f32 v18, v18
    v_exp_f32 v19, v19
    v_mfma_f32_32x32x16_bf16 v[32:47], v[112:115], v[80:83], v[48:63]
    v_exp_f32 v20, v20
    v_exp_f32 v21, v21
    v_exp_f32 v22, v22
    v_exp_f32 v23, v23
    v_mfma_f32_32x32x16_bf16 v[64:79], v[132:135], v[100:103], v[64:79]
    v_cvt_pk_bf16_f32 v88, v16, v17
    v_cvt_pk_bf16_f32 v89, v18, v19
    v_exp_f32 v24, v24
    v_exp_f32 v25, v25
    v_exp_f32 v26, v26
    v_exp_f32 v27, v27
    v_mfma_f32_32x32x16_bf16 v[32:47], v[116:119], v[84:87], v[32:47]
    v_cvt_pk_bf16_f32 v90, v20, v21
    v_cvt_pk_bf16_f32 v91, v22, v23
    v_exp_f32 v28, v28
    v_exp_f32 v29, v29
    v_exp_f32 v30, v30
    v_exp_f32 v31, v31
    v_cvt_pk_bf16_f32 v92, v24, v25
    v_cvt_pk_bf16_f32 v93, v26, v27
    v_cvt_pk_bf16_f32 v94, v28, v29
    v_cvt_pk_bf16_f32 v95, v30, v31
    s_nop 1
    s_mov_b64 exec, s[56:57]
    ds_read_b128 v[128:131], v144 offset:0
    ds_read_b128 v[132:135], v145 offset:0
    s_mov_b64 exec, s[54:55]
    ds_read_b128 v[116:119], v137 offset:7680
    s_mov_b64 exec, -1
    ds_read_b128 v[112:115], v136 offset:7680
    v_max3_f32 v150, v32, v33, v34
    v_max3_f32 v151, v35, v36, v37
    v_max3_f32 v152, v38, v39, v40
    v_max3_f32 v153, v41, v42, v43
    v_max3_f32 v150, v150, v44, v45
    v_max3_f32 v151, v151, v46, v47
    v_max3_f32 v150, v150, v151, v152
    v_max_f32 v154, v150, v153
    v_cmp_lt_f32 vcc, s32, v154
    s_cbranch_vccnz at_slow3
at_back3:
    s_waitcnt lgkmcnt(4)
    v_mfma_f32_32x32x16_bf16 v[64:79], v[120:123], v[88:91], v[64:79]
    v_exp_f32 v32, v32
    v_exp_f32 v33, v33
    v_exp_f32 v34, v34
    v_exp_f32 v35, v35
    v_mfma_f32_32x32x16_bf16 v[16:31], v[104:107], v[80:83], v[48:63]
    v_exp_f32 v36, v36
    v_exp_f32 v37, v37
    v_exp_f32 v38, v38
    v_exp_f32 v39, v39
    v_mfma_f32_32x32x16_bf16 v[64:79], v[124:127], v[92:95], v[64:79]
    v_cvt_pk_bf16_f32 v96, v32, v33
    v_cvt_pk_bf16_f32 v97, v34, v35
    v_exp_f32 v40, v40
    v_exp_f32 v41, v41
    v_exp_f32 v42, v42
    v_exp_f32 v43, v43
    v_mfma_f32_32x32x16_bf16 v[16:31], v[108:111], v[84:87], v[16:31]
    v_cvt_pk_bf16_f32 v98, v36, v37
    v_cvt_pk_bf16_f32 v99, v38, v39
    v_exp_f32 v44, v44
    v_exp_f32 v45, v45
    v_exp_f32 v46, v46
    v_exp_f32 v47, v47
    v_cvt_pk_bf16_f32 v100, v40, v41
    v_cvt_pk_bf16_f32 v101, v42, v43
    v_cvt_pk_bf16_f32 v102, v44, v45
    v_cvt_pk_bf16_f32 v103, v46, v47
    s_nop 1
    s_cmp_eq_u32 s31, 0
    s_cbranch_scc1 at_nb1s
    s_cmp_eq_u32 s31, 3
    s_cbranch_scc1 at_nb1s
    s_add_u32 s58, s58, 8
sy6:
    ds_read_b32 v156, v155 offset:0
    s_waitcnt lgkmcnt(0)
    v_readfirstlane_b32 s59, v156
    s_cmp_ge_u32 s59, s58
    s_cbranch_scc1 sd6
    s_sleep 1
    s_branch sy6
sd6:
    s_mov_b32 m0, s29
    s_nop 0
    buffer_load_dwordx4 v146, s[4:7], s27 offen offset:0 lds
    buffer_load_dwordx4 v146, s[4:7], s27 offen offset:1024 lds
    buffer_load_dwordx4 v146, s[4:7], s27 offen offset:2048 lds
    s_mov_b32 m0, s30
    s_nop 0
    buffer_load_dwordx4 v147, s[8:11], s28 offen lds
    s_add_u32 m0, s30, 1024
    s_nop 0
    buffer_load_dwordx4 v148, s[8:11], s28 offen lds
    s_cmp_ge_u32 s26, 2
    s_cbranch_scc1 at_dskipcs
    s_lshl_b32 s33, s26, 10
    s_sub_u32 s33, s30, s33
    s_add_u32 m0, s33, 16384
    s_nop 0
    buffer_load_dwordx4 v149, s[8:11], s28 offen lds
at_dskipcs:
    s_add_u32 s27, s27, 24576
    s_add_u32 s28, s28, 1024
    s_add_u32 s29, s29, s39
    s_add_u32 s30, s30, s39
    s_sub_u32 s39, 0, s39
at_nb1s:
    s_mov_b64 exec, s[56:57]
    ds_read_b128 v[120:123], v138 offset:256
    ds_read_b128 v[124:127], v139 offset:256
    s_mov_b64 exec, s[54:55]
    ds_read_b128 v[108:111], v137 offset:9216
    s_mov_b64 exec, -1
    ds_read_b128 v[104:107], v136 offset:9216
    v_max3_f32 v150, v16, v17, v18
    v_max3_f32 v151, v19, v20, v21
    v_max3_f32 v152, v22, v23, v24
    v_max3_f32 v153, v25, v26, v27
    v_max3_f32 v150, v150, v28, v29
    v_max3_f32 v151, v151, v30, v31
    v_max3_f32 v150, v150, v151, v152
    v_max_f32 v154, v150, v153
    v_cmp_lt_f32 vcc, s32, v154
    s_cbranch_vccnz at_slow4
at_back4:
    s_waitcnt lgkmcnt(4)
    v_mfma_f32_32x32x16_bf16 v[64:79], v[128:131], v[96:99], v[64:79]
    v_exp_f32 v16, v16
    v_exp_f32 v17, v17
    v_exp_f32 v18, v18
    v_exp_f32 v19, v19
    v_mfma_f32_32x32x16_bf16 v[32:47], v[112:115], v[80:83], v[48:63]
    v_exp_f32 v20, v20
    v_exp_f32 v21, v21
    v_exp_f32 v22, v22
    v_exp_f32 v23, v23
    v_mfma_f32_32x32x16_bf16 v[64:79], v[132:135], v[100:103], v[64:79]
    v_cvt_pk_bf16_f32 v88, v16, v17
    v_cvt_pk_bf16_f32 v89, v18, v19
    v_exp_f32 v24, v24
    v_exp_f32 v25, v25
    v_exp_f32 v26, v26
    v_exp_f32 v27, v27
    v_mfma_f32_32x32x16_bf16 v[32:47], v[116:119], v[84:87], v[32:47]
    v_cvt_pk_bf16_f32 v90, v20, v21
    v_cvt_pk_bf16_f32 v91, v22, v23
    v_exp_f32 v28, v28
    v_exp_f32 v29, v29
    v_exp_f32 v30, v30
    v_exp_f32 v31, v31
    v_cvt_pk_bf16_f32 v92, v24, v25
    v_cvt_pk_bf16_f32 v93, v26, v27
    v_cvt_pk_bf16_f32 v94, v28, v29
    v_cvt_pk_bf16_f32 v95, v30, v31
    s_nop 1
    s_mov_b64 exec, s[56:57]
    ds_read_b128 v[128:131], v140 offset:256
    ds_read_b128 v[132:135], v141 offset:256
    s_mov_b64 exec, s[54:55]
    ds_read_b128 v[116:119], v137 offset:10752
    s_mov_b64 exec, -1
    ds_read_b128 v[112:115], v136 offset:10752
    v_max3_f32 v150, v32, v33, v34
    v_max3_f32 v151, v35, v36, v37
    v_max3_f32 v152, v38, v39, v40
    v_max3_f32 v153, v41, v42, v43
    v_max3_f32 v150, v150, v44, v45
    v_max3_f32 v151, v151, v46, v47
    v_max3_f32 v150, v150, v151, v152
    v_max_f32 v154, v150, v153
    v_cmp_lt_f32 vcc, s32, v154
    s_cbranch_vccnz at_slow5
at_back5:
    s_waitcnt lgkmcnt(4)
    v_mfma_f32_32x32x16_bf16 v[64:79], v[120:123], v[88:91], v[64:79]
    v_exp_f32 v32, v32
    v_exp_f32 v33, v33
    v_exp_f32 v34, v34
    v_exp_f32 v35, v35
    v_mfma_f32_32x32x16_bf16 v[16:31], v[104:107], v[80:83], v[48:63]
    v_exp_f32 v36, v36
    v_exp_f32 v37, v37
    v_exp_f32 v38, v38
    v_exp_f32 v39, v39
    v_mfma_f32_32x32x16_bf16 v[64:79], v[124:127], v[92:95], v[64:79]
    v_cvt_pk_bf16_f32 v96, v32, v33
    v_cvt_pk_bf16_f32 v97, v34, v35
    v_exp_f32 v40, v40
    v_exp_f32 v41, v41
    v_exp_f32 v42, v42
    v_exp_f32 v43, v43
    v_mfma_f32_32x32x16_bf16 v[16:31], v[108:111], v[84:87], v[16:31]
    v_cvt_pk_bf16_f32 v98, v36, v37
    v_cvt_pk_bf16_f32 v99, v38, v39
    v_exp_f32 v44, v44
    v_exp_f32 v45, v45
    v_exp_f32 v46, v46
    v_exp_f32 v47, v47
    v_cvt_pk_bf16_f32 v100, v40, v41
    v_cvt_pk_bf16_f32 v101, v42, v43
    v_cvt_pk_bf16_f32 v102, v44, v45
    v_cvt_pk_bf16_f32 v103, v46, v47
    s_nop 1
    s_mov_b64 exec, s[56:57]
    ds_read_b128 v[120:123], v142 offset:256
    ds_read_b128 v[124:127], v143 offset:256
    s_mov_b64 exec, s[54:55]
    ds_read_b128 v[108:111], v137 offset:12288
    s_mov_b64 exec, -1
    ds_read_b128 v[104:107], v136 offset:12288
    v_max3_f32 v150, v16, v17, v18
    v_max3_f32 v151, v19, v20, v21
    v_max3_f32 v152, v22, v23, v24
    v_max3_f32 v153, v25, v26, v27
    v_max3_f32 v150, v150, v28, v29
    v_max3_f32 v151, v151, v30, v31
    v_max3_f32 v150, v150, v151, v152
    v_max_f32 v154, v150, v153
    v_cmp_lt_f32 vcc, s32, v154
    s_cbranch_vccnz at_slow6
at_back6:
    s_waitcnt lgkmcnt(4)
    v_mfma_f32_32x32x16_bf16 v[64:79], v[128:131], v[96:99], v[64:79]
    v_exp_f32 v16, v16
    v_exp_f32 v17, v17
    v_exp_f32 v18, v18
    v_exp_f32 v19, v19
    v_mfma_f32_32x32x16_bf16 v[32:47], v[112:115], v[80:83], v[48:63]
    v_exp_f32 v20, v20
    v_exp_f32 v21, v21
    v_exp_f32 v22, v22
    v_exp_f32 v23, v23
    v_mfma_f32_32x32x16_bf16 v[64:79], v[132:135], v[100:103], v[64:79]
    v_cvt_pk_bf16_f32 v88, v16, v17
    v_cvt_pk_bf16_f32 v89, v18, v19
    v_exp_f32 v24, v24
    v_exp_f32 v25, v25
    v_exp_f32 v26, v26
    v_exp_f32 v27, v27
    v_mfma_f32_32x32x16_bf16 v[32:47], v[116:119], v[84:87], v[32:47]
    v_cvt_pk_bf16_f32 v90, v20, v21
    v_cvt_pk_bf16_f32 v91, v22, v23
    v_exp_f32 v28, v28
    v_exp_f32 v29, v29
    v_exp_f32 v30, v30
    v_exp_f32 v31, v31
    v_cvt_pk_bf16_f32 v92, v24, v25
    v_cvt_pk_bf16_f32 v93, v26, v27
    v_cvt_pk_bf16_f32 v94, v28, v29
    v_cvt_pk_bf16_f32 v95, v30, v31
    s_nop 1
    s_mov_b64 exec, s[56:57]
    ds_read_b128 v[128:131], v144 offset:256
    ds_read_b128 v[132:135], v145 offset:256
    s_mov_b64 exec, s[54:55]
    ds_read_b128 v[116:119], v137 offset:13824
    s_mov_b64 exec, -1
    ds_read_b128 v[112:115], v136 offset:13824
    v_max3_f32 v150, v32, v33, v34
    v_max3_f32 v151, v35, v36, v37
    v_max3_f32 v152, v38, v39, v40
    v_max3_f32 v153, v41, v42, v43
    v_max3_f32 v150, v150, v44, v45
    v_max3_f32 v151, v151, v46, v47
    v_max3_f32 v150, v150, v151, v152
    v_max_f32 v154, v150, v153
    v_cmp_lt_f32 vcc, s32, v154
    s_cbranch_vccnz at_slow7
at_back7:
    s_waitcnt lgkmcnt(4)
    v_mfma_f32_32x32x16_bf16 v[64:79], v[120:123], v[88:91], v[64:79]
    v_exp_f32 v32, v32
    v_exp_f32 v33, v33
    v_exp_f32 v34, v34
    v_exp_f32 v35, v35
    v_mfma_f32_32x32x16_bf16 v[16:31], v[104:107], v[80:83], v[48:63]
    v_exp_f32 v36, v36
    v_exp_f32 v37, v37
    v_exp_f32 v38, v38
    v_exp_f32 v39, v39
    v_mfma_f32_32x32x16_bf16 v[64:79], v[124:127], v[92:95], v[64:79]
    v_cvt_pk_bf16_f32 v96, v32, v33
    v_cvt_pk_bf16_f32 v97, v34, v35
    v_exp_f32 v40, v40
    v_exp_f32 v41, v41
    v_exp_f32 v42, v42
    v_exp_f32 v43, v43
    v_mfma_f32_32x32x16_bf16 v[16:31], v[108:111], v[84:87], v[16:31]
    v_cvt_pk_bf16_f32 v98, v36, v37
    v_cvt_pk_bf16_f32 v99, v38, v39
    v_exp_f32 v44, v44
    v_exp_f32 v45, v45
    v_exp_f32 v46, v46
    v_exp_f32 v47, v47
    v_cvt_pk_bf16_f32 v100, v40, v41
    v_cvt_pk_bf16_f32 v101, v42, v43
    v_cvt_pk_bf16_f32 v102, v44, v45
    v_cvt_pk_bf16_f32 v103, v46, v47
    s_nop 1
    s_mov_b64 exec, s[56:57]
    ds_read_b128 v[120:123], v138 offset:512
    ds_read_b128 v[124:127], v139 offset:512
    s_mov_b64 exec, s[54:55]
    ds_read_b128 v[108:111], v137 offset:15360
    s_mov_b64 exec, -1
    ds_read_b128 v[104:107], v136 offset:15360
    v_max3_f32 v150, v16, v17, v18
    v_max3_f32 v151, v19, v20, v21
    v_max3_f32 v152, v22, v23, v24
    v_max3_f32 v153, v25, v26, v27
    v_max3_f32 v150, v150, v28, v29
    v_max3_f32 v151, v151, v30, v31
    v_max3_f32 v150, v150, v151, v152
    v_max_f32 v154, v150, v153
    v_cmp_lt_f32 vcc, s32, v154
    s_cbranch_vccnz at_slow8
at_back8:
    s_waitcnt lgkmcnt(4)
    v_mfma_f32_32x32x16_bf16 v[64:79], v[128:131], v[96:99], v[64:79]
    v_exp_f32 v16, v16
    v_exp_f32 v17, v17
    v_exp_f32 v18, v18
    v_exp_f32 v19, v19
    v_mfma_f32_32x32x16_bf16 v[32:47], v[112:115], v[80:83], v[48:63]
    v_exp_f32 v20, v20
    v_exp_f32 v21, v21
    v_exp_f32 v22, v22
    v_exp_f32 v23, v23
    v_mfma_f32_32x32x16_bf16 v[64:79], v[132:135], v[100:103], v[64:79]
    v_cvt_pk_bf16_f32 v88, v16, v17
    v_cvt_pk_bf16_f32 v89, v18, v19
    v_exp_f32 v24, v24
    v_exp_f32 v25, v25
    v_exp_f32 v26, v26
    v_exp_f32 v27, v27
    v_mfma_f32_32x32x16_bf16 v[32:47], v[116:119], v[84:87], v[32:47]
    v_cvt_pk_bf16_f32 v90, v20, v21
    v_cvt_pk_bf16_f32 v91, v22, v23
    v_exp_f32 v28, v28
    v_exp_f32 v29, v29
    v_exp_f32 v30, v30
    v_exp_f32 v31, v31
    v_cvt_pk_bf16_f32 v92, v24, v25
    v_cvt_pk_bf16_f32 v93, v26, v27
    v_cvt_pk_bf16_f32 v94, v28, v29
    v_cvt_pk_bf16_f32 v95, v30, v31
    s_nop 1
    s_mov_b64 exec, s[56:57]
    ds_read_b128 v[128:131], v140 offset:512
    ds_read_b128 v[132:135], v141 offset:512
    s_mov_b64 exec, s[54:55]
    ds_read_b128 v[116:119], v137 offset:16896
    s_mov_b64 exec, -1
    ds_read_b128 v[112:115], v136 offset:16896
    v_max3_f32 v150, v32, v33, v34
    v_max3_f32 v151, v35, v36, v37
    v_max3_f32 v152, v38, v39, v40
    v_max3_f32 v153, v41, v42, v43
    v_max3_f32 v150, v150, v44, v45
    v_max3_f32 v151, v151, v46, v47
    v_max3_f32 v150, v150, v151, v152
    v_max_f32 v154, v150, v153
    v_cmp_lt_f32 vcc, s32, v154
    s_cbranch_vccnz at_slow9
at_back9:
    s_waitcnt lgkmcnt(4)
    v_mfma_f32_32x32x16_bf16 v[64:79], v[120:123], v[88:91], v[64:79]
    v_exp_f32 v32, v32
    v_exp_f32 v33, v33
    v_exp_f32 v34, v34
    v_exp_f32 v35, v35
    v_mfma_f32_32x32x16_bf16 v[16:31], v[104:107], v[80:83], v[48:63]
    v_exp_f32 v36, v36
    v_exp_f32 v37, v37
    v_exp_f32 v38, v38
    v_exp_f32 v39, v39
    v_mfma_f32_32x32x16_bf16 v[64:79], v[124:127], v[92:95], v[64:79]
    v_cvt_pk_bf16_f32 v96, v32, v33
    v_cvt_pk_bf16_f32 v97, v34, v35
    v_exp_f32 v40, v40
    v_exp_f32 v41, v41
    v_exp_f32 v42, v42
    v_exp_f32 v43, v43
    v_mfma_f32_32x32x16_bf16 v[16:31], v[108:111], v[84:87], v[16:31]
    v_cvt_pk_bf16_f32 v98, v36, v37
    v_cvt_pk_bf16_f32 v99, v38, v39
    v_exp_f32 v44, v44
    v_exp_f32 v45, v45
    v_exp_f32 v46, v46
    v_exp_f32 v47, v47
    v_cvt_pk_bf16_f32 v100, v40, v41
    v_cvt_pk_bf16_f32 v101, v42, v43
    v_cvt_pk_bf16_f32 v102, v44, v45
    v_cvt_pk_bf16_f32 v103, v46, v47
    s_nop 1
    s_mov_b64 exec, s[56:57]
    ds_read_b128 v[120:123], v142 offset:512
    ds_read_b128 v[124:127], v143 offset:512
    s_mov_b64 exec, s[54:55]
    ds_read_b128 v[108:111], v137 offset:18432
    s_mov_b64 exec, -1
    ds_read_b128 v[104:107], v136 offset:18432
    v_max3_f32 v150, v16, v17, v18
    v_max3_f32 v151, v19, v20, v21
    v_max3_f32 v152, v22, v23, v24
    v_max3_f32 v153, v25, v26, v27
    v_max3_f32 v150, v150, v28, v29
    v_max3_f32 v151, v151, v30, v31
    v_max3_f32 v150, v150, v151, v152
    v_max_f32 v154, v150, v153
    v_cmp_lt_f32 vcc, s32, v154
    s_cbranch_vccnz at_slow10
at_back10:
    s_waitcnt lgkmcnt(4)
    v_mfma_f32_32x32x16_bf16 v[64:79], v[128:131], v[96:99], v[64:79]
    v_exp_f32 v16, v16
    v_exp_f32 v17, v17
    v_exp_f32 v18, v18
    v_exp_f32 v19, v19
    v_mfma_f32_32x32x16_bf16 v[32:47], v[112:115], v[80:83], v[48:63]
    v_exp_f32 v20, v20
    v_exp_f32 v21, v21
    v_exp_f32 v22, v22
    v_exp_f32 v23, v23
    v_mfma_f32_32x32x16_bf16 v[64:79], v[132:135], v[100:103], v[64:79]
    v_cvt_pk_bf16_f32 v88, v16, v17
    v_cvt_pk_bf16_f32 v89, v18, v19
    v_exp_f32 v24, v24
    v_exp_f32 v25, v25
    v_exp_f32 v26, v26
    v_exp_f32 v27, v27
    v_mfma_f32_32x32x16_bf16 v[32:47], v[116:119], v[84:87], v[32:47]
    v_cvt_pk_bf16_f32 v90, v20, v21
    v_cvt_pk_bf16_f32 v91, v22, v23
    v_exp_f32 v28, v28
    v_exp_f32 v29, v29
    v_exp_f32 v30, v30
    v_exp_f32 v31, v31
    v_cvt_pk_bf16_f32 v92, v24, v25
    v_cvt_pk_bf16_f32 v93, v26, v27
    v_cvt_pk_bf16_f32 v94, v28, v29
    v_cvt_pk_bf16_f32 v95, v30, v31
    s_nop 1
    s_cmp_eq_u32 s31, 3
    s_cbranch_scc1 at_nbbs
    s_waitcnt vmcnt(0)
    v_mov_b32 v156, 1
    s_mov_b64 exec, 1
    ds_add_u32 v155, v156 offset:0
    s_mov_b64 exec, -1
at_nbbs:
    s_mov_b64 exec, s[56:57]
    ds_read_b128 v[128:131], v144 offset:512
    ds_read_b128 v[132:135], v145 offset:512
    s_mov_b64 exec, s[54:55]
    ds_read_b128 v[116:119], v137 offset:19968
    s_mov_b64 exec, -1
    ds_read_b128 v[112:115], v136 offset:19968
    v_max3_f32 v150, v32, v33, v34
    v_max3_f32 v151, v35, v36, v37
    v_max3_f32 v152, v38, v39, v40
    v_max3_f32 v153, v41, v42, v43
    v_max3_f32 v150, v150, v44, v45
    v_max3_f32 v151, v151, v46, v47
    v_max3_f32 v150, v150, v151, v152
    v_max_f32 v154, v150, v153
    v_cmp_lt_f32 vcc, s32, v154
    s_cbranch_vccnz at_slow11
at_back11:
    s_waitcnt lgkmcnt(4)
    v_mfma_f32_32x32x16_bf16 v[64:79], v[120:123], v[88:91], v[64:79]
    v_exp_f32 v32, v32
    v_exp_f32 v33, v33
    v_exp_f32 v34, v34
    v_exp_f32 v35, v35
    v_mfma_f32_32x32x16_bf16 v[16:31], v[104:107], v[80:83], v[48:63]
    v_exp_f32 v36, v36
    v_exp_f32 v37, v37
    v_exp_f32 v38, v38
    v_exp_f32 v39, v39
    v_mfma_f32_32x32x16_bf16 v[64:79], v[124:127], v[92:95], v[64:79]
    v_cvt_pk_bf16_f32 v96, v32, v33
    v_cvt_pk_bf16_f32 v97, v34, v35
    v_exp_f32 v40, v40
    v_exp_f32 v41, v41
    v_exp_f32 v42, v42
    v_exp_f32 v43, v43
    v_mfma_f32_32x32x16_bf16 v[16:31], v[108:111], v[84:87], v[16:31]
    v_cvt_pk_bf16_f32 v98, v36, v37
    v_cvt_pk_bf16_f32 v99, v38, v39
    v_exp_f32 v44, v44
    v_exp_f32 v45, v45
    v_exp_f32 v46, v46
    v_exp_f32 v47, v47
    v_cvt_pk_bf16_f32 v100, v40, v41
    v_cvt_pk_bf16_f32 v101, v42, v43
    v_cvt_pk_bf16_f32 v102, v44, v45
    v_cvt_pk_bf16_f32 v103, v46, v47
    s_nop 1
    s_mov_b64 exec, s[56:57]
    ds_read_b128 v[120:123], v138 offset:768
    ds_read_b128 v[124:127], v139 offset:768
    s_mov_b64 exec, s[54:55]
    ds_read_b128 v[108:111], v137 offset:21504
    s_mov_b64 exec, -1
    ds_read_b128 v[104:107], v136 offset:21504
    v_max3_f32 v150, v16, v17, v18
    v_max3_f32 v151, v19, v20, v21
    v_max3_f32 v152, v22, v23, v24
    v_max3_f32 v153, v25, v26, v27
    v_max3_f32 v150, v150, v28, v29
    v_max3_f32 v151, v151, v30, v31
    v_max3_f32 v150, v150, v151, v152
    v_max_f32 v154, v150, v153
    v_cmp_lt_f32 vcc, s32, v154
    s_cbranch_vccnz at_slow12
at_back12:
    s_waitcnt lgkmcnt(4)
    v_mfma_f32_32x32x16_bf16 v[64:79], v[128:131], v[96:99], v[64:79]
    v_exp_f32 v16, v16
    v_exp_f32 v17, v17
    v_exp_f32 v18, v18
    v_exp_f32 v19, v19
    v_mfma_f32_32x32x16_bf16 v[32:47], v[112:115], v[80:83], v[48:63]
    v_exp_f32 v20, v20
    v_exp_f32 v21, v21
    v_exp_f32 v22, v22
    v_exp_f32 v23, v23
    v_mfma_f32_32x32x16_bf16 v[64:79], v[132:135], v[100:103], v[64:79]
    v_cvt_pk_bf16_f32 v88, v16, v17
    v_cvt_pk_bf16_f32 v89, v18, v19
    v_exp_f32 v24, v24
    v_exp_f32 v25, v25
    v_exp_f32 v26, v26
    v_exp_f32 v27, v27
    v_mfma_f32_32x32x16_bf16 v[32:47], v[116:119], v[84:87], v[32:47]
    v_cvt_pk_bf16_f32 v90, v20, v21
    v_cvt_pk_bf16_f32 v91, v22, v23
    v_exp_f32 v28, v28
    v_exp_f32 v29, v29
    v_exp_f32 v30, v30
    v_exp_f32 v31, v31
    v_cvt_pk_bf16_f32 v92, v24, v25
    v_cvt_pk_bf16_f32 v93, v26, v27
    v_cvt_pk_bf16_f32 v94, v28, v29
    v_cvt_pk_bf16_f32 v95, v30, v31
    s_nop 1
    s_mov_b64 exec, s[56:57]
    ds_read_b128 v[128:131], v140 offset:768
    ds_read_b128 v[132:135], v141 offset:768
    s_mov_b64 exec, s[54:55]
    ds_read_b128 v[116:119], v137 offset:23040
    s_mov_b64 exec, -1
    ds_read_b128 v[112:115], v136 offset:23040
    v_max3_f32 v150, v32, v33, v34
    v_max3_f32 v151, v35, v36, v37
    v_max3_f32 v152, v38, v39, v40
    v_max3_f32 v153, v41, v42, v43
    v_max3_f32 v150, v150, v44, v45
    v_max3_f32 v151, v151, v46, v47
    v_max3_f32 v150, v150, v151, v152
    v_max_f32 v154, v150, v153
    v_cmp_lt_f32 vcc, s32, v154
    s_cbranch_vccnz at_slow13
at_back13:
    s_waitcnt lgkmcnt(4)
    v_mfma_f32_32x32x16_bf16 v[64:79], v[120:123], v[88:91], v[64:79]
    v_exp_f32 v32, v32
    v_exp_f32 v33, v33
    v_exp_f32 v34, v34
    v_exp_f32 v35, v35
    v_mfma_f32_32x32x16_bf16 v[16:31], v[104:107], v[80:83], v[48:63]
    v_exp_f32 v36, v36
    v_exp_f32 v37, v37
    v_exp_f32 v38, v38
    v_exp_f32 v39, v39
    v_mfma_f32_32x32x16_bf16 v[64:79], v[124:127], v[92:95], v[64:79]
    v_cvt_pk_bf16_f32 v96, v32, v33
    v_cvt_pk_bf16_f32 v97, v34, v35
    v_exp_f32 v40, v40
    v_exp_f32 v41, v41
    v_exp_f32 v42, v42
    v_exp_f32 v43, v43
    v_mfma_f32_32x32x16_bf16 v[16:31], v[108:111], v[84:87], v[16:31]
    v_cvt_pk_bf16_f32 v98, v36, v37
    v_cvt_pk_bf16_f32 v99, v38, v39
    v_exp_f32 v44, v44
    v_exp_f32 v45, v45
    v_exp_f32 v46, v46
    v_exp_f32 v47, v47
    v_cvt_pk_bf16_f32 v100, v40, v41
    v_cvt_pk_bf16_f32 v101, v42, v43
    v_cvt_pk_bf16_f32 v102, v44, v45
    v_cvt_pk_bf16_f32 v103, v46, v47
    s_nop 1
    s_cmp_eq_u32 s31, 3
    s_cbranch_scc1 at_nb14s
    s_add_u32 s58, s58, 8
sy7:
    ds_read_b32 v156, v155 offset:0
    s_waitcnt lgkmcnt(0)
    v_readfirstlane_b32 s59, v156
    s_cmp_ge_u32 s59, s58
    s_cbranch_scc1 sd7
    s_sleep 1
    s_branch sy7
sd7:
at_nb14s:
    v_add_u32 v136, s37, v136
    v_add_u32 v137, s37, v137
    s_sub_u32 s37, 0, s37
    s_mov_b64 exec, s[56:57]
    ds_read_b128 v[120:123], v142 offset:768
    ds_read_b128 v[124:127], v143 offset:768
    s_mov_b64 exec, s[54:55]
    ds_read_b128 v[108:111], v137 offset:0
    s_mov_b64 exec, -1
    ds_read_b128 v[104:107], v136 offset:0
    v_max3_f32 v150, v16, v17, v18
    v_max3_f32 v151, v19, v20, v21
    v_max3_f32 v152, v22, v23, v24
    v_max3_f32 v153, v25, v26, v27
    v_max3_f32 v150, v150, v28, v29
    v_max3_f32 v151, v151, v30, v31
    v_max3_f32 v150, v150, v151, v152
    v_max_f32 v154, v150, v153
    v_cmp_lt_f32 vcc, s32, v154
    s_cbranch_vccnz at_slow14
at_back14:
    s_waitcnt lgkmcnt(4)
    v_mfma_f32_32x32x16_bf16 v[64:79], v[128:131], v[96:99], v[64:79]
    v_exp_f32 v16, v16
    v_exp_f32 v17, v17
    v_exp_f32 v18, v18
    v_exp_f32 v19, v19
    v_mfma_f32_32x32x16_bf16 v[32:47], v[112:115], v[80:83], v[48:63]
    v_exp_f32 v20, v20
    v_exp_f32 v21, v21
    v_exp_f32 v22, v22
    v_exp_f32 v23, v23
    v_mfma_f32_32x32x16_bf16 v[64:79], v[132:135], v[100:103], v[64:79]
    v_cvt_pk_bf16_f32 v88, v16, v17
    v_cvt_pk_bf16_f32 v89, v18, v19
    v_exp_f32 v24, v24
    v_exp_f32 v25, v25
    v_exp_f32 v26, v26
    v_exp_f32 v27, v27
    v_mfma_f32_32x32x16_bf16 v[32:47], v[116:119], v[84:87], v[32:47]
    v_cvt_pk_bf16_f32 v90, v20, v21
    v_cvt_pk_bf16_f32 v91, v22, v23
    v_exp_f32 v28, v28
    v_exp_f32 v29, v29
    v_exp_f32 v30, v30
    v_exp_f32 v31, v31
    v_cvt_pk_bf16_f32 v92, v24, v25
    v_cvt_pk_bf16_f32 v93, v26, v27
    v_cvt_pk_bf16_f32 v94, v28, v29
    v_cvt_pk_bf16_f32 v95, v30, v31
    s_nop 1
    s_mov_b64 exec, s[56:57]
    ds_read_b128 v[128:131], v144 offset:768
    ds_read_b128 v[132:135], v145 offset:768
    s_mov_b64 exec, s[54:55]
    ds_read_b128 v[116:119], v137 offset:1536
    s_mov_b64 exec, -1
    ds_read_b128 v[112:115], v136 offset:1536
    v_max3_f32 v150, v32, v33, v34
    v_max3_f32 v151, v35, v36, v37
    v_max3_f32 v152, v38, v39, v40
    v_max3_f32 v153, v41, v42, v43
    v_max3_f32 v150, v150, v44, v45
    v_max3_f32 v151, v151, v46, v47
    v_max3_f32 v150, v150, v151, v152
    v_max_f32 v154, v150, v153
    v_cmp_lt_f32 vcc, s32, v154
    s_cbranch_vccnz at_slow15
at_back15:
    s_waitcnt lgkmcnt(4)
    v_mfma_f32_32x32x16_bf16 v[64:79], v[120:123], v[88:91], v[64:79]
    v_exp_f32 v32, v32
    v_exp_f32 v33, v33
    v_exp_f32 v34, v34
    v_exp_f32 v35, v35
    v_mfma_f32_32x32x16_bf16 v[16:31], v[104:107], v[80:83], v[48:63]
    v_exp_f32 v36, v36
    v_exp_f32 v37, v37
    v_exp_f32 v38, v38
    v_exp_f32 v39, v39
    v_mfma_f32_32x32x16_bf16 v[64:79], v[124:127], v[92:95], v[64:79]
    v_cvt_pk_bf16_f32 v96, v32, v33
    v_cvt_pk_bf16_f32 v97, v34, v35
    v_exp_f32 v40, v40
    v_exp_f32 v41, v41
    v_exp_f32 v42, v42
    v_exp_f32 v43, v43
    v_mfma_f32_32x32x16_bf16 v[16:31], v[108:111], v[84:87], v[16:31]
    v_cvt_pk_bf16_f32 v98, v36, v37
    v_cvt_pk_bf16_f32 v99, v38, v39
    v_exp_f32 v44, v44
    v_exp_f32 v45, v45
    v_exp_f32 v46, v46
    v_exp_f32 v47, v47
    v_cvt_pk_bf16_f32 v100, v40, v41
    v_cvt_pk_bf16_f32 v101, v42, v43
    v_cvt_pk_bf16_f32 v102, v44, v45
    v_cvt_pk_bf16_f32 v103, v46, v47
    s_nop 1
    v_add_u32 v138, s38, v138
    v_add_u32 v139, s38, v139
    v_add_u32 v140, s38, v140
    v_add_u32 v141, s38, v141
    v_add_u32 v142, s38, v142
    v_add_u32 v143, s38, v143
    v_add_u32 v144, s38, v144
    v_add_u32 v145, s38, v145
    s_sub_u32 s38, 0, s38
    s_add_u32 s31, s31, 1
    s_cmp_lt_u32 s31, 4
    s_cbranch_scc1 at_chunks
    s_waitcnt lgkmcnt(0)
    v_mfma_f32_32x32x16_bf16 v[64:79], v[128:131], v[96:99], v[64:79]
    v_mfma_f32_32x32x16_bf16 v[64:79], v[132:135], v[100:103], v[64:79]
    s_nop 15
    s_nop 3
at_epi:
    v_rcp_f32 v150, v74
    s_nop 1
    v_mov_b32 v151, v150
    s_nop 1
    v_permlane32_swap_b32 v151, v150
    s_nop 1
    v_mul_f32 v64, v64, v151
    v_mul_f32 v65, v65, v151
    v_mul_f32 v66, v66, v151
    v_mul_f32 v67, v67, v151
    v_mul_f32 v68, v68, v151
    v_mul_f32 v69, v69, v151
    v_mul_f32 v70, v70, v151
    v_mul_f32 v71, v71, v151
    v_mul_f32 v72, v72, v151
    v_mul_f32 v73, v73, v151
    v_cvt_pk_bf16_f32 v88, v64, v65
    v_cvt_pk_bf16_f32 v89, v66, v67
    v_cvt_pk_bf16_f32 v90, v68, v69
    v_cvt_pk_bf16_f32 v91, v70, v71
    v_cvt_pk_bf16_f32 v92, v72, v73
    s_lshl_b32 s33, s26, 5
    s_add_u32 s33, s33, s25
    s_lshl_b32 s34, s24, 11
    s_add_u32 s33, s33, s34
    v_and_b32 v2, 31, v0
    v_bfe_u32 v3, v0, 5, 1
    v_permlane32_swap_b32 v88, v90
    v_permlane32_swap_b32 v89, v91
    v_add_u32 v2, s33, v2
    v_lshlrev_b32 v4, 5, v2
    v_lshl_add_u32 v4, v3, 4, v4
    v_lshlrev_b32 v5, 2, v2
    s_mov_b32 s33, 2097152
    buffer_store_dwordx4 v[88:91], v4, s[16:19], 0 offen
    s_mov_b64 exec, 0xffffffff
    buffer_store_dword v92, v5, s[16:19], s33 offen
at_done:
    s_endpgm
f2_start:
    s_load_dwordx2 s[4:5], s[0:1], 88
    s_load_dwordx2 s[8:9], s[0:1], 48
    s_load_dwordx2 s[12:13], s[0:1], 88
    s_sub_u32 s29, s26, 8
    s_and_b32 s26, s2, 3
    s_bfe_u32 s24, s2, 0x10002
    s_lshl_b32 s24, s24, 3
    s_lshr_b32 s31, s2, 5
    s_add_u32 s24, s24, s31
    s_lshl_b32 s24, s24, 7
    s_bfe_u32 s25, s2, 0x20003
    s_mul_i32 s25, s25, 144
    s_mul_i32 s27, s26, 36864
    s_mul_i32 s28, s26, 1327104
    v_mov_b32 v10, 161792
    v_and_b32 v1, 63, v0
    v_and_b32 v3, 15, v1
    v_lshrrev_b32 v4, 4, v1
    s_lshl_b32 s31, s29, 5
    s_add_u32 s31, s31, s24
    v_add_u32 v5, s31, v3
    v_mul_u32_u24 v5, 9216, v5
    v_lshl_add_u32 v156, v4, 4, v5
    v_add_u32 v157, 147456, v156
    s_lshr_b32 s31, s31, 4
    s_mul_i32 s31, s31, 147456
    v_lshl_add_u32 v156, v1, 4, s31
    v_add_u32 v157, 147456, v156
    v_lshrrev_b32 v5, 2, v3
    v_lshl_add_u32 v5, v4, 2, v5
    v_mul_u32_u24 v5, 288, v5
    v_and_b32 v6, 3, v1
    v_lshl_add_u32 v5, v6, 3, v5
    v_add_u32 v163, 88064, v5
    v_add_u32 v164, 124928, v5
    s_mul_i32 s31, s29, 320
    s_lshl_b32 s32, s25, 1
    v_add_u32 v3, s31, v1
    v_mul_u32_u24 v4, 3641, v3
    v_lshrrev_b32 v4, 16, v4
    v_mul_u32_u24 v5, 18, v4
    v_sub_u32 v5, v3, v5
    v_and_b32 v6, 32, v4
    v_and_b32 v7, 3, v4
    v_add_u32 v6, v6, v7
    v_bfe_u32 v7, v4, 2, 2
    v_lshl_add_u32 v6, v7, 3, v6
    v_bfe_u32 v7, v4, 4, 1
    v_lshl_add_u32 v6, v7, 2, v6
    v_mul_u32_u24 v6, 1152, v6
    v_lshl_add_u32 v6, v5, 4, v6
    v_add_u32 v158, s32, v6
    v_add_u32 v3, s31, v1
    v_add_u32 v3, 64, v3
    v_mul_u32_u24 v4, 3641, v3
    v_lshrrev_b32 v4, 16, v4
    v_mul_u32_u24 v5, 18, v4
    v_sub_u32 v5, v3, v5
    v_and_b32 v6, 32, v4
    v_and_b32 v7, 3, v4
    v_add_u32 v6, v6, v7
    v_bfe_u32 v7, v4, 2, 2
    v_lshl_add_u32 v6, v7, 3, v6
    v_bfe_u32 v7, v4, 4, 1
    v_lshl_add_u32 v6, v7, 2, v6
    v_mul_u32_u24 v6, 1152, v6
    v_lshl_add_u32 v6, v5, 4, v6
    v_add_u32 v159, s32, v6
    v_add_u32 v3, s31, v1
    v_add_u32 v3, 128, v3
    v_mul_u32_u24 v4, 3641, v3
    v_lshrrev_b32 v4, 16, v4
    v_mul_u32_u24 v5, 18, v4
    v_sub_u32 v5, v3, v5
    v_and_b32 v6, 32, v4
    v_and_b32 v7, 3, v4
    v_add_u32 v6, v6, v7
    v_bfe_u32 v7, v4, 2, 2
    v_lshl_add_u32 v6, v7, 3, v6
    v_bfe_u32 v7, v4, 4, 1
    v_lshl_add_u32 v6, v7, 2, v6
    v_mul_u32_u24 v6, 1152, v6
    v_lshl_add_u32 v6, v5, 4, v6
    v_add_u32 v160, s32, v6
    v_add_u32 v3, s31, v1
    v_add_u32 v3, 192, v3
    v_mul_u32_u24 v4, 3641, v3
    v_lshrrev_b32 v4, 16, v4
    v_mul_u32_u24 v5, 18, v4
    v_sub_u32 v5, v3, v5
    v_and_b32 v6, 32, v4
    v_and_b32 v7, 3, v4
    v_add_u32 v6, v6, v7
    v_bfe_u32 v7, v4, 2, 2
    v_lshl_add_u32 v6, v7, 3, v6
    v_bfe_u32 v7, v4, 4, 1
    v_lshl_add_u32 v6, v7, 2, v6
    v_mul_u32_u24 v6, 1152, v6
    v_lshl_add_u32 v6, v5, 4, v6
    v_add_u32 v161, s32, v6
    v_add_u32 v3, s31, v1
    v_add_u32 v3, 256, v3
    v_mul_u32_u24 v4, 3641, v3
    v_lshrrev_b32 v4, 16, v4
    v_mul_u32_u24 v5, 18, v4
    v_sub_u32 v5, v3, v5
    v_and_b32 v6, 32, v4
    v_and_b32 v7, 3, v4
    v_add_u32 v6, v6, v7
    v_bfe_u32 v7, v4, 2, 2
    v_lshl_add_u32 v6, v7, 3, v6
    v_bfe_u32 v7, v4, 4, 1
    v_lshl_add_u32 v6, v7, 2, v6
    v_mul_u32_u24 v6, 1152, v6
    v_lshl_add_u32 v6, v5, 4, v6
    v_add_u32 v162, s32, v6
    s_mul_i32 s30, s29, 5120
    s_waitcnt lgkmcnt(0)
    s_add_u32 s4, s4, 0x1000000
    s_addc_u32 s5, s5, 0
    s_mov_b32 s6, 0x1200000
    s_mov_b32 s7, 0x20000
    s_mov_b32 s10, 0x510000
    s_mov_b32 s11, 0x20000
    s_add_u32 s12, s12, 0x3000000
    s_addc_u32 s13, s13, 0
    s_mov_b32 s14, 0x1200000
    s_mov_b32 s15, 0x20000
    s_add_u32 m0, s30, 88064
    s_nop 0
    buffer_load_dwordx4 v158, s[8:11], s28 offen lds
    s_add_u32 m0, s30, 89088
    s_nop 0
    buffer_load_dwordx4 v159, s[8:11], s28 offen lds
    s_add_u32 m0, s30, 90112
    s_nop 0
    buffer_load_dwordx4 v160, s[8:11], s28 offen lds
    s_cmp_eq_u32 s29, 3
    s_cbranch_scc1 f2sk8
    s_add_u32 m0, s30, 91136
    s_nop 0
    buffer_load_dwordx4 v161, s[8:11], s28 offen lds
    s_add_u32 m0, s30, 92160
    s_nop 0
    buffer_load_dwordx4 v162, s[8:11], s28 offen lds
    f2sk8:
    s_add_u32 s28, s28, 73728
    s_add_u32 m0, s30, 106496
    s_nop 0
    buffer_load_dwordx4 v158, s[8:11], s28 offen lds
    s_add_u32 m0, s30, 107520
    s_nop 0
    buffer_load_dwordx4 v159, s[8:11], s28 offen lds
    s_add_u32 m0, s30, 108544
    s_nop 0
    buffer_load_dwordx4 v160, s[8:11], s28 offen lds
    s_cmp_eq_u32 s29, 3
    s_cbranch_scc1 f2sk9
    s_add_u32 m0, s30, 109568
    s_nop 0
    buffer_load_dwordx4 v161, s[8:11], s28 offen lds
    s_add_u32 m0, s30, 110592
    s_nop 0
    buffer_load_dwordx4 v162, s[8:11], s28 offen lds
    f2sk9:
    s_add_u32 s28, s28, 73728
    buffer_load_dwordx4 v[108:111], v156, s[4:7], s27 offen offset:0
    buffer_load_dwordx4 v[116:119], v156, s[4:7], s27 offen offset:1024
    buffer_load_dwordx4 v[112:115], v157, s[4:7], s27 offen offset:0
    buffer_load_dwordx4 v[120:123], v157, s[4:7], s27 offen offset:1024
    s_add_u32 s27, s27, 2048
    buffer_load_dwordx4 v[124:127], v156, s[4:7], s27 offen offset:0
    buffer_load_dwordx4 v[132:135], v156, s[4:7], s27 offen offset:1024
    buffer_load_dwordx4 v[128:131], v157, s[4:7], s27 offen offset:0
    buffer_load_dwordx4 v[136:139], v157, s[4:7], s27 offen offset:1024
    s_add_u32 s27, s27, 2048
    s_waitcnt vmcnt(4)
    s_add_u32 s58, s58, 4
    v_mov_b32 v11, 1
    s_mov_b64 exec, 1
    ds_add_u32 v10, v11 offset:4
sy10:
    ds_read_b32 v11, v10 offset:4
    s_waitcnt lgkmcnt(0)
    v_readfirstlane_b32 s59, v11
    s_cmp_ge_u32 s59, s58
    s_cbranch_scc1 sd10
    s_sleep 1
    s_branch sy10
sd10:
    s_mov_b64 exec, -1
    ds_read_b64_tr_b16 v[84:85], v163 offset:0
    ds_read_b64_tr_b16 v[86:87], v163 offset:4608
    ds_read_b64_tr_b16 v[88:89], v163 offset:32
    ds_read_b64_tr_b16 v[90:91], v163 offset:4640
    ds_read_b64_tr_b16 v[92:93], v163 offset:64
    ds_read_b64_tr_b16 v[94:95], v163 offset:4672
    ds_read_b64_tr_b16 v[96:97], v163 offset:96
    ds_read_b64_tr_b16 v[98:99], v163 offset:4704
    s_waitcnt lgkmcnt(6)
    v_mfma_f32_16x16x32_bf16 v[12:15], v[84:87], v[108:111], 0
    v_mfma_f32_16x16x32_bf16 v[16:19], v[84:87], v[112:115], 0
    ds_read_b64_tr_b16 v[100:101], v163 offset:128
    ds_read_b64_tr_b16 v[102:103], v163 offset:4736
    s_add_u32 m0, s30, 124928
    s_nop 0
    buffer_load_dwordx4 v158, s[8:11], s28 offen lds
    s_waitcnt lgkmcnt(6)
    v_mfma_f32_16x16x32_bf16 v[20:23], v[88:91], v[108:111], 0
    v_mfma_f32_16x16x32_bf16 v[24:27], v[88:91], v[112:115], 0
    ds_read_b64_tr_b16 v[104:105], v163 offset:160
    ds_read_b64_tr_b16 v[106:107], v163 offset:4768
    s_add_u32 m0, s30, 125952
    s_nop 0
    buffer_load_dwordx4 v159, s[8:11], s28 offen lds
    s_waitcnt lgkmcnt(6)
    v_mfma_f32_16x16x32_bf16 v[28:31], v[92:95], v[108:111], 0
    v_mfma_f32_16x16x32_bf16 v[32:35], v[92:95], v[112:115], 0
    ds_read_b64_tr_b16 v[84:85], v163 offset:192
    ds_read_b64_tr_b16 v[86:87], v163 offset:4800
    buffer_load_dwordx4 v[140:143], v156, s[4:7], s27 offen offset:0
    buffer_load_dwordx4 v[148:151], v156, s[4:7], s27 offen offset:1024
    s_waitcnt lgkmcnt(6)
    v_mfma_f32_16x16x32_bf16 v[36:39], v[96:99], v[108:111], 0
    v_mfma_f32_16x16x32_bf16 v[40:43], v[96:99], v[112:115], 0
    ds_read_b64_tr_b16 v[88:89], v163 offset:224
    ds_read_b64_tr_b16 v[90:91], v163 offset:4832
    buffer_load_dwordx4 v[144:147], v157, s[4:7], s27 offen offset:0
    buffer_load_dwordx4 v[152:155], v157, s[4:7], s27 offen offset:1024
    s_add_u32 s27, s27, 2048
    s_waitcnt lgkmcnt(6)
    v_mfma_f32_16x16x32_bf16 v[44:47], v[100:103], v[108:111], 0
    v_mfma_f32_16x16x32_bf16 v[48:51], v[100:103], v[112:115], 0
    ds_read_b64_tr_b16 v[92:93], v163 offset:256
    ds_read_b64_tr_b16 v[94:95], v163 offset:4864
    s_add_u32 m0, s30, 126976
    s_nop 0
    buffer_load_dwordx4 v160, s[8:11], s28 offen lds
    s_waitcnt lgkmcnt(6)
    v_mfma_f32_16x16x32_bf16 v[52:55], v[104:107], v[108:111], 0
    v_mfma_f32_16x16x32_bf16 v[56:59], v[104:107], v[112:115], 0
    ds_read_b64_tr_b16 v[96:97], v163 offset:9216
    ds_read_b64_tr_b16 v[98:99], v163 offset:13824
    s_cmp_eq_u32 s29, 3
    s_cbranch_scc1 f2sk11
    s_add_u32 m0, s30, 128000
    s_nop 0
    buffer_load_dwordx4 v161, s[8:11], s28 offen lds
    s_add_u32 m0, s30, 129024
    s_nop 0
    buffer_load_dwordx4 v162, s[8:11], s28 offen lds
    f2sk11:
    s_add_u32 s28, s28, 73728
    s_waitcnt lgkmcnt(6)
    v_mfma_f32_16x16x32_bf16 v[60:63], v[84:87], v[108:111], 0
    v_mfma_f32_16x16x32_bf16 v[64:67], v[84:87], v[112:115], 0
    ds_read_b64_tr_b16 v[100:101], v163 offset:9248
    ds_read_b64_tr_b16 v[102:103], v163 offset:13856
    s_add_u32 m0, s30, 143360
    s_nop 0
    buffer_load_dwordx4 v158, s[8:11], s28 offen lds
    s_waitcnt lgkmcnt(6)
    v_mfma_f32_16x16x32_bf16 v[68:71], v[88:91], v[108:111], 0
    v_mfma_f32_16x16x32_bf16 v[72:75], v[88:91], v[112:115], 0
    ds_read_b64_tr_b16 v[104:105], v163 offset:9280
    ds_read_b64_tr_b16 v[106:107], v163 offset:13888
    s_add_u32 m0, s30, 144384
    s_nop 0
    buffer_load_dwordx4 v159, s[8:11], s28 offen lds
    s_waitcnt lgkmcnt(6)
    v_mfma_f32_16x16x32_bf16 v[76:79], v[92:95], v[108:111], 0
    v_mfma_f32_16x16x32_bf16 v[80:83], v[92:95], v[112:115], 0
    ds_read_b64_tr_b16 v[84:85], v163 offset:9312
    ds_read_b64_tr_b16 v[86:87], v163 offset:13920
    s_add_u32 m0, s30, 145408
    s_nop 0
    buffer_load_dwordx4 v160, s[8:11], s28 offen lds
    s_waitcnt lgkmcnt(6)
    v_mfma_f32_16x16x32_bf16 v[12:15], v[96:99], v[116:119], v[12:15]
    v_mfma_f32_16x16x32_bf16 v[16:19], v[96:99], v[120:123], v[16:19]
    ds_read_b64_tr_b16 v[88:89], v163 offset:9344
    ds_read_b64_tr_b16 v[90:91], v163 offset:13952
    s_cmp_eq_u32 s29, 3
    s_cbranch_scc1 f2sk12
    s_add_u32 m0, s30, 146432
    s_nop 0
    buffer_load_dwordx4 v161, s[8:11], s28 offen lds
    s_add_u32 m0, s30, 147456
    s_nop 0
    buffer_load_dwordx4 v162, s[8:11], s28 offen lds
    f2sk12:
    s_add_u32 s28, s28, 73728
    s_waitcnt lgkmcnt(6)
    v_mfma_f32_16x16x32_bf16 v[20:23], v[100:103], v[116:119], v[20:23]
    v_mfma_f32_16x16x32_bf16 v[24:27], v[100:103], v[120:123], v[24:27]
    ds_read_b64_tr_b16 v[92:93], v163 offset:9376
    ds_read_b64_tr_b16 v[94:95], v163 offset:13984
    s_waitcnt lgkmcnt(6)
    v_mfma_f32_16x16x32_bf16 v[28:31], v[104:107], v[116:119], v[28:31]
    v_mfma_f32_16x16x32_bf16 v[32:35], v[104:107], v[120:123], v[32:35]
    ds_read_b64_tr_b16 v[96:97], v163 offset:9408
    ds_read_b64_tr_b16 v[98:99], v163 offset:14016
    s_waitcnt lgkmcnt(6)
    v_mfma_f32_16x16x32_bf16 v[36:39], v[84:87], v[116:119], v[36:39]
    v_mfma_f32_16x16x32_bf16 v[40:43], v[84:87], v[120:123], v[40:43]
    ds_read_b64_tr_b16 v[100:101], v163 offset:9440
    ds_read_b64_tr_b16 v[102:103], v163 offset:14048
    s_waitcnt lgkmcnt(6)
    v_mfma_f32_16x16x32_bf16 v[44:47], v[88:91], v[116:119], v[44:47]
    v_mfma_f32_16x16x32_bf16 v[48:51], v[88:91], v[120:123], v[48:51]
    ds_read_b64_tr_b16 v[104:105], v163 offset:9472
    ds_read_b64_tr_b16 v[106:107], v163 offset:14080
    s_waitcnt lgkmcnt(6)
    v_mfma_f32_16x16x32_bf16 v[52:55], v[92:95], v[116:119], v[52:55]
    v_mfma_f32_16x16x32_bf16 v[56:59], v[92:95], v[120:123], v[56:59]
    ds_read_b64_tr_b16 v[84:85], v163 offset:18432
    ds_read_b64_tr_b16 v[86:87], v163 offset:23040
    s_waitcnt lgkmcnt(6)
    v_mfma_f32_16x16x32_bf16 v[60:63], v[96:99], v[116:119], v[60:63]
    v_mfma_f32_16x16x32_bf16 v[64:67], v[96:99], v[120:123], v[64:67]
    ds_read_b64_tr_b16 v[88:89], v163 offset:18464
    ds_read_b64_tr_b16 v[90:91], v163 offset:23072
    s_waitcnt lgkmcnt(6)
    v_mfma_f32_16x16x32_bf16 v[68:71], v[100:103], v[116:119], v[68:71]
    v_mfma_f32_16x16x32_bf16 v[72:75], v[100:103], v[120:123], v[72:75]
    ds_read_b64_tr_b16 v[92:93], v163 offset:18496
    ds_read_b64_tr_b16 v[94:95], v163 offset:23104
    s_waitcnt lgkmcnt(6)
    v_mfma_f32_16x16x32_bf16 v[76:79], v[104:107], v[116:119], v[76:79]
    v_mfma_f32_16x16x32_bf16 v[80:83], v[104:107], v[120:123], v[80:83]
    ds_read_b64_tr_b16 v[96:97], v163 offset:18528
    ds_read_b64_tr_b16 v[98:99], v163 offset:23136
    s_waitcnt vmcnt(10)
    s_waitcnt lgkmcnt(6)
    v_mfma_f32_16x16x32_bf16 v[12:15], v[84:87], v[124:127], v[12:15]
    v_mfma_f32_16x16x32_bf16 v[16:19], v[84:87], v[128:131], v[16:19]
    ds_read_b64_tr_b16 v[100:101], v163 offset:18560
    ds_read_b64_tr_b16 v[102:103], v163 offset:23168
    buffer_load_dwordx4 v[108:111], v156, s[4:7], s27 offen offset:0
    buffer_load_dwordx4 v[116:119], v156, s[4:7], s27 offen offset:1024
    s_waitcnt lgkmcnt(6)
    v_mfma_f32_16x16x32_bf16 v[20:23], v[88:91], v[124:127], v[20:23]
    v_mfma_f32_16x16x32_bf16 v[24:27], v[88:91], v[128:131], v[24:27]
    ds_read_b64_tr_b16 v[104:105], v163 offset:18592
    ds_read_b64_tr_b16 v[106:107], v163 offset:23200
    buffer_load_dwordx4 v[112:115], v157, s[4:7], s27 offen offset:0
    buffer_load_dwordx4 v[120:123], v157, s[4:7], s27 offen offset:1024
    s_add_u32 s27, s27, 2048
    s_waitcnt lgkmcnt(6)
    v_mfma_f32_16x16x32_bf16 v[28:31], v[92:95], v[124:127], v[28:31]
    v_mfma_f32_16x16x32_bf16 v[32:35], v[92:95], v[128:131], v[32:35]
    ds_read_b64_tr_b16 v[84:85], v163 offset:18624
    ds_read_b64_tr_b16 v[86:87], v163 offset:23232
    s_waitcnt lgkmcnt(6)
    v_mfma_f32_16x16x32_bf16 v[36:39], v[96:99], v[124:127], v[36:39]
    v_mfma_f32_16x16x32_bf16 v[40:43], v[96:99], v[128:131], v[40:43]
    ds_read_b64_tr_b16 v[88:89], v163 offset:18656
    ds_read_b64_tr_b16 v[90:91], v163 offset:23264
    s_waitcnt lgkmcnt(6)
    v_mfma_f32_16x16x32_bf16 v[44:47], v[100:103], v[124:127], v[44:47]
    v_mfma_f32_16x16x32_bf16 v[48:51], v[100:103], v[128:131], v[48:51]
    ds_read_b64_tr_b16 v[92:93], v163 offset:18688
    ds_read_b64_tr_b16 v[94:95], v163 offset:23296
    s_waitcnt lgkmcnt(6)
    v_mfma_f32_16x16x32_bf16 v[52:55], v[104:107], v[124:127], v[52:55]
    v_mfma_f32_16x16x32_bf16 v[56:59], v[104:107], v[128:131], v[56:59]
    ds_read_b64_tr_b16 v[96:97], v163 offset:27648
    ds_read_b64_tr_b16 v[98:99], v163 offset:32256
    s_waitcnt lgkmcnt(6)
    v_mfma_f32_16x16x32_bf16 v[60:63], v[84:87], v[124:127], v[60:63]
    v_mfma_f32_16x16x32_bf16 v[64:67], v[84:87], v[128:131], v[64:67]
    ds_read_b64_tr_b16 v[100:101], v163 offset:27680
    ds_read_b64_tr_b16 v[102:103], v163 offset:32288
    s_waitcnt lgkmcnt(6)
    v_mfma_f32_16x16x32_bf16 v[68:71], v[88:91], v[124:127], v[68:71]
    v_mfma_f32_16x16x32_bf16 v[72:75], v[88:91], v[128:131], v[72:75]
    ds_read_b64_tr_b16 v[104:105], v163 offset:27712
    ds_read_b64_tr_b16 v[106:107], v163 offset:32320
    s_waitcnt lgkmcnt(6)
    v_mfma_f32_16x16x32_bf16 v[76:79], v[92:95], v[124:127], v[76:79]
    v_mfma_f32_16x16x32_bf16 v[80:83], v[92:95], v[128:131], v[80:83]
    ds_read_b64_tr_b16 v[84:85], v163 offset:27744
    ds_read_b64_tr_b16 v[86:87], v163 offset:32352
    s_waitcnt lgkmcnt(6)
    v_mfma_f32_16x16x32_bf16 v[12:15], v[96:99], v[132:135], v[12:15]
    v_mfma_f32_16x16x32_bf16 v[16:19], v[96:99], v[136:139], v[16:19]
    ds_read_b64_tr_b16 v[88:89], v163 offset:27776
    ds_read_b64_tr_b16 v[90:91], v163 offset:32384
    s_waitcnt lgkmcnt(6)
    v_mfma_f32_16x16x32_bf16 v[20:23], v[100:103], v[132:135], v[20:23]
    v_mfma_f32_16x16x32_bf16 v[24:27], v[100:103], v[136:139], v[24:27]
    ds_read_b64_tr_b16 v[92:93], v163 offset:27808
    ds_read_b64_tr_b16 v[94:95], v163 offset:32416
    s_waitcnt lgkmcnt(6)
    v_mfma_f32_16x16x32_bf16 v[28:31], v[104:107], v[132:135], v[28:31]
    v_mfma_f32_16x16x32_bf16 v[32:35], v[104:107], v[136:139], v[32:35]
    ds_read_b64_tr_b16 v[96:97], v163 offset:27840
    ds_read_b64_tr_b16 v[98:99], v163 offset:32448
    s_waitcnt lgkmcnt(6)
    v_mfma_f32_16x16x32_bf16 v[36:39], v[84:87], v[132:135], v[36:39]
    v_mfma_f32_16x16x32_bf16 v[40:43], v[84:87], v[136:139], v[40:43]
    ds_read_b64_tr_b16 v[100:101], v163 offset:27872
    ds_read_b64_tr_b16 v[102:103], v163 offset:32480
    s_waitcnt lgkmcnt(6)
    v_mfma_f32_16x16x32_bf16 v[44:47], v[88:91], v[132:135], v[44:47]
    v_mfma_f32_16x16x32_bf16 v[48:51], v[88:91], v[136:139], v[48:51]
    ds_read_b64_tr_b16 v[104:105], v163 offset:27904
    ds_read_b64_tr_b16 v[106:107], v163 offset:32512
    s_waitcnt lgkmcnt(6)
    v_mfma_f32_16x16x32_bf16 v[52:55], v[92:95], v[132:135], v[52:55]
    v_mfma_f32_16x16x32_bf16 v[56:59], v[92:95], v[136:139], v[56:59]
    s_waitcnt lgkmcnt(4)
    v_mfma_f32_16x16x32_bf16 v[60:63], v[96:99], v[132:135], v[60:63]
    v_mfma_f32_16x16x32_bf16 v[64:67], v[96:99], v[136:139], v[64:67]
    s_waitcnt lgkmcnt(2)
    v_mfma_f32_16x16x32_bf16 v[68:71], v[100:103], v[132:135], v[68:71]
    v_mfma_f32_16x16x32_bf16 v[72:75], v[100:103], v[136:139], v[72:75]
    s_waitcnt lgkmcnt(0)
    v_mfma_f32_16x16x32_bf16 v[76:79], v[104:107], v[132:135], v[76:79]
    v_mfma_f32_16x16x32_bf16 v[80:83], v[104:107], v[136:139], v[80:83]
    s_waitcnt vmcnt(4)
    s_add_u32 s58, s58, 4
    v_mov_b32 v11, 1
    s_mov_b64 exec, 1
    ds_add_u32 v10, v11 offset:4
sy13:
    ds_read_b32 v11, v10 offset:4
    s_waitcnt lgkmcnt(0)
    v_readfirstlane_b32 s59, v11
    s_cmp_ge_u32 s59, s58
    s_cbranch_scc1 sd13
    s_sleep 1
    s_branch sy13
sd13:
    s_mov_b64 exec, -1
    ds_read_b64_tr_b16 v[84:85], v164 offset:0
    ds_read_b64_tr_b16 v[86:87], v164 offset:4608
    ds_read_b64_tr_b16 v[88:89], v164 offset:32
    ds_read_b64_tr_b16 v[90:91], v164 offset:4640
    ds_read_b64_tr_b16 v[92:93], v164 offset:64
    ds_read_b64_tr_b16 v[94:95], v164 offset:4672
    ds_read_b64_tr_b16 v[96:97], v164 offset:96
    ds_read_b64_tr_b16 v[98:99], v164 offset:4704
    s_waitcnt lgkmcnt(6)
    v_mfma_f32_16x16x32_bf16 v[12:15], v[84:87], v[140:143], v[12:15]
    v_mfma_f32_16x16x32_bf16 v[16:19], v[84:87], v[144:147], v[16:19]
    ds_read_b64_tr_b16 v[100:101], v164 offset:128
    ds_read_b64_tr_b16 v[102:103], v164 offset:4736
    s_add_u32 m0, s30, 88064
    s_nop 0
    buffer_load_dwordx4 v158, s[8:11], s28 offen lds
    s_waitcnt lgkmcnt(6)
    v_mfma_f32_16x16x32_bf16 v[20:23], v[88:91], v[140:143], v[20:23]
    v_mfma_f32_16x16x32_bf16 v[24:27], v[88:91], v[144:147], v[24:27]
    ds_read_b64_tr_b16 v[104:105], v164 offset:160
    ds_read_b64_tr_b16 v[106:107], v164 offset:4768
    s_add_u32 m0, s30, 89088
    s_nop 0
    buffer_load_dwordx4 v159, s[8:11], s28 offen lds
    s_waitcnt lgkmcnt(6)
    v_mfma_f32_16x16x32_bf16 v[28:31], v[92:95], v[140:143], v[28:31]
    v_mfma_f32_16x16x32_bf16 v[32:35], v[92:95], v[144:147], v[32:35]
    ds_read_b64_tr_b16 v[84:85], v164 offset:192
    ds_read_b64_tr_b16 v[86:87], v164 offset:4800
    buffer_load_dwordx4 v[124:127], v156, s[4:7], s27 offen offset:0
    buffer_load_dwordx4 v[132:135], v156, s[4:7], s27 offen offset:1024
    s_waitcnt lgkmcnt(6)
    v_mfma_f32_16x16x32_bf16 v[36:39], v[96:99], v[140:143], v[36:39]
    v_mfma_f32_16x16x32_bf16 v[40:43], v[96:99], v[144:147], v[40:43]
    ds_read_b64_tr_b16 v[88:89], v164 offset:224
    ds_read_b64_tr_b16 v[90:91], v164 offset:4832
    buffer_load_dwordx4 v[128:131], v157, s[4:7], s27 offen offset:0
    buffer_load_dwordx4 v[136:139], v157, s[4:7], s27 offen offset:1024
    s_add_u32 s27, s27, 2048
    s_waitcnt lgkmcnt(6)
    v_mfma_f32_16x16x32_bf16 v[44:47], v[100:103], v[140:143], v[44:47]
    v_mfma_f32_16x16x32_bf16 v[48:51], v[100:103], v[144:147], v[48:51]
    ds_read_b64_tr_b16 v[92:93], v164 offset:256
    ds_read_b64_tr_b16 v[94:95], v164 offset:4864
    s_add_u32 m0, s30, 90112
    s_nop 0
    buffer_load_dwordx4 v160, s[8:11], s28 offen lds
    s_waitcnt lgkmcnt(6)
    v_mfma_f32_16x16x32_bf16 v[52:55], v[104:107], v[140:143], v[52:55]
    v_mfma_f32_16x16x32_bf16 v[56:59], v[104:107], v[144:147], v[56:59]
    ds_read_b64_tr_b16 v[96:97], v164 offset:9216
    ds_read_b64_tr_b16 v[98:99], v164 offset:13824
    s_cmp_eq_u32 s29, 3
    s_cbranch_scc1 f2sk14
    s_add_u32 m0, s30, 91136
    s_nop 0
    buffer_load_dwordx4 v161, s[8:11], s28 offen lds
    s_add_u32 m0, s30, 92160
    s_nop 0
    buffer_load_dwordx4 v162, s[8:11], s28 offen lds
    f2sk14:
    s_add_u32 s28, s28, 73728
    s_waitcnt lgkmcnt(6)
    v_mfma_f32_16x16x32_bf16 v[60:63], v[84:87], v[140:143], v[60:63]
    v_mfma_f32_16x16x32_bf16 v[64:67], v[84:87], v[144:147], v[64:67]
    ds_read_b64_tr_b16 v[100:101], v164 offset:9248
    ds_read_b64_tr_b16 v[102:103], v164 offset:13856
    s_add_u32 m0, s30, 106496
    s_nop 0
    buffer_load_dwordx4 v158, s[8:11], s28 offen lds
    s_waitcnt lgkmcnt(6)
    v_mfma_f32_16x16x32_bf16 v[68:71], v[88:91], v[140:143], v[68:71]
    v_mfma_f32_16x16x32_bf16 v[72:75], v[88:91], v[144:147], v[72:75]
    ds_read_b64_tr_b16 v[104:105], v164 offset:9280
    ds_read_b64_tr_b16 v[106:107], v164 offset:13888
    s_add_u32 m0, s30, 107520
    s_nop 0
    buffer_load_dwordx4 v159, s[8:11], s28 offen lds
    s_waitcnt lgkmcnt(6)
    v_mfma_f32_16x16x32_bf16 v[76:79], v[92:95], v[140:143], v[76:79]
    v_mfma_f32_16x16x32_bf16 v[80:83], v[92:95], v[144:147], v[80:83]
    ds_read_b64_tr_b16 v[84:85], v164 offset:9312
    ds_read_b64_tr_b16 v[86:87], v164 offset:13920
    s_add_u32 m0, s30, 108544
    s_nop 0
    buffer_load_dwordx4 v160, s[8:11], s28 offen lds
    s_waitcnt lgkmcnt(6)
    v_mfma_f32_16x16x32_bf16 v[12:15], v[96:99], v[148:151], v[12:15]
    v_mfma_f32_16x16x32_bf16 v[16:19], v[96:99], v[152:155], v[16:19]
    ds_read_b64_tr_b16 v[88:89], v164 offset:9344
    ds_read_b64_tr_b16 v[90:91], v164 offset:13952
    s_cmp_eq_u32 s29, 3
    s_cbranch_scc1 f2sk15
    s_add_u32 m0, s30, 109568
    s_nop 0
    buffer_load_dwordx4 v161, s[8:11], s28 offen lds
    s_add_u32 m0, s30, 110592
    s_nop 0
    buffer_load_dwordx4 v162, s[8:11], s28 offen lds
    f2sk15:
    s_add_u32 s28, s28, 73728
    s_waitcnt lgkmcnt(6)
    v_mfma_f32_16x16x32_bf16 v[20:23], v[100:103], v[148:151], v[20:23]
    v_mfma_f32_16x16x32_bf16 v[24:27], v[100:103], v[152:155], v[24:27]
    ds_read_b64_tr_b16 v[92:93], v164 offset:9376
    ds_read_b64_tr_b16 v[94:95], v164 offset:13984
    s_waitcnt lgkmcnt(6)
    v_mfma_f32_16x16x32_bf16 v[28:31], v[104:107], v[148:151], v[28:31]
    v_mfma_f32_16x16x32_bf16 v[32:35], v[104:107], v[152:155], v[32:35]
    ds_read_b64_tr_b16 v[96:97], v164 offset:9408
    ds_read_b64_tr_b16 v[98:99], v164 offset:14016
    s_waitcnt lgkmcnt(6)
    v_mfma_f32_16x16x32_bf16 v[36:39], v[84:87], v[148:151], v[36:39]
    v_mfma_f32_16x16x32_bf16 v[40:43], v[84:87], v[152:155], v[40:43]
    ds_read_b64_tr_b16 v[100:101], v164 offset:9440
    ds_read_b64_tr_b16 v[102:103], v164 offset:14048
    s_waitcnt lgkmcnt(6)
    v_mfma_f32_16x16x32_bf16 v[44:47], v[88:91], v[148:151], v[44:47]
    v_mfma_f32_16x16x32_bf16 v[48:51], v[88:91], v[152:155], v[48:51]
    ds_read_b64_tr_b16 v[104:105], v164 offset:9472
    ds_read_b64_tr_b16 v[106:107], v164 offset:14080
    s_waitcnt lgkmcnt(6)
    v_mfma_f32_16x16x32_bf16 v[52:55], v[92:95], v[148:151], v[52:55]
    v_mfma_f32_16x16x32_bf16 v[56:59], v[92:95], v[152:155], v[56:59]
    ds_read_b64_tr_b16 v[84:85], v164 offset:18432
    ds_read_b64_tr_b16 v[86:87], v164 offset:23040
    s_waitcnt lgkmcnt(6)
    v_mfma_f32_16x16x32_bf16 v[60:63], v[96:99], v[148:151], v[60:63]
    v_mfma_f32_16x16x32_bf16 v[64:67], v[96:99], v[152:155], v[64:67]
    ds_read_b64_tr_b16 v[88:89], v164 offset:18464
    ds_read_b64_tr_b16 v[90:91], v164 offset:23072
    s_waitcnt lgkmcnt(6)
    v_mfma_f32_16x16x32_bf16 v[68:71], v[100:103], v[148:151], v[68:71]
    v_mfma_f32_16x16x32_bf16 v[72:75], v[100:103], v[152:155], v[72:75]
    ds_read_b64_tr_b16 v[92:93], v164 offset:18496
    ds_read_b64_tr_b16 v[94:95], v164 offset:23104
    s_waitcnt lgkmcnt(6)
    v_mfma_f32_16x16x32_bf16 v[76:79], v[104:107], v[148:151], v[76:79]
    v_mfma_f32_16x16x32_bf16 v[80:83], v[104:107], v[152:155], v[80:83]
    ds_read_b64_tr_b16 v[96:97], v164 offset:18528
    ds_read_b64_tr_b16 v[98:99], v164 offset:23136
    s_waitcnt vmcnt(10)
    s_waitcnt lgkmcnt(6)
    v_mfma_f32_16x16x32_bf16 v[12:15], v[84:87], v[108:111], v[12:15]
    v_mfma_f32_16x16x32_bf16 v[16:19], v[84:87], v[112:115], v[16:19]
    ds_read_b64_tr_b16 v[100:101], v164 offset:18560
    ds_read_b64_tr_b16 v[102:103], v164 offset:23168
    buffer_load_dwordx4 v[140:143], v156, s[4:7], s27 offen offset:0
    buffer_load_dwordx4 v[148:151], v156, s[4:7], s27 offen offset:1024
    s_waitcnt lgkmcnt(6)
    v_mfma_f32_16x16x32_bf16 v[20:23], v[88:91], v[108:111], v[20:23]
    v_mfma_f32_16x16x32_bf16 v[24:27], v[88:91], v[112:115], v[24:27]
    ds_read_b64_tr_b16 v[104:105], v164 offset:18592
    ds_read_b64_tr_b16 v[106:107], v164 offset:23200
    buffer_load_dwordx4 v[144:147], v157, s[4:7], s27 offen offset:0
    buffer_load_dwordx4 v[152:155], v157, s[4:7], s27 offen offset:1024
    s_add_u32 s27, s27, 2048
    s_waitcnt lgkmcnt(6)
    v_mfma_f32_16x16x32_bf16 v[28:31], v[92:95], v[108:111], v[28:31]
    v_mfma_f32_16x16x32_bf16 v[32:35], v[92:95], v[112:115], v[32:35]
    ds_read_b64_tr_b16 v[84:85], v164 offset:18624
    ds_read_b64_tr_b16 v[86:87], v164 offset:23232
    s_waitcnt lgkmcnt(6)
    v_mfma_f32_16x16x32_bf16 v[36:39], v[96:99], v[108:111], v[36:39]
    v_mfma_f32_16x16x32_bf16 v[40:43], v[96:99], v[112:115], v[40:43]
    ds_read_b64_tr_b16 v[88:89], v164 offset:18656
    ds_read_b64_tr_b16 v[90:91], v164 offset:23264
    s_waitcnt lgkmcnt(6)
    v_mfma_f32_16x16x32_bf16 v[44:47], v[100:103], v[108:111], v[44:47]
    v_mfma_f32_16x16x32_bf16 v[48:51], v[100:103], v[112:115], v[48:51]
    ds_read_b64_tr_b16 v[92:93], v164 offset:18688
    ds_read_b64_tr_b16 v[94:95], v164 offset:23296
    s_waitcnt lgkmcnt(6)
    v_mfma_f32_16x16x32_bf16 v[52:55], v[104:107], v[108:111], v[52:55]
    v_mfma_f32_16x16x32_bf16 v[56:59], v[104:107], v[112:115], v[56:59]
    ds_read_b64_tr_b16 v[96:97], v164 offset:27648
    ds_read_b64_tr_b16 v[98:99], v164 offset:32256
    s_waitcnt lgkmcnt(6)
    v_mfma_f32_16x16x32_bf16 v[60:63], v[84:87], v[108:111], v[60:63]
    v_mfma_f32_16x16x32_bf16 v[64:67], v[84:87], v[112:115], v[64:67]
    ds_read_b64_tr_b16 v[100:101], v164 offset:27680
    ds_read_b64_tr_b16 v[102:103], v164 offset:32288
    s_waitcnt lgkmcnt(6)
    v_mfma_f32_16x16x32_bf16 v[68:71], v[88:91], v[108:111], v[68:71]
    v_mfma_f32_16x16x32_bf16 v[72:75], v[88:91], v[112:115], v[72:75]
    ds_read_b64_tr_b16 v[104:105], v164 offset:27712
    ds_read_b64_tr_b16 v[106:107], v164 offset:32320
    s_waitcnt lgkmcnt(6)
    v_mfma_f32_16x16x32_bf16 v[76:79], v[92:95], v[108:111], v[76:79]
    v_mfma_f32_16x16x32_bf16 v[80:83], v[92:95], v[112:115], v[80:83]
    ds_read_b64_tr_b16 v[84:85], v164 offset:27744
    ds_read_b64_tr_b16 v[86:87], v164 offset:32352
    s_waitcnt lgkmcnt(6)
    v_mfma_f32_16x16x32_bf16 v[12:15], v[96:99], v[116:119], v[12:15]
    v_mfma_f32_16x16x32_bf16 v[16:19], v[96:99], v[120:123], v[16:19]
    ds_read_b64_tr_b16 v[88:89], v164 offset:27776
    ds_read_b64_tr_b16 v[90:91], v164 offset:32384
    s_waitcnt lgkmcnt(6)
    v_mfma_f32_16x16x32_bf16 v[20:23], v[100:103], v[116:119], v[20:23]
    v_mfma_f32_16x16x32_bf16 v[24:27], v[100:103], v[120:123], v[24:27]
    ds_read_b64_tr_b16 v[92:93], v164 offset:27808
    ds_read_b64_tr_b16 v[94:95], v164 offset:32416
    s_waitcnt lgkmcnt(6)
    v_mfma_f32_16x16x32_bf16 v[28:31], v[104:107], v[116:119], v[28:31]
    v_mfma_f32_16x16x32_bf16 v[32:35], v[104:107], v[120:123], v[32:35]
    ds_read_b64_tr_b16 v[96:97], v164 offset:27840
    ds_read_b64_tr_b16 v[98:99], v164 offset:32448
    s_waitcnt lgkmcnt(6)
    v_mfma_f32_16x16x32_bf16 v[36:39], v[84:87], v[116:119], v[36:39]
    v_mfma_f32_16x16x32_bf16 v[40:43], v[84:87], v[120:123], v[40:43]
    ds_read_b64_tr_b16 v[100:101], v164 offset:27872
    ds_read_b64_tr_b16 v[102:103], v164 offset:32480
    s_waitcnt lgkmcnt(6)
    v_mfma_f32_16x16x32_bf16 v[44:47], v[88:91], v[116:119], v[44:47]
    v_mfma_f32_16x16x32_bf16 v[48:51], v[88:91], v[120:123], v[48:51]
    ds_read_b64_tr_b16 v[104:105], v164 offset:27904
    ds_read_b64_tr_b16 v[106:107], v164 offset:32512
    s_waitcnt lgkmcnt(6)
    v_mfma_f32_16x16x32_bf16 v[52:55], v[92:95], v[116:119], v[52:55]
    v_mfma_f32_16x16x32_bf16 v[56:59], v[92:95], v[120:123], v[56:59]
    s_waitcnt lgkmcnt(4)
    v_mfma_f32_16x16x32_bf16 v[60:63], v[96:99], v[116:119], v[60:63]
    v_mfma_f32_16x16x32_bf16 v[64:67], v[96:99], v[120:123], v[64:67]
    s_waitcnt lgkmcnt(2)
    v_mfma_f32_16x16x32_bf16 v[68:71], v[100:103], v[116:119], v[68:71]
    v_mfma_f32_16x16x32_bf16 v[72:75], v[100:103], v[120:123], v[72:75]
    s_waitcnt lgkmcnt(0)
    v_mfma_f32_16x16x32_bf16 v[76:79], v[104:107], v[116:119], v[76:79]
    v_mfma_f32_16x16x32_bf16 v[80:83], v[104:107], v[120:123], v[80:83]
    s_waitcnt vmcnt(4)
    s_add_u32 s58, s58, 4
    v_mov_b32 v11, 1
    s_mov_b64 exec, 1
    ds_add_u32 v10, v11 offset:4
sy16:
    ds_read_b32 v11, v10 offset:4
    s_waitcnt lgkmcnt(0)
    v_readfirstlane_b32 s59, v11
    s_cmp_ge_u32 s59, s58
    s_cbranch_scc1 sd16
    s_sleep 1
    s_branch sy16
sd16:
    s_mov_b64 exec, -1
    ds_read_b64_tr_b16 v[84:85], v163 offset:0
    ds_read_b64_tr_b16 v[86:87], v163 offset:4608
    ds_read_b64_tr_b16 v[88:89], v163 offset:32
    ds_read_b64_tr_b16 v[90:91], v163 offset:4640
    ds_read_b64_tr_b16 v[92:93], v163 offset:64
    ds_read_b64_tr_b16 v[94:95], v163 offset:4672
    ds_read_b64_tr_b16 v[96:97], v163 offset:96
    ds_read_b64_tr_b16 v[98:99], v163 offset:4704
    s_waitcnt lgkmcnt(6)
    v_mfma_f32_16x16x32_bf16 v[12:15], v[84:87], v[124:127], v[12:15]
    v_mfma_f32_16x16x32_bf16 v[16:19], v[84:87], v[128:131], v[16:19]
    ds_read_b64_tr_b16 v[100:101], v163 offset:128
    ds_read_b64_tr_b16 v[102:103], v163 offset:4736
    s_add_u32 m0, s30, 124928
    s_nop 0
    buffer_load_dwordx4 v158, s[8:11], s28 offen lds
    s_waitcnt lgkmcnt(6)
    v_mfma_f32_16x16x32_bf16 v[20:23], v[88:91], v[124:127], v[20:23]
    v_mfma_f32_16x16x32_bf16 v[24:27], v[88:91], v[128:131], v[24:27]
    ds_read_b64_tr_b16 v[104:105], v163 offset:160
    ds_read_b64_tr_b16 v[106:107], v163 offset:4768
    s_add_u32 m0, s30, 125952
    s_nop 0
    buffer_load_dwordx4 v159, s[8:11], s28 offen lds
    s_waitcnt lgkmcnt(6)
    v_mfma_f32_16x16x32_bf16 v[28:31], v[92:95], v[124:127], v[28:31]
    v_mfma_f32_16x16x32_bf16 v[32:35], v[92:95], v[128:131], v[32:35]
    ds_read_b64_tr_b16 v[84:85], v163 offset:192
    ds_read_b64_tr_b16 v[86:87], v163 offset:4800
    buffer_load_dwordx4 v[108:111], v156, s[4:7], s27 offen offset:0
    buffer_load_dwordx4 v[116:119], v156, s[4:7], s27 offen offset:1024
    s_waitcnt lgkmcnt(6)
    v_mfma_f32_16x16x32_bf16 v[36:39], v[96:99], v[124:127], v[36:39]
    v_mfma_f32_16x16x32_bf16 v[40:43], v[96:99], v[128:131], v[40:43]
    ds_read_b64_tr_b16 v[88:89], v163 offset:224
    ds_read_b64_tr_b16 v[90:91], v163 offset:4832
    buffer_load_dwordx4 v[112:115], v157, s[4:7], s27 offen offset:0
    buffer_load_dwordx4 v[120:123], v157, s[4:7], s27 offen offset:1024
    s_add_u32 s27, s27, 2048
    s_waitcnt lgkmcnt(6)
    v_mfma_f32_16x16x32_bf16 v[44:47], v[100:103], v[124:127], v[44:47]
    v_mfma_f32_16x16x32_bf16 v[48:51], v[100:103], v[128:131], v[48:51]
    ds_read_b64_tr_b16 v[92:93], v163 offset:256
    ds_read_b64_tr_b16 v[94:95], v163 offset:4864
    s_add_u32 m0, s30, 126976
    s_nop 0
    buffer_load_dwordx4 v160, s[8:11], s28 offen lds
    s_waitcnt lgkmcnt(6)
    v_mfma_f32_16x16x32_bf16 v[52:55], v[104:107], v[124:127], v[52:55]
    v_mfma_f32_16x16x32_bf16 v[56:59], v[104:107], v[128:131], v[56:59]
    ds_read_b64_tr_b16 v[96:97], v163 offset:9216
    ds_read_b64_tr_b16 v[98:99], v163 offset:13824
    s_cmp_eq_u32 s29, 3
    s_cbranch_scc1 f2sk17
    s_add_u32 m0, s30, 128000
    s_nop 0
    buffer_load_dwordx4 v161, s[8:11], s28 offen lds
    s_add_u32 m0, s30, 129024
    s_nop 0
    buffer_load_dwordx4 v162, s[8:11], s28 offen lds
    f2sk17:
    s_add_u32 s28, s28, 73728
    s_waitcnt lgkmcnt(6)
    v_mfma_f32_16x16x32_bf16 v[60:63], v[84:87], v[124:127], v[60:63]
    v_mfma_f32_16x16x32_bf16 v[64:67], v[84:87], v[128:131], v[64:67]
    ds_read_b64_tr_b16 v[100:101], v163 offset:9248
    ds_read_b64_tr_b16 v[102:103], v163 offset:13856
    s_add_u32 m0, s30, 143360
    s_nop 0
    buffer_load_dwordx4 v158, s[8:11], s28 offen lds
    s_waitcnt lgkmcnt(6)
    v_mfma_f32_16x16x32_bf16 v[68:71], v[88:91], v[124:127], v[68:71]
    v_mfma_f32_16x16x32_bf16 v[72:75], v[88:91], v[128:131], v[72:75]
    ds_read_b64_tr_b16 v[104:105], v163 offset:9280
    ds_read_b64_tr_b16 v[106:107], v163 offset:13888
    s_add_u32 m0, s30, 144384
    s_nop 0
    buffer_load_dwordx4 v159, s[8:11], s28 offen lds
    s_waitcnt lgkmcnt(6)
    v_mfma_f32_16x16x32_bf16 v[76:79], v[92:95], v[124:127], v[76:79]
    v_mfma_f32_16x16x32_bf16 v[80:83], v[92:95], v[128:131], v[80:83]
    ds_read_b64_tr_b16 v[84:85], v163 offset:9312
    ds_read_b64_tr_b16 v[86:87], v163 offset:13920
    s_add_u32 m0, s30, 145408
    s_nop 0
    buffer_load_dwordx4 v160, s[8:11], s28 offen lds
    s_waitcnt lgkmcnt(6)
    v_mfma_f32_16x16x32_bf16 v[12:15], v[96:99], v[132:135], v[12:15]
    v_mfma_f32_16x16x32_bf16 v[16:19], v[96:99], v[136:139], v[16:19]
    ds_read_b64_tr_b16 v[88:89], v163 offset:9344
    ds_read_b64_tr_b16 v[90:91], v163 offset:13952
    s_cmp_eq_u32 s29, 3
    s_cbranch_scc1 f2sk18
    s_add_u32 m0, s30, 146432
    s_nop 0
    buffer_load_dwordx4 v161, s[8:11], s28 offen lds
    s_add_u32 m0, s30, 147456
    s_nop 0
    buffer_load_dwordx4 v162, s[8:11], s28 offen lds
    f2sk18:
    s_add_u32 s28, s28, 73728
    s_waitcnt lgkmcnt(6)
    v_mfma_f32_16x16x32_bf16 v[20:23], v[100:103], v[132:135], v[20:23]
    v_mfma_f32_16x16x32_bf16 v[24:27], v[100:103], v[136:139], v[24:27]
    ds_read_b64_tr_b16 v[92:93], v163 offset:9376
    ds_read_b64_tr_b16 v[94:95], v163 offset:13984
    s_waitcnt lgkmcnt(6)
    v_mfma_f32_16x16x32_bf16 v[28:31], v[104:107], v[132:135], v[28:31]
    v_mfma_f32_16x16x32_bf16 v[32:35], v[104:107], v[136:139], v[32:35]
    ds_read_b64_tr_b16 v[96:97], v163 offset:9408
    ds_read_b64_tr_b16 v[98:99], v163 offset:14016
    s_waitcnt lgkmcnt(6)
    v_mfma_f32_16x16x32_bf16 v[36:39], v[84:87], v[132:135], v[36:39]
    v_mfma_f32_16x16x32_bf16 v[40:43], v[84:87], v[136:139], v[40:43]
    ds_read_b64_tr_b16 v[100:101], v163 offset:9440
    ds_read_b64_tr_b16 v[102:103], v163 offset:14048
    s_waitcnt lgkmcnt(6)
    v_mfma_f32_16x16x32_bf16 v[44:47], v[88:91], v[132:135], v[44:47]
    v_mfma_f32_16x16x32_bf16 v[48:51], v[88:91], v[136:139], v[48:51]
    ds_read_b64_tr_b16 v[104:105], v163 offset:9472
    ds_read_b64_tr_b16 v[106:107], v163 offset:14080
    s_waitcnt lgkmcnt(6)
    v_mfma_f32_16x16x32_bf16 v[52:55], v[92:95], v[132:135], v[52:55]
    v_mfma_f32_16x16x32_bf16 v[56:59], v[92:95], v[136:139], v[56:59]
    ds_read_b64_tr_b16 v[84:85], v163 offset:18432
    ds_read_b64_tr_b16 v[86:87], v163 offset:23040
    s_waitcnt lgkmcnt(6)
    v_mfma_f32_16x16x32_bf16 v[60:63], v[96:99], v[132:135], v[60:63]
    v_mfma_f32_16x16x32_bf16 v[64:67], v[96:99], v[136:139], v[64:67]
    ds_read_b64_tr_b16 v[88:89], v163 offset:18464
    ds_read_b64_tr_b16 v[90:91], v163 offset:23072
    s_waitcnt lgkmcnt(6)
    v_mfma_f32_16x16x32_bf16 v[68:71], v[100:103], v[132:135], v[68:71]
    v_mfma_f32_16x16x32_bf16 v[72:75], v[100:103], v[136:139], v[72:75]
    ds_read_b64_tr_b16 v[92:93], v163 offset:18496
    ds_read_b64_tr_b16 v[94:95], v163 offset:23104
    s_waitcnt lgkmcnt(6)
    v_mfma_f32_16x16x32_bf16 v[76:79], v[104:107], v[132:135], v[76:79]
    v_mfma_f32_16x16x32_bf16 v[80:83], v[104:107], v[136:139], v[80:83]
    ds_read_b64_tr_b16 v[96:97], v163 offset:18528
    ds_read_b64_tr_b16 v[98:99], v163 offset:23136
    s_waitcnt vmcnt(10)
    s_waitcnt lgkmcnt(6)
    v_mfma_f32_16x16x32_bf16 v[12:15], v[84:87], v[140:143], v[12:15]
    v_mfma_f32_16x16x32_bf16 v[16:19], v[84:87], v[144:147], v[16:19]
    ds_read_b64_tr_b16 v[100:101], v163 offset:18560
    ds_read_b64_tr_b16 v[102:103], v163 offset:23168
    buffer_load_dwordx4 v[124:127], v156, s[4:7], s27 offen offset:0
    buffer_load_dwordx4 v[132:135], v156, s[4:7], s27 offen offset:1024
    s_waitcnt lgkmcnt(6)
    v_mfma_f32_16x16x32_bf16 v[20:23], v[88:91], v[140:143], v[20:23]
    v_mfma_f32_16x16x32_bf16 v[24:27], v[88:91], v[144:147], v[24:27]
    ds_read_b64_tr_b16 v[104:105], v163 offset:18592
    ds_read_b64_tr_b16 v[106:107], v163 offset:23200
    buffer_load_dwordx4 v[128:131], v157, s[4:7], s27 offen offset:0
    buffer_load_dwordx4 v[136:139], v157, s[4:7], s27 offen offset:1024
    s_add_u32 s27, s27, 2048
    s_waitcnt lgkmcnt(6)
    v_mfma_f32_16x16x32_bf16 v[28:31], v[92:95], v[140:143], v[28:31]
    v_mfma_f32_16x16x32_bf16 v[32:35], v[92:95], v[144:147], v[32:35]
    ds_read_b64_tr_b16 v[84:85], v163 offset:18624
    ds_read_b64_tr_b16 v[86:87], v163 offset:23232
    s_waitcnt lgkmcnt(6)
    v_mfma_f32_16x16x32_bf16 v[36:39], v[96:99], v[140:143], v[36:39]
    v_mfma_f32_16x16x32_bf16 v[40:43], v[96:99], v[144:147], v[40:43]
    ds_read_b64_tr_b16 v[88:89], v163 offset:18656
    ds_read_b64_tr_b16 v[90:91], v163 offset:23264
    s_waitcnt lgkmcnt(6)
    v_mfma_f32_16x16x32_bf16 v[44:47], v[100:103], v[140:143], v[44:47]
    v_mfma_f32_16x16x32_bf16 v[48:51], v[100:103], v[144:147], v[48:51]
    ds_read_b64_tr_b16 v[92:93], v163 offset:18688
    ds_read_b64_tr_b16 v[94:95], v163 offset:23296
    s_waitcnt lgkmcnt(6)
    v_mfma_f32_16x16x32_bf16 v[52:55], v[104:107], v[140:143], v[52:55]
    v_mfma_f32_16x16x32_bf16 v[56:59], v[104:107], v[144:147], v[56:59]
    ds_read_b64_tr_b16 v[96:97], v163 offset:27648
    ds_read_b64_tr_b16 v[98:99], v163 offset:32256
    s_waitcnt lgkmcnt(6)
    v_mfma_f32_16x16x32_bf16 v[60:63], v[84:87], v[140:143], v[60:63]
    v_mfma_f32_16x16x32_bf16 v[64:67], v[84:87], v[144:147], v[64:67]
    ds_read_b64_tr_b16 v[100:101], v163 offset:27680
    ds_read_b64_tr_b16 v[102:103], v163 offset:32288
    s_waitcnt lgkmcnt(6)
    v_mfma_f32_16x16x32_bf16 v[68:71], v[88:91], v[140:143], v[68:71]
    v_mfma_f32_16x16x32_bf16 v[72:75], v[88:91], v[144:147], v[72:75]
    ds_read_b64_tr_b16 v[104:105], v163 offset:27712
    ds_read_b64_tr_b16 v[106:107], v163 offset:32320
    s_waitcnt lgkmcnt(6)
    v_mfma_f32_16x16x32_bf16 v[76:79], v[92:95], v[140:143], v[76:79]
    v_mfma_f32_16x16x32_bf16 v[80:83], v[92:95], v[144:147], v[80:83]
    ds_read_b64_tr_b16 v[84:85], v163 offset:27744
    ds_read_b64_tr_b16 v[86:87], v163 offset:32352
    s_waitcnt lgkmcnt(6)
    v_mfma_f32_16x16x32_bf16 v[12:15], v[96:99], v[148:151], v[12:15]
    v_mfma_f32_16x16x32_bf16 v[16:19], v[96:99], v[152:155], v[16:19]
    ds_read_b64_tr_b16 v[88:89], v163 offset:27776
    ds_read_b64_tr_b16 v[90:91], v163 offset:32384
    s_waitcnt lgkmcnt(6)
    v_mfma_f32_16x16x32_bf16 v[20:23], v[100:103], v[148:151], v[20:23]
    v_mfma_f32_16x16x32_bf16 v[24:27], v[100:103], v[152:155], v[24:27]
    ds_read_b64_tr_b16 v[92:93], v163 offset:27808
    ds_read_b64_tr_b16 v[94:95], v163 offset:32416
    s_waitcnt lgkmcnt(6)
    v_mfma_f32_16x16x32_bf16 v[28:31], v[104:107], v[148:151], v[28:31]
    v_mfma_f32_16x16x32_bf16 v[32:35], v[104:107], v[152:155], v[32:35]
    ds_read_b64_tr_b16 v[96:97], v163 offset:27840
    ds_read_b64_tr_b16 v[98:99], v163 offset:32448
    s_waitcnt lgkmcnt(6)
    v_mfma_f32_16x16x32_bf16 v[36:39], v[84:87], v[148:151], v[36:39]
    v_mfma_f32_16x16x32_bf16 v[40:43], v[84:87], v[152:155], v[40:43]
    ds_read_b64_tr_b16 v[100:101], v163 offset:27872
    ds_read_b64_tr_b16 v[102:103], v163 offset:32480
    s_waitcnt lgkmcnt(6)
    v_mfma_f32_16x16x32_bf16 v[44:47], v[88:91], v[148:151], v[44:47]
    v_mfma_f32_16x16x32_bf16 v[48:51], v[88:91], v[152:155], v[48:51]
    ds_read_b64_tr_b16 v[104:105], v163 offset:27904
    ds_read_b64_tr_b16 v[106:107], v163 offset:32512
    s_waitcnt lgkmcnt(6)
    v_mfma_f32_16x16x32_bf16 v[52:55], v[92:95], v[148:151], v[52:55]
    v_mfma_f32_16x16x32_bf16 v[56:59], v[92:95], v[152:155], v[56:59]
    s_waitcnt lgkmcnt(4)
    v_mfma_f32_16x16x32_bf16 v[60:63], v[96:99], v[148:151], v[60:63]
    v_mfma_f32_16x16x32_bf16 v[64:67], v[96:99], v[152:155], v[64:67]
    s_waitcnt lgkmcnt(2)
    v_mfma_f32_16x16x32_bf16 v[68:71], v[100:103], v[148:151], v[68:71]
    v_mfma_f32_16x16x32_bf16 v[72:75], v[100:103], v[152:155], v[72:75]
    s_waitcnt lgkmcnt(0)
    v_mfma_f32_16x16x32_bf16 v[76:79], v[104:107], v[148:151], v[76:79]
    v_mfma_f32_16x16x32_bf16 v[80:83], v[104:107], v[152:155], v[80:83]
    s_waitcnt vmcnt(4)
    s_add_u32 s58, s58, 4
    v_mov_b32 v11, 1
    s_mov_b64 exec, 1
    ds_add_u32 v10, v11 offset:4
sy19:
    ds_read_b32 v11, v10 offset:4
    s_waitcnt lgkmcnt(0)
    v_readfirstlane_b32 s59, v11
    s_cmp_ge_u32 s59, s58
    s_cbranch_scc1 sd19
    s_sleep 1
    s_branch sy19
sd19:
    s_mov_b64 exec, -1
    ds_read_b64_tr_b16 v[84:85], v164 offset:0
    ds_read_b64_tr_b16 v[86:87], v164 offset:4608
    ds_read_b64_tr_b16 v[88:89], v164 offset:32
    ds_read_b64_tr_b16 v[90:91], v164 offset:4640
    ds_read_b64_tr_b16 v[92:93], v164 offset:64
    ds_read_b64_tr_b16 v[94:95], v164 offset:4672
    ds_read_b64_tr_b16 v[96:97], v164 offset:96
    ds_read_b64_tr_b16 v[98:99], v164 offset:4704
    s_waitcnt lgkmcnt(6)
    v_mfma_f32_16x16x32_bf16 v[12:15], v[84:87], v[108:111], v[12:15]
    v_mfma_f32_16x16x32_bf16 v[16:19], v[84:87], v[112:115], v[16:19]
    ds_read_b64_tr_b16 v[100:101], v164 offset:128
    ds_read_b64_tr_b16 v[102:103], v164 offset:4736
    s_add_u32 m0, s30, 88064
    s_nop 0
    buffer_load_dwordx4 v158, s[8:11], s28 offen lds
    s_waitcnt lgkmcnt(6)
    v_mfma_f32_16x16x32_bf16 v[20:23], v[88:91], v[108:111], v[20:23]
    v_mfma_f32_16x16x32_bf16 v[24:27], v[88:91], v[112:115], v[24:27]
    ds_read_b64_tr_b16 v[104:105], v164 offset:160
    ds_read_b64_tr_b16 v[106:107], v164 offset:4768
    s_add_u32 m0, s30, 89088
    s_nop 0
    buffer_load_dwordx4 v159, s[8:11], s28 offen lds
    s_waitcnt lgkmcnt(6)
    v_mfma_f32_16x16x32_bf16 v[28:31], v[92:95], v[108:111], v[28:31]
    v_mfma_f32_16x16x32_bf16 v[32:35], v[92:95], v[112:115], v[32:35]
    ds_read_b64_tr_b16 v[84:85], v164 offset:192
    ds_read_b64_tr_b16 v[86:87], v164 offset:4800
    buffer_load_dwordx4 v[140:143], v156, s[4:7], s27 offen offset:0
    buffer_load_dwordx4 v[148:151], v156, s[4:7], s27 offen offset:1024
    s_waitcnt lgkmcnt(6)
    v_mfma_f32_16x16x32_bf16 v[36:39], v[96:99], v[108:111], v[36:39]
    v_mfma_f32_16x16x32_bf16 v[40:43], v[96:99], v[112:115], v[40:43]
    ds_read_b64_tr_b16 v[88:89], v164 offset:224
    ds_read_b64_tr_b16 v[90:91], v164 offset:4832
    buffer_load_dwordx4 v[144:147], v157, s[4:7], s27 offen offset:0
    buffer_load_dwordx4 v[152:155], v157, s[4:7], s27 offen offset:1024
    s_add_u32 s27, s27, 2048
    s_waitcnt lgkmcnt(6)
    v_mfma_f32_16x16x32_bf16 v[44:47], v[100:103], v[108:111], v[44:47]
    v_mfma_f32_16x16x32_bf16 v[48:51], v[100:103], v[112:115], v[48:51]
    ds_read_b64_tr_b16 v[92:93], v164 offset:256
    ds_read_b64_tr_b16 v[94:95], v164 offset:4864
    s_add_u32 m0, s30, 90112
    s_nop 0
    buffer_load_dwordx4 v160, s[8:11], s28 offen lds
    s_waitcnt lgkmcnt(6)
    v_mfma_f32_16x16x32_bf16 v[52:55], v[104:107], v[108:111], v[52:55]
    v_mfma_f32_16x16x32_bf16 v[56:59], v[104:107], v[112:115], v[56:59]
    ds_read_b64_tr_b16 v[96:97], v164 offset:9216
    ds_read_b64_tr_b16 v[98:99], v164 offset:13824
    s_cmp_eq_u32 s29, 3
    s_cbranch_scc1 f2sk20
    s_add_u32 m0, s30, 91136
    s_nop 0
    buffer_load_dwordx4 v161, s[8:11], s28 offen lds
    s_add_u32 m0, s30, 92160
    s_nop 0
    buffer_load_dwordx4 v162, s[8:11], s28 offen lds
    f2sk20:
    s_add_u32 s28, s28, 73728
    s_waitcnt lgkmcnt(6)
    v_mfma_f32_16x16x32_bf16 v[60:63], v[84:87], v[108:111], v[60:63]
    v_mfma_f32_16x16x32_bf16 v[64:67], v[84:87], v[112:115], v[64:67]
    ds_read_b64_tr_b16 v[100:101], v164 offset:9248
    ds_read_b64_tr_b16 v[102:103], v164 offset:13856
    s_add_u32 m0, s30, 106496
    s_nop 0
    buffer_load_dwordx4 v158, s[8:11], s28 offen lds
    s_waitcnt lgkmcnt(6)
    v_mfma_f32_16x16x32_bf16 v[68:71], v[88:91], v[108:111], v[68:71]
    v_mfma_f32_16x16x32_bf16 v[72:75], v[88:91], v[112:115], v[72:75]
    ds_read_b64_tr_b16 v[104:105], v164 offset:9280
    ds_read_b64_tr_b16 v[106:107], v164 offset:13888
    s_add_u32 m0, s30, 107520
    s_nop 0
    buffer_load_dwordx4 v159, s[8:11], s28 offen lds
    s_waitcnt lgkmcnt(6)
    v_mfma_f32_16x16x32_bf16 v[76:79], v[92:95], v[108:111], v[76:79]
    v_mfma_f32_16x16x32_bf16 v[80:83], v[92:95], v[112:115], v[80:83]
    ds_read_b64_tr_b16 v[84:85], v164 offset:9312
    ds_read_b64_tr_b16 v[86:87], v164 offset:13920
    s_add_u32 m0, s30, 108544
    s_nop 0
    buffer_load_dwordx4 v160, s[8:11], s28 offen lds
    s_waitcnt lgkmcnt(6)
    v_mfma_f32_16x16x32_bf16 v[12:15], v[96:99], v[116:119], v[12:15]
    v_mfma_f32_16x16x32_bf16 v[16:19], v[96:99], v[120:123], v[16:19]
    ds_read_b64_tr_b16 v[88:89], v164 offset:9344
    ds_read_b64_tr_b16 v[90:91], v164 offset:13952
    s_cmp_eq_u32 s29, 3
    s_cbranch_scc1 f2sk21
    s_add_u32 m0, s30, 109568
    s_nop 0
    buffer_load_dwordx4 v161, s[8:11], s28 offen lds
    s_add_u32 m0, s30, 110592
    s_nop 0
    buffer_load_dwordx4 v162, s[8:11], s28 offen lds
    f2sk21:
    s_add_u32 s28, s28, 73728
    s_waitcnt lgkmcnt(6)
    v_mfma_f32_16x16x32_bf16 v[20:23], v[100:103], v[116:119], v[20:23]
    v_mfma_f32_16x16x32_bf16 v[24:27], v[100:103], v[120:123], v[24:27]
    ds_read_b64_tr_b16 v[92:93], v164 offset:9376
    ds_read_b64_tr_b16 v[94:95], v164 offset:13984
    s_waitcnt lgkmcnt(6)
    v_mfma_f32_16x16x32_bf16 v[28:31], v[104:107], v[116:119], v[28:31]
    v_mfma_f32_16x16x32_bf16 v[32:35], v[104:107], v[120:123], v[32:35]
    ds_read_b64_tr_b16 v[96:97], v164 offset:9408
    ds_read_b64_tr_b16 v[98:99], v164 offset:14016
    s_waitcnt lgkmcnt(6)
    v_mfma_f32_16x16x32_bf16 v[36:39], v[84:87], v[116:119], v[36:39]
    v_mfma_f32_16x16x32_bf16 v[40:43], v[84:87], v[120:123], v[40:43]
    ds_read_b64_tr_b16 v[100:101], v164 offset:9440
    ds_read_b64_tr_b16 v[102:103], v164 offset:14048
    s_waitcnt lgkmcnt(6)
    v_mfma_f32_16x16x32_bf16 v[44:47], v[88:91], v[116:119], v[44:47]
    v_mfma_f32_16x16x32_bf16 v[48:51], v[88:91], v[120:123], v[48:51]
    ds_read_b64_tr_b16 v[104:105], v164 offset:9472
    ds_read_b64_tr_b16 v[106:107], v164 offset:14080
    s_waitcnt lgkmcnt(6)
    v_mfma_f32_16x16x32_bf16 v[52:55], v[92:95], v[116:119], v[52:55]
    v_mfma_f32_16x16x32_bf16 v[56:59], v[92:95], v[120:123], v[56:59]
    ds_read_b64_tr_b16 v[84:85], v164 offset:18432
    ds_read_b64_tr_b16 v[86:87], v164 offset:23040
    s_waitcnt lgkmcnt(6)
    v_mfma_f32_16x16x32_bf16 v[60:63], v[96:99], v[116:119], v[60:63]
    v_mfma_f32_16x16x32_bf16 v[64:67], v[96:99], v[120:123], v[64:67]
    ds_read_b64_tr_b16 v[88:89], v164 offset:18464
    ds_read_b64_tr_b16 v[90:91], v164 offset:23072
    s_waitcnt lgkmcnt(6)
    v_mfma_f32_16x16x32_bf16 v[68:71], v[100:103], v[116:119], v[68:71]
    v_mfma_f32_16x16x32_bf16 v[72:75], v[100:103], v[120:123], v[72:75]
    ds_read_b64_tr_b16 v[92:93], v164 offset:18496
    ds_read_b64_tr_b16 v[94:95], v164 offset:23104
    s_waitcnt lgkmcnt(6)
    v_mfma_f32_16x16x32_bf16 v[76:79], v[104:107], v[116:119], v[76:79]
    v_mfma_f32_16x16x32_bf16 v[80:83], v[104:107], v[120:123], v[80:83]
    ds_read_b64_tr_b16 v[96:97], v164 offset:18528
    ds_read_b64_tr_b16 v[98:99], v164 offset:23136
    s_waitcnt vmcnt(10)
    s_waitcnt lgkmcnt(6)
    v_mfma_f32_16x16x32_bf16 v[12:15], v[84:87], v[124:127], v[12:15]
    v_mfma_f32_16x16x32_bf16 v[16:19], v[84:87], v[128:131], v[16:19]
    ds_read_b64_tr_b16 v[100:101], v164 offset:18560
    ds_read_b64_tr_b16 v[102:103], v164 offset:23168
    buffer_load_dwordx4 v[108:111], v156, s[4:7], s27 offen offset:0
    buffer_load_dwordx4 v[116:119], v156, s[4:7], s27 offen offset:1024
    s_waitcnt lgkmcnt(6)
    v_mfma_f32_16x16x32_bf16 v[20:23], v[88:91], v[124:127], v[20:23]
    v_mfma_f32_16x16x32_bf16 v[24:27], v[88:91], v[128:131], v[24:27]
    ds_read_b64_tr_b16 v[104:105], v164 offset:18592
    ds_read_b64_tr_b16 v[106:107], v164 offset:23200
    buffer_load_dwordx4 v[112:115], v157, s[4:7], s27 offen offset:0
    buffer_load_dwordx4 v[120:123], v157, s[4:7], s27 offen offset:1024
    s_add_u32 s27, s27, 2048
    s_waitcnt lgkmcnt(6)
    v_mfma_f32_16x16x32_bf16 v[28:31], v[92:95], v[124:127], v[28:31]
    v_mfma_f32_16x16x32_bf16 v[32:35], v[92:95], v[128:131], v[32:35]
    ds_read_b64_tr_b16 v[84:85], v164 offset:18624
    ds_read_b64_tr_b16 v[86:87], v164 offset:23232
    s_waitcnt lgkmcnt(6)
    v_mfma_f32_16x16x32_bf16 v[36:39], v[96:99], v[124:127], v[36:39]
    v_mfma_f32_16x16x32_bf16 v[40:43], v[96:99], v[128:131], v[40:43]
    ds_read_b64_tr_b16 v[88:89], v164 offset:18656
    ds_read_b64_tr_b16 v[90:91], v164 offset:23264
    s_waitcnt lgkmcnt(6)
    v_mfma_f32_16x16x32_bf16 v[44:47], v[100:103], v[124:127], v[44:47]
    v_mfma_f32_16x16x32_bf16 v[48:51], v[100:103], v[128:131], v[48:51]
    ds_read_b64_tr_b16 v[92:93], v164 offset:18688
    ds_read_b64_tr_b16 v[94:95], v164 offset:23296
    s_waitcnt lgkmcnt(6)
    v_mfma_f32_16x16x32_bf16 v[52:55], v[104:107], v[124:127], v[52:55]
    v_mfma_f32_16x16x32_bf16 v[56:59], v[104:107], v[128:131], v[56:59]
    ds_read_b64_tr_b16 v[96:97], v164 offset:27648
    ds_read_b64_tr_b16 v[98:99], v164 offset:32256
    s_waitcnt lgkmcnt(6)
    v_mfma_f32_16x16x32_bf16 v[60:63], v[84:87], v[124:127], v[60:63]
    v_mfma_f32_16x16x32_bf16 v[64:67], v[84:87], v[128:131], v[64:67]
    ds_read_b64_tr_b16 v[100:101], v164 offset:27680
    ds_read_b64_tr_b16 v[102:103], v164 offset:32288
    s_waitcnt lgkmcnt(6)
    v_mfma_f32_16x16x32_bf16 v[68:71], v[88:91], v[124:127], v[68:71]
    v_mfma_f32_16x16x32_bf16 v[72:75], v[88:91], v[128:131], v[72:75]
    ds_read_b64_tr_b16 v[104:105], v164 offset:27712
    ds_read_b64_tr_b16 v[106:107], v164 offset:32320
    s_waitcnt lgkmcnt(6)
    v_mfma_f32_16x16x32_bf16 v[76:79], v[92:95], v[124:127], v[76:79]
    v_mfma_f32_16x16x32_bf16 v[80:83], v[92:95], v[128:131], v[80:83]
    ds_read_b64_tr_b16 v[84:85], v164 offset:27744
    ds_read_b64_tr_b16 v[86:87], v164 offset:32352
    s_waitcnt lgkmcnt(6)
    v_mfma_f32_16x16x32_bf16 v[12:15], v[96:99], v[132:135], v[12:15]
    v_mfma_f32_16x16x32_bf16 v[16:19], v[96:99], v[136:139], v[16:19]
    ds_read_b64_tr_b16 v[88:89], v164 offset:27776
    ds_read_b64_tr_b16 v[90:91], v164 offset:32384
    s_waitcnt lgkmcnt(6)
    v_mfma_f32_16x16x32_bf16 v[20:23], v[100:103], v[132:135], v[20:23]
    v_mfma_f32_16x16x32_bf16 v[24:27], v[100:103], v[136:139], v[24:27]
    ds_read_b64_tr_b16 v[92:93], v164 offset:27808
    ds_read_b64_tr_b16 v[94:95], v164 offset:32416
    s_waitcnt lgkmcnt(6)
    v_mfma_f32_16x16x32_bf16 v[28:31], v[104:107], v[132:135], v[28:31]
    v_mfma_f32_16x16x32_bf16 v[32:35], v[104:107], v[136:139], v[32:35]
    ds_read_b64_tr_b16 v[96:97], v164 offset:27840
    ds_read_b64_tr_b16 v[98:99], v164 offset:32448
    s_waitcnt lgkmcnt(6)
    v_mfma_f32_16x16x32_bf16 v[36:39], v[84:87], v[132:135], v[36:39]
    v_mfma_f32_16x16x32_bf16 v[40:43], v[84:87], v[136:139], v[40:43]
    ds_read_b64_tr_b16 v[100:101], v164 offset:27872
    ds_read_b64_tr_b16 v[102:103], v164 offset:32480
    s_waitcnt lgkmcnt(6)
    v_mfma_f32_16x16x32_bf16 v[44:47], v[88:91], v[132:135], v[44:47]
    v_mfma_f32_16x16x32_bf16 v[48:51], v[88:91], v[136:139], v[48:51]
    ds_read_b64_tr_b16 v[104:105], v164 offset:27904
    ds_read_b64_tr_b16 v[106:107], v164 offset:32512
    s_waitcnt lgkmcnt(6)
    v_mfma_f32_16x16x32_bf16 v[52:55], v[92:95], v[132:135], v[52:55]
    v_mfma_f32_16x16x32_bf16 v[56:59], v[92:95], v[136:139], v[56:59]
    s_waitcnt lgkmcnt(4)
    v_mfma_f32_16x16x32_bf16 v[60:63], v[96:99], v[132:135], v[60:63]
    v_mfma_f32_16x16x32_bf16 v[64:67], v[96:99], v[136:139], v[64:67]
    s_waitcnt lgkmcnt(2)
    v_mfma_f32_16x16x32_bf16 v[68:71], v[100:103], v[132:135], v[68:71]
    v_mfma_f32_16x16x32_bf16 v[72:75], v[100:103], v[136:139], v[72:75]
    s_waitcnt lgkmcnt(0)
    v_mfma_f32_16x16x32_bf16 v[76:79], v[104:107], v[132:135], v[76:79]
    v_mfma_f32_16x16x32_bf16 v[80:83], v[104:107], v[136:139], v[80:83]
    s_waitcnt vmcnt(4)
    s_add_u32 s58, s58, 4
    v_mov_b32 v11, 1
    s_mov_b64 exec, 1
    ds_add_u32 v10, v11 offset:4
sy22:
    ds_read_b32 v11, v10 offset:4
    s_waitcnt lgkmcnt(0)
    v_readfirstlane_b32 s59, v11
    s_cmp_ge_u32 s59, s58
    s_cbranch_scc1 sd22
    s_sleep 1
    s_branch sy22
sd22:
    s_mov_b64 exec, -1
    ds_read_b64_tr_b16 v[84:85], v163 offset:0
    ds_read_b64_tr_b16 v[86:87], v163 offset:4608
    ds_read_b64_tr_b16 v[88:89], v163 offset:32
    ds_read_b64_tr_b16 v[90:91], v163 offset:4640
    ds_read_b64_tr_b16 v[92:93], v163 offset:64
    ds_read_b64_tr_b16 v[94:95], v163 offset:4672
    ds_read_b64_tr_b16 v[96:97], v163 offset:96
    ds_read_b64_tr_b16 v[98:99], v163 offset:4704
    s_waitcnt lgkmcnt(6)
    v_mfma_f32_16x16x32_bf16 v[12:15], v[84:87], v[140:143], v[12:15]
    v_mfma_f32_16x16x32_bf16 v[16:19], v[84:87], v[144:147], v[16:19]
    ds_read_b64_tr_b16 v[100:101], v163 offset:128
    ds_read_b64_tr_b16 v[102:103], v163 offset:4736
    s_add_u32 m0, s30, 124928
    s_nop 0
    buffer_load_dwordx4 v158, s[8:11], s28 offen lds
    s_waitcnt lgkmcnt(6)
    v_mfma_f32_16x16x32_bf16 v[20:23], v[88:91], v[140:143], v[20:23]
    v_mfma_f32_16x16x32_bf16 v[24:27], v[88:91], v[144:147], v[24:27]
    ds_read_b64_tr_b16 v[104:105], v163 offset:160
    ds_read_b64_tr_b16 v[106:107], v163 offset:4768
    s_add_u32 m0, s30, 125952
    s_nop 0
    buffer_load_dwordx4 v159, s[8:11], s28 offen lds
    s_waitcnt lgkmcnt(6)
    v_mfma_f32_16x16x32_bf16 v[28:31], v[92:95], v[140:143], v[28:31]
    v_mfma_f32_16x16x32_bf16 v[32:35], v[92:95], v[144:147], v[32:35]
    ds_read_b64_tr_b16 v[84:85], v163 offset:192
    ds_read_b64_tr_b16 v[86:87], v163 offset:4800
    buffer_load_dwordx4 v[124:127], v156, s[4:7], s27 offen offset:0
    buffer_load_dwordx4 v[132:135], v156, s[4:7], s27 offen offset:1024
    s_waitcnt lgkmcnt(6)
    v_mfma_f32_16x16x32_bf16 v[36:39], v[96:99], v[140:143], v[36:39]
    v_mfma_f32_16x16x32_bf16 v[40:43], v[96:99], v[144:147], v[40:43]
    ds_read_b64_tr_b16 v[88:89], v163 offset:224
    ds_read_b64_tr_b16 v[90:91], v163 offset:4832
    buffer_load_dwordx4 v[128:131], v157, s[4:7], s27 offen offset:0
    buffer_load_dwordx4 v[136:139], v157, s[4:7], s27 offen offset:1024
    s_add_u32 s27, s27, 2048
    s_waitcnt lgkmcnt(6)
    v_mfma_f32_16x16x32_bf16 v[44:47], v[100:103], v[140:143], v[44:47]
    v_mfma_f32_16x16x32_bf16 v[48:51], v[100:103], v[144:147], v[48:51]
    ds_read_b64_tr_b16 v[92:93], v163 offset:256
    ds_read_b64_tr_b16 v[94:95], v163 offset:4864
    s_add_u32 m0, s30, 126976
    s_nop 0
    buffer_load_dwordx4 v160, s[8:11], s28 offen lds
    s_waitcnt lgkmcnt(6)
    v_mfma_f32_16x16x32_bf16 v[52:55], v[104:107], v[140:143], v[52:55]
    v_mfma_f32_16x16x32_bf16 v[56:59], v[104:107], v[144:147], v[56:59]
    ds_read_b64_tr_b16 v[96:97], v163 offset:9216
    ds_read_b64_tr_b16 v[98:99], v163 offset:13824
    s_cmp_eq_u32 s29, 3
    s_cbranch_scc1 f2sk23
    s_add_u32 m0, s30, 128000
    s_nop 0
    buffer_load_dwordx4 v161, s[8:11], s28 offen lds
    s_add_u32 m0, s30, 129024
    s_nop 0
    buffer_load_dwordx4 v162, s[8:11], s28 offen lds
    f2sk23:
    s_add_u32 s28, s28, 73728
    s_waitcnt lgkmcnt(6)
    v_mfma_f32_16x16x32_bf16 v[60:63], v[84:87], v[140:143], v[60:63]
    v_mfma_f32_16x16x32_bf16 v[64:67], v[84:87], v[144:147], v[64:67]
    ds_read_b64_tr_b16 v[100:101], v163 offset:9248
    ds_read_b64_tr_b16 v[102:103], v163 offset:13856
    s_add_u32 m0, s30, 143360
    s_nop 0
    buffer_load_dwordx4 v158, s[8:11], s28 offen lds
    s_waitcnt lgkmcnt(6)
    v_mfma_f32_16x16x32_bf16 v[68:71], v[88:91], v[140:143], v[68:71]
    v_mfma_f32_16x16x32_bf16 v[72:75], v[88:91], v[144:147], v[72:75]
    ds_read_b64_tr_b16 v[104:105], v163 offset:9280
    ds_read_b64_tr_b16 v[106:107], v163 offset:13888
    s_add_u32 m0, s30, 144384
    s_nop 0
    buffer_load_dwordx4 v159, s[8:11], s28 offen lds
    s_waitcnt lgkmcnt(6)
    v_mfma_f32_16x16x32_bf16 v[76:79], v[92:95], v[140:143], v[76:79]
    v_mfma_f32_16x16x32_bf16 v[80:83], v[92:95], v[144:147], v[80:83]
    ds_read_b64_tr_b16 v[84:85], v163 offset:9312
    ds_read_b64_tr_b16 v[86:87], v163 offset:13920
    s_add_u32 m0, s30, 145408
    s_nop 0
    buffer_load_dwordx4 v160, s[8:11], s28 offen lds
    s_waitcnt lgkmcnt(6)
    v_mfma_f32_16x16x32_bf16 v[12:15], v[96:99], v[148:151], v[12:15]
    v_mfma_f32_16x16x32_bf16 v[16:19], v[96:99], v[152:155], v[16:19]
    ds_read_b64_tr_b16 v[88:89], v163 offset:9344
    ds_read_b64_tr_b16 v[90:91], v163 offset:13952
    s_cmp_eq_u32 s29, 3
    s_cbranch_scc1 f2sk24
    s_add_u32 m0, s30, 146432
    s_nop 0
    buffer_load_dwordx4 v161, s[8:11], s28 offen lds
    s_add_u32 m0, s30, 147456
    s_nop 0
    buffer_load_dwordx4 v162, s[8:11], s28 offen lds
    f2sk24:
    s_add_u32 s28, s28, 73728
    s_waitcnt lgkmcnt(6)
    v_mfma_f32_16x16x32_bf16 v[20:23], v[100:103], v[148:151], v[20:23]
    v_mfma_f32_16x16x32_bf16 v[24:27], v[100:103], v[152:155], v[24:27]
    ds_read_b64_tr_b16 v[92:93], v163 offset:9376
    ds_read_b64_tr_b16 v[94:95], v163 offset:13984
    s_waitcnt lgkmcnt(6)
    v_mfma_f32_16x16x32_bf16 v[28:31], v[104:107], v[148:151], v[28:31]
    v_mfma_f32_16x16x32_bf16 v[32:35], v[104:107], v[152:155], v[32:35]
    ds_read_b64_tr_b16 v[96:97], v163 offset:9408
    ds_read_b64_tr_b16 v[98:99], v163 offset:14016
    s_waitcnt lgkmcnt(6)
    v_mfma_f32_16x16x32_bf16 v[36:39], v[84:87], v[148:151], v[36:39]
    v_mfma_f32_16x16x32_bf16 v[40:43], v[84:87], v[152:155], v[40:43]
    ds_read_b64_tr_b16 v[100:101], v163 offset:9440
    ds_read_b64_tr_b16 v[102:103], v163 offset:14048
    s_waitcnt lgkmcnt(6)
    v_mfma_f32_16x16x32_bf16 v[44:47], v[88:91], v[148:151], v[44:47]
    v_mfma_f32_16x16x32_bf16 v[48:51], v[88:91], v[152:155], v[48:51]
    ds_read_b64_tr_b16 v[104:105], v163 offset:9472
    ds_read_b64_tr_b16 v[106:107], v163 offset:14080
    s_waitcnt lgkmcnt(6)
    v_mfma_f32_16x16x32_bf16 v[52:55], v[92:95], v[148:151], v[52:55]
    v_mfma_f32_16x16x32_bf16 v[56:59], v[92:95], v[152:155], v[56:59]
    ds_read_b64_tr_b16 v[84:85], v163 offset:18432
    ds_read_b64_tr_b16 v[86:87], v163 offset:23040
    s_waitcnt lgkmcnt(6)
    v_mfma_f32_16x16x32_bf16 v[60:63], v[96:99], v[148:151], v[60:63]
    v_mfma_f32_16x16x32_bf16 v[64:67], v[96:99], v[152:155], v[64:67]
    ds_read_b64_tr_b16 v[88:89], v163 offset:18464
    ds_read_b64_tr_b16 v[90:91], v163 offset:23072
    s_waitcnt lgkmcnt(6)
    v_mfma_f32_16x16x32_bf16 v[68:71], v[100:103], v[148:151], v[68:71]
    v_mfma_f32_16x16x32_bf16 v[72:75], v[100:103], v[152:155], v[72:75]
    ds_read_b64_tr_b16 v[92:93], v163 offset:18496
    ds_read_b64_tr_b16 v[94:95], v163 offset:23104
    s_waitcnt lgkmcnt(6)
    v_mfma_f32_16x16x32_bf16 v[76:79], v[104:107], v[148:151], v[76:79]
    v_mfma_f32_16x16x32_bf16 v[80:83], v[104:107], v[152:155], v[80:83]
    ds_read_b64_tr_b16 v[96:97], v163 offset:18528
    ds_read_b64_tr_b16 v[98:99], v163 offset:23136
    s_waitcnt vmcnt(10)
    s_waitcnt lgkmcnt(6)
    v_mfma_f32_16x16x32_bf16 v[12:15], v[84:87], v[108:111], v[12:15]
    v_mfma_f32_16x16x32_bf16 v[16:19], v[84:87], v[112:115], v[16:19]
    ds_read_b64_tr_b16 v[100:101], v163 offset:18560
    ds_read_b64_tr_b16 v[102:103], v163 offset:23168
    buffer_load_dwordx4 v[140:143], v156, s[4:7], s27 offen offset:0
    buffer_load_dwordx4 v[148:151], v156, s[4:7], s27 offen offset:1024
    s_waitcnt lgkmcnt(6)
    v_mfma_f32_16x16x32_bf16 v[20:23], v[88:91], v[108:111], v[20:23]
    v_mfma_f32_16x16x32_bf16 v[24:27], v[88:91], v[112:115], v[24:27]
    ds_read_b64_tr_b16 v[104:105], v163 offset:18592
    ds_read_b64_tr_b16 v[106:107], v163 offset:23200
    buffer_load_dwordx4 v[144:147], v157, s[4:7], s27 offen offset:0
    buffer_load_dwordx4 v[152:155], v157, s[4:7], s27 offen offset:1024
    s_add_u32 s27, s27, 2048
    s_waitcnt lgkmcnt(6)
    v_mfma_f32_16x16x32_bf16 v[28:31], v[92:95], v[108:111], v[28:31]
    v_mfma_f32_16x16x32_bf16 v[32:35], v[92:95], v[112:115], v[32:35]
    ds_read_b64_tr_b16 v[84:85], v163 offset:18624
    ds_read_b64_tr_b16 v[86:87], v163 offset:23232
    s_waitcnt lgkmcnt(6)
    v_mfma_f32_16x16x32_bf16 v[36:39], v[96:99], v[108:111], v[36:39]
    v_mfma_f32_16x16x32_bf16 v[40:43], v[96:99], v[112:115], v[40:43]
    ds_read_b64_tr_b16 v[88:89], v163 offset:18656
    ds_read_b64_tr_b16 v[90:91], v163 offset:23264
    s_waitcnt lgkmcnt(6)
    v_mfma_f32_16x16x32_bf16 v[44:47], v[100:103], v[108:111], v[44:47]
    v_mfma_f32_16x16x32_bf16 v[48:51], v[100:103], v[112:115], v[48:51]
    ds_read_b64_tr_b16 v[92:93], v163 offset:18688
    ds_read_b64_tr_b16 v[94:95], v163 offset:23296
    s_waitcnt lgkmcnt(6)
    v_mfma_f32_16x16x32_bf16 v[52:55], v[104:107], v[108:111], v[52:55]
    v_mfma_f32_16x16x32_bf16 v[56:59], v[104:107], v[112:115], v[56:59]
    ds_read_b64_tr_b16 v[96:97], v163 offset:27648
    ds_read_b64_tr_b16 v[98:99], v163 offset:32256
    s_waitcnt lgkmcnt(6)
    v_mfma_f32_16x16x32_bf16 v[60:63], v[84:87], v[108:111], v[60:63]
    v_mfma_f32_16x16x32_bf16 v[64:67], v[84:87], v[112:115], v[64:67]
    ds_read_b64_tr_b16 v[100:101], v163 offset:27680
    ds_read_b64_tr_b16 v[102:103], v163 offset:32288
    s_waitcnt lgkmcnt(6)
    v_mfma_f32_16x16x32_bf16 v[68:71], v[88:91], v[108:111], v[68:71]
    v_mfma_f32_16x16x32_bf16 v[72:75], v[88:91], v[112:115], v[72:75]
    ds_read_b64_tr_b16 v[104:105], v163 offset:27712
    ds_read_b64_tr_b16 v[106:107], v163 offset:32320
    s_waitcnt lgkmcnt(6)
    v_mfma_f32_16x16x32_bf16 v[76:79], v[92:95], v[108:111], v[76:79]
    v_mfma_f32_16x16x32_bf16 v[80:83], v[92:95], v[112:115], v[80:83]
    ds_read_b64_tr_b16 v[84:85], v163 offset:27744
    ds_read_b64_tr_b16 v[86:87], v163 offset:32352
    s_waitcnt lgkmcnt(6)
    v_mfma_f32_16x16x32_bf16 v[12:15], v[96:99], v[116:119], v[12:15]
    v_mfma_f32_16x16x32_bf16 v[16:19], v[96:99], v[120:123], v[16:19]
    ds_read_b64_tr_b16 v[88:89], v163 offset:27776
    ds_read_b64_tr_b16 v[90:91], v163 offset:32384
    s_waitcnt lgkmcnt(6)
    v_mfma_f32_16x16x32_bf16 v[20:23], v[100:103], v[116:119], v[20:23]
    v_mfma_f32_16x16x32_bf16 v[24:27], v[100:103], v[120:123], v[24:27]
    ds_read_b64_tr_b16 v[92:93], v163 offset:27808
    ds_read_b64_tr_b16 v[94:95], v163 offset:32416
    s_waitcnt lgkmcnt(6)
    v_mfma_f32_16x16x32_bf16 v[28:31], v[104:107], v[116:119], v[28:31]
    v_mfma_f32_16x16x32_bf16 v[32:35], v[104:107], v[120:123], v[32:35]
    ds_read_b64_tr_b16 v[96:97], v163 offset:27840
    ds_read_b64_tr_b16 v[98:99], v163 offset:32448
    s_waitcnt lgkmcnt(6)
    v_mfma_f32_16x16x32_bf16 v[36:39], v[84:87], v[116:119], v[36:39]
    v_mfma_f32_16x16x32_bf16 v[40:43], v[84:87], v[120:123], v[40:43]
    ds_read_b64_tr_b16 v[100:101], v163 offset:27872
    ds_read_b64_tr_b16 v[102:103], v163 offset:32480
    s_waitcnt lgkmcnt(6)
    v_mfma_f32_16x16x32_bf16 v[44:47], v[88:91], v[116:119], v[44:47]
    v_mfma_f32_16x16x32_bf16 v[48:51], v[88:91], v[120:123], v[48:51]
    ds_read_b64_tr_b16 v[104:105], v163 offset:27904
    ds_read_b64_tr_b16 v[106:107], v163 offset:32512
    s_waitcnt lgkmcnt(6)
    v_mfma_f32_16x16x32_bf16 v[52:55], v[92:95], v[116:119], v[52:55]
    v_mfma_f32_16x16x32_bf16 v[56:59], v[92:95], v[120:123], v[56:59]
    s_waitcnt lgkmcnt(4)
    v_mfma_f32_16x16x32_bf16 v[60:63], v[96:99], v[116:119], v[60:63]
    v_mfma_f32_16x16x32_bf16 v[64:67], v[96:99], v[120:123], v[64:67]
    s_waitcnt lgkmcnt(2)
    v_mfma_f32_16x16x32_bf16 v[68:71], v[100:103], v[116:119], v[68:71]
    v_mfma_f32_16x16x32_bf16 v[72:75], v[100:103], v[120:123], v[72:75]
    s_waitcnt lgkmcnt(0)
    v_mfma_f32_16x16x32_bf16 v[76:79], v[104:107], v[116:119], v[76:79]
    v_mfma_f32_16x16x32_bf16 v[80:83], v[104:107], v[120:123], v[80:83]
    s_setprio 1
    s_waitcnt vmcnt(4)
    s_add_u32 s58, s58, 4
    v_mov_b32 v11, 1
    s_mov_b64 exec, 1
    ds_add_u32 v10, v11 offset:4
sy25:
    ds_read_b32 v11, v10 offset:4
    s_waitcnt lgkmcnt(0)
    v_readfirstlane_b32 s59, v11
    s_cmp_ge_u32 s59, s58
    s_cbranch_scc1 sd25
    s_sleep 1
    s_branch sy25
sd25:
    s_mov_b64 exec, -1
    ds_read_b64_tr_b16 v[84:85], v164 offset:0
    ds_read_b64_tr_b16 v[86:87], v164 offset:4608
    ds_read_b64_tr_b16 v[88:89], v164 offset:32
    ds_read_b64_tr_b16 v[90:91], v164 offset:4640
    ds_read_b64_tr_b16 v[92:93], v164 offset:64
    ds_read_b64_tr_b16 v[94:95], v164 offset:4672
    ds_read_b64_tr_b16 v[96:97], v164 offset:96
    ds_read_b64_tr_b16 v[98:99], v164 offset:4704
    s_waitcnt lgkmcnt(6)
    v_mfma_f32_16x16x32_bf16 v[12:15], v[84:87], v[124:127], v[12:15]
    v_mfma_f32_16x16x32_bf16 v[16:19], v[84:87], v[128:131], v[16:19]
    ds_read_b64_tr_b16 v[100:101], v164 offset:128
    ds_read_b64_tr_b16 v[102:103], v164 offset:4736
    s_add_u32 m0, s30, 88064
    s_nop 0
    buffer_load_dwordx4 v158, s[8:11], s28 offen lds
    s_waitcnt lgkmcnt(6)
    v_mfma_f32_16x16x32_bf16 v[20:23], v[88:91], v[124:127], v[20:23]
    v_mfma_f32_16x16x32_bf16 v[24:27], v[88:91], v[128:131], v[24:27]
    ds_read_b64_tr_b16 v[104:105], v164 offset:160
    ds_read_b64_tr_b16 v[106:107], v164 offset:4768
    s_add_u32 m0, s30, 89088
    s_nop 0
    buffer_load_dwordx4 v159, s[8:11], s28 offen lds
    s_waitcnt lgkmcnt(6)
    v_mfma_f32_16x16x32_bf16 v[28:31], v[92:95], v[124:127], v[28:31]
    v_mfma_f32_16x16x32_bf16 v[32:35], v[92:95], v[128:131], v[32:35]
    ds_read_b64_tr_b16 v[84:85], v164 offset:192
    ds_read_b64_tr_b16 v[86:87], v164 offset:4800
    buffer_load_dwordx4 v[108:111], v156, s[4:7], s27 offen offset:0
    buffer_load_dwordx4 v[116:119], v156, s[4:7], s27 offen offset:1024
    s_waitcnt lgkmcnt(6)
    v_mfma_f32_16x16x32_bf16 v[36:39], v[96:99], v[124:127], v[36:39]
    v_mfma_f32_16x16x32_bf16 v[40:43], v[96:99], v[128:131], v[40:43]
    ds_read_b64_tr_b16 v[88:89], v164 offset:224
    ds_read_b64_tr_b16 v[90:91], v164 offset:4832
    buffer_load_dwordx4 v[112:115], v157, s[4:7], s27 offen offset:0
    buffer_load_dwordx4 v[120:123], v157, s[4:7], s27 offen offset:1024
    s_add_u32 s27, s27, 2048
    s_waitcnt lgkmcnt(6)
    v_mfma_f32_16x16x32_bf16 v[44:47], v[100:103], v[124:127], v[44:47]
    v_mfma_f32_16x16x32_bf16 v[48:51], v[100:103], v[128:131], v[48:51]
    ds_read_b64_tr_b16 v[92:93], v164 offset:256
    ds_read_b64_tr_b16 v[94:95], v164 offset:4864
    s_add_u32 m0, s30, 90112
    s_nop 0
    buffer_load_dwordx4 v160, s[8:11], s28 offen lds
    s_waitcnt lgkmcnt(6)
    v_mfma_f32_16x16x32_bf16 v[52:55], v[104:107], v[124:127], v[52:55]
    v_mfma_f32_16x16x32_bf16 v[56:59], v[104:107], v[128:131], v[56:59]
    ds_read_b64_tr_b16 v[96:97], v164 offset:9216
    ds_read_b64_tr_b16 v[98:99], v164 offset:13824
    s_cmp_eq_u32 s29, 3
    s_cbranch_scc1 f2sk26
    s_add_u32 m0, s30, 91136
    s_nop 0
    buffer_load_dwordx4 v161, s[8:11], s28 offen lds
    s_add_u32 m0, s30, 92160
    s_nop 0
    buffer_load_dwordx4 v162, s[8:11], s28 offen lds
    f2sk26:
    s_add_u32 s28, s28, 73728
    s_waitcnt lgkmcnt(6)
    v_mfma_f32_16x16x32_bf16 v[60:63], v[84:87], v[124:127], v[60:63]
    v_mfma_f32_16x16x32_bf16 v[64:67], v[84:87], v[128:131], v[64:67]
    ds_read_b64_tr_b16 v[100:101], v164 offset:9248
    ds_read_b64_tr_b16 v[102:103], v164 offset:13856
    s_add_u32 m0, s30, 106496
    s_nop 0
    buffer_load_dwordx4 v158, s[8:11], s28 offen lds
    s_waitcnt lgkmcnt(6)
    v_mfma_f32_16x16x32_bf16 v[68:71], v[88:91], v[124:127], v[68:71]
    v_mfma_f32_16x16x32_bf16 v[72:75], v[88:91], v[128:131], v[72:75]
    ds_read_b64_tr_b16 v[104:105], v164 offset:9280
    ds_read_b64_tr_b16 v[106:107], v164 offset:13888
    s_add_u32 m0, s30, 107520
    s_nop 0
    buffer_load_dwordx4 v159, s[8:11], s28 offen lds
    s_waitcnt lgkmcnt(6)
    v_mfma_f32_16x16x32_bf16 v[76:79], v[92:95], v[124:127], v[76:79]
    v_mfma_f32_16x16x32_bf16 v[80:83], v[92:95], v[128:131], v[80:83]
    ds_read_b64_tr_b16 v[84:85], v164 offset:9312
    ds_read_b64_tr_b16 v[86:87], v164 offset:13920
    s_add_u32 m0, s30, 108544
    s_nop 0
    buffer_load_dwordx4 v160, s[8:11], s28 offen lds
    s_waitcnt lgkmcnt(6)
    v_mfma_f32_16x16x32_bf16 v[12:15], v[96:99], v[132:135], v[12:15]
    v_mfma_f32_16x16x32_bf16 v[16:19], v[96:99], v[136:139], v[16:19]
    ds_read_b64_tr_b16 v[88:89], v164 offset:9344
    ds_read_b64_tr_b16 v[90:91], v164 offset:13952
    s_cmp_eq_u32 s29, 3
    s_cbranch_scc1 f2sk27
    s_add_u32 m0, s30, 109568
    s_nop 0
    buffer_load_dwordx4 v161, s[8:11], s28 offen lds
    s_add_u32 m0, s30, 110592
    s_nop 0
    buffer_load_dwordx4 v162, s[8:11], s28 offen lds
    f2sk27:
    s_add_u32 s28, s28, 73728
    s_waitcnt lgkmcnt(6)
    v_mfma_f32_16x16x32_bf16 v[20:23], v[100:103], v[132:135], v[20:23]
    v_mfma_f32_16x16x32_bf16 v[24:27], v[100:103], v[136:139], v[24:27]
    ds_read_b64_tr_b16 v[92:93], v164 offset:9376
    ds_read_b64_tr_b16 v[94:95], v164 offset:13984
    s_waitcnt lgkmcnt(6)
    v_mfma_f32_16x16x32_bf16 v[28:31], v[104:107], v[132:135], v[28:31]
    v_mfma_f32_16x16x32_bf16 v[32:35], v[104:107], v[136:139], v[32:35]
    ds_read_b64_tr_b16 v[96:97], v164 offset:9408
    ds_read_b64_tr_b16 v[98:99], v164 offset:14016
    s_waitcnt lgkmcnt(6)
    v_mfma_f32_16x16x32_bf16 v[36:39], v[84:87], v[132:135], v[36:39]
    v_mfma_f32_16x16x32_bf16 v[40:43], v[84:87], v[136:139], v[40:43]
    ds_read_b64_tr_b16 v[100:101], v164 offset:9440
    ds_read_b64_tr_b16 v[102:103], v164 offset:14048
    s_waitcnt lgkmcnt(6)
    v_mfma_f32_16x16x32_bf16 v[44:47], v[88:91], v[132:135], v[44:47]
    v_mfma_f32_16x16x32_bf16 v[48:51], v[88:91], v[136:139], v[48:51]
    ds_read_b64_tr_b16 v[104:105], v164 offset:9472
    ds_read_b64_tr_b16 v[106:107], v164 offset:14080
    s_waitcnt lgkmcnt(6)
    v_mfma_f32_16x16x32_bf16 v[52:55], v[92:95], v[132:135], v[52:55]
    v_mfma_f32_16x16x32_bf16 v[56:59], v[92:95], v[136:139], v[56:59]
    ds_read_b64_tr_b16 v[84:85], v164 offset:18432
    ds_read_b64_tr_b16 v[86:87], v164 offset:23040
    s_waitcnt lgkmcnt(6)
    v_mfma_f32_16x16x32_bf16 v[60:63], v[96:99], v[132:135], v[60:63]
    v_mfma_f32_16x16x32_bf16 v[64:67], v[96:99], v[136:139], v[64:67]
    ds_read_b64_tr_b16 v[88:89], v164 offset:18464
    ds_read_b64_tr_b16 v[90:91], v164 offset:23072
    s_waitcnt lgkmcnt(6)
    v_mfma_f32_16x16x32_bf16 v[68:71], v[100:103], v[132:135], v[68:71]
    v_mfma_f32_16x16x32_bf16 v[72:75], v[100:103], v[136:139], v[72:75]
    ds_read_b64_tr_b16 v[92:93], v164 offset:18496
    ds_read_b64_tr_b16 v[94:95], v164 offset:23104
    s_waitcnt lgkmcnt(6)
    v_mfma_f32_16x16x32_bf16 v[76:79], v[104:107], v[132:135], v[76:79]
    v_mfma_f32_16x16x32_bf16 v[80:83], v[104:107], v[136:139], v[80:83]
    ds_read_b64_tr_b16 v[96:97], v164 offset:18528
    ds_read_b64_tr_b16 v[98:99], v164 offset:23136
    s_waitcnt vmcnt(10)
    s_waitcnt lgkmcnt(6)
    v_mfma_f32_16x16x32_bf16 v[12:15], v[84:87], v[140:143], v[12:15]
    v_mfma_f32_16x16x32_bf16 v[16:19], v[84:87], v[144:147], v[16:19]
    ds_read_b64_tr_b16 v[100:101], v164 offset:18560
    ds_read_b64_tr_b16 v[102:103], v164 offset:23168
    buffer_load_dwordx4 v[124:127], v156, s[4:7], s27 offen offset:0
    buffer_load_dwordx4 v[132:135], v156, s[4:7], s27 offen offset:1024
    s_waitcnt lgkmcnt(6)
    v_mfma_f32_16x16x32_bf16 v[20:23], v[88:91], v[140:143], v[20:23]
    v_mfma_f32_16x16x32_bf16 v[24:27], v[88:91], v[144:147], v[24:27]
    ds_read_b64_tr_b16 v[104:105], v164 offset:18592
    ds_read_b64_tr_b16 v[106:107], v164 offset:23200
    buffer_load_dwordx4 v[128:131], v157, s[4:7], s27 offen offset:0
    buffer_load_dwordx4 v[136:139], v157, s[4:7], s27 offen offset:1024
    s_add_u32 s27, s27, 2048
    s_waitcnt lgkmcnt(6)
    v_mfma_f32_16x16x32_bf16 v[28:31], v[92:95], v[140:143], v[28:31]
    v_mfma_f32_16x16x32_bf16 v[32:35], v[92:95], v[144:147], v[32:35]
    ds_read_b64_tr_b16 v[84:85], v164 offset:18624
    ds_read_b64_tr_b16 v[86:87], v164 offset:23232
    s_waitcnt lgkmcnt(6)
    v_mfma_f32_16x16x32_bf16 v[36:39], v[96:99], v[140:143], v[36:39]
    v_mfma_f32_16x16x32_bf16 v[40:43], v[96:99], v[144:147], v[40:43]
    ds_read_b64_tr_b16 v[88:89], v164 offset:18656
    ds_read_b64_tr_b16 v[90:91], v164 offset:23264
    s_waitcnt lgkmcnt(6)
    v_mfma_f32_16x16x32_bf16 v[44:47], v[100:103], v[140:143], v[44:47]
    v_mfma_f32_16x16x32_bf16 v[48:51], v[100:103], v[144:147], v[48:51]
    ds_read_b64_tr_b16 v[92:93], v164 offset:18688
    ds_read_b64_tr_b16 v[94:95], v164 offset:23296
    s_waitcnt lgkmcnt(6)
    v_mfma_f32_16x16x32_bf16 v[52:55], v[104:107], v[140:143], v[52:55]
    v_mfma_f32_16x16x32_bf16 v[56:59], v[104:107], v[144:147], v[56:59]
    ds_read_b64_tr_b16 v[96:97], v164 offset:27648
    ds_read_b64_tr_b16 v[98:99], v164 offset:32256
    s_waitcnt lgkmcnt(6)
    v_mfma_f32_16x16x32_bf16 v[60:63], v[84:87], v[140:143], v[60:63]
    v_mfma_f32_16x16x32_bf16 v[64:67], v[84:87], v[144:147], v[64:67]
    ds_read_b64_tr_b16 v[100:101], v164 offset:27680
    ds_read_b64_tr_b16 v[102:103], v164 offset:32288
    s_waitcnt lgkmcnt(6)
    v_mfma_f32_16x16x32_bf16 v[68:71], v[88:91], v[140:143], v[68:71]
    v_mfma_f32_16x16x32_bf16 v[72:75], v[88:91], v[144:147], v[72:75]
    ds_read_b64_tr_b16 v[104:105], v164 offset:27712
    ds_read_b64_tr_b16 v[106:107], v164 offset:32320
    s_waitcnt lgkmcnt(6)
    v_mfma_f32_16x16x32_bf16 v[76:79], v[92:95], v[140:143], v[76:79]
    v_mfma_f32_16x16x32_bf16 v[80:83], v[92:95], v[144:147], v[80:83]
    ds_read_b64_tr_b16 v[84:85], v164 offset:27744
    ds_read_b64_tr_b16 v[86:87], v164 offset:32352
    s_waitcnt lgkmcnt(6)
    v_mfma_f32_16x16x32_bf16 v[12:15], v[96:99], v[148:151], v[12:15]
    v_mfma_f32_16x16x32_bf16 v[16:19], v[96:99], v[152:155], v[16:19]
    ds_read_b64_tr_b16 v[88:89], v164 offset:27776
    ds_read_b64_tr_b16 v[90:91], v164 offset:32384
    s_waitcnt lgkmcnt(6)
    v_mfma_f32_16x16x32_bf16 v[20:23], v[100:103], v[148:151], v[20:23]
    v_mfma_f32_16x16x32_bf16 v[24:27], v[100:103], v[152:155], v[24:27]
    ds_read_b64_tr_b16 v[92:93], v164 offset:27808
    ds_read_b64_tr_b16 v[94:95], v164 offset:32416
    s_waitcnt lgkmcnt(6)
    v_mfma_f32_16x16x32_bf16 v[28:31], v[104:107], v[148:151], v[28:31]
    v_mfma_f32_16x16x32_bf16 v[32:35], v[104:107], v[152:155], v[32:35]
    ds_read_b64_tr_b16 v[96:97], v164 offset:27840
    ds_read_b64_tr_b16 v[98:99], v164 offset:32448
    s_waitcnt lgkmcnt(6)
    v_mfma_f32_16x16x32_bf16 v[36:39], v[84:87], v[148:151], v[36:39]
    v_mfma_f32_16x16x32_bf16 v[40:43], v[84:87], v[152:155], v[40:43]
    ds_read_b64_tr_b16 v[100:101], v164 offset:27872
    ds_read_b64_tr_b16 v[102:103], v164 offset:32480
    s_waitcnt lgkmcnt(6)
    v_mfma_f32_16x16x32_bf16 v[44:47], v[88:91], v[148:151], v[44:47]
    v_mfma_f32_16x16x32_bf16 v[48:51], v[88:91], v[152:155], v[48:51]
    ds_read_b64_tr_b16 v[104:105], v164 offset:27904
    ds_read_b64_tr_b16 v[106:107], v164 offset:32512
    s_waitcnt lgkmcnt(6)
    v_mfma_f32_16x16x32_bf16 v[52:55], v[92:95], v[148:151], v[52:55]
    v_mfma_f32_16x16x32_bf16 v[56:59], v[92:95], v[152:155], v[56:59]
    s_waitcnt lgkmcnt(4)
    v_mfma_f32_16x16x32_bf16 v[60:63], v[96:99], v[148:151], v[60:63]
    v_mfma_f32_16x16x32_bf16 v[64:67], v[96:99], v[152:155], v[64:67]
    s_waitcnt lgkmcnt(2)
    v_mfma_f32_16x16x32_bf16 v[68:71], v[100:103], v[148:151], v[68:71]
    v_mfma_f32_16x16x32_bf16 v[72:75], v[100:103], v[152:155], v[72:75]
    s_waitcnt lgkmcnt(0)
    v_mfma_f32_16x16x32_bf16 v[76:79], v[104:107], v[148:151], v[76:79]
    v_mfma_f32_16x16x32_bf16 v[80:83], v[104:107], v[152:155], v[80:83]
    s_waitcnt vmcnt(4)
    s_add_u32 s58, s58, 4
    v_mov_b32 v11, 1
    s_mov_b64 exec, 1
    ds_add_u32 v10, v11 offset:4
sy28:
    ds_read_b32 v11, v10 offset:4
    s_waitcnt lgkmcnt(0)
    v_readfirstlane_b32 s59, v11
    s_cmp_ge_u32 s59, s58
    s_cbranch_scc1 sd28
    s_sleep 1
    s_branch sy28
sd28:
    s_mov_b64 exec, -1
    ds_read_b64_tr_b16 v[84:85], v163 offset:0
    ds_read_b64_tr_b16 v[86:87], v163 offset:4608
    ds_read_b64_tr_b16 v[88:89], v163 offset:32
    ds_read_b64_tr_b16 v[90:91], v163 offset:4640
    ds_read_b64_tr_b16 v[92:93], v163 offset:64
    ds_read_b64_tr_b16 v[94:95], v163 offset:4672
    ds_read_b64_tr_b16 v[96:97], v163 offset:96
    ds_read_b64_tr_b16 v[98:99], v163 offset:4704
    s_waitcnt lgkmcnt(6)
    v_mfma_f32_16x16x32_bf16 v[12:15], v[84:87], v[108:111], v[12:15]
    v_mfma_f32_16x16x32_bf16 v[16:19], v[84:87], v[112:115], v[16:19]
    ds_read_b64_tr_b16 v[100:101], v163 offset:128
    ds_read_b64_tr_b16 v[102:103], v163 offset:4736
    s_add_u32 m0, s30, 124928
    s_nop 0
    buffer_load_dwordx4 v158, s[8:11], s28 offen lds
    s_waitcnt lgkmcnt(6)
    v_mfma_f32_16x16x32_bf16 v[20:23], v[88:91], v[108:111], v[20:23]
    v_mfma_f32_16x16x32_bf16 v[24:27], v[88:91], v[112:115], v[24:27]
    ds_read_b64_tr_b16 v[104:105], v163 offset:160
    ds_read_b64_tr_b16 v[106:107], v163 offset:4768
    s_add_u32 m0, s30, 125952
    s_nop 0
    buffer_load_dwordx4 v159, s[8:11], s28 offen lds
    s_waitcnt lgkmcnt(6)
    v_mfma_f32_16x16x32_bf16 v[28:31], v[92:95], v[108:111], v[28:31]
    v_mfma_f32_16x16x32_bf16 v[32:35], v[92:95], v[112:115], v[32:35]
    ds_read_b64_tr_b16 v[84:85], v163 offset:192
    ds_read_b64_tr_b16 v[86:87], v163 offset:4800
    buffer_load_dwordx4 v[140:143], v156, s[4:7], s27 offen offset:0
    buffer_load_dwordx4 v[148:151], v156, s[4:7], s27 offen offset:1024
    s_waitcnt lgkmcnt(6)
    v_mfma_f32_16x16x32_bf16 v[36:39], v[96:99], v[108:111], v[36:39]
    v_mfma_f32_16x16x32_bf16 v[40:43], v[96:99], v[112:115], v[40:43]
    ds_read_b64_tr_b16 v[88:89], v163 offset:224
    ds_read_b64_tr_b16 v[90:91], v163 offset:4832
    buffer_load_dwordx4 v[144:147], v157, s[4:7], s27 offen offset:0
    buffer_load_dwordx4 v[152:155], v157, s[4:7], s27 offen offset:1024
    s_add_u32 s27, s27, 2048
    s_waitcnt lgkmcnt(6)
    v_mfma_f32_16x16x32_bf16 v[44:47], v[100:103], v[108:111], v[44:47]
    v_mfma_f32_16x16x32_bf16 v[48:51], v[100:103], v[112:115], v[48:51]
    ds_read_b64_tr_b16 v[92:93], v163 offset:256
    ds_read_b64_tr_b16 v[94:95], v163 offset:4864
    s_add_u32 m0, s30, 126976
    s_nop 0
    buffer_load_dwordx4 v160, s[8:11], s28 offen lds
    s_waitcnt lgkmcnt(6)
    v_mfma_f32_16x16x32_bf16 v[52:55], v[104:107], v[108:111], v[52:55]
    v_mfma_f32_16x16x32_bf16 v[56:59], v[104:107], v[112:115], v[56:59]
    ds_read_b64_tr_b16 v[96:97], v163 offset:9216
    ds_read_b64_tr_b16 v[98:99], v163 offset:13824
    s_cmp_eq_u32 s29, 3
    s_cbranch_scc1 f2sk29
    s_add_u32 m0, s30, 128000
    s_nop 0
    buffer_load_dwordx4 v161, s[8:11], s28 offen lds
    s_add_u32 m0, s30, 129024
    s_nop 0
    buffer_load_dwordx4 v162, s[8:11], s28 offen lds
    f2sk29:
    s_add_u32 s28, s28, 73728
    s_waitcnt lgkmcnt(6)
    v_mfma_f32_16x16x32_bf16 v[60:63], v[84:87], v[108:111], v[60:63]
    v_mfma_f32_16x16x32_bf16 v[64:67], v[84:87], v[112:115], v[64:67]
    ds_read_b64_tr_b16 v[100:101], v163 offset:9248
    ds_read_b64_tr_b16 v[102:103], v163 offset:13856
    s_add_u32 m0, s30, 143360
    s_nop 0
    buffer_load_dwordx4 v158, s[8:11], s28 offen lds
    s_waitcnt lgkmcnt(6)
    v_mfma_f32_16x16x32_bf16 v[68:71], v[88:91], v[108:111], v[68:71]
    v_mfma_f32_16x16x32_bf16 v[72:75], v[88:91], v[112:115], v[72:75]
    ds_read_b64_tr_b16 v[104:105], v163 offset:9280
    ds_read_b64_tr_b16 v[106:107], v163 offset:13888
    s_add_u32 m0, s30, 144384
    s_nop 0
    buffer_load_dwordx4 v159, s[8:11], s28 offen lds
    s_waitcnt lgkmcnt(6)
    v_mfma_f32_16x16x32_bf16 v[76:79], v[92:95], v[108:111], v[76:79]
    v_mfma_f32_16x16x32_bf16 v[80:83], v[92:95], v[112:115], v[80:83]
    ds_read_b64_tr_b16 v[84:85], v163 offset:9312
    ds_read_b64_tr_b16 v[86:87], v163 offset:13920
    s_add_u32 m0, s30, 145408
    s_nop 0
    buffer_load_dwordx4 v160, s[8:11], s28 offen lds
    s_waitcnt lgkmcnt(6)
    v_mfma_f32_16x16x32_bf16 v[12:15], v[96:99], v[116:119], v[12:15]
    v_mfma_f32_16x16x32_bf16 v[16:19], v[96:99], v[120:123], v[16:19]
    ds_read_b64_tr_b16 v[88:89], v163 offset:9344
    ds_read_b64_tr_b16 v[90:91], v163 offset:13952
    s_cmp_eq_u32 s29, 3
    s_cbranch_scc1 f2sk30
    s_add_u32 m0, s30, 146432
    s_nop 0
    buffer_load_dwordx4 v161, s[8:11], s28 offen lds
    s_add_u32 m0, s30, 147456
    s_nop 0
    buffer_load_dwordx4 v162, s[8:11], s28 offen lds
    f2sk30:
    s_add_u32 s28, s28, 73728
    s_waitcnt lgkmcnt(6)
    v_mfma_f32_16x16x32_bf16 v[20:23], v[100:103], v[116:119], v[20:23]
    v_mfma_f32_16x16x32_bf16 v[24:27], v[100:103], v[120:123], v[24:27]
    ds_read_b64_tr_b16 v[92:93], v163 offset:9376
    ds_read_b64_tr_b16 v[94:95], v163 offset:13984
    s_waitcnt lgkmcnt(6)
    v_mfma_f32_16x16x32_bf16 v[28:31], v[104:107], v[116:119], v[28:31]
    v_mfma_f32_16x16x32_bf16 v[32:35], v[104:107], v[120:123], v[32:35]
    ds_read_b64_tr_b16 v[96:97], v163 offset:9408
    ds_read_b64_tr_b16 v[98:99], v163 offset:14016
    s_waitcnt lgkmcnt(6)
    v_mfma_f32_16x16x32_bf16 v[36:39], v[84:87], v[116:119], v[36:39]
    v_mfma_f32_16x16x32_bf16 v[40:43], v[84:87], v[120:123], v[40:43]
    ds_read_b64_tr_b16 v[100:101], v163 offset:9440
    ds_read_b64_tr_b16 v[102:103], v163 offset:14048
    s_waitcnt lgkmcnt(6)
    v_mfma_f32_16x16x32_bf16 v[44:47], v[88:91], v[116:119], v[44:47]
    v_mfma_f32_16x16x32_bf16 v[48:51], v[88:91], v[120:123], v[48:51]
    ds_read_b64_tr_b16 v[104:105], v163 offset:9472
    ds_read_b64_tr_b16 v[106:107], v163 offset:14080
    s_waitcnt lgkmcnt(6)
    v_mfma_f32_16x16x32_bf16 v[52:55], v[92:95], v[116:119], v[52:55]
    v_mfma_f32_16x16x32_bf16 v[56:59], v[92:95], v[120:123], v[56:59]
    ds_read_b64_tr_b16 v[84:85], v163 offset:18432
    ds_read_b64_tr_b16 v[86:87], v163 offset:23040
    s_waitcnt lgkmcnt(6)
    v_mfma_f32_16x16x32_bf16 v[60:63], v[96:99], v[116:119], v[60:63]
    v_mfma_f32_16x16x32_bf16 v[64:67], v[96:99], v[120:123], v[64:67]
    ds_read_b64_tr_b16 v[88:89], v163 offset:18464
    ds_read_b64_tr_b16 v[90:91], v163 offset:23072
    s_waitcnt lgkmcnt(6)
    v_mfma_f32_16x16x32_bf16 v[68:71], v[100:103], v[116:119], v[68:71]
    v_mfma_f32_16x16x32_bf16 v[72:75], v[100:103], v[120:123], v[72:75]
    ds_read_b64_tr_b16 v[92:93], v163 offset:18496
    ds_read_b64_tr_b16 v[94:95], v163 offset:23104
    s_waitcnt lgkmcnt(6)
    v_mfma_f32_16x16x32_bf16 v[76:79], v[104:107], v[116:119], v[76:79]
    v_mfma_f32_16x16x32_bf16 v[80:83], v[104:107], v[120:123], v[80:83]
    ds_read_b64_tr_b16 v[96:97], v163 offset:18528
    ds_read_b64_tr_b16 v[98:99], v163 offset:23136
    s_waitcnt vmcnt(10)
    s_waitcnt lgkmcnt(6)
    v_mfma_f32_16x16x32_bf16 v[12:15], v[84:87], v[124:127], v[12:15]
    v_mfma_f32_16x16x32_bf16 v[16:19], v[84:87], v[128:131], v[16:19]
    ds_read_b64_tr_b16 v[100:101], v163 offset:18560
    ds_read_b64_tr_b16 v[102:103], v163 offset:23168
    buffer_load_dwordx4 v[108:111], v156, s[4:7], s27 offen offset:0
    buffer_load_dwordx4 v[116:119], v156, s[4:7], s27 offen offset:1024
    s_waitcnt lgkmcnt(6)
    v_mfma_f32_16x16x32_bf16 v[20:23], v[88:91], v[124:127], v[20:23]
    v_mfma_f32_16x16x32_bf16 v[24:27], v[88:91], v[128:131], v[24:27]
    ds_read_b64_tr_b16 v[104:105], v163 offset:18592
    ds_read_b64_tr_b16 v[106:107], v163 offset:23200
    buffer_load_dwordx4 v[112:115], v157, s[4:7], s27 offen offset:0
    buffer_load_dwordx4 v[120:123], v157, s[4:7], s27 offen offset:1024
    s_add_u32 s27, s27, 2048
    s_waitcnt lgkmcnt(6)
    v_mfma_f32_16x16x32_bf16 v[28:31], v[92:95], v[124:127], v[28:31]
    v_mfma_f32_16x16x32_bf16 v[32:35], v[92:95], v[128:131], v[32:35]
    ds_read_b64_tr_b16 v[84:85], v163 offset:18624
    ds_read_b64_tr_b16 v[86:87], v163 offset:23232
    s_waitcnt lgkmcnt(6)
    v_mfma_f32_16x16x32_bf16 v[36:39], v[96:99], v[124:127], v[36:39]
    v_mfma_f32_16x16x32_bf16 v[40:43], v[96:99], v[128:131], v[40:43]
    ds_read_b64_tr_b16 v[88:89], v163 offset:18656
    ds_read_b64_tr_b16 v[90:91], v163 offset:23264
    s_waitcnt lgkmcnt(6)
    v_mfma_f32_16x16x32_bf16 v[44:47], v[100:103], v[124:127], v[44:47]
    v_mfma_f32_16x16x32_bf16 v[48:51], v[100:103], v[128:131], v[48:51]
    ds_read_b64_tr_b16 v[92:93], v163 offset:18688
    ds_read_b64_tr_b16 v[94:95], v163 offset:23296
    s_waitcnt lgkmcnt(6)
    v_mfma_f32_16x16x32_bf16 v[52:55], v[104:107], v[124:127], v[52:55]
    v_mfma_f32_16x16x32_bf16 v[56:59], v[104:107], v[128:131], v[56:59]
    ds_read_b64_tr_b16 v[96:97], v163 offset:27648
    ds_read_b64_tr_b16 v[98:99], v163 offset:32256
    s_waitcnt lgkmcnt(6)
    v_mfma_f32_16x16x32_bf16 v[60:63], v[84:87], v[124:127], v[60:63]
    v_mfma_f32_16x16x32_bf16 v[64:67], v[84:87], v[128:131], v[64:67]
    ds_read_b64_tr_b16 v[100:101], v163 offset:27680
    ds_read_b64_tr_b16 v[102:103], v163 offset:32288
    s_waitcnt lgkmcnt(6)
    v_mfma_f32_16x16x32_bf16 v[68:71], v[88:91], v[124:127], v[68:71]
    v_mfma_f32_16x16x32_bf16 v[72:75], v[88:91], v[128:131], v[72:75]
    ds_read_b64_tr_b16 v[104:105], v163 offset:27712
    ds_read_b64_tr_b16 v[106:107], v163 offset:32320
    s_waitcnt lgkmcnt(6)
    v_mfma_f32_16x16x32_bf16 v[76:79], v[92:95], v[124:127], v[76:79]
    v_mfma_f32_16x16x32_bf16 v[80:83], v[92:95], v[128:131], v[80:83]
    ds_read_b64_tr_b16 v[84:85], v163 offset:27744
    ds_read_b64_tr_b16 v[86:87], v163 offset:32352
    s_waitcnt lgkmcnt(6)
    v_mfma_f32_16x16x32_bf16 v[12:15], v[96:99], v[132:135], v[12:15]
    v_mfma_f32_16x16x32_bf16 v[16:19], v[96:99], v[136:139], v[16:19]
    ds_read_b64_tr_b16 v[88:89], v163 offset:27776
    ds_read_b64_tr_b16 v[90:91], v163 offset:32384
    s_waitcnt lgkmcnt(6)
    v_mfma_f32_16x16x32_bf16 v[20:23], v[100:103], v[132:135], v[20:23]
    v_mfma_f32_16x16x32_bf16 v[24:27], v[100:103], v[136:139], v[24:27]
    ds_read_b64_tr_b16 v[92:93], v163 offset:27808
    ds_read_b64_tr_b16 v[94:95], v163 offset:32416
    s_waitcnt lgkmcnt(6)
    v_mfma_f32_16x16x32_bf16 v[28:31], v[104:107], v[132:135], v[28:31]
    v_mfma_f32_16x16x32_bf16 v[32:35], v[104:107], v[136:139], v[32:35]
    ds_read_b64_tr_b16 v[96:97], v163 offset:27840
    ds_read_b64_tr_b16 v[98:99], v163 offset:32448
    s_waitcnt lgkmcnt(6)
    v_mfma_f32_16x16x32_bf16 v[36:39], v[84:87], v[132:135], v[36:39]
    v_mfma_f32_16x16x32_bf16 v[40:43], v[84:87], v[136:139], v[40:43]
    ds_read_b64_tr_b16 v[100:101], v163 offset:27872
    ds_read_b64_tr_b16 v[102:103], v163 offset:32480
    s_waitcnt lgkmcnt(6)
    v_mfma_f32_16x16x32_bf16 v[44:47], v[88:91], v[132:135], v[44:47]
    v_mfma_f32_16x16x32_bf16 v[48:51], v[88:91], v[136:139], v[48:51]
    ds_read_b64_tr_b16 v[104:105], v163 offset:27904
    ds_read_b64_tr_b16 v[106:107], v163 offset:32512
    s_waitcnt lgkmcnt(6)
    v_mfma_f32_16x16x32_bf16 v[52:55], v[92:95], v[132:135], v[52:55]
    v_mfma_f32_16x16x32_bf16 v[56:59], v[92:95], v[136:139], v[56:59]
    s_waitcnt lgkmcnt(4)
    v_mfma_f32_16x16x32_bf16 v[60:63], v[96:99], v[132:135], v[60:63]
    v_mfma_f32_16x16x32_bf16 v[64:67], v[96:99], v[136:139], v[64:67]
    s_waitcnt lgkmcnt(2)
    v_mfma_f32_16x16x32_bf16 v[68:71], v[100:103], v[132:135], v[68:71]
    v_mfma_f32_16x16x32_bf16 v[72:75], v[100:103], v[136:139], v[72:75]
    s_waitcnt lgkmcnt(0)
    v_mfma_f32_16x16x32_bf16 v[76:79], v[104:107], v[132:135], v[76:79]
    v_mfma_f32_16x16x32_bf16 v[80:83], v[104:107], v[136:139], v[80:83]
    s_waitcnt vmcnt(4)
    s_add_u32 s58, s58, 4
    v_mov_b32 v11, 1
    s_mov_b64 exec, 1
    ds_add_u32 v10, v11 offset:4
sy31:
    ds_read_b32 v11, v10 offset:4
    s_waitcnt lgkmcnt(0)
    v_readfirstlane_b32 s59, v11
    s_cmp_ge_u32 s59, s58
    s_cbranch_scc1 sd31
    s_sleep 1
    s_branch sy31
sd31:
    s_mov_b64 exec, -1
    ds_read_b64_tr_b16 v[84:85], v164 offset:0
    ds_read_b64_tr_b16 v[86:87], v164 offset:4608
    ds_read_b64_tr_b16 v[88:89], v164 offset:32
    ds_read_b64_tr_b16 v[90:91], v164 offset:4640
    ds_read_b64_tr_b16 v[92:93], v164 offset:64
    ds_read_b64_tr_b16 v[94:95], v164 offset:4672
    ds_read_b64_tr_b16 v[96:97], v164 offset:96
    ds_read_b64_tr_b16 v[98:99], v164 offset:4704
    s_waitcnt lgkmcnt(6)
    v_mfma_f32_16x16x32_bf16 v[12:15], v[84:87], v[140:143], v[12:15]
    v_mfma_f32_16x16x32_bf16 v[16:19], v[84:87], v[144:147], v[16:19]
    ds_read_b64_tr_b16 v[100:101], v164 offset:128
    ds_read_b64_tr_b16 v[102:103], v164 offset:4736
    s_add_u32 m0, s30, 88064
    s_nop 0
    buffer_load_dwordx4 v158, s[8:11], s28 offen lds
    s_waitcnt lgkmcnt(6)
    v_mfma_f32_16x16x32_bf16 v[20:23], v[88:91], v[140:143], v[20:23]
    v_mfma_f32_16x16x32_bf16 v[24:27], v[88:91], v[144:147], v[24:27]
    ds_read_b64_tr_b16 v[104:105], v164 offset:160
    ds_read_b64_tr_b16 v[106:107], v164 offset:4768
    s_add_u32 m0, s30, 89088
    s_nop 0
    buffer_load_dwordx4 v159, s[8:11], s28 offen lds
    s_waitcnt lgkmcnt(6)
    v_mfma_f32_16x16x32_bf16 v[28:31], v[92:95], v[140:143], v[28:31]
    v_mfma_f32_16x16x32_bf16 v[32:35], v[92:95], v[144:147], v[32:35]
    ds_read_b64_tr_b16 v[84:85], v164 offset:192
    ds_read_b64_tr_b16 v[86:87], v164 offset:4800
    buffer_load_dwordx4 v[124:127], v156, s[4:7], s27 offen offset:0
    buffer_load_dwordx4 v[132:135], v156, s[4:7], s27 offen offset:1024
    s_waitcnt lgkmcnt(6)
    v_mfma_f32_16x16x32_bf16 v[36:39], v[96:99], v[140:143], v[36:39]
    v_mfma_f32_16x16x32_bf16 v[40:43], v[96:99], v[144:147], v[40:43]
    ds_read_b64_tr_b16 v[88:89], v164 offset:224
    ds_read_b64_tr_b16 v[90:91], v164 offset:4832
    buffer_load_dwordx4 v[128:131], v157, s[4:7], s27 offen offset:0
    buffer_load_dwordx4 v[136:139], v157, s[4:7], s27 offen offset:1024
    s_add_u32 s27, s27, 2048
    s_waitcnt lgkmcnt(6)
    v_mfma_f32_16x16x32_bf16 v[44:47], v[100:103], v[140:143], v[44:47]
    v_mfma_f32_16x16x32_bf16 v[48:51], v[100:103], v[144:147], v[48:51]
    ds_read_b64_tr_b16 v[92:93], v164 offset:256
    ds_read_b64_tr_b16 v[94:95], v164 offset:4864
    s_add_u32 m0, s30, 90112
    s_nop 0
    buffer_load_dwordx4 v160, s[8:11], s28 offen lds
    s_waitcnt lgkmcnt(6)
    v_mfma_f32_16x16x32_bf16 v[52:55], v[104:107], v[140:143], v[52:55]
    v_mfma_f32_16x16x32_bf16 v[56:59], v[104:107], v[144:147], v[56:59]
    ds_read_b64_tr_b16 v[96:97], v164 offset:9216
    ds_read_b64_tr_b16 v[98:99], v164 offset:13824
    s_cmp_eq_u32 s29, 3
    s_cbranch_scc1 f2sk32
    s_add_u32 m0, s30, 91136
    s_nop 0
    buffer_load_dwordx4 v161, s[8:11], s28 offen lds
    s_add_u32 m0, s30, 92160
    s_nop 0
    buffer_load_dwordx4 v162, s[8:11], s28 offen lds
    f2sk32:
    s_add_u32 s28, s28, 73728
    s_waitcnt lgkmcnt(6)
    v_mfma_f32_16x16x32_bf16 v[60:63], v[84:87], v[140:143], v[60:63]
    v_mfma_f32_16x16x32_bf16 v[64:67], v[84:87], v[144:147], v[64:67]
    ds_read_b64_tr_b16 v[100:101], v164 offset:9248
    ds_read_b64_tr_b16 v[102:103], v164 offset:13856
    s_add_u32 m0, s30, 106496
    s_nop 0
    buffer_load_dwordx4 v158, s[8:11], s28 offen lds
    s_waitcnt lgkmcnt(6)
    v_mfma_f32_16x16x32_bf16 v[68:71], v[88:91], v[140:143], v[68:71]
    v_mfma_f32_16x16x32_bf16 v[72:75], v[88:91], v[144:147], v[72:75]
    ds_read_b64_tr_b16 v[104:105], v164 offset:9280
    ds_read_b64_tr_b16 v[106:107], v164 offset:13888
    s_add_u32 m0, s30, 107520
    s_nop 0
    buffer_load_dwordx4 v159, s[8:11], s28 offen lds
    s_waitcnt lgkmcnt(6)
    v_mfma_f32_16x16x32_bf16 v[76:79], v[92:95], v[140:143], v[76:79]
    v_mfma_f32_16x16x32_bf16 v[80:83], v[92:95], v[144:147], v[80:83]
    ds_read_b64_tr_b16 v[84:85], v164 offset:9312
    ds_read_b64_tr_b16 v[86:87], v164 offset:13920
    s_add_u32 m0, s30, 108544
    s_nop 0
    buffer_load_dwordx4 v160, s[8:11], s28 offen lds
    s_waitcnt lgkmcnt(6)
    v_mfma_f32_16x16x32_bf16 v[12:15], v[96:99], v[148:151], v[12:15]
    v_mfma_f32_16x16x32_bf16 v[16:19], v[96:99], v[152:155], v[16:19]
    ds_read_b64_tr_b16 v[88:89], v164 offset:9344
    ds_read_b64_tr_b16 v[90:91], v164 offset:13952
    s_cmp_eq_u32 s29, 3
    s_cbranch_scc1 f2sk33
    s_add_u32 m0, s30, 109568
    s_nop 0
    buffer_load_dwordx4 v161, s[8:11], s28 offen lds
    s_add_u32 m0, s30, 110592
    s_nop 0
    buffer_load_dwordx4 v162, s[8:11], s28 offen lds
    f2sk33:
    s_add_u32 s28, s28, 73728
    s_waitcnt lgkmcnt(6)
    v_mfma_f32_16x16x32_bf16 v[20:23], v[100:103], v[148:151], v[20:23]
    v_mfma_f32_16x16x32_bf16 v[24:27], v[100:103], v[152:155], v[24:27]
    ds_read_b64_tr_b16 v[92:93], v164 offset:9376
    ds_read_b64_tr_b16 v[94:95], v164 offset:13984
    s_waitcnt lgkmcnt(6)
    v_mfma_f32_16x16x32_bf16 v[28:31], v[104:107], v[148:151], v[28:31]
    v_mfma_f32_16x16x32_bf16 v[32:35], v[104:107], v[152:155], v[32:35]
    ds_read_b64_tr_b16 v[96:97], v164 offset:9408
    ds_read_b64_tr_b16 v[98:99], v164 offset:14016
    s_waitcnt lgkmcnt(6)
    v_mfma_f32_16x16x32_bf16 v[36:39], v[84:87], v[148:151], v[36:39]
    v_mfma_f32_16x16x32_bf16 v[40:43], v[84:87], v[152:155], v[40:43]
    ds_read_b64_tr_b16 v[100:101], v164 offset:9440
    ds_read_b64_tr_b16 v[102:103], v164 offset:14048
    s_waitcnt lgkmcnt(6)
    v_mfma_f32_16x16x32_bf16 v[44:47], v[88:91], v[148:151], v[44:47]
    v_mfma_f32_16x16x32_bf16 v[48:51], v[88:91], v[152:155], v[48:51]
    ds_read_b64_tr_b16 v[104:105], v164 offset:9472
    ds_read_b64_tr_b16 v[106:107], v164 offset:14080
    s_waitcnt lgkmcnt(6)
    v_mfma_f32_16x16x32_bf16 v[52:55], v[92:95], v[148:151], v[52:55]
    v_mfma_f32_16x16x32_bf16 v[56:59], v[92:95], v[152:155], v[56:59]
    ds_read_b64_tr_b16 v[84:85], v164 offset:18432
    ds_read_b64_tr_b16 v[86:87], v164 offset:23040
    s_waitcnt lgkmcnt(6)
    v_mfma_f32_16x16x32_bf16 v[60:63], v[96:99], v[148:151], v[60:63]
    v_mfma_f32_16x16x32_bf16 v[64:67], v[96:99], v[152:155], v[64:67]
    ds_read_b64_tr_b16 v[88:89], v164 offset:18464
    ds_read_b64_tr_b16 v[90:91], v164 offset:23072
    s_waitcnt lgkmcnt(6)
    v_mfma_f32_16x16x32_bf16 v[68:71], v[100:103], v[148:151], v[68:71]
    v_mfma_f32_16x16x32_bf16 v[72:75], v[100:103], v[152:155], v[72:75]
    ds_read_b64_tr_b16 v[92:93], v164 offset:18496
    ds_read_b64_tr_b16 v[94:95], v164 offset:23104
    s_waitcnt lgkmcnt(6)
    v_mfma_f32_16x16x32_bf16 v[76:79], v[104:107], v[148:151], v[76:79]
    v_mfma_f32_16x16x32_bf16 v[80:83], v[104:107], v[152:155], v[80:83]
    ds_read_b64_tr_b16 v[96:97], v164 offset:18528
    ds_read_b64_tr_b16 v[98:99], v164 offset:23136
    s_waitcnt vmcnt(10)
    s_waitcnt lgkmcnt(6)
    v_mfma_f32_16x16x32_bf16 v[12:15], v[84:87], v[108:111], v[12:15]
    v_mfma_f32_16x16x32_bf16 v[16:19], v[84:87], v[112:115], v[16:19]
    ds_read_b64_tr_b16 v[100:101], v164 offset:18560
    ds_read_b64_tr_b16 v[102:103], v164 offset:23168
    buffer_load_dwordx4 v[140:143], v156, s[4:7], s27 offen offset:0
    buffer_load_dwordx4 v[148:151], v156, s[4:7], s27 offen offset:1024
    s_waitcnt lgkmcnt(6)
    v_mfma_f32_16x16x32_bf16 v[20:23], v[88:91], v[108:111], v[20:23]
    v_mfma_f32_16x16x32_bf16 v[24:27], v[88:91], v[112:115], v[24:27]
    ds_read_b64_tr_b16 v[104:105], v164 offset:18592
    ds_read_b64_tr_b16 v[106:107], v164 offset:23200
    buffer_load_dwordx4 v[144:147], v157, s[4:7], s27 offen offset:0
    buffer_load_dwordx4 v[152:155], v157, s[4:7], s27 offen offset:1024
    s_add_u32 s27, s27, 2048
    s_waitcnt lgkmcnt(6)
    v_mfma_f32_16x16x32_bf16 v[28:31], v[92:95], v[108:111], v[28:31]
    v_mfma_f32_16x16x32_bf16 v[32:35], v[92:95], v[112:115], v[32:35]
    ds_read_b64_tr_b16 v[84:85], v164 offset:18624
    ds_read_b64_tr_b16 v[86:87], v164 offset:23232
    s_waitcnt lgkmcnt(6)
    v_mfma_f32_16x16x32_bf16 v[36:39], v[96:99], v[108:111], v[36:39]
    v_mfma_f32_16x16x32_bf16 v[40:43], v[96:99], v[112:115], v[40:43]
    ds_read_b64_tr_b16 v[88:89], v164 offset:18656
    ds_read_b64_tr_b16 v[90:91], v164 offset:23264
    s_waitcnt lgkmcnt(6)
    v_mfma_f32_16x16x32_bf16 v[44:47], v[100:103], v[108:111], v[44:47]
    v_mfma_f32_16x16x32_bf16 v[48:51], v[100:103], v[112:115], v[48:51]
    ds_read_b64_tr_b16 v[92:93], v164 offset:18688
    ds_read_b64_tr_b16 v[94:95], v164 offset:23296
    s_waitcnt lgkmcnt(6)
    v_mfma_f32_16x16x32_bf16 v[52:55], v[104:107], v[108:111], v[52:55]
    v_mfma_f32_16x16x32_bf16 v[56:59], v[104:107], v[112:115], v[56:59]
    ds_read_b64_tr_b16 v[96:97], v164 offset:27648
    ds_read_b64_tr_b16 v[98:99], v164 offset:32256
    s_waitcnt lgkmcnt(6)
    v_mfma_f32_16x16x32_bf16 v[60:63], v[84:87], v[108:111], v[60:63]
    v_mfma_f32_16x16x32_bf16 v[64:67], v[84:87], v[112:115], v[64:67]
    ds_read_b64_tr_b16 v[100:101], v164 offset:27680
    ds_read_b64_tr_b16 v[102:103], v164 offset:32288
    s_waitcnt lgkmcnt(6)
    v_mfma_f32_16x16x32_bf16 v[68:71], v[88:91], v[108:111], v[68:71]
    v_mfma_f32_16x16x32_bf16 v[72:75], v[88:91], v[112:115], v[72:75]
    ds_read_b64_tr_b16 v[104:105], v164 offset:27712
    ds_read_b64_tr_b16 v[106:107], v164 offset:32320
    s_waitcnt lgkmcnt(6)
    v_mfma_f32_16x16x32_bf16 v[76:79], v[92:95], v[108:111], v[76:79]
    v_mfma_f32_16x16x32_bf16 v[80:83], v[92:95], v[112:115], v[80:83]
    ds_read_b64_tr_b16 v[84:85], v164 offset:27744
    ds_read_b64_tr_b16 v[86:87], v164 offset:32352
    s_waitcnt lgkmcnt(6)
    v_mfma_f32_16x16x32_bf16 v[12:15], v[96:99], v[116:119], v[12:15]
    v_mfma_f32_16x16x32_bf16 v[16:19], v[96:99], v[120:123], v[16:19]
    ds_read_b64_tr_b16 v[88:89], v164 offset:27776
    ds_read_b64_tr_b16 v[90:91], v164 offset:32384
    s_waitcnt lgkmcnt(6)
    v_mfma_f32_16x16x32_bf16 v[20:23], v[100:103], v[116:119], v[20:23]
    v_mfma_f32_16x16x32_bf16 v[24:27], v[100:103], v[120:123], v[24:27]
    ds_read_b64_tr_b16 v[92:93], v164 offset:27808
    ds_read_b64_tr_b16 v[94:95], v164 offset:32416
    s_waitcnt lgkmcnt(6)
    v_mfma_f32_16x16x32_bf16 v[28:31], v[104:107], v[116:119], v[28:31]
    v_mfma_f32_16x16x32_bf16 v[32:35], v[104:107], v[120:123], v[32:35]
    ds_read_b64_tr_b16 v[96:97], v164 offset:27840
    ds_read_b64_tr_b16 v[98:99], v164 offset:32448
    s_waitcnt lgkmcnt(6)
    v_mfma_f32_16x16x32_bf16 v[36:39], v[84:87], v[116:119], v[36:39]
    v_mfma_f32_16x16x32_bf16 v[40:43], v[84:87], v[120:123], v[40:43]
    ds_read_b64_tr_b16 v[100:101], v164 offset:27872
    ds_read_b64_tr_b16 v[102:103], v164 offset:32480
    s_waitcnt lgkmcnt(6)
    v_mfma_f32_16x16x32_bf16 v[44:47], v[88:91], v[116:119], v[44:47]
    v_mfma_f32_16x16x32_bf16 v[48:51], v[88:91], v[120:123], v[48:51]
    ds_read_b64_tr_b16 v[104:105], v164 offset:27904
    ds_read_b64_tr_b16 v[106:107], v164 offset:32512
    s_waitcnt lgkmcnt(6)
    v_mfma_f32_16x16x32_bf16 v[52:55], v[92:95], v[116:119], v[52:55]
    v_mfma_f32_16x16x32_bf16 v[56:59], v[92:95], v[120:123], v[56:59]
    s_waitcnt lgkmcnt(4)
    v_mfma_f32_16x16x32_bf16 v[60:63], v[96:99], v[116:119], v[60:63]
    v_mfma_f32_16x16x32_bf16 v[64:67], v[96:99], v[120:123], v[64:67]
    s_waitcnt lgkmcnt(2)
    v_mfma_f32_16x16x32_bf16 v[68:71], v[100:103], v[116:119], v[68:71]
    v_mfma_f32_16x16x32_bf16 v[72:75], v[100:103], v[120:123], v[72:75]
    s_waitcnt lgkmcnt(0)
    v_mfma_f32_16x16x32_bf16 v[76:79], v[104:107], v[116:119], v[76:79]
    v_mfma_f32_16x16x32_bf16 v[80:83], v[104:107], v[120:123], v[80:83]
    s_waitcnt vmcnt(4)
    s_add_u32 s58, s58, 4
    v_mov_b32 v11, 1
    s_mov_b64 exec, 1
    ds_add_u32 v10, v11 offset:4
sy34:
    ds_read_b32 v11, v10 offset:4
    s_waitcnt lgkmcnt(0)
    v_readfirstlane_b32 s59, v11
    s_cmp_ge_u32 s59, s58
    s_cbranch_scc1 sd34
    s_sleep 1
    s_branch sy34
sd34:
    s_mov_b64 exec, -1
    ds_read_b64_tr_b16 v[84:85], v163 offset:0
    ds_read_b64_tr_b16 v[86:87], v163 offset:4608
    ds_read_b64_tr_b16 v[88:89], v163 offset:32
    ds_read_b64_tr_b16 v[90:91], v163 offset:4640
    ds_read_b64_tr_b16 v[92:93], v163 offset:64
    ds_read_b64_tr_b16 v[94:95], v163 offset:4672
    ds_read_b64_tr_b16 v[96:97], v163 offset:96
    ds_read_b64_tr_b16 v[98:99], v163 offset:4704
    s_waitcnt lgkmcnt(6)
    v_mfma_f32_16x16x32_bf16 v[12:15], v[84:87], v[124:127], v[12:15]
    v_mfma_f32_16x16x32_bf16 v[16:19], v[84:87], v[128:131], v[16:19]
    ds_read_b64_tr_b16 v[100:101], v163 offset:128
    ds_read_b64_tr_b16 v[102:103], v163 offset:4736
    s_waitcnt lgkmcnt(6)
    v_mfma_f32_16x16x32_bf16 v[20:23], v[88:91], v[124:127], v[20:23]
    v_mfma_f32_16x16x32_bf16 v[24:27], v[88:91], v[128:131], v[24:27]
    ds_read_b64_tr_b16 v[104:105], v163 offset:160
    ds_read_b64_tr_b16 v[106:107], v163 offset:4768
    s_waitcnt lgkmcnt(6)
    v_mfma_f32_16x16x32_bf16 v[28:31], v[92:95], v[124:127], v[28:31]
    v_mfma_f32_16x16x32_bf16 v[32:35], v[92:95], v[128:131], v[32:35]
    ds_read_b64_tr_b16 v[84:85], v163 offset:192
    ds_read_b64_tr_b16 v[86:87], v163 offset:4800
    s_waitcnt lgkmcnt(6)
    v_mfma_f32_16x16x32_bf16 v[36:39], v[96:99], v[124:127], v[36:39]
    v_mfma_f32_16x16x32_bf16 v[40:43], v[96:99], v[128:131], v[40:43]
    ds_read_b64_tr_b16 v[88:89], v163 offset:224
    ds_read_b64_tr_b16 v[90:91], v163 offset:4832
    s_waitcnt lgkmcnt(6)
    v_mfma_f32_16x16x32_bf16 v[44:47], v[100:103], v[124:127], v[44:47]
    v_mfma_f32_16x16x32_bf16 v[48:51], v[100:103], v[128:131], v[48:51]
    ds_read_b64_tr_b16 v[92:93], v163 offset:256
    ds_read_b64_tr_b16 v[94:95], v163 offset:4864
    s_waitcnt lgkmcnt(6)
    v_mfma_f32_16x16x32_bf16 v[52:55], v[104:107], v[124:127], v[52:55]
    v_mfma_f32_16x16x32_bf16 v[56:59], v[104:107], v[128:131], v[56:59]
    ds_read_b64_tr_b16 v[96:97], v163 offset:9216
    ds_read_b64_tr_b16 v[98:99], v163 offset:13824
    s_waitcnt lgkmcnt(6)
    v_mfma_f32_16x16x32_bf16 v[60:63], v[84:87], v[124:127], v[60:63]
    v_mfma_f32_16x16x32_bf16 v[64:67], v[84:87], v[128:131], v[64:67]
    ds_read_b64_tr_b16 v[100:101], v163 offset:9248
    ds_read_b64_tr_b16 v[102:103], v163 offset:13856
    s_waitcnt lgkmcnt(6)
    v_mfma_f32_16x16x32_bf16 v[68:71], v[88:91], v[124:127], v[68:71]
    v_mfma_f32_16x16x32_bf16 v[72:75], v[88:91], v[128:131], v[72:75]
    ds_read_b64_tr_b16 v[104:105], v163 offset:9280
    ds_read_b64_tr_b16 v[106:107], v163 offset:13888
    s_waitcnt lgkmcnt(6)
    v_mfma_f32_16x16x32_bf16 v[76:79], v[92:95], v[124:127], v[76:79]
    v_mfma_f32_16x16x32_bf16 v[80:83], v[92:95], v[128:131], v[80:83]
    ds_read_b64_tr_b16 v[84:85], v163 offset:9312
    ds_read_b64_tr_b16 v[86:87], v163 offset:13920
    s_waitcnt lgkmcnt(6)
    v_mfma_f32_16x16x32_bf16 v[12:15], v[96:99], v[132:135], v[12:15]
    v_mfma_f32_16x16x32_bf16 v[16:19], v[96:99], v[136:139], v[16:19]
    ds_read_b64_tr_b16 v[88:89], v163 offset:9344
    ds_read_b64_tr_b16 v[90:91], v163 offset:13952
    s_waitcnt lgkmcnt(6)
    v_mfma_f32_16x16x32_bf16 v[20:23], v[100:103], v[132:135], v[20:23]
    v_mfma_f32_16x16x32_bf16 v[24:27], v[100:103], v[136:139], v[24:27]
    ds_read_b64_tr_b16 v[92:93], v163 offset:9376
    ds_read_b64_tr_b16 v[94:95], v163 offset:13984
    s_waitcnt lgkmcnt(6)
    v_mfma_f32_16x16x32_bf16 v[28:31], v[104:107], v[132:135], v[28:31]
    v_mfma_f32_16x16x32_bf16 v[32:35], v[104:107], v[136:139], v[32:35]
    ds_read_b64_tr_b16 v[96:97], v163 offset:9408
    ds_read_b64_tr_b16 v[98:99], v163 offset:14016
    s_waitcnt lgkmcnt(6)
    v_mfma_f32_16x16x32_bf16 v[36:39], v[84:87], v[132:135], v[36:39]
    v_mfma_f32_16x16x32_bf16 v[40:43], v[84:87], v[136:139], v[40:43]
    ds_read_b64_tr_b16 v[100:101], v163 offset:9440
    ds_read_b64_tr_b16 v[102:103], v163 offset:14048
    s_waitcnt lgkmcnt(6)
    v_mfma_f32_16x16x32_bf16 v[44:47], v[88:91], v[132:135], v[44:47]
    v_mfma_f32_16x16x32_bf16 v[48:51], v[88:91], v[136:139], v[48:51]
    ds_read_b64_tr_b16 v[104:105], v163 offset:9472
    ds_read_b64_tr_b16 v[106:107], v163 offset:14080
    s_waitcnt lgkmcnt(6)
    v_mfma_f32_16x16x32_bf16 v[52:55], v[92:95], v[132:135], v[52:55]
    v_mfma_f32_16x16x32_bf16 v[56:59], v[92:95], v[136:139], v[56:59]
    ds_read_b64_tr_b16 v[84:85], v163 offset:18432
    ds_read_b64_tr_b16 v[86:87], v163 offset:23040
    s_waitcnt lgkmcnt(6)
    v_mfma_f32_16x16x32_bf16 v[60:63], v[96:99], v[132:135], v[60:63]
    v_mfma_f32_16x16x32_bf16 v[64:67], v[96:99], v[136:139], v[64:67]
    ds_read_b64_tr_b16 v[88:89], v163 offset:18464
    ds_read_b64_tr_b16 v[90:91], v163 offset:23072
    s_waitcnt lgkmcnt(6)
    v_mfma_f32_16x16x32_bf16 v[68:71], v[100:103], v[132:135], v[68:71]
    v_mfma_f32_16x16x32_bf16 v[72:75], v[100:103], v[136:139], v[72:75]
    ds_read_b64_tr_b16 v[92:93], v163 offset:18496
    ds_read_b64_tr_b16 v[94:95], v163 offset:23104
    s_waitcnt lgkmcnt(6)
    v_mfma_f32_16x16x32_bf16 v[76:79], v[104:107], v[132:135], v[76:79]
    v_mfma_f32_16x16x32_bf16 v[80:83], v[104:107], v[136:139], v[80:83]
    ds_read_b64_tr_b16 v[96:97], v163 offset:18528
    ds_read_b64_tr_b16 v[98:99], v163 offset:23136
    s_waitcnt vmcnt(0)
    s_waitcnt lgkmcnt(6)
    v_mfma_f32_16x16x32_bf16 v[12:15], v[84:87], v[140:143], v[12:15]
    v_mfma_f32_16x16x32_bf16 v[16:19], v[84:87], v[144:147], v[16:19]
    ds_read_b64_tr_b16 v[100:101], v163 offset:18560
    ds_read_b64_tr_b16 v[102:103], v163 offset:23168
    s_waitcnt lgkmcnt(6)
    v_mfma_f32_16x16x32_bf16 v[20:23], v[88:91], v[140:143], v[20:23]
    v_mfma_f32_16x16x32_bf16 v[24:27], v[88:91], v[144:147], v[24:27]
    ds_read_b64_tr_b16 v[104:105], v163 offset:18592
    ds_read_b64_tr_b16 v[106:107], v163 offset:23200
    s_waitcnt lgkmcnt(6)
    v_mfma_f32_16x16x32_bf16 v[28:31], v[92:95], v[140:143], v[28:31]
    v_mfma_f32_16x16x32_bf16 v[32:35], v[92:95], v[144:147], v[32:35]
    ds_read_b64_tr_b16 v[84:85], v163 offset:18624
    ds_read_b64_tr_b16 v[86:87], v163 offset:23232
    s_waitcnt lgkmcnt(6)
    v_mfma_f32_16x16x32_bf16 v[36:39], v[96:99], v[140:143], v[36:39]
    v_mfma_f32_16x16x32_bf16 v[40:43], v[96:99], v[144:147], v[40:43]
    ds_read_b64_tr_b16 v[88:89], v163 offset:18656
    ds_read_b64_tr_b16 v[90:91], v163 offset:23264
    s_waitcnt lgkmcnt(6)
    v_mfma_f32_16x16x32_bf16 v[44:47], v[100:103], v[140:143], v[44:47]
    v_mfma_f32_16x16x32_bf16 v[48:51], v[100:103], v[144:147], v[48:51]
    ds_read_b64_tr_b16 v[92:93], v163 offset:18688
    ds_read_b64_tr_b16 v[94:95], v163 offset:23296
    s_waitcnt lgkmcnt(6)
    v_mfma_f32_16x16x32_bf16 v[52:55], v[104:107], v[140:143], v[52:55]
    v_mfma_f32_16x16x32_bf16 v[56:59], v[104:107], v[144:147], v[56:59]
    ds_read_b64_tr_b16 v[96:97], v163 offset:27648
    ds_read_b64_tr_b16 v[98:99], v163 offset:32256
    s_waitcnt lgkmcnt(6)
    v_mfma_f32_16x16x32_bf16 v[60:63], v[84:87], v[140:143], v[60:63]
    v_mfma_f32_16x16x32_bf16 v[64:67], v[84:87], v[144:147], v[64:67]
    ds_read_b64_tr_b16 v[100:101], v163 offset:27680
    ds_read_b64_tr_b16 v[102:103], v163 offset:32288
    s_waitcnt lgkmcnt(6)
    v_mfma_f32_16x16x32_bf16 v[68:71], v[88:91], v[140:143], v[68:71]
    v_mfma_f32_16x16x32_bf16 v[72:75], v[88:91], v[144:147], v[72:75]
    ds_read_b64_tr_b16 v[104:105], v163 offset:27712
    ds_read_b64_tr_b16 v[106:107], v163 offset:32320
    s_waitcnt lgkmcnt(6)
    v_mfma_f32_16x16x32_bf16 v[76:79], v[92:95], v[140:143], v[76:79]
    v_mfma_f32_16x16x32_bf16 v[80:83], v[92:95], v[144:147], v[80:83]
    ds_read_b64_tr_b16 v[84:85], v163 offset:27744
    ds_read_b64_tr_b16 v[86:87], v163 offset:32352
    s_waitcnt lgkmcnt(6)
    v_mfma_f32_16x16x32_bf16 v[12:15], v[96:99], v[148:151], v[12:15]
    v_mfma_f32_16x16x32_bf16 v[16:19], v[96:99], v[152:155], v[16:19]
    ds_read_b64_tr_b16 v[88:89], v163 offset:27776
    ds_read_b64_tr_b16 v[90:91], v163 offset:32384
    s_waitcnt lgkmcnt(6)
    v_mfma_f32_16x16x32_bf16 v[20:23], v[100:103], v[148:151], v[20:23]
    v_mfma_f32_16x16x32_bf16 v[24:27], v[100:103], v[152:155], v[24:27]
    ds_read_b64_tr_b16 v[92:93], v163 offset:27808
    ds_read_b64_tr_b16 v[94:95], v163 offset:32416
    s_waitcnt lgkmcnt(6)
    v_mfma_f32_16x16x32_bf16 v[28:31], v[104:107], v[148:151], v[28:31]
    v_mfma_f32_16x16x32_bf16 v[32:35], v[104:107], v[152:155], v[32:35]
    ds_read_b64_tr_b16 v[96:97], v163 offset:27840
    ds_read_b64_tr_b16 v[98:99], v163 offset:32448
    s_waitcnt lgkmcnt(6)
    v_mfma_f32_16x16x32_bf16 v[36:39], v[84:87], v[148:151], v[36:39]
    v_mfma_f32_16x16x32_bf16 v[40:43], v[84:87], v[152:155], v[40:43]
    ds_read_b64_tr_b16 v[100:101], v163 offset:27872
    ds_read_b64_tr_b16 v[102:103], v163 offset:32480
    s_waitcnt lgkmcnt(6)
    v_mfma_f32_16x16x32_bf16 v[44:47], v[88:91], v[148:151], v[44:47]
    v_mfma_f32_16x16x32_bf16 v[48:51], v[88:91], v[152:155], v[48:51]
    ds_read_b64_tr_b16 v[104:105], v163 offset:27904
    ds_read_b64_tr_b16 v[106:107], v163 offset:32512
    s_waitcnt lgkmcnt(6)
    v_mfma_f32_16x16x32_bf16 v[52:55], v[92:95], v[148:151], v[52:55]
    v_mfma_f32_16x16x32_bf16 v[56:59], v[92:95], v[152:155], v[56:59]
    s_waitcnt lgkmcnt(4)
    v_mfma_f32_16x16x32_bf16 v[60:63], v[96:99], v[148:151], v[60:63]
    v_mfma_f32_16x16x32_bf16 v[64:67], v[96:99], v[152:155], v[64:67]
    s_waitcnt lgkmcnt(2)
    v_mfma_f32_16x16x32_bf16 v[68:71], v[100:103], v[148:151], v[68:71]
    v_mfma_f32_16x16x32_bf16 v[72:75], v[100:103], v[152:155], v[72:75]
    s_waitcnt lgkmcnt(0)
    v_mfma_f32_16x16x32_bf16 v[76:79], v[104:107], v[148:151], v[76:79]
    v_mfma_f32_16x16x32_bf16 v[80:83], v[104:107], v[152:155], v[80:83]
    s_nop 7
    s_nop 1
    v_and_b32 v2, 15, v1
    v_lshrrev_b32 v3, 4, v1
    s_lshl_b32 s31, s29, 5
    s_add_u32 s31, s31, s24
    s_lshl_b32 s32, s26, 11
    s_add_u32 s31, s31, s32
    v_add_u32 v2, s31, v2
    v_mul_u32_u24 v4, 1152, v2
    s_lshl_b32 s31, s25, 1
    v_lshl_add_u32 v5, v3, 3, s31
    v_add_u32 v4, v4, v5
    v_and_b32 v7, 1, v3
    v_mul_u32_u24 v6, 18424, v7
    v_add_u32 v6, v6, v4
    v_mul_u32_u24 v7, 24, v7
    v_add_u32 v4, v4, v7
    v_add_u32 v5, 18432, v4
    v_and_b32 v2, 15, v1
    s_lshl_b32 s31, s29, 1
    s_lshr_b32 s32, s24, 4
    s_add_u32 s31, s31, s32
    s_lshl_b32 s32, s26, 7
    s_add_u32 s31, s31, s32
    s_mul_i32 s31, s31, 18432
    s_lshl_b32 s32, s25, 5
    s_add_u32 s31, s31, s32
    s_add_u32 s32, s31, 18432
    v_lshlrev_b32 v2, 4, v2
    v_and_b32 v4, 1, v3
    v_lshrrev_b32 v5, 1, v3
    v_lshl_add_u32 v4, v4, 1, v5
    v_add_u32 v6, 0, v4
    v_cmp_lt_u32 vcc, 8, v6
    v_subrev_u32 v7, 9, v6
    v_mov_b32 v8, 2304
    v_cndmask_b32 v7, v6, v7, vcc
    v_cndmask_b32 v8, 0, v8, vcc
    v_lshrrev_b32 v9, 2, v7
    v_lshl_add_u32 v8, v9, 10, v8
    v_and_b32 v9, 1, v7
    v_lshl_add_u32 v8, v9, 9, v8
    v_bfe_u32 v9, v7, 1, 1
    v_lshl_add_u32 v8, v9, 8, v8
    v_add_u32 v5, v8, v2
    v_cvt_pk_bf16_f32 v12, v12, v13
    v_cvt_pk_bf16_f32 v13, v14, v15
    v_cvt_pk_bf16_f32 v14, v20, v21
    v_cvt_pk_bf16_f32 v15, v22, v23
    s_nop 1
    v_permlane16_swap_b32 v12, v14
    v_permlane16_swap_b32 v13, v15
    s_nop 0
    buffer_store_dwordx4 v[12:15], v5, s[12:15], s31 offen
    v_cvt_pk_bf16_f32 v16, v16, v17
    v_cvt_pk_bf16_f32 v17, v18, v19
    v_cvt_pk_bf16_f32 v18, v24, v25
    v_cvt_pk_bf16_f32 v19, v26, v27
    s_nop 1
    v_permlane16_swap_b32 v16, v18
    v_permlane16_swap_b32 v17, v19
    s_nop 0
    buffer_store_dwordx4 v[16:19], v5, s[12:15], s32 offen
    v_add_u32 v6, 4, v4
    v_cmp_lt_u32 vcc, 8, v6
    v_subrev_u32 v7, 9, v6
    v_mov_b32 v8, 2304
    v_cndmask_b32 v7, v6, v7, vcc
    v_cndmask_b32 v8, 0, v8, vcc
    v_lshrrev_b32 v9, 2, v7
    v_lshl_add_u32 v8, v9, 10, v8
    v_and_b32 v9, 1, v7
    v_lshl_add_u32 v8, v9, 9, v8
    v_bfe_u32 v9, v7, 1, 1
    v_lshl_add_u32 v8, v9, 8, v8
    v_add_u32 v5, v8, v2
    v_cvt_pk_bf16_f32 v28, v28, v29
    v_cvt_pk_bf16_f32 v29, v30, v31
    v_cvt_pk_bf16_f32 v30, v36, v37
    v_cvt_pk_bf16_f32 v31, v38, v39
    s_nop 1
    v_permlane16_swap_b32 v28, v30
    v_permlane16_swap_b32 v29, v31
    s_nop 0
    buffer_store_dwordx4 v[28:31], v5, s[12:15], s31 offen
    v_cvt_pk_bf16_f32 v32, v32, v33
    v_cvt_pk_bf16_f32 v33, v34, v35
    v_cvt_pk_bf16_f32 v34, v40, v41
    v_cvt_pk_bf16_f32 v35, v42, v43
    s_nop 1
    v_permlane16_swap_b32 v32, v34
    v_permlane16_swap_b32 v33, v35
    s_nop 0
    buffer_store_dwordx4 v[32:35], v5, s[12:15], s32 offen
    v_add_u32 v6, 8, v4
    v_cmp_lt_u32 vcc, 8, v6
    v_subrev_u32 v7, 9, v6
    v_mov_b32 v8, 2304
    v_cndmask_b32 v7, v6, v7, vcc
    v_cndmask_b32 v8, 0, v8, vcc
    v_lshrrev_b32 v9, 2, v7
    v_lshl_add_u32 v8, v9, 10, v8
    v_and_b32 v9, 1, v7
    v_lshl_add_u32 v8, v9, 9, v8
    v_bfe_u32 v9, v7, 1, 1
    v_lshl_add_u32 v8, v9, 8, v8
    v_add_u32 v5, v8, v2
    v_cvt_pk_bf16_f32 v44, v44, v45
    v_cvt_pk_bf16_f32 v45, v46, v47
    v_cvt_pk_bf16_f32 v46, v52, v53
    v_cvt_pk_bf16_f32 v47, v54, v55
    s_nop 1
    v_permlane16_swap_b32 v44, v46
    v_permlane16_swap_b32 v45, v47
    s_nop 0
    buffer_store_dwordx4 v[44:47], v5, s[12:15], s31 offen
    v_cvt_pk_bf16_f32 v48, v48, v49
    v_cvt_pk_bf16_f32 v49, v50, v51
    v_cvt_pk_bf16_f32 v50, v56, v57
    v_cvt_pk_bf16_f32 v51, v58, v59
    s_nop 1
    v_permlane16_swap_b32 v48, v50
    v_permlane16_swap_b32 v49, v51
    s_nop 0
    buffer_store_dwordx4 v[48:51], v5, s[12:15], s32 offen
    v_add_u32 v6, 12, v4
    v_cmp_lt_u32 vcc, 8, v6
    v_subrev_u32 v7, 9, v6
    v_mov_b32 v8, 2304
    v_cndmask_b32 v7, v6, v7, vcc
    v_cndmask_b32 v8, 0, v8, vcc
    v_lshrrev_b32 v9, 2, v7
    v_lshl_add_u32 v8, v9, 10, v8
    v_and_b32 v9, 1, v7
    v_lshl_add_u32 v8, v9, 9, v8
    v_bfe_u32 v9, v7, 1, 1
    v_lshl_add_u32 v8, v9, 8, v8
    v_add_u32 v5, v8, v2
    v_cvt_pk_bf16_f32 v60, v60, v61
    v_cvt_pk_bf16_f32 v61, v62, v63
    v_cvt_pk_bf16_f32 v62, v68, v69
    v_cvt_pk_bf16_f32 v63, v70, v71
    s_nop 1
    v_permlane16_swap_b32 v60, v62
    v_permlane16_swap_b32 v61, v63
    s_nop 0
    buffer_store_dwordx4 v[60:63], v5, s[12:15], s31 offen
    v_cvt_pk_bf16_f32 v64, v64, v65
    v_cvt_pk_bf16_f32 v65, v66, v67
    v_cvt_pk_bf16_f32 v66, v72, v73
    v_cvt_pk_bf16_f32 v67, v74, v75
    s_nop 1
    v_permlane16_swap_b32 v64, v66
    v_permlane16_swap_b32 v65, v67
    s_nop 0
    buffer_store_dwordx4 v[64:67], v5, s[12:15], s32 offen
    v_lshrrev_b32 v6, 1, v3
    v_add_u32 v6, 16, v6
    v_cmp_lt_u32 vcc, 8, v6
    v_subrev_u32 v7, 9, v6
    v_mov_b32 v8, 2304
    v_cndmask_b32 v7, v6, v7, vcc
    v_cndmask_b32 v8, 0, v8, vcc
    v_lshrrev_b32 v9, 2, v7
    v_lshl_add_u32 v8, v9, 10, v8
    v_and_b32 v9, 1, v7
    v_lshl_add_u32 v8, v9, 9, v8
    v_bfe_u32 v9, v7, 1, 1
    v_lshl_add_u32 v8, v9, 8, v8
    v_add_u32 v5, v8, v2
    v_and_b32 v6, 1, v3
    v_mul_u32_u24 v6, 18432, v6
    v_add_u32 v5, v5, v6
    v_cvt_pk_bf16_f32 v76, v76, v77
    v_cvt_pk_bf16_f32 v77, v78, v79
    v_cvt_pk_bf16_f32 v78, v80, v81
    v_cvt_pk_bf16_f32 v79, v82, v83
    s_nop 1
    v_permlane16_swap_b32 v76, v78
    v_permlane16_swap_b32 v77, v79
    s_nop 0
    buffer_store_dwordx4 v[76:79], v5, s[12:15], s31 offen
    s_endpgm
at_slow0:
    s_waitcnt lgkmcnt(0)
    v_mfma_f32_32x32x16_bf16 v[64:79], v[128:131], v[96:99], v[64:79]
    v_mfma_f32_32x32x16_bf16 v[64:79], v[132:135], v[100:103], v[64:79]
    v_mov_b32 v150, v154
    s_nop 1
    v_permlane32_swap_b32 v150, v154
    s_nop 1
    v_max_f32 v154, v154, v150
    v_max_f32 v154, 0, v154
    v_sub_f32 v151, 0, v154
    v_exp_f32 v151, v151
    s_nop 15
    s_nop 15
    v_mov_b32 v96, 0
    v_mov_b32 v97, 0
    v_mov_b32 v98, 0
    v_mov_b32 v99, 0
    v_mov_b32 v100, 0
    v_mov_b32 v101, 0
    v_mov_b32 v102, 0
    v_mov_b32 v103, 0
    v_sub_f32 v16, v16, v154
    v_sub_f32 v48, v48, v154
    v_mul_f32 v64, v64, v151
    v_sub_f32 v17, v17, v154
    v_sub_f32 v49, v49, v154
    v_mul_f32 v65, v65, v151
    v_sub_f32 v18, v18, v154
    v_sub_f32 v50, v50, v154
    v_mul_f32 v66, v66, v151
    v_sub_f32 v19, v19, v154
    v_sub_f32 v51, v51, v154
    v_mul_f32 v67, v67, v151
    v_sub_f32 v20, v20, v154
    v_sub_f32 v52, v52, v154
    v_mul_f32 v68, v68, v151
    v_sub_f32 v21, v21, v154
    v_sub_f32 v53, v53, v154
    v_mul_f32 v69, v69, v151
    v_sub_f32 v22, v22, v154
    v_sub_f32 v54, v54, v154
    v_mul_f32 v70, v70, v151
    v_sub_f32 v23, v23, v154
    v_sub_f32 v55, v55, v154
    v_mul_f32 v71, v71, v151
    v_sub_f32 v24, v24, v154
    v_sub_f32 v56, v56, v154
    v_mul_f32 v72, v72, v151
    v_sub_f32 v25, v25, v154
    v_sub_f32 v57, v57, v154
    v_mul_f32 v73, v73, v151
    v_sub_f32 v26, v26, v154
    v_sub_f32 v58, v58, v154
    v_mul_f32 v74, v74, v151
    v_sub_f32 v27, v27, v154
    v_sub_f32 v59, v59, v154
    v_mul_f32 v75, v75, v151
    v_sub_f32 v28, v28, v154
    v_sub_f32 v60, v60, v154
    v_mul_f32 v76, v76, v151
    v_sub_f32 v29, v29, v154
    v_sub_f32 v61, v61, v154
    v_mul_f32 v77, v77, v151
    v_sub_f32 v30, v30, v154
    v_sub_f32 v62, v62, v154
    v_mul_f32 v78, v78, v151
    v_sub_f32 v31, v31, v154
    v_sub_f32 v63, v63, v154
    v_mul_f32 v79, v79, v151
    s_nop 1
    s_branch at_back0
at_slow1:
    s_waitcnt lgkmcnt(0)
    v_mfma_f32_32x32x16_bf16 v[64:79], v[120:123], v[88:91], v[64:79]
    v_mfma_f32_32x32x16_bf16 v[64:79], v[124:127], v[92:95], v[64:79]
    v_mov_b32 v150, v154
    s_nop 1
    v_permlane32_swap_b32 v150, v154
    s_nop 1
    v_max_f32 v154, v154, v150
    v_max_f32 v154, 0, v154
    v_sub_f32 v151, 0, v154
    v_exp_f32 v151, v151
    s_nop 15
    s_nop 15
    v_mov_b32 v88, 0
    v_mov_b32 v89, 0
    v_mov_b32 v90, 0
    v_mov_b32 v91, 0
    v_mov_b32 v92, 0
    v_mov_b32 v93, 0
    v_mov_b32 v94, 0
    v_mov_b32 v95, 0
    v_sub_f32 v32, v32, v154
    v_sub_f32 v48, v48, v154
    v_mul_f32 v64, v64, v151
    v_sub_f32 v33, v33, v154
    v_sub_f32 v49, v49, v154
    v_mul_f32 v65, v65, v151
    v_sub_f32 v34, v34, v154
    v_sub_f32 v50, v50, v154
    v_mul_f32 v66, v66, v151
    v_sub_f32 v35, v35, v154
    v_sub_f32 v51, v51, v154
    v_mul_f32 v67, v67, v151
    v_sub_f32 v36, v36, v154
    v_sub_f32 v52, v52, v154
    v_mul_f32 v68, v68, v151
    v_sub_f32 v37, v37, v154
    v_sub_f32 v53, v53, v154
    v_mul_f32 v69, v69, v151
    v_sub_f32 v38, v38, v154
    v_sub_f32 v54, v54, v154
    v_mul_f32 v70, v70, v151
    v_sub_f32 v39, v39, v154
    v_sub_f32 v55, v55, v154
    v_mul_f32 v71, v71, v151
    v_sub_f32 v40, v40, v154
    v_sub_f32 v56, v56, v154
    v_mul_f32 v72, v72, v151
    v_sub_f32 v41, v41, v154
    v_sub_f32 v57, v57, v154
    v_mul_f32 v73, v73, v151
    v_sub_f32 v42, v42, v154
    v_sub_f32 v58, v58, v154
    v_mul_f32 v74, v74, v151
    v_sub_f32 v43, v43, v154
    v_sub_f32 v59, v59, v154
    v_mul_f32 v75, v75, v151
    v_sub_f32 v44, v44, v154
    v_sub_f32 v60, v60, v154
    v_mul_f32 v76, v76, v151
    v_sub_f32 v45, v45, v154
    v_sub_f32 v61, v61, v154
    v_mul_f32 v77, v77, v151
    v_sub_f32 v46, v46, v154
    v_sub_f32 v62, v62, v154
    v_mul_f32 v78, v78, v151
    v_sub_f32 v47, v47, v154
    v_sub_f32 v63, v63, v154
    v_mul_f32 v79, v79, v151
    s_nop 1
    s_branch at_back1
at_slow2:
    s_waitcnt lgkmcnt(0)
    v_mfma_f32_32x32x16_bf16 v[64:79], v[128:131], v[96:99], v[64:79]
    v_mfma_f32_32x32x16_bf16 v[64:79], v[132:135], v[100:103], v[64:79]
    v_mov_b32 v150, v154
    s_nop 1
    v_permlane32_swap_b32 v150, v154
    s_nop 1
    v_max_f32 v154, v154, v150
    v_max_f32 v154, 0, v154
    v_sub_f32 v151, 0, v154
    v_exp_f32 v151, v151
    s_nop 15
    s_nop 15
    v_mov_b32 v96, 0
    v_mov_b32 v97, 0
    v_mov_b32 v98, 0
    v_mov_b32 v99, 0
    v_mov_b32 v100, 0
    v_mov_b32 v101, 0
    v_mov_b32 v102, 0
    v_mov_b32 v103, 0
    v_sub_f32 v16, v16, v154
    v_sub_f32 v48, v48, v154
    v_mul_f32 v64, v64, v151
    v_sub_f32 v17, v17, v154
    v_sub_f32 v49, v49, v154
    v_mul_f32 v65, v65, v151
    v_sub_f32 v18, v18, v154
    v_sub_f32 v50, v50, v154
    v_mul_f32 v66, v66, v151
    v_sub_f32 v19, v19, v154
    v_sub_f32 v51, v51, v154
    v_mul_f32 v67, v67, v151
    v_sub_f32 v20, v20, v154
    v_sub_f32 v52, v52, v154
    v_mul_f32 v68, v68, v151
    v_sub_f32 v21, v21, v154
    v_sub_f32 v53, v53, v154
    v_mul_f32 v69, v69, v151
    v_sub_f32 v22, v22, v154
    v_sub_f32 v54, v54, v154
    v_mul_f32 v70, v70, v151
    v_sub_f32 v23, v23, v154
    v_sub_f32 v55, v55, v154
    v_mul_f32 v71, v71, v151
    v_sub_f32 v24, v24, v154
    v_sub_f32 v56, v56, v154
    v_mul_f32 v72, v72, v151
    v_sub_f32 v25, v25, v154
    v_sub_f32 v57, v57, v154
    v_mul_f32 v73, v73, v151
    v_sub_f32 v26, v26, v154
    v_sub_f32 v58, v58, v154
    v_mul_f32 v74, v74, v151
    v_sub_f32 v27, v27, v154
    v_sub_f32 v59, v59, v154
    v_mul_f32 v75, v75, v151
    v_sub_f32 v28, v28, v154
    v_sub_f32 v60, v60, v154
    v_mul_f32 v76, v76, v151
    v_sub_f32 v29, v29, v154
    v_sub_f32 v61, v61, v154
    v_mul_f32 v77, v77, v151
    v_sub_f32 v30, v30, v154
    v_sub_f32 v62, v62, v154
    v_mul_f32 v78, v78, v151
    v_sub_f32 v31, v31, v154
    v_sub_f32 v63, v63, v154
    v_mul_f32 v79, v79, v151
    s_nop 1
    s_branch at_back2
at_slow3:
    s_waitcnt lgkmcnt(0)
    v_mfma_f32_32x32x16_bf16 v[64:79], v[120:123], v[88:91], v[64:79]
    v_mfma_f32_32x32x16_bf16 v[64:79], v[124:127], v[92:95], v[64:79]
    v_mov_b32 v150, v154
    s_nop 1
    v_permlane32_swap_b32 v150, v154
    s_nop 1
    v_max_f32 v154, v154, v150
    v_max_f32 v154, 0, v154
    v_sub_f32 v151, 0, v154
    v_exp_f32 v151, v151
    s_nop 15
    s_nop 15
    v_mov_b32 v88, 0
    v_mov_b32 v89, 0
    v_mov_b32 v90, 0
    v_mov_b32 v91, 0
    v_mov_b32 v92, 0
    v_mov_b32 v93, 0
    v_mov_b32 v94, 0
    v_mov_b32 v95, 0
    v_sub_f32 v32, v32, v154
    v_sub_f32 v48, v48, v154
    v_mul_f32 v64, v64, v151
    v_sub_f32 v33, v33, v154
    v_sub_f32 v49, v49, v154
    v_mul_f32 v65, v65, v151
    v_sub_f32 v34, v34, v154
    v_sub_f32 v50, v50, v154
    v_mul_f32 v66, v66, v151
    v_sub_f32 v35, v35, v154
    v_sub_f32 v51, v51, v154
    v_mul_f32 v67, v67, v151
    v_sub_f32 v36, v36, v154
    v_sub_f32 v52, v52, v154
    v_mul_f32 v68, v68, v151
    v_sub_f32 v37, v37, v154
    v_sub_f32 v53, v53, v154
    v_mul_f32 v69, v69, v151
    v_sub_f32 v38, v38, v154
    v_sub_f32 v54, v54, v154
    v_mul_f32 v70, v70, v151
    v_sub_f32 v39, v39, v154
    v_sub_f32 v55, v55, v154
    v_mul_f32 v71, v71, v151
    v_sub_f32 v40, v40, v154
    v_sub_f32 v56, v56, v154
    v_mul_f32 v72, v72, v151
    v_sub_f32 v41, v41, v154
    v_sub_f32 v57, v57, v154
    v_mul_f32 v73, v73, v151
    v_sub_f32 v42, v42, v154
    v_sub_f32 v58, v58, v154
    v_mul_f32 v74, v74, v151
    v_sub_f32 v43, v43, v154
    v_sub_f32 v59, v59, v154
    v_mul_f32 v75, v75, v151
    v_sub_f32 v44, v44, v154
    v_sub_f32 v60, v60, v154
    v_mul_f32 v76, v76, v151
    v_sub_f32 v45, v45, v154
    v_sub_f32 v61, v61, v154
    v_mul_f32 v77, v77, v151
    v_sub_f32 v46, v46, v154
    v_sub_f32 v62, v62, v154
    v_mul_f32 v78, v78, v151
    v_sub_f32 v47, v47, v154
    v_sub_f32 v63, v63, v154
    v_mul_f32 v79, v79, v151
    s_nop 1
    s_branch at_back3
at_slow4:
    s_waitcnt lgkmcnt(0)
    v_mfma_f32_32x32x16_bf16 v[64:79], v[128:131], v[96:99], v[64:79]
    v_mfma_f32_32x32x16_bf16 v[64:79], v[132:135], v[100:103], v[64:79]
    v_mov_b32 v150, v154
    s_nop 1
    v_permlane32_swap_b32 v150, v154
    s_nop 1
    v_max_f32 v154, v154, v150
    v_max_f32 v154, 0, v154
    v_sub_f32 v151, 0, v154
    v_exp_f32 v151, v151
    s_nop 15
    s_nop 15
    v_mov_b32 v96, 0
    v_mov_b32 v97, 0
    v_mov_b32 v98, 0
    v_mov_b32 v99, 0
    v_mov_b32 v100, 0
    v_mov_b32 v101, 0
    v_mov_b32 v102, 0
    v_mov_b32 v103, 0
    v_sub_f32 v16, v16, v154
    v_sub_f32 v48, v48, v154
    v_mul_f32 v64, v64, v151
    v_sub_f32 v17, v17, v154
    v_sub_f32 v49, v49, v154
    v_mul_f32 v65, v65, v151
    v_sub_f32 v18, v18, v154
    v_sub_f32 v50, v50, v154
    v_mul_f32 v66, v66, v151
    v_sub_f32 v19, v19, v154
    v_sub_f32 v51, v51, v154
    v_mul_f32 v67, v67, v151
    v_sub_f32 v20, v20, v154
    v_sub_f32 v52, v52, v154
    v_mul_f32 v68, v68, v151
    v_sub_f32 v21, v21, v154
    v_sub_f32 v53, v53, v154
    v_mul_f32 v69, v69, v151
    v_sub_f32 v22, v22, v154
    v_sub_f32 v54, v54, v154
    v_mul_f32 v70, v70, v151
    v_sub_f32 v23, v23, v154
    v_sub_f32 v55, v55, v154
    v_mul_f32 v71, v71, v151
    v_sub_f32 v24, v24, v154
    v_sub_f32 v56, v56, v154
    v_mul_f32 v72, v72, v151
    v_sub_f32 v25, v25, v154
    v_sub_f32 v57, v57, v154
    v_mul_f32 v73, v73, v151
    v_sub_f32 v26, v26, v154
    v_sub_f32 v58, v58, v154
    v_mul_f32 v74, v74, v151
    v_sub_f32 v27, v27, v154
    v_sub_f32 v59, v59, v154
    v_mul_f32 v75, v75, v151
    v_sub_f32 v28, v28, v154
    v_sub_f32 v60, v60, v154
    v_mul_f32 v76, v76, v151
    v_sub_f32 v29, v29, v154
    v_sub_f32 v61, v61, v154
    v_mul_f32 v77, v77, v151
    v_sub_f32 v30, v30, v154
    v_sub_f32 v62, v62, v154
    v_mul_f32 v78, v78, v151
    v_sub_f32 v31, v31, v154
    v_sub_f32 v63, v63, v154
    v_mul_f32 v79, v79, v151
    s_nop 1
    s_branch at_back4
at_slow5:
    s_waitcnt lgkmcnt(0)
    v_mfma_f32_32x32x16_bf16 v[64:79], v[120:123], v[88:91], v[64:79]
    v_mfma_f32_32x32x16_bf16 v[64:79], v[124:127], v[92:95], v[64:79]
    v_mov_b32 v150, v154
    s_nop 1
    v_permlane32_swap_b32 v150, v154
    s_nop 1
    v_max_f32 v154, v154, v150
    v_max_f32 v154, 0, v154
    v_sub_f32 v151, 0, v154
    v_exp_f32 v151, v151
    s_nop 15
    s_nop 15
    v_mov_b32 v88, 0
    v_mov_b32 v89, 0
    v_mov_b32 v90, 0
    v_mov_b32 v91, 0
    v_mov_b32 v92, 0
    v_mov_b32 v93, 0
    v_mov_b32 v94, 0
    v_mov_b32 v95, 0
    v_sub_f32 v32, v32, v154
    v_sub_f32 v48, v48, v154
    v_mul_f32 v64, v64, v151
    v_sub_f32 v33, v33, v154
    v_sub_f32 v49, v49, v154
    v_mul_f32 v65, v65, v151
    v_sub_f32 v34, v34, v154
    v_sub_f32 v50, v50, v154
    v_mul_f32 v66, v66, v151
    v_sub_f32 v35, v35, v154
    v_sub_f32 v51, v51, v154
    v_mul_f32 v67, v67, v151
    v_sub_f32 v36, v36, v154
    v_sub_f32 v52, v52, v154
    v_mul_f32 v68, v68, v151
    v_sub_f32 v37, v37, v154
    v_sub_f32 v53, v53, v154
    v_mul_f32 v69, v69, v151
    v_sub_f32 v38, v38, v154
    v_sub_f32 v54, v54, v154
    v_mul_f32 v70, v70, v151
    v_sub_f32 v39, v39, v154
    v_sub_f32 v55, v55, v154
    v_mul_f32 v71, v71, v151
    v_sub_f32 v40, v40, v154
    v_sub_f32 v56, v56, v154
    v_mul_f32 v72, v72, v151
    v_sub_f32 v41, v41, v154
    v_sub_f32 v57, v57, v154
    v_mul_f32 v73, v73, v151
    v_sub_f32 v42, v42, v154
    v_sub_f32 v58, v58, v154
    v_mul_f32 v74, v74, v151
    v_sub_f32 v43, v43, v154
    v_sub_f32 v59, v59, v154
    v_mul_f32 v75, v75, v151
    v_sub_f32 v44, v44, v154
    v_sub_f32 v60, v60, v154
    v_mul_f32 v76, v76, v151
    v_sub_f32 v45, v45, v154
    v_sub_f32 v61, v61, v154
    v_mul_f32 v77, v77, v151
    v_sub_f32 v46, v46, v154
    v_sub_f32 v62, v62, v154
    v_mul_f32 v78, v78, v151
    v_sub_f32 v47, v47, v154
    v_sub_f32 v63, v63, v154
    v_mul_f32 v79, v79, v151
    s_nop 1
    s_branch at_back5
at_slow6:
    s_waitcnt lgkmcnt(0)
    v_mfma_f32_32x32x16_bf16 v[64:79], v[128:131], v[96:99], v[64:79]
    v_mfma_f32_32x32x16_bf16 v[64:79], v[132:135], v[100:103], v[64:79]
    v_mov_b32 v150, v154
    s_nop 1
    v_permlane32_swap_b32 v150, v154
    s_nop 1
    v_max_f32 v154, v154, v150
    v_max_f32 v154, 0, v154
    v_sub_f32 v151, 0, v154
    v_exp_f32 v151, v151
    s_nop 15
    s_nop 15
    v_mov_b32 v96, 0
    v_mov_b32 v97, 0
    v_mov_b32 v98, 0
    v_mov_b32 v99, 0
    v_mov_b32 v100, 0
    v_mov_b32 v101, 0
    v_mov_b32 v102, 0
    v_mov_b32 v103, 0
    v_sub_f32 v16, v16, v154
    v_sub_f32 v48, v48, v154
    v_mul_f32 v64, v64, v151
    v_sub_f32 v17, v17, v154
    v_sub_f32 v49, v49, v154
    v_mul_f32 v65, v65, v151
    v_sub_f32 v18, v18, v154
    v_sub_f32 v50, v50, v154
    v_mul_f32 v66, v66, v151
    v_sub_f32 v19, v19, v154
    v_sub_f32 v51, v51, v154
    v_mul_f32 v67, v67, v151
    v_sub_f32 v20, v20, v154
    v_sub_f32 v52, v52, v154
    v_mul_f32 v68, v68, v151
    v_sub_f32 v21, v21, v154
    v_sub_f32 v53, v53, v154
    v_mul_f32 v69, v69, v151
    v_sub_f32 v22, v22, v154
    v_sub_f32 v54, v54, v154
    v_mul_f32 v70, v70, v151
    v_sub_f32 v23, v23, v154
    v_sub_f32 v55, v55, v154
    v_mul_f32 v71, v71, v151
    v_sub_f32 v24, v24, v154
    v_sub_f32 v56, v56, v154
    v_mul_f32 v72, v72, v151
    v_sub_f32 v25, v25, v154
    v_sub_f32 v57, v57, v154
    v_mul_f32 v73, v73, v151
    v_sub_f32 v26, v26, v154
    v_sub_f32 v58, v58, v154
    v_mul_f32 v74, v74, v151
    v_sub_f32 v27, v27, v154
    v_sub_f32 v59, v59, v154
    v_mul_f32 v75, v75, v151
    v_sub_f32 v28, v28, v154
    v_sub_f32 v60, v60, v154
    v_mul_f32 v76, v76, v151
    v_sub_f32 v29, v29, v154
    v_sub_f32 v61, v61, v154
    v_mul_f32 v77, v77, v151
    v_sub_f32 v30, v30, v154
    v_sub_f32 v62, v62, v154
    v_mul_f32 v78, v78, v151
    v_sub_f32 v31, v31, v154
    v_sub_f32 v63, v63, v154
    v_mul_f32 v79, v79, v151
    s_nop 1
    s_branch at_back6
at_slow7:
    s_waitcnt lgkmcnt(0)
    v_mfma_f32_32x32x16_bf16 v[64:79], v[120:123], v[88:91], v[64:79]
    v_mfma_f32_32x32x16_bf16 v[64:79], v[124:127], v[92:95], v[64:79]
    v_mov_b32 v150, v154
    s_nop 1
    v_permlane32_swap_b32 v150, v154
    s_nop 1
    v_max_f32 v154, v154, v150
    v_max_f32 v154, 0, v154
    v_sub_f32 v151, 0, v154
    v_exp_f32 v151, v151
    s_nop 15
    s_nop 15
    v_mov_b32 v88, 0
    v_mov_b32 v89, 0
    v_mov_b32 v90, 0
    v_mov_b32 v91, 0
    v_mov_b32 v92, 0
    v_mov_b32 v93, 0
    v_mov_b32 v94, 0
    v_mov_b32 v95, 0
    v_sub_f32 v32, v32, v154
    v_sub_f32 v48, v48, v154
    v_mul_f32 v64, v64, v151
    v_sub_f32 v33, v33, v154
    v_sub_f32 v49, v49, v154
    v_mul_f32 v65, v65, v151
    v_sub_f32 v34, v34, v154
    v_sub_f32 v50, v50, v154
    v_mul_f32 v66, v66, v151
    v_sub_f32 v35, v35, v154
    v_sub_f32 v51, v51, v154
    v_mul_f32 v67, v67, v151
    v_sub_f32 v36, v36, v154
    v_sub_f32 v52, v52, v154
    v_mul_f32 v68, v68, v151
    v_sub_f32 v37, v37, v154
    v_sub_f32 v53, v53, v154
    v_mul_f32 v69, v69, v151
    v_sub_f32 v38, v38, v154
    v_sub_f32 v54, v54, v154
    v_mul_f32 v70, v70, v151
    v_sub_f32 v39, v39, v154
    v_sub_f32 v55, v55, v154
    v_mul_f32 v71, v71, v151
    v_sub_f32 v40, v40, v154
    v_sub_f32 v56, v56, v154
    v_mul_f32 v72, v72, v151
    v_sub_f32 v41, v41, v154
    v_sub_f32 v57, v57, v154
    v_mul_f32 v73, v73, v151
    v_sub_f32 v42, v42, v154
    v_sub_f32 v58, v58, v154
    v_mul_f32 v74, v74, v151
    v_sub_f32 v43, v43, v154
    v_sub_f32 v59, v59, v154
    v_mul_f32 v75, v75, v151
    v_sub_f32 v44, v44, v154
    v_sub_f32 v60, v60, v154
    v_mul_f32 v76, v76, v151
    v_sub_f32 v45, v45, v154
    v_sub_f32 v61, v61, v154
    v_mul_f32 v77, v77, v151
    v_sub_f32 v46, v46, v154
    v_sub_f32 v62, v62, v154
    v_mul_f32 v78, v78, v151
    v_sub_f32 v47, v47, v154
    v_sub_f32 v63, v63, v154
    v_mul_f32 v79, v79, v151
    s_nop 1
    s_branch at_back7
at_slow8:
    s_waitcnt lgkmcnt(0)
    v_mfma_f32_32x32x16_bf16 v[64:79], v[128:131], v[96:99], v[64:79]
    v_mfma_f32_32x32x16_bf16 v[64:79], v[132:135], v[100:103], v[64:79]
    v_mov_b32 v150, v154
    s_nop 1
    v_permlane32_swap_b32 v150, v154
    s_nop 1
    v_max_f32 v154, v154, v150
    v_max_f32 v154, 0, v154
    v_sub_f32 v151, 0, v154
    v_exp_f32 v151, v151
    s_nop 15
    s_nop 15
    v_mov_b32 v96, 0
    v_mov_b32 v97, 0
    v_mov_b32 v98, 0
    v_mov_b32 v99, 0
    v_mov_b32 v100, 0
    v_mov_b32 v101, 0
    v_mov_b32 v102, 0
    v_mov_b32 v103, 0
    v_sub_f32 v16, v16, v154
    v_sub_f32 v48, v48, v154
    v_mul_f32 v64, v64, v151
    v_sub_f32 v17, v17, v154
    v_sub_f32 v49, v49, v154
    v_mul_f32 v65, v65, v151
    v_sub_f32 v18, v18, v154
    v_sub_f32 v50, v50, v154
    v_mul_f32 v66, v66, v151
    v_sub_f32 v19, v19, v154
    v_sub_f32 v51, v51, v154
    v_mul_f32 v67, v67, v151
    v_sub_f32 v20, v20, v154
    v_sub_f32 v52, v52, v154
    v_mul_f32 v68, v68, v151
    v_sub_f32 v21, v21, v154
    v_sub_f32 v53, v53, v154
    v_mul_f32 v69, v69, v151
    v_sub_f32 v22, v22, v154
    v_sub_f32 v54, v54, v154
    v_mul_f32 v70, v70, v151
    v_sub_f32 v23, v23, v154
    v_sub_f32 v55, v55, v154
    v_mul_f32 v71, v71, v151
    v_sub_f32 v24, v24, v154
    v_sub_f32 v56, v56, v154
    v_mul_f32 v72, v72, v151
    v_sub_f32 v25, v25, v154
    v_sub_f32 v57, v57, v154
    v_mul_f32 v73, v73, v151
    v_sub_f32 v26, v26, v154
    v_sub_f32 v58, v58, v154
    v_mul_f32 v74, v74, v151
    v_sub_f32 v27, v27, v154
    v_sub_f32 v59, v59, v154
    v_mul_f32 v75, v75, v151
    v_sub_f32 v28, v28, v154
    v_sub_f32 v60, v60, v154
    v_mul_f32 v76, v76, v151
    v_sub_f32 v29, v29, v154
    v_sub_f32 v61, v61, v154
    v_mul_f32 v77, v77, v151
    v_sub_f32 v30, v30, v154
    v_sub_f32 v62, v62, v154
    v_mul_f32 v78, v78, v151
    v_sub_f32 v31, v31, v154
    v_sub_f32 v63, v63, v154
    v_mul_f32 v79, v79, v151
    s_nop 1
    s_branch at_back8
at_slow9:
    s_waitcnt lgkmcnt(0)
    v_mfma_f32_32x32x16_bf16 v[64:79], v[120:123], v[88:91], v[64:79]
    v_mfma_f32_32x32x16_bf16 v[64:79], v[124:127], v[92:95], v[64:79]
    v_mov_b32 v150, v154
    s_nop 1
    v_permlane32_swap_b32 v150, v154
    s_nop 1
    v_max_f32 v154, v154, v150
    v_max_f32 v154, 0, v154
    v_sub_f32 v151, 0, v154
    v_exp_f32 v151, v151
    s_nop 15
    s_nop 15
    v_mov_b32 v88, 0
    v_mov_b32 v89, 0
    v_mov_b32 v90, 0
    v_mov_b32 v91, 0
    v_mov_b32 v92, 0
    v_mov_b32 v93, 0
    v_mov_b32 v94, 0
    v_mov_b32 v95, 0
    v_sub_f32 v32, v32, v154
    v_sub_f32 v48, v48, v154
    v_mul_f32 v64, v64, v151
    v_sub_f32 v33, v33, v154
    v_sub_f32 v49, v49, v154
    v_mul_f32 v65, v65, v151
    v_sub_f32 v34, v34, v154
    v_sub_f32 v50, v50, v154
    v_mul_f32 v66, v66, v151
    v_sub_f32 v35, v35, v154
    v_sub_f32 v51, v51, v154
    v_mul_f32 v67, v67, v151
    v_sub_f32 v36, v36, v154
    v_sub_f32 v52, v52, v154
    v_mul_f32 v68, v68, v151
    v_sub_f32 v37, v37, v154
    v_sub_f32 v53, v53, v154
    v_mul_f32 v69, v69, v151
    v_sub_f32 v38, v38, v154
    v_sub_f32 v54, v54, v154
    v_mul_f32 v70, v70, v151
    v_sub_f32 v39, v39, v154
    v_sub_f32 v55, v55, v154
    v_mul_f32 v71, v71, v151
    v_sub_f32 v40, v40, v154
    v_sub_f32 v56, v56, v154
    v_mul_f32 v72, v72, v151
    v_sub_f32 v41, v41, v154
    v_sub_f32 v57, v57, v154
    v_mul_f32 v73, v73, v151
    v_sub_f32 v42, v42, v154
    v_sub_f32 v58, v58, v154
    v_mul_f32 v74, v74, v151
    v_sub_f32 v43, v43, v154
    v_sub_f32 v59, v59, v154
    v_mul_f32 v75, v75, v151
    v_sub_f32 v44, v44, v154
    v_sub_f32 v60, v60, v154
    v_mul_f32 v76, v76, v151
    v_sub_f32 v45, v45, v154
    v_sub_f32 v61, v61, v154
    v_mul_f32 v77, v77, v151
    v_sub_f32 v46, v46, v154
    v_sub_f32 v62, v62, v154
    v_mul_f32 v78, v78, v151
    v_sub_f32 v47, v47, v154
    v_sub_f32 v63, v63, v154
    v_mul_f32 v79, v79, v151
    s_nop 1
    s_branch at_back9
at_slow10:
    s_waitcnt lgkmcnt(0)
    v_mfma_f32_32x32x16_bf16 v[64:79], v[128:131], v[96:99], v[64:79]
    v_mfma_f32_32x32x16_bf16 v[64:79], v[132:135], v[100:103], v[64:79]
    v_mov_b32 v150, v154
    s_nop 1
    v_permlane32_swap_b32 v150, v154
    s_nop 1
    v_max_f32 v154, v154, v150
    v_max_f32 v154, 0, v154
    v_sub_f32 v151, 0, v154
    v_exp_f32 v151, v151
    s_nop 15
    s_nop 15
    v_mov_b32 v96, 0
    v_mov_b32 v97, 0
    v_mov_b32 v98, 0
    v_mov_b32 v99, 0
    v_mov_b32 v100, 0
    v_mov_b32 v101, 0
    v_mov_b32 v102, 0
    v_mov_b32 v103, 0
    v_sub_f32 v16, v16, v154
    v_sub_f32 v48, v48, v154
    v_mul_f32 v64, v64, v151
    v_sub_f32 v17, v17, v154
    v_sub_f32 v49, v49, v154
    v_mul_f32 v65, v65, v151
    v_sub_f32 v18, v18, v154
    v_sub_f32 v50, v50, v154
    v_mul_f32 v66, v66, v151
    v_sub_f32 v19, v19, v154
    v_sub_f32 v51, v51, v154
    v_mul_f32 v67, v67, v151
    v_sub_f32 v20, v20, v154
    v_sub_f32 v52, v52, v154
    v_mul_f32 v68, v68, v151
    v_sub_f32 v21, v21, v154
    v_sub_f32 v53, v53, v154
    v_mul_f32 v69, v69, v151
    v_sub_f32 v22, v22, v154
    v_sub_f32 v54, v54, v154
    v_mul_f32 v70, v70, v151
    v_sub_f32 v23, v23, v154
    v_sub_f32 v55, v55, v154
    v_mul_f32 v71, v71, v151
    v_sub_f32 v24, v24, v154
    v_sub_f32 v56, v56, v154
    v_mul_f32 v72, v72, v151
    v_sub_f32 v25, v25, v154
    v_sub_f32 v57, v57, v154
    v_mul_f32 v73, v73, v151
    v_sub_f32 v26, v26, v154
    v_sub_f32 v58, v58, v154
    v_mul_f32 v74, v74, v151
    v_sub_f32 v27, v27, v154
    v_sub_f32 v59, v59, v154
    v_mul_f32 v75, v75, v151
    v_sub_f32 v28, v28, v154
    v_sub_f32 v60, v60, v154
    v_mul_f32 v76, v76, v151
    v_sub_f32 v29, v29, v154
    v_sub_f32 v61, v61, v154
    v_mul_f32 v77, v77, v151
    v_sub_f32 v30, v30, v154
    v_sub_f32 v62, v62, v154
    v_mul_f32 v78, v78, v151
    v_sub_f32 v31, v31, v154
    v_sub_f32 v63, v63, v154
    v_mul_f32 v79, v79, v151
    s_nop 1
    s_branch at_back10
at_slow11:
    s_waitcnt lgkmcnt(0)
    v_mfma_f32_32x32x16_bf16 v[64:79], v[120:123], v[88:91], v[64:79]
    v_mfma_f32_32x32x16_bf16 v[64:79], v[124:127], v[92:95], v[64:79]
    v_mov_b32 v150, v154
    s_nop 1
    v_permlane32_swap_b32 v150, v154
    s_nop 1
    v_max_f32 v154, v154, v150
    v_max_f32 v154, 0, v154
    v_sub_f32 v151, 0, v154
    v_exp_f32 v151, v151
    s_nop 15
    s_nop 15
    v_mov_b32 v88, 0
    v_mov_b32 v89, 0
    v_mov_b32 v90, 0
    v_mov_b32 v91, 0
    v_mov_b32 v92, 0
    v_mov_b32 v93, 0
    v_mov_b32 v94, 0
    v_mov_b32 v95, 0
    v_sub_f32 v32, v32, v154
    v_sub_f32 v48, v48, v154
    v_mul_f32 v64, v64, v151
    v_sub_f32 v33, v33, v154
    v_sub_f32 v49, v49, v154
    v_mul_f32 v65, v65, v151
    v_sub_f32 v34, v34, v154
    v_sub_f32 v50, v50, v154
    v_mul_f32 v66, v66, v151
    v_sub_f32 v35, v35, v154
    v_sub_f32 v51, v51, v154
    v_mul_f32 v67, v67, v151
    v_sub_f32 v36, v36, v154
    v_sub_f32 v52, v52, v154
    v_mul_f32 v68, v68, v151
    v_sub_f32 v37, v37, v154
    v_sub_f32 v53, v53, v154
    v_mul_f32 v69, v69, v151
    v_sub_f32 v38, v38, v154
    v_sub_f32 v54, v54, v154
    v_mul_f32 v70, v70, v151
    v_sub_f32 v39, v39, v154
    v_sub_f32 v55, v55, v154
    v_mul_f32 v71, v71, v151
    v_sub_f32 v40, v40, v154
    v_sub_f32 v56, v56, v154
    v_mul_f32 v72, v72, v151
    v_sub_f32 v41, v41, v154
    v_sub_f32 v57, v57, v154
    v_mul_f32 v73, v73, v151
    v_sub_f32 v42, v42, v154
    v_sub_f32 v58, v58, v154
    v_mul_f32 v74, v74, v151
    v_sub_f32 v43, v43, v154
    v_sub_f32 v59, v59, v154
    v_mul_f32 v75, v75, v151
    v_sub_f32 v44, v44, v154
    v_sub_f32 v60, v60, v154
    v_mul_f32 v76, v76, v151
    v_sub_f32 v45, v45, v154
    v_sub_f32 v61, v61, v154
    v_mul_f32 v77, v77, v151
    v_sub_f32 v46, v46, v154
    v_sub_f32 v62, v62, v154
    v_mul_f32 v78, v78, v151
    v_sub_f32 v47, v47, v154
    v_sub_f32 v63, v63, v154
    v_mul_f32 v79, v79, v151
    s_nop 1
    s_branch at_back11
at_slow12:
    s_waitcnt lgkmcnt(0)
    v_mfma_f32_32x32x16_bf16 v[64:79], v[128:131], v[96:99], v[64:79]
    v_mfma_f32_32x32x16_bf16 v[64:79], v[132:135], v[100:103], v[64:79]
    v_mov_b32 v150, v154
    s_nop 1
    v_permlane32_swap_b32 v150, v154
    s_nop 1
    v_max_f32 v154, v154, v150
    v_max_f32 v154, 0, v154
    v_sub_f32 v151, 0, v154
    v_exp_f32 v151, v151
    s_nop 15
    s_nop 15
    v_mov_b32 v96, 0
    v_mov_b32 v97, 0
    v_mov_b32 v98, 0
    v_mov_b32 v99, 0
    v_mov_b32 v100, 0
    v_mov_b32 v101, 0
    v_mov_b32 v102, 0
    v_mov_b32 v103, 0
    v_sub_f32 v16, v16, v154
    v_sub_f32 v48, v48, v154
    v_mul_f32 v64, v64, v151
    v_sub_f32 v17, v17, v154
    v_sub_f32 v49, v49, v154
    v_mul_f32 v65, v65, v151
    v_sub_f32 v18, v18, v154
    v_sub_f32 v50, v50, v154
    v_mul_f32 v66, v66, v151
    v_sub_f32 v19, v19, v154
    v_sub_f32 v51, v51, v154
    v_mul_f32 v67, v67, v151
    v_sub_f32 v20, v20, v154
    v_sub_f32 v52, v52, v154
    v_mul_f32 v68, v68, v151
    v_sub_f32 v21, v21, v154
    v_sub_f32 v53, v53, v154
    v_mul_f32 v69, v69, v151
    v_sub_f32 v22, v22, v154
    v_sub_f32 v54, v54, v154
    v_mul_f32 v70, v70, v151
    v_sub_f32 v23, v23, v154
    v_sub_f32 v55, v55, v154
    v_mul_f32 v71, v71, v151
    v_sub_f32 v24, v24, v154
    v_sub_f32 v56, v56, v154
    v_mul_f32 v72, v72, v151
    v_sub_f32 v25, v25, v154
    v_sub_f32 v57, v57, v154
    v_mul_f32 v73, v73, v151
    v_sub_f32 v26, v26, v154
    v_sub_f32 v58, v58, v154
    v_mul_f32 v74, v74, v151
    v_sub_f32 v27, v27, v154
    v_sub_f32 v59, v59, v154
    v_mul_f32 v75, v75, v151
    v_sub_f32 v28, v28, v154
    v_sub_f32 v60, v60, v154
    v_mul_f32 v76, v76, v151
    v_sub_f32 v29, v29, v154
    v_sub_f32 v61, v61, v154
    v_mul_f32 v77, v77, v151
    v_sub_f32 v30, v30, v154
    v_sub_f32 v62, v62, v154
    v_mul_f32 v78, v78, v151
    v_sub_f32 v31, v31, v154
    v_sub_f32 v63, v63, v154
    v_mul_f32 v79, v79, v151
    s_nop 1
    s_branch at_back12
at_slow13:
    s_waitcnt lgkmcnt(0)
    v_mfma_f32_32x32x16_bf16 v[64:79], v[120:123], v[88:91], v[64:79]
    v_mfma_f32_32x32x16_bf16 v[64:79], v[124:127], v[92:95], v[64:79]
    v_mov_b32 v150, v154
    s_nop 1
    v_permlane32_swap_b32 v150, v154
    s_nop 1
    v_max_f32 v154, v154, v150
    v_max_f32 v154, 0, v154
    v_sub_f32 v151, 0, v154
    v_exp_f32 v151, v151
    s_nop 15
    s_nop 15
    v_mov_b32 v88, 0
    v_mov_b32 v89, 0
    v_mov_b32 v90, 0
    v_mov_b32 v91, 0
    v_mov_b32 v92, 0
    v_mov_b32 v93, 0
    v_mov_b32 v94, 0
    v_mov_b32 v95, 0
    v_sub_f32 v32, v32, v154
    v_sub_f32 v48, v48, v154
    v_mul_f32 v64, v64, v151
    v_sub_f32 v33, v33, v154
    v_sub_f32 v49, v49, v154
    v_mul_f32 v65, v65, v151
    v_sub_f32 v34, v34, v154
    v_sub_f32 v50, v50, v154
    v_mul_f32 v66, v66, v151
    v_sub_f32 v35, v35, v154
    v_sub_f32 v51, v51, v154
    v_mul_f32 v67, v67, v151
    v_sub_f32 v36, v36, v154
    v_sub_f32 v52, v52, v154
    v_mul_f32 v68, v68, v151
    v_sub_f32 v37, v37, v154
    v_sub_f32 v53, v53, v154
    v_mul_f32 v69, v69, v151
    v_sub_f32 v38, v38, v154
    v_sub_f32 v54, v54, v154
    v_mul_f32 v70, v70, v151
    v_sub_f32 v39, v39, v154
    v_sub_f32 v55, v55, v154
    v_mul_f32 v71, v71, v151
    v_sub_f32 v40, v40, v154
    v_sub_f32 v56, v56, v154
    v_mul_f32 v72, v72, v151
    v_sub_f32 v41, v41, v154
    v_sub_f32 v57, v57, v154
    v_mul_f32 v73, v73, v151
    v_sub_f32 v42, v42, v154
    v_sub_f32 v58, v58, v154
    v_mul_f32 v74, v74, v151
    v_sub_f32 v43, v43, v154
    v_sub_f32 v59, v59, v154
    v_mul_f32 v75, v75, v151
    v_sub_f32 v44, v44, v154
    v_sub_f32 v60, v60, v154
    v_mul_f32 v76, v76, v151
    v_sub_f32 v45, v45, v154
    v_sub_f32 v61, v61, v154
    v_mul_f32 v77, v77, v151
    v_sub_f32 v46, v46, v154
    v_sub_f32 v62, v62, v154
    v_mul_f32 v78, v78, v151
    v_sub_f32 v47, v47, v154
    v_sub_f32 v63, v63, v154
    v_mul_f32 v79, v79, v151
    s_nop 1
    s_branch at_back13
at_slow14:
    s_waitcnt lgkmcnt(0)
    v_mfma_f32_32x32x16_bf16 v[64:79], v[128:131], v[96:99], v[64:79]
    v_mfma_f32_32x32x16_bf16 v[64:79], v[132:135], v[100:103], v[64:79]
    v_mov_b32 v150, v154
    s_nop 1
    v_permlane32_swap_b32 v150, v154
    s_nop 1
    v_max_f32 v154, v154, v150
    v_max_f32 v154, 0, v154
    v_sub_f32 v151, 0, v154
    v_exp_f32 v151, v151
    s_nop 15
    s_nop 15
    v_mov_b32 v96, 0
    v_mov_b32 v97, 0
    v_mov_b32 v98, 0
    v_mov_b32 v99, 0
    v_mov_b32 v100, 0
    v_mov_b32 v101, 0
    v_mov_b32 v102, 0
    v_mov_b32 v103, 0
    v_sub_f32 v16, v16, v154
    v_sub_f32 v48, v48, v154
    v_mul_f32 v64, v64, v151
    v_sub_f32 v17, v17, v154
    v_sub_f32 v49, v49, v154
    v_mul_f32 v65, v65, v151
    v_sub_f32 v18, v18, v154
    v_sub_f32 v50, v50, v154
    v_mul_f32 v66, v66, v151
    v_sub_f32 v19, v19, v154
    v_sub_f32 v51, v51, v154
    v_mul_f32 v67, v67, v151
    v_sub_f32 v20, v20, v154
    v_sub_f32 v52, v52, v154
    v_mul_f32 v68, v68, v151
    v_sub_f32 v21, v21, v154
    v_sub_f32 v53, v53, v154
    v_mul_f32 v69, v69, v151
    v_sub_f32 v22, v22, v154
    v_sub_f32 v54, v54, v154
    v_mul_f32 v70, v70, v151
    v_sub_f32 v23, v23, v154
    v_sub_f32 v55, v55, v154
    v_mul_f32 v71, v71, v151
    v_sub_f32 v24, v24, v154
    v_sub_f32 v56, v56, v154
    v_mul_f32 v72, v72, v151
    v_sub_f32 v25, v25, v154
    v_sub_f32 v57, v57, v154
    v_mul_f32 v73, v73, v151
    v_sub_f32 v26, v26, v154
    v_sub_f32 v58, v58, v154
    v_mul_f32 v74, v74, v151
    v_sub_f32 v27, v27, v154
    v_sub_f32 v59, v59, v154
    v_mul_f32 v75, v75, v151
    v_sub_f32 v28, v28, v154
    v_sub_f32 v60, v60, v154
    v_mul_f32 v76, v76, v151
    v_sub_f32 v29, v29, v154
    v_sub_f32 v61, v61, v154
    v_mul_f32 v77, v77, v151
    v_sub_f32 v30, v30, v154
    v_sub_f32 v62, v62, v154
    v_mul_f32 v78, v78, v151
    v_sub_f32 v31, v31, v154
    v_sub_f32 v63, v63, v154
    v_mul_f32 v79, v79, v151
    s_nop 1
    s_branch at_back14
at_slow15:
    s_waitcnt lgkmcnt(0)
    v_mfma_f32_32x32x16_bf16 v[64:79], v[120:123], v[88:91], v[64:79]
    v_mfma_f32_32x32x16_bf16 v[64:79], v[124:127], v[92:95], v[64:79]
    v_mov_b32 v150, v154
    s_nop 1
    v_permlane32_swap_b32 v150, v154
    s_nop 1
    v_max_f32 v154, v154, v150
    v_max_f32 v154, 0, v154
    v_sub_f32 v151, 0, v154
    v_exp_f32 v151, v151
    s_nop 15
    s_nop 15
    v_mov_b32 v88, 0
    v_mov_b32 v89, 0
    v_mov_b32 v90, 0
    v_mov_b32 v91, 0
    v_mov_b32 v92, 0
    v_mov_b32 v93, 0
    v_mov_b32 v94, 0
    v_mov_b32 v95, 0
    v_sub_f32 v32, v32, v154
    v_sub_f32 v48, v48, v154
    v_mul_f32 v64, v64, v151
    v_sub_f32 v33, v33, v154
    v_sub_f32 v49, v49, v154
    v_mul_f32 v65, v65, v151
    v_sub_f32 v34, v34, v154
    v_sub_f32 v50, v50, v154
    v_mul_f32 v66, v66, v151
    v_sub_f32 v35, v35, v154
    v_sub_f32 v51, v51, v154
    v_mul_f32 v67, v67, v151
    v_sub_f32 v36, v36, v154
    v_sub_f32 v52, v52, v154
    v_mul_f32 v68, v68, v151
    v_sub_f32 v37, v37, v154
    v_sub_f32 v53, v53, v154
    v_mul_f32 v69, v69, v151
    v_sub_f32 v38, v38, v154
    v_sub_f32 v54, v54, v154
    v_mul_f32 v70, v70, v151
    v_sub_f32 v39, v39, v154
    v_sub_f32 v55, v55, v154
    v_mul_f32 v71, v71, v151
    v_sub_f32 v40, v40, v154
    v_sub_f32 v56, v56, v154
    v_mul_f32 v72, v72, v151
    v_sub_f32 v41, v41, v154
    v_sub_f32 v57, v57, v154
    v_mul_f32 v73, v73, v151
    v_sub_f32 v42, v42, v154
    v_sub_f32 v58, v58, v154
    v_mul_f32 v74, v74, v151
    v_sub_f32 v43, v43, v154
    v_sub_f32 v59, v59, v154
    v_mul_f32 v75, v75, v151
    v_sub_f32 v44, v44, v154
    v_sub_f32 v60, v60, v154
    v_mul_f32 v76, v76, v151
    v_sub_f32 v45, v45, v154
    v_sub_f32 v61, v61, v154
    v_mul_f32 v77, v77, v151
    v_sub_f32 v46, v46, v154
    v_sub_f32 v62, v62, v154
    v_mul_f32 v78, v78, v151
    v_sub_f32 v47, v47, v154
    v_sub_f32 v63, v63, v154
    v_mul_f32 v79, v79, v151
    s_nop 1
    s_branch at_back15
.globl fin_kernel
.p2align 8
.type fin_kernel,@function
fin_kernel:
    s_cmp_ge_u32 s2, 256
    s_cbranch_scc1 fn_done
    s_load_dwordx2 s[8:9], s[0:1], 16
    s_load_dwordx2 s[4:5], s[0:1], 88
    s_load_dwordx2 s[20:21], s[0:1], 88
    s_load_dwordx2 s[24:25], s[0:1], 88
    s_load_dwordx2 s[16:17], s[0:1], 56
    s_load_dwordx2 s[12:13], s[0:1], 72
    v_and_b32 v1, 63, v0
    v_lshrrev_b32 v2, 6, v0
    s_and_b32 s29, s2, 31
    v_readfirstlane_b32 s28, v2
    s_lshl_b32 s29, s29, 6
    s_lshr_b32 s30, s2, 5
    s_mul_i32 s30, s30, 72
    s_lshl_b32 s34, s30, 1
    s_lshl_b32 s31, s28, 6
    v_add_u32 v3, s31, v1
    v_mul_u32_u24 v5, 6554, v3
    v_lshrrev_b32 v5, 16, v5
    v_mul_u32_u24 v6, 10, v5
    v_sub_u32 v6, v3, v6
    v_and_b32 v7, 3, v5
    v_bfe_u32 v8, v5, 2, 2
    v_lshl_add_u32 v7, v8, 3, v7
    v_bfe_u32 v8, v5, 4, 1
    v_lshl_add_u32 v7, v8, 2, v7
    v_lshrrev_b32 v8, 1, v7
    v_mul_u32_u24 v8, 18, v8
    v_and_b32 v9, 1, v7
    v_add3_u32 v8, v8, v9, 16
    v_mul_u32_u24 v8, 1152, v8
    v_lshl_add_u32 v8, v6, 4, v8
    v_add_u32 v234, s34, v8
    v_lshrrev_b32 v8, 4, v7
    v_lshl_add_u32 v7, v8, 1, v7
    v_mul_u32_u24 v7, 1152, v7
    v_lshl_add_u32 v7, v6, 4, v7
    v_add_u32 v4, s34, v7
    v_cmp_eq_u32 vcc, 9, v6
    v_mov_b32 v7, 0x80000000
    s_nop 0
    v_cndmask_b32 v4, v4, v7, vcc
    v_cndmask_b32 v234, v234, v7, vcc
    v_add_u32 v3, 256, v1
    v_mul_u32_u24 v5, 6554, v3
    v_lshrrev_b32 v5, 16, v5
    v_mul_u32_u24 v6, 10, v5
    v_sub_u32 v6, v3, v6
    v_and_b32 v7, 3, v5
    v_bfe_u32 v8, v5, 2, 2
    v_lshl_add_u32 v7, v8, 3, v7
    v_bfe_u32 v8, v5, 4, 1
    v_lshl_add_u32 v7, v8, 2, v7
    v_lshrrev_b32 v8, 1, v7
    v_mul_u32_u24 v8, 18, v8
    v_and_b32 v9, 1, v7
    v_add3_u32 v8, v8, v9, 16
    v_mul_u32_u24 v8, 1152, v8
    v_lshl_add_u32 v8, v6, 4, v8
    v_add_u32 v235, s34, v8
    v_lshrrev_b32 v8, 4, v7
    v_lshl_add_u32 v7, v8, 1, v7
    v_mul_u32_u24 v7, 1152, v7
    v_lshl_add_u32 v7, v6, 4, v7
    v_add_u32 v13, s34, v7
    v_cmp_eq_u32 vcc, 9, v6
    v_mov_b32 v7, 0x80000000
    s_nop 0
    v_cndmask_b32 v13, v13, v7, vcc
    v_cndmask_b32 v235, v235, v7, vcc
    s_lshl_b32 s32, s28, 10
    s_mov_b32 s33, 0
    v_and_b32 v2, 15, v1
    v_lshrrev_b32 v3, 4, v1
    s_lshl_b32 s31, s28, 4
    s_add_u32 s31, s31, s29
    v_add_u32 v5, s31, v2
    v_mul_u32_u24 v6, 1152, v5
    v_lshl_add_u32 v7, v3, 4, v6
    v_lshrrev_b32 v8, 1, v3
    v_lshl_add_u32 v8, v8, 11, v5
    v_and_b32 v9, 1, v3
    v_lshlrev_b32 v9, 4, v9
    v_lshl_add_u32 v7, v8, 5, v9
    v_lshl_add_u32 v236, v3, 13, v5
    v_lshlrev_b32 v236, 2, v236
    s_waitcnt lgkmcnt(0)
    s_mov_b32 s10, 0xa2000
    s_mov_b32 s11, 0x20000
    s_add_u32 s4, s4, 0x5000000
    s_addc_u32 s5, s5, 0
    s_mov_b32 s6, 0x240000
    s_mov_b32 s7, 0x20000
    s_mul_i32 s46, s28, 41472
    s_mul_i32 s48, s28, 331776
    s_mul_i32 s47, s28, 5120
    s_add_u32 m0, s32, 0
    s_mov_b32 s33, 0
    buffer_load_dwordx4 v4, s[8:11], s33 offen lds
    s_add_u32 m0, s47, 4096
    s_add_u32 s33, s46, 0
    buffer_load_dwordx4 v13, s[8:11], s33 offen lds
    s_mov_b32 s49, 0
    buffer_load_dwordx4 v[16:19], v7, s[4:7], s49 offen
    s_add_u32 m0, s32, 5120
    s_mov_b32 s33, 41472
    buffer_load_dwordx4 v4, s[8:11], s33 offen lds
    s_mov_b32 s49, 131072
    buffer_load_dwordx4 v[20:23], v7, s[4:7], s49 offen
    s_add_u32 m0, s32, 10240
    s_mov_b32 s33, 82944
    buffer_load_dwordx4 v4, s[8:11], s33 offen lds
    s_mov_b32 s49, 262144
    buffer_load_dwordx4 v[24:27], v7, s[4:7], s49 offen
    s_add_u32 m0, s32, 15360
    s_mov_b32 s33, 124416
    buffer_load_dwordx4 v4, s[8:11], s33 offen lds
    s_mov_b32 s49, 393216
    buffer_load_dwordx4 v[28:31], v7, s[4:7], s49 offen
    s_add_u32 s20, s20, 0x3000000
    s_addc_u32 s21, s21, 0
    s_mov_b32 s22, 0x1200000
    s_mov_b32 s23, 0x20000
    s_add_u32 s24, s24, 0x240000
    s_addc_u32 s25, s25, 0
    s_mov_b32 s26, 0x2000
    s_mov_b32 s27, 0x20000
    s_mov_b32 s18, 0x480
    s_mov_b32 s19, 0x20000
    s_mov_b32 s14, 0x240000
    s_mov_b32 s15, 0x20000
    s_lshl_b32 s31, s30, 1
    v_lshl_add_u32 v9, v3, 3, s31
    v_and_b32 v10, 1, v3
    v_mul_u32_u24 v10, 24, v10
    v_add_u32 v15, v9, v10
    v_add_u32 v8, v6, v15
    s_mov_b32 s44, 0x3f80
    s_mov_b32 s45, 0x3f800000
    v_add_u32 v14, v6, v9
    v_mov_b32 v10, 0x80000000
    v_cmp_lt_u32 vcc, 31, v1
    s_nop 1
    v_cndmask_b32 v14, v14, v10, vcc
    s_lshr_b32 s31, s29, 4
    s_add_u32 s31, s31, s28
    s_mul_i32 s31, s31, 18432
    s_lshl_b32 s50, s30, 5
    s_add_u32 s31, s31, s50
    v_lshl_add_u32 v237, v1, 4, s31
    v_lshl_add_u32 v238, v2, 4, s31
    v_lshl_add_u32 v238, v3, 3, v238
    v_cndmask_b32 v238, v238, v10, vcc
    s_mov_b32 s40, 0
    s_mov_b32 s41, 2359296
    s_mov_b32 s42, 4718592
    s_mov_b32 s43, 7077888
    v_lshlrev_b32 v12, 2, v5
    s_add_u32 m0, s32, 20480
    s_mov_b32 s33, 165888
    buffer_load_dwordx4 v4, s[8:11], s33 offen lds
    s_add_u32 m0, s47, 24576
    s_add_u32 s33, s46, 165888
    buffer_load_dwordx4 v13, s[8:11], s33 offen lds
    s_mov_b32 s49, 524288
    buffer_load_dwordx4 v[32:35], v7, s[4:7], s49 offen
    s_add_u32 m0, s32, 25600
    s_mov_b32 s33, 207360
    buffer_load_dwordx4 v4, s[8:11], s33 offen lds
    s_mov_b32 s49, 655360
    buffer_load_dwordx4 v[36:39], v7, s[4:7], s49 offen
    s_add_u32 m0, s32, 30720
    s_mov_b32 s33, 248832
    buffer_load_dwordx4 v4, s[8:11], s33 offen lds
    s_mov_b32 s49, 786432
    buffer_load_dwordx4 v[40:43], v7, s[4:7], s49 offen
    s_add_u32 m0, s32, 35840
    s_mov_b32 s33, 290304
    buffer_load_dwordx4 v4, s[8:11], s33 offen lds
    s_mov_b32 s49, 917504
    buffer_load_dwordx4 v[44:47], v7, s[4:7], s49 offen
    s_add_u32 m0, s32, 40960
    s_mov_b32 s33, 331776
    buffer_load_dwordx4 v4, s[8:11], s33 offen lds
    s_add_u32 m0, s47, 45056
    s_add_u32 s33, s46, 331776
    buffer_load_dwordx4 v13, s[8:11], s33 offen lds
    s_mov_b32 s49, 1048576
    buffer_load_dwordx4 v[48:51], v7, s[4:7], s49 offen
    s_add_u32 m0, s32, 46080
    s_mov_b32 s33, 373248
    buffer_load_dwordx4 v4, s[8:11], s33 offen lds
    s_mov_b32 s49, 1179648
    buffer_load_dwordx4 v[52:55], v7, s[4:7], s49 offen
    s_add_u32 m0, s32, 51200
    s_mov_b32 s33, 414720
    buffer_load_dwordx4 v4, s[8:11], s33 offen lds
    s_mov_b32 s49, 1310720
    buffer_load_dwordx4 v[56:59], v7, s[4:7], s49 offen
    s_add_u32 m0, s32, 56320
    s_mov_b32 s33, 456192
    buffer_load_dwordx4 v4, s[8:11], s33 offen lds
    s_mov_b32 s49, 1441792
    buffer_load_dwordx4 v[60:63], v7, s[4:7], s49 offen
    v_lshrrev_b32 v10, 2, v2
    v_lshl_add_u32 v11, v3, 2, v10
    v_mul_u32_u24 v11, 160, v11
    v_and_b32 v10, 3, v1
    v_lshl_add_u32 v232, v10, 3, v11
    v_add_u32 v233, 46080, v232
    s_waitcnt vmcnt(18)
    s_barrier
    ds_read_b64_tr_b16 v[188:189], v232 offset:0
    ds_read_b64_tr_b16 v[190:191], v232 offset:2560
    ds_read_b64_tr_b16 v[192:193], v232 offset:32
    ds_read_b64_tr_b16 v[194:195], v232 offset:2592
    ds_read_b64_tr_b16 v[196:197], v232 offset:64
    ds_read_b64_tr_b16 v[198:199], v232 offset:2624
    ds_read_b64_tr_b16 v[200:201], v232 offset:96
    ds_read_b64_tr_b16 v[202:203], v232 offset:2656
    ds_read_b64_tr_b16 v[204:205], v232 offset:128
    ds_read_b64_tr_b16 v[206:207], v232 offset:2688
    ds_read_b64_tr_b16 v[208:209], v232 offset:5120
    ds_read_b64_tr_b16 v[210:211], v232 offset:7680
    s_waitcnt lgkmcnt(10)
    v_mfma_f32_16x16x32_bf16 v[168:171], v[188:191], v[16:19], 0
    ds_read_b64_tr_b16 v[212:213], v232 offset:5152
    ds_read_b64_tr_b16 v[214:215], v232 offset:7712
    s_add_u32 m0, s32, 61440
    s_mov_b32 s33, 497664
    buffer_load_dwordx4 v4, s[8:11], s33 offen lds
    s_waitcnt lgkmcnt(10)
    v_mfma_f32_16x16x32_bf16 v[172:175], v[192:195], v[16:19], 0
    ds_read_b64_tr_b16 v[216:217], v232 offset:5184
    ds_read_b64_tr_b16 v[218:219], v232 offset:7744
    s_waitcnt lgkmcnt(10)
    v_mfma_f32_16x16x32_bf16 v[176:179], v[196:199], v[16:19], 0
    ds_read_b64_tr_b16 v[188:189], v232 offset:5216
    ds_read_b64_tr_b16 v[190:191], v232 offset:7776
    s_add_u32 m0, s47, 65536
    s_add_u32 s33, s46, 497664
    buffer_load_dwordx4 v13, s[8:11], s33 offen lds
    s_waitcnt lgkmcnt(10)
    v_mfma_f32_16x16x32_bf16 v[180:183], v[200:203], v[16:19], 0
    ds_read_b64_tr_b16 v[192:193], v232 offset:5248
    ds_read_b64_tr_b16 v[194:195], v232 offset:7808
    s_waitcnt lgkmcnt(10)
    v_mfma_f32_16x16x32_bf16 v[184:187], v[204:207], v[16:19], 0
    ds_read_b64_tr_b16 v[196:197], v232 offset:10240
    ds_read_b64_tr_b16 v[198:199], v232 offset:12800
    s_mov_b32 s49, 1572864
    buffer_load_dwordx4 v[64:67], v7, s[4:7], s49 offen
    s_waitcnt lgkmcnt(10)
    v_mfma_f32_16x16x32_bf16 v[168:171], v[208:211], v[20:23], v[168:171]
    ds_read_b64_tr_b16 v[200:201], v232 offset:10272
    ds_read_b64_tr_b16 v[202:203], v232 offset:12832
    s_waitcnt lgkmcnt(10)
    v_mfma_f32_16x16x32_bf16 v[172:175], v[212:215], v[20:23], v[172:175]
    ds_read_b64_tr_b16 v[204:205], v232 offset:10304
    ds_read_b64_tr_b16 v[206:207], v232 offset:12864
    s_add_u32 m0, s32, 66560
    s_mov_b32 s33, 539136
    buffer_load_dwordx4 v4, s[8:11], s33 offen lds
    s_waitcnt lgkmcnt(10)
    v_mfma_f32_16x16x32_bf16 v[176:179], v[216:219], v[20:23], v[176:179]
    ds_read_b64_tr_b16 v[208:209], v232 offset:10336
    ds_read_b64_tr_b16 v[210:211], v232 offset:12896
    s_waitcnt lgkmcnt(10)
    v_mfma_f32_16x16x32_bf16 v[180:183], v[188:191], v[20:23], v[180:183]
    ds_read_b64_tr_b16 v[212:213], v232 offset:10368
    ds_read_b64_tr_b16 v[214:215], v232 offset:12928
    s_mov_b32 s49, 1703936
    buffer_load_dwordx4 v[68:71], v7, s[4:7], s49 offen
    s_waitcnt lgkmcnt(10)
    v_mfma_f32_16x16x32_bf16 v[184:187], v[192:195], v[20:23], v[184:187]
    ds_read_b64_tr_b16 v[216:217], v232 offset:15360
    ds_read_b64_tr_b16 v[218:219], v232 offset:17920
    s_waitcnt lgkmcnt(10)
    v_mfma_f32_16x16x32_bf16 v[168:171], v[196:199], v[24:27], v[168:171]
    ds_read_b64_tr_b16 v[188:189], v232 offset:15392
    ds_read_b64_tr_b16 v[190:191], v232 offset:17952
    s_add_u32 m0, s32, 71680
    s_mov_b32 s33, 580608
    buffer_load_dwordx4 v4, s[8:11], s33 offen lds
    s_waitcnt lgkmcnt(10)
    v_mfma_f32_16x16x32_bf16 v[172:175], v[200:203], v[24:27], v[172:175]
    ds_read_b64_tr_b16 v[192:193], v232 offset:15424
    ds_read_b64_tr_b16 v[194:195], v232 offset:17984
    s_waitcnt lgkmcnt(10)
    v_mfma_f32_16x16x32_bf16 v[176:179], v[204:207], v[24:27], v[176:179]
    ds_read_b64_tr_b16 v[196:197], v232 offset:15456
    ds_read_b64_tr_b16 v[198:199], v232 offset:18016
    s_mov_b32 s49, 1835008
    buffer_load_dwordx4 v[72:75], v7, s[4:7], s49 offen
    s_waitcnt lgkmcnt(10)
    v_mfma_f32_16x16x32_bf16 v[180:183], v[208:211], v[24:27], v[180:183]
    ds_read_b64_tr_b16 v[200:201], v232 offset:15488
    ds_read_b64_tr_b16 v[202:203], v232 offset:18048
    s_waitcnt lgkmcnt(10)
    v_mfma_f32_16x16x32_bf16 v[184:187], v[212:215], v[24:27], v[184:187]
    s_add_u32 m0, s32, 76800
    s_mov_b32 s33, 622080
    buffer_load_dwordx4 v4, s[8:11], s33 offen lds
    s_waitcnt lgkmcnt(8)
    v_mfma_f32_16x16x32_bf16 v[168:171], v[216:219], v[28:31], v[168:171]
    s_waitcnt lgkmcnt(6)
    v_mfma_f32_16x16x32_bf16 v[172:175], v[188:191], v[28:31], v[172:175]
    s_mov_b32 s49, 1966080
    buffer_load_dwordx4 v[76:79], v7, s[4:7], s49 offen
    s_waitcnt lgkmcnt(4)
    v_mfma_f32_16x16x32_bf16 v[176:179], v[192:195], v[28:31], v[176:179]
    s_waitcnt lgkmcnt(2)
    v_mfma_f32_16x16x32_bf16 v[180:183], v[196:199], v[28:31], v[180:183]
    s_add_u32 m0, s32, 81920
    s_mov_b32 s33, 0
    buffer_load_dwordx4 v234, s[8:11], s33 offen lds
    s_waitcnt lgkmcnt(0)
    v_mfma_f32_16x16x32_bf16 v[184:187], v[200:203], v[28:31], v[184:187]
    s_waitcnt vmcnt(10)
    s_barrier
    ds_read_b64_tr_b16 v[204:205], v232 offset:20480
    ds_read_b64_tr_b16 v[206:207], v232 offset:23040
    ds_read_b64_tr_b16 v[208:209], v232 offset:20512
    ds_read_b64_tr_b16 v[210:211], v232 offset:23072
    ds_read_b64_tr_b16 v[212:213], v232 offset:20544
    ds_read_b64_tr_b16 v[214:215], v232 offset:23104
    ds_read_b64_tr_b16 v[216:217], v232 offset:20576
    ds_read_b64_tr_b16 v[218:219], v232 offset:23136
    ds_read_b64_tr_b16 v[188:189], v232 offset:20608
    ds_read_b64_tr_b16 v[190:191], v232 offset:23168
    ds_read_b64_tr_b16 v[192:193], v232 offset:25600
    ds_read_b64_tr_b16 v[194:195], v232 offset:28160
    s_waitcnt lgkmcnt(10)
    v_mfma_f32_16x16x32_bf16 v[168:171], v[204:207], v[32:35], v[168:171]
    ds_read_b64_tr_b16 v[196:197], v232 offset:25632
    ds_read_b64_tr_b16 v[198:199], v232 offset:28192
    s_cmp_ge_u32 s28, 2
    s_cbranch_scc1 fn_sk
    s_add_u32 m0, s47, 86016
    s_nop 0
    buffer_load_dwordx4 v235, s[8:11], s48 offen lds
    fn_sk:
    s_waitcnt lgkmcnt(10)
    v_mfma_f32_16x16x32_bf16 v[172:175], v[208:211], v[32:35], v[172:175]
    ds_read_b64_tr_b16 v[200:201], v232 offset:25664
    ds_read_b64_tr_b16 v[202:203], v232 offset:28224
    s_waitcnt lgkmcnt(10)
    v_mfma_f32_16x16x32_bf16 v[176:179], v[212:215], v[32:35], v[176:179]
    ds_read_b64_tr_b16 v[204:205], v232 offset:25696
    ds_read_b64_tr_b16 v[206:207], v232 offset:28256
    s_mov_b32 s49, 2097152
    buffer_load_dword v80, v236, s[4:7], s49 offen
    s_waitcnt lgkmcnt(10)
    v_mfma_f32_16x16x32_bf16 v[180:183], v[216:219], v[32:35], v[180:183]
    ds_read_b64_tr_b16 v[208:209], v232 offset:25728
    ds_read_b64_tr_b16 v[210:211], v232 offset:28288
    s_waitcnt lgkmcnt(10)
    v_mfma_f32_16x16x32_bf16 v[184:187], v[188:191], v[32:35], v[184:187]
    ds_read_b64_tr_b16 v[212:213], v232 offset:30720
    ds_read_b64_tr_b16 v[214:215], v232 offset:33280
    s_mov_b32 s49, 2105344
    buffer_load_dword v81, v236, s[4:7], s49 offen
    s_waitcnt lgkmcnt(10)
    v_mfma_f32_16x16x32_bf16 v[168:171], v[192:195], v[36:39], v[168:171]
    ds_read_b64_tr_b16 v[216:217], v232 offset:30752
    ds_read_b64_tr_b16 v[218:219], v232 offset:33312
    s_waitcnt lgkmcnt(10)
    v_mfma_f32_16x16x32_bf16 v[172:175], v[196:199], v[36:39], v[172:175]
    ds_read_b64_tr_b16 v[188:189], v232 offset:30784
    ds_read_b64_tr_b16 v[190:191], v232 offset:33344
    s_mov_b32 s49, 2113536
    buffer_load_dword v82, v236, s[4:7], s49 offen
    s_waitcnt lgkmcnt(10)
    v_mfma_f32_16x16x32_bf16 v[176:179], v[200:203], v[36:39], v[176:179]
    ds_read_b64_tr_b16 v[192:193], v232 offset:30816
    ds_read_b64_tr_b16 v[194:195], v232 offset:33376
    s_waitcnt lgkmcnt(10)
    v_mfma_f32_16x16x32_bf16 v[180:183], v[204:207], v[36:39], v[180:183]
    ds_read_b64_tr_b16 v[196:197], v232 offset:30848
    ds_read_b64_tr_b16 v[198:199], v232 offset:33408
    s_mov_b32 s49, 2121728
    buffer_load_dword v83, v236, s[4:7], s49 offen
    s_waitcnt lgkmcnt(10)
    v_mfma_f32_16x16x32_bf16 v[184:187], v[208:211], v[36:39], v[184:187]
    ds_read_b64_tr_b16 v[200:201], v232 offset:35840
    ds_read_b64_tr_b16 v[202:203], v232 offset:38400
    s_waitcnt lgkmcnt(10)
    v_mfma_f32_16x16x32_bf16 v[168:171], v[212:215], v[40:43], v[168:171]
    ds_read_b64_tr_b16 v[204:205], v232 offset:35872
    ds_read_b64_tr_b16 v[206:207], v232 offset:38432
    s_add_u32 m0, s32, 87040
    s_mov_b32 s33, 331776
    buffer_load_dwordx4 v234, s[8:11], s33 offen lds
    s_waitcnt lgkmcnt(10)
    v_mfma_f32_16x16x32_bf16 v[172:175], v[216:219], v[40:43], v[172:175]
    ds_read_b64_tr_b16 v[208:209], v232 offset:35904
    ds_read_b64_tr_b16 v[210:211], v232 offset:38464
    s_waitcnt lgkmcnt(10)
    v_mfma_f32_16x16x32_bf16 v[176:179], v[188:191], v[40:43], v[176:179]
    ds_read_b64_tr_b16 v[212:213], v232 offset:35936
    ds_read_b64_tr_b16 v[214:215], v232 offset:38496
    s_mov_b32 s49, 2228224
    buffer_load_dword v84, v236, s[4:7], s49 offen
    s_waitcnt lgkmcnt(10)
    v_mfma_f32_16x16x32_bf16 v[180:183], v[192:195], v[40:43], v[180:183]
    ds_read_b64_tr_b16 v[216:217], v232 offset:35968
    ds_read_b64_tr_b16 v[218:219], v232 offset:38528
    s_waitcnt lgkmcnt(10)
    v_mfma_f32_16x16x32_bf16 v[184:187], v[196:199], v[40:43], v[184:187]
    ds_read_b64_tr_b16 v[188:189], v232 offset:40960
    ds_read_b64_tr_b16 v[190:191], v232 offset:43520
    s_mov_b32 s49, 2236416
    buffer_load_dword v85, v236, s[4:7], s49 offen
    s_waitcnt lgkmcnt(10)
    v_mfma_f32_16x16x32_bf16 v[168:171], v[200:203], v[44:47], v[168:171]
    ds_read_b64_tr_b16 v[192:193], v232 offset:40992
    ds_read_b64_tr_b16 v[194:195], v232 offset:43552
    s_waitcnt lgkmcnt(10)
    v_mfma_f32_16x16x32_bf16 v[172:175], v[204:207], v[44:47], v[172:175]
    ds_read_b64_tr_b16 v[196:197], v232 offset:41024
    ds_read_b64_tr_b16 v[198:199], v232 offset:43584
    s_mov_b32 s49, 2244608
    buffer_load_dword v86, v236, s[4:7], s49 offen
    s_waitcnt lgkmcnt(10)
    v_mfma_f32_16x16x32_bf16 v[176:179], v[208:211], v[44:47], v[176:179]
    ds_read_b64_tr_b16 v[200:201], v232 offset:41056
    ds_read_b64_tr_b16 v[202:203], v232 offset:43616
    s_waitcnt lgkmcnt(10)
    v_mfma_f32_16x16x32_bf16 v[180:183], v[212:215], v[44:47], v[180:183]
    ds_read_b64_tr_b16 v[204:205], v232 offset:41088
    ds_read_b64_tr_b16 v[206:207], v232 offset:43648
    s_mov_b32 s49, 2252800
    buffer_load_dword v87, v236, s[4:7], s49 offen
    s_waitcnt lgkmcnt(10)
    v_mfma_f32_16x16x32_bf16 v[184:187], v[216:219], v[44:47], v[184:187]
    ds_read_b64_tr_b16 v[208:209], v233 offset:0
    ds_read_b64_tr_b16 v[210:211], v233 offset:2560
    s_waitcnt lgkmcnt(10)
    v_mfma_f32_16x16x32_bf16 v[168:171], v[188:191], v[48:51], v[168:171]
    ds_read_b64_tr_b16 v[212:213], v233 offset:32
    ds_read_b64_tr_b16 v[214:215], v233 offset:2592
    buffer_load_dwordx4 v[88:91], v237, s[20:23], s40 offen
    s_waitcnt lgkmcnt(10)
    v_mfma_f32_16x16x32_bf16 v[172:175], v[192:195], v[48:51], v[172:175]
    ds_read_b64_tr_b16 v[216:217], v233 offset:64
    ds_read_b64_tr_b16 v[218:219], v233 offset:2624
    s_waitcnt lgkmcnt(10)
    v_mfma_f32_16x16x32_bf16 v[176:179], v[196:199], v[48:51], v[176:179]
    ds_read_b64_tr_b16 v[188:189], v233 offset:96
    ds_read_b64_tr_b16 v[190:191], v233 offset:2656
    buffer_load_dwordx4 v[92:95], v237, s[20:23], s40 offen offset:1024
    s_waitcnt lgkmcnt(10)
    v_mfma_f32_16x16x32_bf16 v[180:183], v[200:203], v[48:51], v[180:183]
    ds_read_b64_tr_b16 v[192:193], v233 offset:128
    ds_read_b64_tr_b16 v[194:195], v233 offset:2688
    s_waitcnt lgkmcnt(10)
    v_mfma_f32_16x16x32_bf16 v[184:187], v[204:207], v[48:51], v[184:187]
    ds_read_b64_tr_b16 v[196:197], v233 offset:5120
    ds_read_b64_tr_b16 v[198:199], v233 offset:7680
    buffer_load_dwordx2 v[96:97], v238, s[20:23], s40 offen offset:2048
    s_waitcnt lgkmcnt(10)
    v_mfma_f32_16x16x32_bf16 v[168:171], v[208:211], v[52:55], v[168:171]
    ds_read_b64_tr_b16 v[200:201], v233 offset:5152
    ds_read_b64_tr_b16 v[202:203], v233 offset:7712
    s_waitcnt lgkmcnt(10)
    v_mfma_f32_16x16x32_bf16 v[172:175], v[212:215], v[52:55], v[172:175]
    ds_read_b64_tr_b16 v[204:205], v233 offset:5184
    ds_read_b64_tr_b16 v[206:207], v233 offset:7744
    buffer_load_dwordx4 v[100:103], v237, s[20:23], s41 offen
    s_waitcnt lgkmcnt(10)
    v_mfma_f32_16x16x32_bf16 v[176:179], v[216:219], v[52:55], v[176:179]
    ds_read_b64_tr_b16 v[208:209], v233 offset:5216
    ds_read_b64_tr_b16 v[210:211], v233 offset:7776
    s_waitcnt lgkmcnt(10)
    v_mfma_f32_16x16x32_bf16 v[180:183], v[188:191], v[52:55], v[180:183]
    ds_read_b64_tr_b16 v[212:213], v233 offset:5248
    ds_read_b64_tr_b16 v[214:215], v233 offset:7808
    buffer_load_dwordx4 v[104:107], v237, s[20:23], s41 offen offset:1024
    s_waitcnt lgkmcnt(10)
    v_mfma_f32_16x16x32_bf16 v[184:187], v[192:195], v[52:55], v[184:187]
    ds_read_b64_tr_b16 v[216:217], v233 offset:10240
    ds_read_b64_tr_b16 v[218:219], v233 offset:12800
    s_waitcnt lgkmcnt(10)
    v_mfma_f32_16x16x32_bf16 v[168:171], v[196:199], v[56:59], v[168:171]
    ds_read_b64_tr_b16 v[188:189], v233 offset:10272
    ds_read_b64_tr_b16 v[190:191], v233 offset:12832
    buffer_load_dwordx2 v[108:109], v238, s[20:23], s41 offen offset:2048
    s_waitcnt lgkmcnt(10)
    v_mfma_f32_16x16x32_bf16 v[172:175], v[200:203], v[56:59], v[172:175]
    ds_read_b64_tr_b16 v[192:193], v233 offset:10304
    ds_read_b64_tr_b16 v[194:195], v233 offset:12864
    s_waitcnt lgkmcnt(10)
    v_mfma_f32_16x16x32_bf16 v[176:179], v[204:207], v[56:59], v[176:179]
    ds_read_b64_tr_b16 v[196:197], v233 offset:10336
    ds_read_b64_tr_b16 v[198:199], v233 offset:12896
    buffer_load_dwordx4 v[112:115], v237, s[20:23], s42 offen
    s_waitcnt lgkmcnt(10)
    v_mfma_f32_16x16x32_bf16 v[180:183], v[208:211], v[56:59], v[180:183]
    ds_read_b64_tr_b16 v[200:201], v233 offset:10368
    ds_read_b64_tr_b16 v[202:203], v233 offset:12928
    s_waitcnt lgkmcnt(10)
    v_mfma_f32_16x16x32_bf16 v[184:187], v[212:215], v[56:59], v[184:187]
    buffer_load_dwordx4 v[116:119], v237, s[20:23], s42 offen offset:1024
    s_waitcnt lgkmcnt(8)
    v_mfma_f32_16x16x32_bf16 v[168:171], v[216:219], v[60:63], v[168:171]
    s_waitcnt lgkmcnt(6)
    v_mfma_f32_16x16x32_bf16 v[172:175], v[188:191], v[60:63], v[172:175]
    buffer_load_dwordx2 v[120:121], v238, s[20:23], s42 offen offset:2048
    s_waitcnt lgkmcnt(4)
    v_mfma_f32_16x16x32_bf16 v[176:179], v[192:195], v[60:63], v[176:179]
    s_waitcnt lgkmcnt(2)
    v_mfma_f32_16x16x32_bf16 v[180:183], v[196:199], v[60:63], v[180:183]
    buffer_load_dwordx4 v[124:127], v237, s[20:23], s43 offen
    s_waitcnt lgkmcnt(0)
    v_mfma_f32_16x16x32_bf16 v[184:187], v[200:203], v[60:63], v[184:187]
    s_waitcnt vmcnt(10)
    s_barrier
    ds_read_b64_tr_b16 v[204:205], v233 offset:15360
    ds_read_b64_tr_b16 v[206:207], v233 offset:17920
    ds_read_b64_tr_b16 v[208:209], v233 offset:15392
    ds_read_b64_tr_b16 v[210:211], v233 offset:17952
    ds_read_b64_tr_b16 v[212:213], v233 offset:15424
    ds_read_b64_tr_b16 v[214:215], v233 offset:17984
    ds_read_b64_tr_b16 v[216:217], v233 offset:15456
    ds_read_b64_tr_b16 v[218:219], v233 offset:18016
    ds_read_b64_tr_b16 v[188:189], v233 offset:15488
    ds_read_b64_tr_b16 v[190:191], v233 offset:18048
    ds_read_b64_tr_b16 v[192:193], v233 offset:20480
    ds_read_b64_tr_b16 v[194:195], v233 offset:23040
    s_waitcnt lgkmcnt(10)
    v_mfma_f32_16x16x32_bf16 v[168:171], v[204:207], v[64:67], v[168:171]
    ds_read_b64_tr_b16 v[196:197], v233 offset:20512
    ds_read_b64_tr_b16 v[198:199], v233 offset:23072
    buffer_load_dwordx4 v[128:131], v237, s[20:23], s43 offen offset:1024
    s_waitcnt lgkmcnt(10)
    v_mfma_f32_16x16x32_bf16 v[172:175], v[208:211], v[64:67], v[172:175]
    ds_read_b64_tr_b16 v[200:201], v233 offset:20544
    ds_read_b64_tr_b16 v[202:203], v233 offset:23104
    s_waitcnt lgkmcnt(10)
    v_mfma_f32_16x16x32_bf16 v[176:179], v[212:215], v[64:67], v[176:179]
    ds_read_b64_tr_b16 v[204:205], v233 offset:20576
    ds_read_b64_tr_b16 v[206:207], v233 offset:23136
    buffer_load_dwordx2 v[132:133], v238, s[20:23], s43 offen offset:2048
    s_waitcnt lgkmcnt(10)
    v_mfma_f32_16x16x32_bf16 v[180:183], v[216:219], v[64:67], v[180:183]
    ds_read_b64_tr_b16 v[208:209], v233 offset:20608
    ds_read_b64_tr_b16 v[210:211], v233 offset:23168
    s_waitcnt lgkmcnt(10)
    v_mfma_f32_16x16x32_bf16 v[184:187], v[188:191], v[64:67], v[184:187]
    ds_read_b64_tr_b16 v[212:213], v233 offset:25600
    ds_read_b64_tr_b16 v[214:215], v233 offset:28160
    buffer_load_dwordx4 v[220:223], v15, s[16:19], 0 offen
    s_waitcnt lgkmcnt(10)
    v_mfma_f32_16x16x32_bf16 v[168:171], v[192:195], v[68:71], v[168:171]
    ds_read_b64_tr_b16 v[216:217], v233 offset:25632
    ds_read_b64_tr_b16 v[218:219], v233 offset:28192
    s_waitcnt lgkmcnt(10)
    v_mfma_f32_16x16x32_bf16 v[172:175], v[196:199], v[68:71], v[172:175]
    ds_read_b64_tr_b16 v[188:189], v233 offset:25664
    ds_read_b64_tr_b16 v[190:191], v233 offset:28224
    buffer_load_dwordx4 v[224:227], v15, s[16:19], 0 offen offset:64
    s_waitcnt lgkmcnt(10)
    v_mfma_f32_16x16x32_bf16 v[176:179], v[200:203], v[68:71], v[176:179]
    ds_read_b64_tr_b16 v[192:193], v233 offset:25696
    ds_read_b64_tr_b16 v[194:195], v233 offset:28256
    s_waitcnt lgkmcnt(10)
    v_mfma_f32_16x16x32_bf16 v[180:183], v[204:207], v[68:71], v[180:183]
    ds_read_b64_tr_b16 v[196:197], v233 offset:25728
    ds_read_b64_tr_b16 v[198:199], v233 offset:28288
    buffer_load_dwordx2 v[228:229], v9, s[16:19], 0 offen offset:128
    s_waitcnt lgkmcnt(10)
    v_mfma_f32_16x16x32_bf16 v[184:187], v[208:211], v[68:71], v[184:187]
    ds_read_b64_tr_b16 v[200:201], v233 offset:30720
    ds_read_b64_tr_b16 v[202:203], v233 offset:33280
    s_waitcnt lgkmcnt(10)
    v_mfma_f32_16x16x32_bf16 v[168:171], v[212:215], v[72:75], v[168:171]
    ds_read_b64_tr_b16 v[204:205], v233 offset:30752
    ds_read_b64_tr_b16 v[206:207], v233 offset:33312
    buffer_load_dword v230, v12, s[24:27], 0 offen
    s_waitcnt lgkmcnt(10)
    v_mfma_f32_16x16x32_bf16 v[172:175], v[216:219], v[72:75], v[172:175]
    ds_read_b64_tr_b16 v[208:209], v233 offset:30784
    ds_read_b64_tr_b16 v[210:211], v233 offset:33344
    s_waitcnt lgkmcnt(10)
    v_mfma_f32_16x16x32_bf16 v[176:179], v[188:191], v[72:75], v[176:179]
    ds_read_b64_tr_b16 v[212:213], v233 offset:30816
    ds_read_b64_tr_b16 v[214:215], v233 offset:33376
    s_waitcnt lgkmcnt(10)
    v_mfma_f32_16x16x32_bf16 v[180:183], v[192:195], v[72:75], v[180:183]
    ds_read_b64_tr_b16 v[216:217], v233 offset:30848
    ds_read_b64_tr_b16 v[218:219], v233 offset:33408
    s_waitcnt lgkmcnt(10)
    v_mfma_f32_16x16x32_bf16 v[184:187], v[196:199], v[72:75], v[184:187]
    ds_read_b64_tr_b16 v[188:189], v233 offset:35840
    ds_read_b64_tr_b16 v[190:191], v233 offset:38400
    s_waitcnt lgkmcnt(10)
    v_mfma_f32_16x16x32_bf16 v[168:171], v[200:203], v[76:79], v[168:171]
    ds_read_b64_tr_b16 v[192:193], v233 offset:35872
    ds_read_b64_tr_b16 v[194:195], v233 offset:38432
    s_waitcnt lgkmcnt(10)
    v_mfma_f32_16x16x32_bf16 v[172:175], v[204:207], v[76:79], v[172:175]
    ds_read_b64_tr_b16 v[196:197], v233 offset:35904
    ds_read_b64_tr_b16 v[198:199], v233 offset:38464
    s_waitcnt lgkmcnt(10)
    v_mfma_f32_16x16x32_bf16 v[176:179], v[208:211], v[76:79], v[176:179]
    ds_read_b64_tr_b16 v[200:201], v233 offset:35936
    ds_read_b64_tr_b16 v[202:203], v233 offset:38496
    s_waitcnt lgkmcnt(10)
    v_mfma_f32_16x16x32_bf16 v[180:183], v[212:215], v[76:79], v[180:183]
    ds_read_b64_tr_b16 v[204:205], v233 offset:35968
    ds_read_b64_tr_b16 v[206:207], v233 offset:38528
    s_waitcnt lgkmcnt(10)
    v_mfma_f32_16x16x32_bf16 v[184:187], v[216:219], v[76:79], v[184:187]
    ds_read_b64_tr_b16 v[208:209], v233 offset:40960
    ds_read_b64_tr_b16 v[210:211], v233 offset:43520
    s_waitcnt lgkmcnt(10)
    v_mfma_f32_16x16x32_bf16 v[168:171], v[188:191], v[80:83], v[168:171]
    ds_read_b64_tr_b16 v[212:213], v233 offset:40992
    ds_read_b64_tr_b16 v[214:215], v233 offset:43552
    s_waitcnt lgkmcnt(10)
    v_mfma_f32_16x16x32_bf16 v[172:175], v[192:195], v[80:83], v[172:175]
    ds_read_b64_tr_b16 v[216:217], v233 offset:41024
    ds_read_b64_tr_b16 v[218:219], v233 offset:43584
    s_waitcnt lgkmcnt(10)
    v_mfma_f32_16x16x32_bf16 v[176:179], v[196:199], v[80:83], v[176:179]
    ds_read_b64_tr_b16 v[188:189], v233 offset:41056
    ds_read_b64_tr_b16 v[190:191], v233 offset:43616
    s_waitcnt lgkmcnt(10)
    v_mfma_f32_16x16x32_bf16 v[180:183], v[200:203], v[80:83], v[180:183]
    ds_read_b64_tr_b16 v[192:193], v233 offset:41088
    ds_read_b64_tr_b16 v[194:195], v233 offset:43648
    s_waitcnt lgkmcnt(10)
    v_mfma_f32_16x16x32_bf16 v[184:187], v[204:207], v[80:83], v[184:187]
    s_waitcnt lgkmcnt(8)
    v_mfma_f32_16x16x32_bf16 v[168:171], v[208:211], v[84:87], v[168:171]
    s_waitcnt lgkmcnt(6)
    v_mfma_f32_16x16x32_bf16 v[172:175], v[212:215], v[84:87], v[172:175]
    s_waitcnt lgkmcnt(4)
    v_mfma_f32_16x16x32_bf16 v[176:179], v[216:219], v[84:87], v[176:179]
    s_waitcnt lgkmcnt(2)
    v_mfma_f32_16x16x32_bf16 v[180:183], v[188:191], v[84:87], v[180:183]
    s_waitcnt lgkmcnt(0)
    v_mfma_f32_16x16x32_bf16 v[184:187], v[192:195], v[84:87], v[184:187]
    s_waitcnt vmcnt(0)
    s_nop 7
    v_permlane16_swap_b32 v168, v172
    v_permlane16_swap_b32 v169, v173
    v_permlane16_swap_b32 v170, v174
    v_permlane16_swap_b32 v171, v175
    v_permlane16_swap_b32 v176, v180
    v_permlane16_swap_b32 v177, v181
    v_permlane16_swap_b32 v178, v182
    v_permlane16_swap_b32 v179, v183
    v_sub_f32 v231, 1.0, v230
    v_dot2_f32_bf16 v239, v220, s44, 0
    v_dot2_f32_bf16 v240, v220, s45, 0
    v_dot2_f32_bf16 v241, v221, s44, 0
    v_dot2_f32_bf16 v242, v221, s45, 0
    v_dot2_f32_bf16 v243, v222, s44, 0
    v_dot2_f32_bf16 v244, v222, s45, 0
    v_dot2_f32_bf16 v245, v223, s44, 0
    v_dot2_f32_bf16 v246, v223, s45, 0
    v_dot2_f32_bf16 v239, v88, s44, v239
    v_dot2_f32_bf16 v240, v88, s45, v240
    v_dot2_f32_bf16 v241, v89, s44, v241
    v_dot2_f32_bf16 v242, v89, s45, v242
    v_dot2_f32_bf16 v243, v90, s44, v243
    v_dot2_f32_bf16 v244, v90, s45, v244
    v_dot2_f32_bf16 v245, v91, s44, v245
    v_dot2_f32_bf16 v246, v91, s45, v246
    v_dot2_f32_bf16 v239, v100, s44, v239
    v_dot2_f32_bf16 v240, v100, s45, v240
    v_dot2_f32_bf16 v241, v101, s44, v241
    v_dot2_f32_bf16 v242, v101, s45, v242
    v_dot2_f32_bf16 v243, v102, s44, v243
    v_dot2_f32_bf16 v244, v102, s45, v244
    v_dot2_f32_bf16 v245, v103, s44, v245
    v_dot2_f32_bf16 v246, v103, s45, v246
    v_dot2_f32_bf16 v239, v112, s44, v239
    v_dot2_f32_bf16 v240, v112, s45, v240
    v_dot2_f32_bf16 v241, v113, s44, v241
    v_dot2_f32_bf16 v242, v113, s45, v242
    v_dot2_f32_bf16 v243, v114, s44, v243
    v_dot2_f32_bf16 v244, v114, s45, v244
    v_dot2_f32_bf16 v245, v115, s44, v245
    v_dot2_f32_bf16 v246, v115, s45, v246
    v_dot2_f32_bf16 v239, v124, s44, v239
    v_dot2_f32_bf16 v240, v124, s45, v240
    v_dot2_f32_bf16 v241, v125, s44, v241
    v_dot2_f32_bf16 v242, v125, s45, v242
    v_dot2_f32_bf16 v243, v126, s44, v243
    v_dot2_f32_bf16 v244, v126, s45, v244
    v_dot2_f32_bf16 v245, v127, s44, v245
    v_dot2_f32_bf16 v246, v127, s45, v246
    v_mul_f32 v239, v239, v231
    v_mul_f32 v240, v240, v231
    v_mul_f32 v241, v241, v231
    v_mul_f32 v242, v242, v231
    v_mul_f32 v243, v243, v231
    v_mul_f32 v244, v244, v231
    v_mul_f32 v245, v245, v231
    v_mul_f32 v246, v246, v231
    v_fmac_f32 v239, v168, v230
    v_fmac_f32 v240, v169, v230
    v_fmac_f32 v241, v170, v230
    v_fmac_f32 v242, v171, v230
    v_fmac_f32 v243, v172, v230
    v_fmac_f32 v244, v173, v230
    v_fmac_f32 v245, v174, v230
    v_fmac_f32 v246, v175, v230
    v_cvt_pk_bf16_f32 v88, v239, v240
    v_cvt_pk_bf16_f32 v89, v241, v242
    v_cvt_pk_bf16_f32 v90, v243, v244
    v_cvt_pk_bf16_f32 v91, v245, v246
    buffer_store_dwordx4 v[88:91], v8, s[12:15], 0 offen offset:0
    v_dot2_f32_bf16 v239, v224, s44, 0
    v_dot2_f32_bf16 v240, v224, s45, 0
    v_dot2_f32_bf16 v241, v225, s44, 0
    v_dot2_f32_bf16 v242, v225, s45, 0
    v_dot2_f32_bf16 v243, v226, s44, 0
    v_dot2_f32_bf16 v244, v226, s45, 0
    v_dot2_f32_bf16 v245, v227, s44, 0
    v_dot2_f32_bf16 v246, v227, s45, 0
    v_dot2_f32_bf16 v239, v92, s44, v239
    v_dot2_f32_bf16 v240, v92, s45, v240
    v_dot2_f32_bf16 v241, v93, s44, v241
    v_dot2_f32_bf16 v242, v93, s45, v242
    v_dot2_f32_bf16 v243, v94, s44, v243
    v_dot2_f32_bf16 v244, v94, s45, v244
    v_dot2_f32_bf16 v245, v95, s44, v245
    v_dot2_f32_bf16 v246, v95, s45, v246
    v_dot2_f32_bf16 v239, v104, s44, v239
    v_dot2_f32_bf16 v240, v104, s45, v240
    v_dot2_f32_bf16 v241, v105, s44, v241
    v_dot2_f32_bf16 v242, v105, s45, v242
    v_dot2_f32_bf16 v243, v106, s44, v243
    v_dot2_f32_bf16 v244, v106, s45, v244
    v_dot2_f32_bf16 v245, v107, s44, v245
    v_dot2_f32_bf16 v246, v107, s45, v246
    v_dot2_f32_bf16 v239, v116, s44, v239
    v_dot2_f32_bf16 v240, v116, s45, v240
    v_dot2_f32_bf16 v241, v117, s44, v241
    v_dot2_f32_bf16 v242, v117, s45, v242
    v_dot2_f32_bf16 v243, v118, s44, v243
    v_dot2_f32_bf16 v244, v118, s45, v244
    v_dot2_f32_bf16 v245, v119, s44, v245
    v_dot2_f32_bf16 v246, v119, s45, v246
    v_dot2_f32_bf16 v239, v128, s44, v239
    v_dot2_f32_bf16 v240, v128, s45, v240
    v_dot2_f32_bf16 v241, v129, s44, v241
    v_dot2_f32_bf16 v242, v129, s45, v242
    v_dot2_f32_bf16 v243, v130, s44, v243
    v_dot2_f32_bf16 v244, v130, s45, v244
    v_dot2_f32_bf16 v245, v131, s44, v245
    v_dot2_f32_bf16 v246, v131, s45, v246
    v_mul_f32 v239, v239, v231
    v_mul_f32 v240, v240, v231
    v_mul_f32 v241, v241, v231
    v_mul_f32 v242, v242, v231
    v_mul_f32 v243, v243, v231
    v_mul_f32 v244, v244, v231
    v_mul_f32 v245, v245, v231
    v_mul_f32 v246, v246, v231
    v_fmac_f32 v239, v176, v230
    v_fmac_f32 v240, v177, v230
    v_fmac_f32 v241, v178, v230
    v_fmac_f32 v242, v179, v230
    v_fmac_f32 v243, v180, v230
    v_fmac_f32 v244, v181, v230
    v_fmac_f32 v245, v182, v230
    v_fmac_f32 v246, v183, v230
    v_cvt_pk_bf16_f32 v92, v239, v240
    v_cvt_pk_bf16_f32 v93, v241, v242
    v_cvt_pk_bf16_f32 v94, v243, v244
    v_cvt_pk_bf16_f32 v95, v245, v246
    buffer_store_dwordx4 v[92:95], v8, s[12:15], 0 offen offset:64
    v_dot2_f32_bf16 v239, v228, s44, 0
    v_dot2_f32_bf16 v240, v228, s45, 0
    v_dot2_f32_bf16 v241, v229, s44, 0
    v_dot2_f32_bf16 v242, v229, s45, 0
    v_dot2_f32_bf16 v239, v96, s44, v239
    v_dot2_f32_bf16 v240, v96, s45, v240
    v_dot2_f32_bf16 v241, v97, s44, v241
    v_dot2_f32_bf16 v242, v97, s45, v242
    v_dot2_f32_bf16 v239, v108, s44, v239
    v_dot2_f32_bf16 v240, v108, s45, v240
    v_dot2_f32_bf16 v241, v109, s44, v241
    v_dot2_f32_bf16 v242, v109, s45, v242
    v_dot2_f32_bf16 v239, v120, s44, v239
    v_dot2_f32_bf16 v240, v120, s45, v240
    v_dot2_f32_bf16 v241, v121, s44, v241
    v_dot2_f32_bf16 v242, v121, s45, v242
    v_dot2_f32_bf16 v239, v132, s44, v239
    v_dot2_f32_bf16 v240, v132, s45, v240
    v_dot2_f32_bf16 v241, v133, s44, v241
    v_dot2_f32_bf16 v242, v133, s45, v242
    v_mul_f32 v239, v239, v231
    v_mul_f32 v240, v240, v231
    v_mul_f32 v241, v241, v231
    v_mul_f32 v242, v242, v231
    v_fmac_f32 v239, v184, v230
    v_fmac_f32 v240, v185, v230
    v_fmac_f32 v241, v186, v230
    v_fmac_f32 v242, v187, v230
    v_cvt_pk_bf16_f32 v96, v239, v240
    v_cvt_pk_bf16_f32 v97, v241, v242
    buffer_store_dwordx2 v[96:97], v14, s[12:15], 0 offen offset:128
fn_done:
    s_endpgm
text_end:
.section .rodata,"a"
.p2align 6
.amdhsa_kernel l1_kernel
  .amdhsa_next_free_vgpr 243
  .amdhsa_next_free_sgpr 102
  .amdhsa_accum_offset 244
  .amdhsa_group_segment_fixed_size 0
  .amdhsa_kernarg_size 96
  .amdhsa_user_sgpr_count 2
  .amdhsa_user_sgpr_kernarg_segment_ptr 1
  .amdhsa_system_sgpr_workgroup_id_x 1
.end_amdhsa_kernel
.p2align 6
.amdhsa_kernel af_kernel
  .amdhsa_next_free_vgpr 168
  .amdhsa_next_free_sgpr 102
  .amdhsa_accum_offset 168
  .amdhsa_group_segment_fixed_size 0
  .amdhsa_kernarg_size 96
  .amdhsa_user_sgpr_count 2
  .amdhsa_user_sgpr_kernarg_segment_ptr 1
  .amdhsa_system_sgpr_workgroup_id_x 1
.end_amdhsa_kernel
.p2align 6
.amdhsa_kernel fin_kernel
  .amdhsa_next_free_vgpr 247
  .amdhsa_next_free_sgpr 102
  .amdhsa_accum_offset 248
  .amdhsa_group_segment_fixed_size 0
  .amdhsa_kernarg_size 96
  .amdhsa_user_sgpr_count 2
  .amdhsa_user_sgpr_kernarg_segment_ptr 1
  .amdhsa_system_sgpr_workgroup_id_x 1
.end_amdhsa_kernel
```
